```python
import torch

def _softmax(x, axis=-1):
    return torch.softmax(x, dim=axis)
def _gelu(x):
    return torch.nn.functional.gelu(x, approximate="tanh")
def _silu(x):
    return torch.nn.functional.silu(x)
def _sigmoid(x):
    return torch.sigmoid(x)
def _layernorm(x, axis=-1, eps=1e-5):
    m = x.mean(dim=axis, keepdim=True)
    v = x.var(dim=axis, keepdim=True, unbiased=False)
    return (x - m) / torch.sqrt(v + eps)
def _scatter_add(tgt, idx, src, axis=0):
    return tgt.clone().index_add_(axis, idx, src)
def _segment_sum(src, seg, n):
    out = torch.zeros((n,) + src.shape[1:], dtype=src.dtype)
    return out.index_add_(0, seg, src)
def _pad(x, pw):
    flat = tuple(v for pair in reversed(pw) for v in pair)
    return torch.nn.functional.pad(x, flat)

kernel_name = 'gated_mix__compressed_kv_cla__moe_arch_mod__prompt'

def setup_inputs():

    _w = (lambda a: (lambda t: t.to(torch.bfloat16) if t.is_floating_point() else t)(torch.as_tensor(a)))
    def _A_setup():
        B, H, Sq, Sk, D, M = 1, 32, 2048, 2048, 128, 512
        Dc = 4 * D
        return {
            "x": _w((lambda *s: torch.randn(*s, dtype=torch.bfloat16) * 0.05)(B, Sq, M)),
            "c_kv": _w((lambda *s: torch.randn(*s, dtype=torch.bfloat16) * 0.8)(B, Sk, Dc)),
            "w_q": _w((lambda *s: torch.randn(*s, dtype=torch.bfloat16) * 6.4)(M, H, D) * (M ** -0.5)),
            "w_uk": _w((lambda *s: torch.randn(*s, dtype=torch.bfloat16) * 6.4)(Dc, H, D) * (Dc ** -0.5)),
            "w_uv": _w((lambda *s: torch.randn(*s, dtype=torch.bfloat16) * 0.8)(Dc, H, D) * (Dc ** -0.5)),
            "w_o": _w((lambda *s: torch.randn(*s, dtype=torch.bfloat16) * 0.8)(H, D, M) * ((H * D) ** -0.5)),
        }
    _A_in = _A_setup()

    def _B_setup():
        B, S, D, F, C = 1, 2048, 512, 1792, 1
        return {
            "x": _w((lambda *s: torch.randn(*s, dtype=torch.bfloat16) * 0.05)(B, S, D)),
            "w_r": _w((lambda *s: torch.randn(*s, dtype=torch.bfloat16) * 3.2)(D)),
            "w_gate": _w((lambda *s: torch.randn(*s, dtype=torch.bfloat16) * 0.4)(D, F)),
            "w_up": _w((lambda *s: torch.randn(*s, dtype=torch.bfloat16) * 0.4)(D, F)),
            "w_down": _w((lambda *s: torch.randn(*s, dtype=torch.bfloat16) * 0.4)(F, D)),
        }
    _B_in = _B_setup()

    return {
        "A_x": _A_in["x"],
        "A_c_kv": _A_in["c_kv"],
        "A_w_q": _A_in["w_q"],
        "A_w_uk": _A_in["w_uk"],
        "A_w_uv": _A_in["w_uv"],
        "A_w_o": _A_in["w_o"],
        "B_x": _B_in["x"],
        "B_w_r": _B_in["w_r"],
        "B_w_gate": _B_in["w_gate"],
        "B_w_up": _B_in["w_up"],
        "B_w_down": _B_in["w_down"],
        "gate_w": _w((lambda *s: torch.randn(*s, dtype=torch.bfloat16) * 0.05)(512) * 16.0),
    }

def reference(A_x, A_c_kv, A_w_q, A_w_uk, A_w_uv, A_w_o, B_x, B_w_r, B_w_gate, B_w_up, B_w_down, gate_w):
    def _A_ref(x, c_kv, w_q, w_uk, w_uv, w_o):
        B, Sq, M = x.shape[0], x.shape[1], x.shape[2]
        Sk = c_kv.shape[1]
        H, D = w_q.shape[1], w_q.shape[2]
        q = torch.einsum("bqm,mhd->bhqd", x, w_q)
        k = torch.einsum("bkc,chd->bhkd", c_kv, w_uk)
        v = torch.einsum("bkc,chd->bhkd", c_kv, w_uv)
        scores = torch.einsum("bhqd,bhkd->bhqk", q, k) * (D ** -0.5)
        off = Sk - Sq
        qi = torch.arange(Sq)[:, None]
        kj = torch.arange(Sk)[None, :]
        cmask = kj <= (qi + off)
        scores = torch.where(cmask[None, None], scores, -1e9)
        p = _softmax(scores, axis=-1)
        ctx = torch.einsum("bhqk,bhkd->bhqd", p, v)
        return torch.einsum("bhqd,hdm->bqm", ctx, w_o)

    def _B_ref(x, w_r, w_gate, w_up, w_down):
        B, S, D = x.shape
        C = 1
        r = x @ w_r
        idx = torch.argsort(-r, axis=-1)[:, :C]
        idx_e = (lambda x, n, axis: torch.repeat_interleave(x, n, dim=axis))(idx.reshape(B, C, 1), D, axis=2)
        x_sel = (lambda x, i, axis: torch.take_along_dim(x, i, dim=axis))(x, idx_e, axis=1)
        g = _silu(x_sel @ w_gate)
        u = x_sel @ w_up
        y = (g * u) @ w_down
        r_sel = _sigmoid((lambda x, i, axis: torch.take_along_dim(x, i, dim=axis))(r, idx, axis=1))
        y = y * r_sel.reshape(B, C, 1)
        b_off = (torch.arange(B) * S).reshape(B, 1)
        flat_idx = (idx + b_off).reshape(B * C)
        zero = (x * 0.0).reshape(B * S, D)
        upd = _scatter_add(zero, flat_idx, y.reshape(B * C, D), axis=0)
        return x + upd.reshape(B, S, D)

    x = A_x
    g = _sigmoid((x * gate_w).sum(-1, keepdims=True))
    a = _A_ref(x, A_c_kv, A_w_q, A_w_uk, A_w_uv, A_w_o)
    b = _B_ref(x, B_w_r, B_w_gate, B_w_up, B_w_down)
    return g * a + (1 - g) * b
```

```asm
; @launch kernel=k12_kernel grid=(256,1,1) block=(512,1,1) lds=163840
.amdgcn_target "amdgcn-amd-amdhsa--gfx950"
.text
.globl k12_kernel
.p2align 8
.type k12_kernel,@function
k12_kernel:
s_cmp_ge_u32 s2, 256
s_cbranch_scc1 L_k12_end
s_load_dwordx4 s[48:51], s[0:1], 0
s_load_dwordx4 s[52:55], s[0:1], 16
s_load_dwordx4 s[56:59], s[0:1], 32
s_load_dwordx4 s[60:63], s[0:1], 96
s_load_dwordx2 s[64:65], s[0:1], 112
s_load_dwordx2 s[66:67], s[0:1], 56
s_load_dwordx2 s[68:69], s[0:1], 88
v_and_b32 v1, 63, v0
v_lshrrev_b32 v14, 6, v0
v_lshlrev_b32 v2, 4, v1
v_readfirstlane_b32 s32, v14
s_and_b32 s30, s2, 7
s_lshl_b32 s30, s30, 2
s_lshr_b32 s41, s2, 3
s_and_b32 s41, s41, 3
s_add_u32 s30, s30, s41
s_lshr_b32 s31, s2, 5
s_lshl_b32 s73, s30, 2
s_add_u32 s73, s73, 128
s_getreg_b32 s72, hwreg(HW_REG_XCC_ID)
s_and_b32 s72, s72, 7
s_lshl_b32 s41, s31, 2
s_min_u32 s41, s41, 8
s_lshl_b32 s39, 1, s41
v_and_b32 v20, 15, v1
v_lshrrev_b32 v21, 4, v1
v_lshrrev_b32 v22, 2, v20
v_and_b32 v23, 3, v1
v_lshrrev_b32 v24, 1, v20
v_xor_b32 v25, v21, v24
v_lshlrev_b32 v25, 4, v25
v_xor_b32 v26, 64, v25
v_lshlrev_b32 v27, 7, v20
s_lshr_b32 s41, s32, 1
s_and_b32 s41, s41, 1
s_lshl_b32 s42, s41, 14
v_add_u32 v28, s42, v27
v_add_u32 v3, v28, v25
v_add_u32 v4, v28, v26
v_add_u32 v5, 0x10000, v3
v_add_u32 v6, 0x10000, v4
v_and_b32 v29, 1, v21
v_lshlrev_b32 v29, 2, v29
v_or_b32 v29, v29, v22
v_lshlrev_b32 v30, 3, v21
v_add_u32 v30, v30, v22
v_lshlrev_b32 v30, 8, v30
v_lshlrev_b32 v31, 3, v23
v_add_u32 v30, v30, v31
v_add_u32 v30, 98304, v30
v_lshlrev_b32 v29, 5, v29
v_add_u32 v30, v30, v29
s_and_b32 s41, s32, 1
s_lshl_b32 s41, s41, 7
s_lshr_b32 s42, s32, 2
s_lshl_b32 s42, s42, 13
v_xor_b32 v31, s41, v30
v_add_u32 v31, s42, v31
v_xor_b32 v7, 0, v31
v_xor_b32 v8, 32, v31
v_xor_b32 v9, 64, v31
v_xor_b32 v10, 96, v31
v_lshrrev_b32 v28, 3, v1
v_lshlrev_b32 v28, 10, v28
v_and_b32 v31, 7, v1
v_xor_b32 v31, v31, v21
v_lshlrev_b32 v31, 4, v31
v_add_u32 v11, v28, v31
v_xor_b32 v12, 64, v11
s_and_b32 s41, s32, 1
s_lshl_b32 s41, s41, 2
v_or_b32 v28, s41, v21
v_lshlrev_b32 v28, 1, v28
v_xor_b32 v28, v28, v20
v_lshlrev_b32 v28, 4, v28
v_lshlrev_b32 v31, 13, v21
v_add_u32 v13, v28, v31
s_lshl_b32 s33, s31, 18
s_lshl_b32 s41, s32, 15
s_add_u32 s33, s33, s41
s_sub_u32 s42, 15, s31
s_cmp_lt_u32 s32, 4
s_cselect_b32 s42, s42, s31
s_lshl_b32 s34, s42, 17
s_and_b32 s41, s32, 3
s_lshl_b32 s41, s41, 15
s_add_u32 s34, s34, s41
s_and_b32 s41, s32, 3
s_lshl_b32 s41, s41, 16
s_lshl_b32 s42, s30, 8
s_add_u32 s35, s41, s42
s_lshl_b32 s41, s32, 16
s_add_u32 s36, s41, s42
s_lshl_b32 s37, s32, 12
s_lshl_b32 s38, s32, 11
s_lshl_b32 s40, s30, 20
s_lshl_b32 s41, s31, 16
s_add_u32 s40, s40, s41
s_lshr_b32 s41, s32, 1
s_and_b32 s41, s41, 1
s_lshl_b32 s41, s41, 15
s_add_u32 s40, s40, s41
s_and_b32 s41, s32, 1
s_lshr_b32 s42, s32, 2
s_add_u32 s44, s42, 11
s_lshl_b32 s41, s41, s44
s_add_u32 s40, s40, s41
s_lshl_b32 s42, s42, 19
s_add_u32 s40, s40, s42
s_waitcnt lgkmcnt(0)
s_mov_b32 s4, s48
s_and_b32 s5, s49, 0xffff
s_mov_b32 s6, 2097152
s_mov_b32 s7, 0x20000
s_mov_b32 s8, s50
s_and_b32 s9, s51, 0xffff
s_mov_b32 s10, 2097152
s_mov_b32 s11, 0x20000
s_mov_b32 s16, s52
s_and_b32 s17, s53, 0xffff
s_mov_b32 s18, 4194304
s_mov_b32 s19, 0x20000
s_cmp_lt_u32 s32, 4
s_cselect_b32 s12, s54, s56
s_cselect_b32 s13, s55, s57
s_and_b32 s13, s13, 0xffff
s_mov_b32 s14, 4194304
s_mov_b32 s15, 0x20000
s_mov_b32 s20, s64
s_and_b32 s21, s65, 0xffff
s_mov_b32 s22, 268435456
s_mov_b32 s23, 0x20000
s_mov_b32 s28, s62
s_mov_b32 s29, s63
s_lshl_b32 s41, s30, 20
s_and_b32 s42, s32, 2
s_lshl_b32 s42, s42, 18
s_add_u32 s41, s41, s42
s_add_u32 s24, s64, s41
s_addc_u32 s25, s65, 0
s_and_b32 s25, s25, 0xffff
s_lshl_b32 s41, s31, 15
s_sub_u32 s26, 524288, s41
s_mov_b32 s27, 0x20000
s_cmp_lg_u32 s32, 0
s_cbranch_scc1 L_pubx_skip
s_lshl_b32 s41, 1, s72
s_sub_u32 s42, s73, 128
v_mov_b32 v14, s42
v_mov_b32 v15, s41
v_mov_b32 v28, 0x100
s_mov_b64 exec, 1
global_atomic_or v14, v15, s[28:29]
global_atomic_add v14, v28, s[28:29]
s_mov_b64 exec, -1
L_pubx_skip:
s_lshl_b32 s41, s2, 3
s_add_u32 s41, s41, s32
s_lshl_b32 s45, s41, 2
s_lshl_b32 s41, s41, 10
buffer_load_dwordx4 v[112:115], v2, s[4:7], s41 offen
global_load_dwordx4 v[116:119], v2, s[66:67]
global_load_dwordx4 v[120:123], v2, s[68:69]
s_add_u32 m0, s37, 0
s_add_u32 s43, s33, 0
buffer_load_dwordx4 v11, s[8:11], s43 offen lds
s_add_u32 m0, s37, 1024
s_add_u32 s43, s33, 8192
buffer_load_dwordx4 v12, s[8:11], s43 offen lds
s_add_u32 m0, s37, 2048
s_add_u32 s43, s33, 16384
buffer_load_dwordx4 v11, s[8:11], s43 offen lds
s_add_u32 m0, s37, 3072
s_add_u32 s43, s33, 24576
buffer_load_dwordx4 v12, s[8:11], s43 offen lds
s_add_u32 m0, s38, 98304
s_add_u32 s43, s35, 0
buffer_load_dwordx4 v13, s[12:15], s43 offen lds
s_add_u32 m0, s38, 99328
s_add_u32 s43, s35, 32768
buffer_load_dwordx4 v13, s[12:15], s43 offen lds
s_add_u32 m0, s38, 114688
s_add_u32 s43, s35, 262144
buffer_load_dwordx4 v13, s[12:15], s43 offen lds
s_add_u32 m0, s38, 115712
s_add_u32 s43, s35, 294912
buffer_load_dwordx4 v13, s[12:15], s43 offen lds
s_add_u32 m0, s37, 32768
s_add_u32 s43, s33, 128
buffer_load_dwordx4 v11, s[8:11], s43 offen lds
s_add_u32 m0, s37, 33792
s_add_u32 s43, s33, 8320
buffer_load_dwordx4 v12, s[8:11], s43 offen lds
s_add_u32 m0, s37, 34816
s_add_u32 s43, s33, 16512
buffer_load_dwordx4 v11, s[8:11], s43 offen lds
s_add_u32 m0, s37, 35840
s_add_u32 s43, s33, 24704
buffer_load_dwordx4 v12, s[8:11], s43 offen lds
s_add_u32 m0, s38, 131072
s_add_u32 s43, s35, 524288
buffer_load_dwordx4 v13, s[12:15], s43 offen lds
s_add_u32 m0, s38, 132096
s_add_u32 s43, s35, 557056
buffer_load_dwordx4 v13, s[12:15], s43 offen lds
s_add_u32 m0, s37, 65536
s_add_u32 s43, s33, 256
buffer_load_dwordx4 v11, s[8:11], s43 offen lds
s_add_u32 m0, s37, 66560
s_add_u32 s43, s33, 8448
buffer_load_dwordx4 v12, s[8:11], s43 offen lds
s_add_u32 m0, s37, 67584
s_add_u32 s43, s33, 16640
buffer_load_dwordx4 v11, s[8:11], s43 offen lds
s_add_u32 m0, s37, 68608
s_add_u32 s43, s33, 24832
buffer_load_dwordx4 v12, s[8:11], s43 offen lds
v_lshlrev_b32 v28, 2, v21
v_add_u32 v29, 0, v28
v_cmp_gt_u32 s[56:57], v29, v20
v_add_u32 v29, 1, v28
v_cmp_gt_u32 s[58:59], v29, v20
v_add_u32 v29, 2, v28
v_cmp_gt_u32 s[60:61], v29, v20
v_add_u32 v29, 3, v28
v_cmp_gt_u32 s[62:63], v29, v20
s_mov_b32 s74, 0x3e0293ee
s_mov_b32 s75, 0x3e0293ee
s_cmp_ge_u32 s32, 4
s_cbranch_scc1 L_vwaves
s_waitcnt vmcnt(12) lgkmcnt(0)
s_barrier
ds_read_b64_tr_b16 v[48:49], v7 offset:0
ds_read_b64_tr_b16 v[50:51], v7 offset:1024
ds_read_b64_tr_b16 v[52:53], v8 offset:0
ds_read_b64_tr_b16 v[54:55], v8 offset:1024
ds_read_b64_tr_b16 v[56:57], v9 offset:0
ds_read_b64_tr_b16 v[58:59], v9 offset:1024
ds_read_b64_tr_b16 v[60:61], v10 offset:0
ds_read_b64_tr_b16 v[62:63], v10 offset:1024
ds_read_b128 v[16:19], v3 offset:0
ds_read_b128 v[20:23], v3 offset:2048
ds_read_b128 v[24:27], v3 offset:4096
ds_read_b128 v[28:31], v3 offset:6144
ds_read_b128 v[32:35], v3 offset:8192
ds_read_b128 v[36:39], v3 offset:10240
ds_read_b128 v[40:43], v3 offset:12288
ds_read_b128 v[44:47], v3 offset:14336
s_add_u32 m0, s38, 147456
s_add_u32 s43, s35, 786432
buffer_load_dwordx4 v13, s[12:15], s43 offen lds
s_add_u32 m0, s38, 148480
s_add_u32 s43, s35, 819200
buffer_load_dwordx4 v13, s[12:15], s43 offen lds
s_waitcnt vmcnt(12) lgkmcnt(0)
s_barrier
v_mfma_f32_16x16x32_bf16 v[128:131], v[48:51], v[16:19], 0
ds_read_b64_tr_b16 v[96:97], v7 offset:16384
v_mfma_f32_16x16x32_bf16 v[132:135], v[52:55], v[16:19], 0
ds_read_b64_tr_b16 v[98:99], v7 offset:17408
v_mfma_f32_16x16x32_bf16 v[136:139], v[56:59], v[16:19], 0
s_add_u32 m0, s38, 98304
s_add_u32 s43, s35, 1048576
buffer_load_dwordx4 v13, s[12:15], s43 offen lds
v_mfma_f32_16x16x32_bf16 v[140:143], v[60:63], v[16:19], 0
ds_read_b64_tr_b16 v[100:101], v8 offset:16384
v_mfma_f32_16x16x32_bf16 v[144:147], v[48:51], v[20:23], 0
v_mfma_f32_16x16x32_bf16 v[148:151], v[52:55], v[20:23], 0
ds_read_b64_tr_b16 v[102:103], v8 offset:17408
v_mfma_f32_16x16x32_bf16 v[152:155], v[56:59], v[20:23], 0
v_mfma_f32_16x16x32_bf16 v[156:159], v[60:63], v[20:23], 0
ds_read_b64_tr_b16 v[104:105], v9 offset:16384
v_mfma_f32_16x16x32_bf16 v[160:163], v[48:51], v[24:27], 0
ds_read_b64_tr_b16 v[106:107], v9 offset:17408
v_mfma_f32_16x16x32_bf16 v[164:167], v[52:55], v[24:27], 0
v_mfma_f32_16x16x32_bf16 v[168:171], v[56:59], v[24:27], 0
ds_read_b64_tr_b16 v[108:109], v10 offset:16384
v_mfma_f32_16x16x32_bf16 v[172:175], v[60:63], v[24:27], 0
v_mfma_f32_16x16x32_bf16 v[176:179], v[48:51], v[28:31], 0
ds_read_b64_tr_b16 v[110:111], v10 offset:17408
v_mfma_f32_16x16x32_bf16 v[180:183], v[52:55], v[28:31], 0
v_mfma_f32_16x16x32_bf16 v[184:187], v[56:59], v[28:31], 0
ds_read_b128 v[64:67], v4 offset:0
v_mfma_f32_16x16x32_bf16 v[188:191], v[60:63], v[28:31], 0
ds_read_b128 v[68:71], v4 offset:2048
v_mfma_f32_16x16x32_bf16 v[192:195], v[48:51], v[32:35], 0
s_add_u32 m0, s38, 99328
s_add_u32 s43, s35, 1081344
buffer_load_dwordx4 v13, s[12:15], s43 offen lds
v_mfma_f32_16x16x32_bf16 v[196:199], v[52:55], v[32:35], 0
ds_read_b128 v[72:75], v4 offset:4096
v_mfma_f32_16x16x32_bf16 v[200:203], v[56:59], v[32:35], 0
v_mfma_f32_16x16x32_bf16 v[204:207], v[60:63], v[32:35], 0
ds_read_b128 v[76:79], v4 offset:6144
v_mfma_f32_16x16x32_bf16 v[208:211], v[48:51], v[36:39], 0
v_mfma_f32_16x16x32_bf16 v[212:215], v[52:55], v[36:39], 0
ds_read_b128 v[80:83], v4 offset:8192
v_lshlrev_b32 v14, 16, v112
v_lshlrev_b32 v15, 16, v116
v_lshlrev_b32 v127, 16, v120
v_mfma_f32_16x16x32_bf16 v[216:219], v[56:59], v[36:39], 0
ds_read_b128 v[84:87], v4 offset:10240
v_mul_f32 v124, v14, v15
v_mul_f32 v126, v14, v127
v_and_b32 v14, 0xffff0000, v112
v_mfma_f32_16x16x32_bf16 v[220:223], v[60:63], v[36:39], 0
v_and_b32 v15, 0xffff0000, v116
v_and_b32 v127, 0xffff0000, v120
v_fmac_f32 v124, v14, v15
v_mfma_f32_16x16x32_bf16 v[224:227], v[48:51], v[40:43], 0
ds_read_b128 v[88:91], v4 offset:12288
v_fmac_f32 v126, v14, v127
v_lshlrev_b32 v14, 16, v113
v_lshlrev_b32 v15, 16, v117
v_mfma_f32_16x16x32_bf16 v[228:231], v[52:55], v[40:43], 0
v_lshlrev_b32 v127, 16, v121
v_fmac_f32 v124, v14, v15
v_fmac_f32 v126, v14, v127
v_mfma_f32_16x16x32_bf16 v[232:235], v[56:59], v[40:43], 0
ds_read_b128 v[92:95], v4 offset:14336
v_and_b32 v14, 0xffff0000, v113
v_and_b32 v15, 0xffff0000, v117
v_and_b32 v127, 0xffff0000, v121
v_mfma_f32_16x16x32_bf16 v[236:239], v[60:63], v[40:43], 0
v_fmac_f32 v124, v14, v15
v_fmac_f32 v126, v14, v127
v_lshlrev_b32 v14, 16, v114
v_mfma_f32_16x16x32_bf16 v[240:243], v[48:51], v[44:47], 0
v_lshlrev_b32 v15, 16, v118
v_lshlrev_b32 v127, 16, v122
v_fmac_f32 v124, v14, v15
v_mfma_f32_16x16x32_bf16 v[244:247], v[52:55], v[44:47], 0
v_fmac_f32 v126, v14, v127
v_and_b32 v14, 0xffff0000, v114
v_and_b32 v15, 0xffff0000, v118
v_mfma_f32_16x16x32_bf16 v[248:251], v[56:59], v[44:47], 0
v_and_b32 v127, 0xffff0000, v122
v_fmac_f32 v124, v14, v15
v_fmac_f32 v126, v14, v127
v_mfma_f32_16x16x32_bf16 v[252:255], v[60:63], v[44:47], 0
s_waitcnt vmcnt(8) lgkmcnt(0)
s_barrier
v_mfma_f32_16x16x32_bf16 v[128:131], v[96:99], v[64:67], v[128:131]
ds_read_b64_tr_b16 v[48:49], v7 offset:32768
v_mfma_f32_16x16x32_bf16 v[132:135], v[100:103], v[64:67], v[132:135]
ds_read_b64_tr_b16 v[50:51], v7 offset:33792
v_mfma_f32_16x16x32_bf16 v[136:139], v[104:107], v[64:67], v[136:139]
s_add_u32 m0, s38, 114688
s_add_u32 s43, s35, 1310720
buffer_load_dwordx4 v13, s[12:15], s43 offen lds
v_mfma_f32_16x16x32_bf16 v[140:143], v[108:111], v[64:67], v[140:143]
ds_read_b64_tr_b16 v[52:53], v8 offset:32768
v_mfma_f32_16x16x32_bf16 v[144:147], v[96:99], v[68:71], v[144:147]
v_mfma_f32_16x16x32_bf16 v[148:151], v[100:103], v[68:71], v[148:151]
ds_read_b64_tr_b16 v[54:55], v8 offset:33792
v_mfma_f32_16x16x32_bf16 v[152:155], v[104:107], v[68:71], v[152:155]
v_mfma_f32_16x16x32_bf16 v[156:159], v[108:111], v[68:71], v[156:159]
ds_read_b64_tr_b16 v[56:57], v9 offset:32768
v_mfma_f32_16x16x32_bf16 v[160:163], v[96:99], v[72:75], v[160:163]
ds_read_b64_tr_b16 v[58:59], v9 offset:33792
v_mfma_f32_16x16x32_bf16 v[164:167], v[100:103], v[72:75], v[164:167]
s_add_u32 m0, s38, 115712
s_add_u32 s43, s35, 1343488
buffer_load_dwordx4 v13, s[12:15], s43 offen lds
v_mfma_f32_16x16x32_bf16 v[168:171], v[104:107], v[72:75], v[168:171]
ds_read_b64_tr_b16 v[60:61], v10 offset:32768
v_mfma_f32_16x16x32_bf16 v[172:175], v[108:111], v[72:75], v[172:175]
v_mfma_f32_16x16x32_bf16 v[176:179], v[96:99], v[76:79], v[176:179]
ds_read_b64_tr_b16 v[62:63], v10 offset:33792
v_mfma_f32_16x16x32_bf16 v[180:183], v[100:103], v[76:79], v[180:183]
v_mfma_f32_16x16x32_bf16 v[184:187], v[104:107], v[76:79], v[184:187]
ds_read_b128 v[16:19], v3 offset:32768
v_mfma_f32_16x16x32_bf16 v[188:191], v[108:111], v[76:79], v[188:191]
ds_read_b128 v[20:23], v3 offset:34816
v_mfma_f32_16x16x32_bf16 v[192:195], v[96:99], v[80:83], v[192:195]
s_add_u32 m0, s37, 0
s_add_u32 s43, s33, 384
buffer_load_dwordx4 v11, s[8:11], s43 offen lds
v_mfma_f32_16x16x32_bf16 v[196:199], v[100:103], v[80:83], v[196:199]
ds_read_b128 v[24:27], v3 offset:36864
v_mfma_f32_16x16x32_bf16 v[200:203], v[104:107], v[80:83], v[200:203]
v_mfma_f32_16x16x32_bf16 v[204:207], v[108:111], v[80:83], v[204:207]
ds_read_b128 v[28:31], v3 offset:38912
v_mfma_f32_16x16x32_bf16 v[208:211], v[96:99], v[84:87], v[208:211]
v_mfma_f32_16x16x32_bf16 v[212:215], v[100:103], v[84:87], v[212:215]
ds_read_b128 v[32:35], v3 offset:40960
s_sub_u32 s41, s31, 2
s_cmp_ge_u32 s41, 2
s_cbranch_scc1 L_pfmo00
s_and_b32 s42, s32, 3
s_cmp_eq_u32 s42, 3
s_cbranch_scc1 L_pfmo00
s_lshl_b32 s41, s41, 5
s_add_u32 s41, s41, s30
s_lshl_b32 s41, s41, 1
s_add_u32 s41, s41, 0
s_cmp_ge_u32 s41, 112
s_cbranch_scc1 L_pfmo00
s_lshl_b32 s43, s42, 3
s_add_u32 s43, s43, 64
s_load_dwordx2 s[70:71], s[0:1], s43
s_cmp_eq_u32 s42, 2
s_cbranch_scc1 L_pfmo00d
s_mul_hi_u32 s42, s41, 0x0924924a
s_mul_i32 s43, s42, 28
s_sub_u32 s43, s41, s43
s_lshl_b32 s43, s43, 7
s_mul_i32 s42, s42, 458752
s_add_u32 s42, s42, s43
s_add_u32 s42, s42, 0
s_movk_i32 s43, 3584
v_mul_lo_u32 v15, v1, s43
s_branch L_pfmo00e
L_pfmo00d:
s_lshl_b32 s42, s41, 14
s_add_u32 s42, s42, 0
v_lshlrev_b32 v15, 7, v1
L_pfmo00e:
v_add_u32 v15, s42, v15
s_waitcnt lgkmcnt(0)
global_load_dword v125, v15, s[70:71]
L_pfmo00:
v_lshlrev_b32 v14, 16, v115
v_lshlrev_b32 v15, 16, v119
v_mfma_f32_16x16x32_bf16 v[216:219], v[104:107], v[84:87], v[216:219]
ds_read_b128 v[36:39], v3 offset:43008
v_lshlrev_b32 v127, 16, v123
v_fmac_f32 v124, v14, v15
v_fmac_f32 v126, v14, v127
v_mfma_f32_16x16x32_bf16 v[220:223], v[108:111], v[84:87], v[220:223]
s_add_u32 m0, s37, 1024
s_add_u32 s43, s33, 8576
buffer_load_dwordx4 v12, s[8:11], s43 offen lds
v_and_b32 v14, 0xffff0000, v115
v_and_b32 v15, 0xffff0000, v119
v_mfma_f32_16x16x32_bf16 v[224:227], v[96:99], v[88:91], v[224:227]
ds_read_b128 v[40:43], v3 offset:45056
v_and_b32 v127, 0xffff0000, v123
v_fmac_f32 v124, v14, v15
v_fmac_f32 v126, v14, v127
v_mfma_f32_16x16x32_bf16 v[228:231], v[100:103], v[88:91], v[228:231]
s_nop 1
v_add_f32 v124, v124, v124 row_ror:8 row_mask:0xf bank_mask:0xf
v_mfma_f32_16x16x32_bf16 v[232:235], v[104:107], v[88:91], v[232:235]
ds_read_b128 v[44:47], v3 offset:47104
v_add_f32 v126, v126, v126 row_ror:8 row_mask:0xf bank_mask:0xf
s_nop 1
v_add_f32 v124, v124, v124 row_ror:4 row_mask:0xf bank_mask:0xf
v_mfma_f32_16x16x32_bf16 v[236:239], v[108:111], v[88:91], v[236:239]
v_add_f32 v126, v126, v126 row_ror:4 row_mask:0xf bank_mask:0xf
s_nop 1
v_add_f32 v124, v124, v124 row_ror:2 row_mask:0xf bank_mask:0xf
v_mfma_f32_16x16x32_bf16 v[240:243], v[96:99], v[92:95], v[240:243]
v_add_f32 v126, v126, v126 row_ror:2 row_mask:0xf bank_mask:0xf
s_nop 1
v_mfma_f32_16x16x32_bf16 v[244:247], v[100:103], v[92:95], v[244:247]
v_add_f32 v124, v124, v124 row_ror:1 row_mask:0xf bank_mask:0xf
v_add_f32 v126, v126, v126 row_ror:1 row_mask:0xf bank_mask:0xf
v_mov_b32 v14, v124
v_mov_b32 v15, v126
s_nop 1
v_permlane16_swap_b32 v124, v14
v_permlane16_swap_b32 v126, v15
s_nop 1
v_add_f32 v124, v124, v14
v_add_f32 v126, v126, v15
v_mfma_f32_16x16x32_bf16 v[248:251], v[104:107], v[92:95], v[248:251]
v_mov_b32 v14, v124
v_mov_b32 v15, v126
s_nop 1
v_permlane32_swap_b32 v124, v14
v_permlane32_swap_b32 v126, v15
s_nop 1
v_add_f32 v124, v124, v14
v_add_f32 v126, v126, v15
v_mul_f32 v14, 0x3fb8aa3b, v126
v_sub_f32 v14, 0, v14
v_exp_f32 v14, v14
s_nop 0
v_add_f32 v14, 1.0, v14
v_rcp_f32 v126, v14
s_nop 0
v_mov_b32 v14, s45
s_mov_b32 s41, 50331648
s_mov_b32 s42, 50339840
s_mov_b64 exec, 1
buffer_store_dword v124, v14, s[20:23], s41 offen sc1
buffer_store_dword v126, v14, s[20:23], s42 offen sc1
s_mov_b64 exec, -1
s_and_b32 s41, s30, 3
s_or_b32 s41, s41, s32
s_lshl_b32 s42, s31, 3
s_lshr_b32 s43, s30, 2
s_add_u32 s42, s42, s43
s_lshl_b32 s42, s42, 7
s_add_u32 s42, s42, 50372608
s_cmp_eq_u32 s41, 0
s_cselect_b32 s42, s42, 0x10000000
v_mov_b32 v14, s42
v_mov_b32 v15, 0
s_mov_b64 exec, 1
buffer_store_dword v15, v14, s[20:23], 0 offen sc1
s_mov_b64 exec, -1
v_mfma_f32_16x16x32_bf16 v[252:255], v[108:111], v[92:95], v[252:255]
s_waitcnt vmcnt(9) lgkmcnt(0)
s_barrier
v_mfma_f32_16x16x32_bf16 v[128:131], v[48:51], v[16:19], v[128:131]
ds_read_b64_tr_b16 v[96:97], v7 offset:49152
v_mfma_f32_16x16x32_bf16 v[132:135], v[52:55], v[16:19], v[132:135]
ds_read_b64_tr_b16 v[98:99], v7 offset:50176
v_mfma_f32_16x16x32_bf16 v[136:139], v[56:59], v[16:19], v[136:139]
s_add_u32 m0, s38, 131072
s_add_u32 s43, s35, 1572864
buffer_load_dwordx4 v13, s[12:15], s43 offen lds
v_mfma_f32_16x16x32_bf16 v[140:143], v[60:63], v[16:19], v[140:143]
ds_read_b64_tr_b16 v[100:101], v8 offset:49152
v_mfma_f32_16x16x32_bf16 v[144:147], v[48:51], v[20:23], v[144:147]
v_mfma_f32_16x16x32_bf16 v[148:151], v[52:55], v[20:23], v[148:151]
ds_read_b64_tr_b16 v[102:103], v8 offset:50176
v_mfma_f32_16x16x32_bf16 v[152:155], v[56:59], v[20:23], v[152:155]
v_mfma_f32_16x16x32_bf16 v[156:159], v[60:63], v[20:23], v[156:159]
ds_read_b64_tr_b16 v[104:105], v9 offset:49152
v_mfma_f32_16x16x32_bf16 v[160:163], v[48:51], v[24:27], v[160:163]
ds_read_b64_tr_b16 v[106:107], v9 offset:50176
v_mfma_f32_16x16x32_bf16 v[164:167], v[52:55], v[24:27], v[164:167]
s_add_u32 m0, s38, 132096
s_add_u32 s43, s35, 1605632
buffer_load_dwordx4 v13, s[12:15], s43 offen lds
v_mfma_f32_16x16x32_bf16 v[168:171], v[56:59], v[24:27], v[168:171]
ds_read_b64_tr_b16 v[108:109], v10 offset:49152
v_mfma_f32_16x16x32_bf16 v[172:175], v[60:63], v[24:27], v[172:175]
v_mfma_f32_16x16x32_bf16 v[176:179], v[48:51], v[28:31], v[176:179]
ds_read_b64_tr_b16 v[110:111], v10 offset:50176
v_mfma_f32_16x16x32_bf16 v[180:183], v[52:55], v[28:31], v[180:183]
v_mfma_f32_16x16x32_bf16 v[184:187], v[56:59], v[28:31], v[184:187]
ds_read_b128 v[64:67], v4 offset:32768
v_mfma_f32_16x16x32_bf16 v[188:191], v[60:63], v[28:31], v[188:191]
ds_read_b128 v[68:71], v4 offset:34816
v_mfma_f32_16x16x32_bf16 v[192:195], v[48:51], v[32:35], v[192:195]
s_add_u32 m0, s37, 2048
s_add_u32 s43, s33, 16768
buffer_load_dwordx4 v11, s[8:11], s43 offen lds
v_mfma_f32_16x16x32_bf16 v[196:199], v[52:55], v[32:35], v[196:199]
ds_read_b128 v[72:75], v4 offset:36864
v_mfma_f32_16x16x32_bf16 v[200:203], v[56:59], v[32:35], v[200:203]
v_mfma_f32_16x16x32_bf16 v[204:207], v[60:63], v[32:35], v[204:207]
ds_read_b128 v[76:79], v4 offset:38912
v_mfma_f32_16x16x32_bf16 v[208:211], v[48:51], v[36:39], v[208:211]
v_mfma_f32_16x16x32_bf16 v[212:215], v[52:55], v[36:39], v[212:215]
ds_read_b128 v[80:83], v4 offset:40960
v_mfma_f32_16x16x32_bf16 v[216:219], v[56:59], v[36:39], v[216:219]
ds_read_b128 v[84:87], v4 offset:43008
v_mfma_f32_16x16x32_bf16 v[220:223], v[60:63], v[36:39], v[220:223]
s_add_u32 m0, s37, 3072
s_add_u32 s43, s33, 24960
buffer_load_dwordx4 v12, s[8:11], s43 offen lds
v_mfma_f32_16x16x32_bf16 v[224:227], v[48:51], v[40:43], v[224:227]
ds_read_b128 v[88:91], v4 offset:45056
v_mfma_f32_16x16x32_bf16 v[228:231], v[52:55], v[40:43], v[228:231]
v_mfma_f32_16x16x32_bf16 v[232:235], v[56:59], v[40:43], v[232:235]
ds_read_b128 v[92:95], v4 offset:47104
v_mfma_f32_16x16x32_bf16 v[236:239], v[60:63], v[40:43], v[236:239]
v_mfma_f32_16x16x32_bf16 v[240:243], v[48:51], v[44:47], v[240:243]
v_mfma_f32_16x16x32_bf16 v[244:247], v[52:55], v[44:47], v[244:247]
v_mfma_f32_16x16x32_bf16 v[248:251], v[56:59], v[44:47], v[248:251]
v_mfma_f32_16x16x32_bf16 v[252:255], v[60:63], v[44:47], v[252:255]
s_waitcnt vmcnt(11) lgkmcnt(0)
s_barrier
v_mfma_f32_16x16x32_bf16 v[128:131], v[96:99], v[64:67], v[128:131]
ds_read_b64_tr_b16 v[48:49], v7 offset:0
v_mfma_f32_16x16x32_bf16 v[132:135], v[100:103], v[64:67], v[132:135]
ds_read_b64_tr_b16 v[50:51], v7 offset:1024
v_mfma_f32_16x16x32_bf16 v[136:139], v[104:107], v[64:67], v[136:139]
s_add_u32 m0, s38, 147456
s_add_u32 s43, s35, 1835008
buffer_load_dwordx4 v13, s[12:15], s43 offen lds
v_mfma_f32_16x16x32_bf16 v[140:143], v[108:111], v[64:67], v[140:143]
ds_read_b64_tr_b16 v[52:53], v8 offset:0
v_mfma_f32_16x16x32_bf16 v[144:147], v[96:99], v[68:71], v[144:147]
v_mfma_f32_16x16x32_bf16 v[148:151], v[100:103], v[68:71], v[148:151]
ds_read_b64_tr_b16 v[54:55], v8 offset:1024
v_mfma_f32_16x16x32_bf16 v[152:155], v[104:107], v[68:71], v[152:155]
v_mfma_f32_16x16x32_bf16 v[156:159], v[108:111], v[68:71], v[156:159]
ds_read_b64_tr_b16 v[56:57], v9 offset:0
v_mfma_f32_16x16x32_bf16 v[160:163], v[96:99], v[72:75], v[160:163]
ds_read_b64_tr_b16 v[58:59], v9 offset:1024
v_mfma_f32_16x16x32_bf16 v[164:167], v[100:103], v[72:75], v[164:167]
s_add_u32 m0, s38, 148480
s_add_u32 s43, s35, 1867776
buffer_load_dwordx4 v13, s[12:15], s43 offen lds
v_mfma_f32_16x16x32_bf16 v[168:171], v[104:107], v[72:75], v[168:171]
ds_read_b64_tr_b16 v[60:61], v10 offset:0
v_mfma_f32_16x16x32_bf16 v[172:175], v[108:111], v[72:75], v[172:175]
v_mfma_f32_16x16x32_bf16 v[176:179], v[96:99], v[76:79], v[176:179]
ds_read_b64_tr_b16 v[62:63], v10 offset:1024
v_mfma_f32_16x16x32_bf16 v[180:183], v[100:103], v[76:79], v[180:183]
v_mfma_f32_16x16x32_bf16 v[184:187], v[104:107], v[76:79], v[184:187]
ds_read_b128 v[16:19], v5 offset:0
v_mfma_f32_16x16x32_bf16 v[188:191], v[108:111], v[76:79], v[188:191]
ds_read_b128 v[20:23], v5 offset:2048
v_mfma_f32_16x16x32_bf16 v[192:195], v[96:99], v[80:83], v[192:195]
s_add_u32 m0, s37, 32768
s_add_u32 s43, s33, 512
buffer_load_dwordx4 v11, s[8:11], s43 offen lds
v_mfma_f32_16x16x32_bf16 v[196:199], v[100:103], v[80:83], v[196:199]
ds_read_b128 v[24:27], v5 offset:4096
v_mfma_f32_16x16x32_bf16 v[200:203], v[104:107], v[80:83], v[200:203]
v_mfma_f32_16x16x32_bf16 v[204:207], v[108:111], v[80:83], v[204:207]
ds_read_b128 v[28:31], v5 offset:6144
v_mfma_f32_16x16x32_bf16 v[208:211], v[96:99], v[84:87], v[208:211]
v_mfma_f32_16x16x32_bf16 v[212:215], v[100:103], v[84:87], v[212:215]
ds_read_b128 v[32:35], v5 offset:8192
v_mfma_f32_16x16x32_bf16 v[216:219], v[104:107], v[84:87], v[216:219]
ds_read_b128 v[36:39], v5 offset:10240
v_mfma_f32_16x16x32_bf16 v[220:223], v[108:111], v[84:87], v[220:223]
s_add_u32 m0, s37, 33792
s_add_u32 s43, s33, 8704
buffer_load_dwordx4 v12, s[8:11], s43 offen lds
v_mfma_f32_16x16x32_bf16 v[224:227], v[96:99], v[88:91], v[224:227]
ds_read_b128 v[40:43], v5 offset:12288
v_mfma_f32_16x16x32_bf16 v[228:231], v[100:103], v[88:91], v[228:231]
v_mfma_f32_16x16x32_bf16 v[232:235], v[104:107], v[88:91], v[232:235]
ds_read_b128 v[44:47], v5 offset:14336
v_mfma_f32_16x16x32_bf16 v[236:239], v[108:111], v[88:91], v[236:239]
v_mfma_f32_16x16x32_bf16 v[240:243], v[96:99], v[92:95], v[240:243]
v_mfma_f32_16x16x32_bf16 v[244:247], v[100:103], v[92:95], v[244:247]
v_mfma_f32_16x16x32_bf16 v[248:251], v[104:107], v[92:95], v[248:251]
v_mfma_f32_16x16x32_bf16 v[252:255], v[108:111], v[92:95], v[252:255]
s_waitcnt vmcnt(8) lgkmcnt(0)
s_barrier
s_cmp_lg_u32 s32, 0
s_cbranch_scc1 L_pubr_skip
v_mov_b32 v14, s73
v_mov_b32 v15, 0x10000000
s_mov_b64 exec, 1
global_atomic_add v14, v15, s[28:29]
s_mov_b64 exec, -1
L_pubr_skip:
v_mfma_f32_16x16x32_bf16 v[128:131], v[48:51], v[16:19], v[128:131]
ds_read_b64_tr_b16 v[96:97], v7 offset:16384
v_mfma_f32_16x16x32_bf16 v[132:135], v[52:55], v[16:19], v[132:135]
ds_read_b64_tr_b16 v[98:99], v7 offset:17408
v_mfma_f32_16x16x32_bf16 v[136:139], v[56:59], v[16:19], v[136:139]
s_add_u32 m0, s38, 98304
s_add_u32 s43, s35, 2097152
buffer_load_dwordx4 v13, s[12:15], s43 offen lds
v_mfma_f32_16x16x32_bf16 v[140:143], v[60:63], v[16:19], v[140:143]
ds_read_b64_tr_b16 v[100:101], v8 offset:16384
v_mfma_f32_16x16x32_bf16 v[144:147], v[48:51], v[20:23], v[144:147]
v_mfma_f32_16x16x32_bf16 v[148:151], v[52:55], v[20:23], v[148:151]
ds_read_b64_tr_b16 v[102:103], v8 offset:17408
v_mfma_f32_16x16x32_bf16 v[152:155], v[56:59], v[20:23], v[152:155]
v_mfma_f32_16x16x32_bf16 v[156:159], v[60:63], v[20:23], v[156:159]
ds_read_b64_tr_b16 v[104:105], v9 offset:16384
v_mfma_f32_16x16x32_bf16 v[160:163], v[48:51], v[24:27], v[160:163]
ds_read_b64_tr_b16 v[106:107], v9 offset:17408
v_mfma_f32_16x16x32_bf16 v[164:167], v[52:55], v[24:27], v[164:167]
s_add_u32 m0, s38, 99328
s_add_u32 s43, s35, 2129920
buffer_load_dwordx4 v13, s[12:15], s43 offen lds
v_mfma_f32_16x16x32_bf16 v[168:171], v[56:59], v[24:27], v[168:171]
ds_read_b64_tr_b16 v[108:109], v10 offset:16384
v_mfma_f32_16x16x32_bf16 v[172:175], v[60:63], v[24:27], v[172:175]
v_mfma_f32_16x16x32_bf16 v[176:179], v[48:51], v[28:31], v[176:179]
ds_read_b64_tr_b16 v[110:111], v10 offset:17408
v_mfma_f32_16x16x32_bf16 v[180:183], v[52:55], v[28:31], v[180:183]
v_mfma_f32_16x16x32_bf16 v[184:187], v[56:59], v[28:31], v[184:187]
ds_read_b128 v[64:67], v6 offset:0
v_mfma_f32_16x16x32_bf16 v[188:191], v[60:63], v[28:31], v[188:191]
ds_read_b128 v[68:71], v6 offset:2048
v_mfma_f32_16x16x32_bf16 v[192:195], v[48:51], v[32:35], v[192:195]
s_add_u32 m0, s37, 34816
s_add_u32 s43, s33, 16896
buffer_load_dwordx4 v11, s[8:11], s43 offen lds
v_mfma_f32_16x16x32_bf16 v[196:199], v[52:55], v[32:35], v[196:199]
ds_read_b128 v[72:75], v6 offset:4096
v_mfma_f32_16x16x32_bf16 v[200:203], v[56:59], v[32:35], v[200:203]
v_mfma_f32_16x16x32_bf16 v[204:207], v[60:63], v[32:35], v[204:207]
ds_read_b128 v[76:79], v6 offset:6144
v_mfma_f32_16x16x32_bf16 v[208:211], v[48:51], v[36:39], v[208:211]
v_mfma_f32_16x16x32_bf16 v[212:215], v[52:55], v[36:39], v[212:215]
ds_read_b128 v[80:83], v6 offset:8192
v_lshlrev_b32 v15, 7, v1
s_and_b32 s41, s32, 3
s_lshl_b32 s42, s41, 15
s_sub_u32 s42, s34, s42
s_lshl_b32 s41, s41, 13
s_add_u32 s42, s42, s41
s_and_b32 s41, s30, 3
s_lshl_b32 s41, s41, 15
s_add_u32 s42, s42, s41
buffer_load_dword v125, v15, s[4:7], s42 offen
v_mfma_f32_16x16x32_bf16 v[216:219], v[56:59], v[36:39], v[216:219]
ds_read_b128 v[84:87], v6 offset:10240
v_mfma_f32_16x16x32_bf16 v[220:223], v[60:63], v[36:39], v[220:223]
s_add_u32 m0, s37, 35840
s_add_u32 s43, s33, 25088
buffer_load_dwordx4 v12, s[8:11], s43 offen lds
v_mfma_f32_16x16x32_bf16 v[224:227], v[48:51], v[40:43], v[224:227]
ds_read_b128 v[88:91], v6 offset:12288
v_mfma_f32_16x16x32_bf16 v[228:231], v[52:55], v[40:43], v[228:231]
v_mfma_f32_16x16x32_bf16 v[232:235], v[56:59], v[40:43], v[232:235]
ds_read_b128 v[92:95], v6 offset:14336
v_mfma_f32_16x16x32_bf16 v[236:239], v[60:63], v[40:43], v[236:239]
v_mfma_f32_16x16x32_bf16 v[240:243], v[48:51], v[44:47], v[240:243]
v_mfma_f32_16x16x32_bf16 v[244:247], v[52:55], v[44:47], v[244:247]
v_mfma_f32_16x16x32_bf16 v[248:251], v[56:59], v[44:47], v[248:251]
v_mfma_f32_16x16x32_bf16 v[252:255], v[60:63], v[44:47], v[252:255]
s_waitcnt vmcnt(9) lgkmcnt(0)
s_barrier
v_mfma_f32_16x16x32_bf16 v[128:131], v[96:99], v[64:67], v[128:131]
ds_read_b64_tr_b16 v[48:49], v7 offset:32768
v_mfma_f32_16x16x32_bf16 v[132:135], v[100:103], v[64:67], v[132:135]
ds_read_b64_tr_b16 v[50:51], v7 offset:33792
v_mfma_f32_16x16x32_bf16 v[136:139], v[104:107], v[64:67], v[136:139]
s_add_u32 m0, s38, 114688
s_add_u32 s43, s35, 2359296
buffer_load_dwordx4 v13, s[12:15], s43 offen lds
v_mfma_f32_16x16x32_bf16 v[140:143], v[108:111], v[64:67], v[140:143]
ds_read_b64_tr_b16 v[52:53], v8 offset:32768
v_mfma_f32_16x16x32_bf16 v[144:147], v[96:99], v[68:71], v[144:147]
v_mfma_f32_16x16x32_bf16 v[148:151], v[100:103], v[68:71], v[148:151]
ds_read_b64_tr_b16 v[54:55], v8 offset:33792
v_mfma_f32_16x16x32_bf16 v[152:155], v[104:107], v[68:71], v[152:155]
v_mfma_f32_16x16x32_bf16 v[156:159], v[108:111], v[68:71], v[156:159]
ds_read_b64_tr_b16 v[56:57], v9 offset:32768
v_mfma_f32_16x16x32_bf16 v[160:163], v[96:99], v[72:75], v[160:163]
ds_read_b64_tr_b16 v[58:59], v9 offset:33792
v_mfma_f32_16x16x32_bf16 v[164:167], v[100:103], v[72:75], v[164:167]
s_add_u32 m0, s38, 115712
s_add_u32 s43, s35, 2392064
buffer_load_dwordx4 v13, s[12:15], s43 offen lds
v_mfma_f32_16x16x32_bf16 v[168:171], v[104:107], v[72:75], v[168:171]
ds_read_b64_tr_b16 v[60:61], v10 offset:32768
v_mfma_f32_16x16x32_bf16 v[172:175], v[108:111], v[72:75], v[172:175]
v_mfma_f32_16x16x32_bf16 v[176:179], v[96:99], v[76:79], v[176:179]
ds_read_b64_tr_b16 v[62:63], v10 offset:33792
v_mfma_f32_16x16x32_bf16 v[180:183], v[100:103], v[76:79], v[180:183]
v_mfma_f32_16x16x32_bf16 v[184:187], v[104:107], v[76:79], v[184:187]
ds_read_b128 v[16:19], v3 offset:0
v_mfma_f32_16x16x32_bf16 v[188:191], v[108:111], v[76:79], v[188:191]
ds_read_b128 v[20:23], v3 offset:2048
v_mfma_f32_16x16x32_bf16 v[192:195], v[96:99], v[80:83], v[192:195]
s_add_u32 m0, s37, 65536
s_add_u32 s43, s33, 640
buffer_load_dwordx4 v11, s[8:11], s43 offen lds
v_mfma_f32_16x16x32_bf16 v[196:199], v[100:103], v[80:83], v[196:199]
ds_read_b128 v[24:27], v3 offset:4096
v_mfma_f32_16x16x32_bf16 v[200:203], v[104:107], v[80:83], v[200:203]
v_mfma_f32_16x16x32_bf16 v[204:207], v[108:111], v[80:83], v[204:207]
ds_read_b128 v[28:31], v3 offset:6144
v_mfma_f32_16x16x32_bf16 v[208:211], v[96:99], v[84:87], v[208:211]
v_mfma_f32_16x16x32_bf16 v[212:215], v[100:103], v[84:87], v[212:215]
ds_read_b128 v[32:35], v3 offset:8192
v_mfma_f32_16x16x32_bf16 v[216:219], v[104:107], v[84:87], v[216:219]
ds_read_b128 v[36:39], v3 offset:10240
v_mfma_f32_16x16x32_bf16 v[220:223], v[108:111], v[84:87], v[220:223]
s_add_u32 m0, s37, 66560
s_add_u32 s43, s33, 8832
buffer_load_dwordx4 v12, s[8:11], s43 offen lds
v_mfma_f32_16x16x32_bf16 v[224:227], v[96:99], v[88:91], v[224:227]
ds_read_b128 v[40:43], v3 offset:12288
v_mfma_f32_16x16x32_bf16 v[228:231], v[100:103], v[88:91], v[228:231]
v_mfma_f32_16x16x32_bf16 v[232:235], v[104:107], v[88:91], v[232:235]
ds_read_b128 v[44:47], v3 offset:14336
v_mfma_f32_16x16x32_bf16 v[236:239], v[108:111], v[88:91], v[236:239]
v_mfma_f32_16x16x32_bf16 v[240:243], v[96:99], v[92:95], v[240:243]
v_mfma_f32_16x16x32_bf16 v[244:247], v[100:103], v[92:95], v[244:247]
v_mfma_f32_16x16x32_bf16 v[248:251], v[104:107], v[92:95], v[248:251]
v_mfma_f32_16x16x32_bf16 v[252:255], v[108:111], v[92:95], v[252:255]
s_waitcnt vmcnt(11) lgkmcnt(0)
s_barrier
v_mfma_f32_16x16x32_bf16 v[128:131], v[48:51], v[16:19], v[128:131]
ds_read_b64_tr_b16 v[96:97], v7 offset:49152
v_mfma_f32_16x16x32_bf16 v[132:135], v[52:55], v[16:19], v[132:135]
ds_read_b64_tr_b16 v[98:99], v7 offset:50176
v_mfma_f32_16x16x32_bf16 v[136:139], v[56:59], v[16:19], v[136:139]
s_add_u32 m0, s38, 131072
s_add_u32 s43, s35, 2621440
buffer_load_dwordx4 v13, s[12:15], s43 offen lds
v_mfma_f32_16x16x32_bf16 v[140:143], v[60:63], v[16:19], v[140:143]
ds_read_b64_tr_b16 v[100:101], v8 offset:49152
v_mfma_f32_16x16x32_bf16 v[144:147], v[48:51], v[20:23], v[144:147]
v_mfma_f32_16x16x32_bf16 v[148:151], v[52:55], v[20:23], v[148:151]
ds_read_b64_tr_b16 v[102:103], v8 offset:50176
v_mfma_f32_16x16x32_bf16 v[152:155], v[56:59], v[20:23], v[152:155]
v_mfma_f32_16x16x32_bf16 v[156:159], v[60:63], v[20:23], v[156:159]
ds_read_b64_tr_b16 v[104:105], v9 offset:49152
v_mfma_f32_16x16x32_bf16 v[160:163], v[48:51], v[24:27], v[160:163]
ds_read_b64_tr_b16 v[106:107], v9 offset:50176
v_mfma_f32_16x16x32_bf16 v[164:167], v[52:55], v[24:27], v[164:167]
s_add_u32 m0, s38, 132096
s_add_u32 s43, s35, 2654208
buffer_load_dwordx4 v13, s[12:15], s43 offen lds
v_mfma_f32_16x16x32_bf16 v[168:171], v[56:59], v[24:27], v[168:171]
ds_read_b64_tr_b16 v[108:109], v10 offset:49152
v_mfma_f32_16x16x32_bf16 v[172:175], v[60:63], v[24:27], v[172:175]
v_mfma_f32_16x16x32_bf16 v[176:179], v[48:51], v[28:31], v[176:179]
ds_read_b64_tr_b16 v[110:111], v10 offset:50176
v_mfma_f32_16x16x32_bf16 v[180:183], v[52:55], v[28:31], v[180:183]
v_mfma_f32_16x16x32_bf16 v[184:187], v[56:59], v[28:31], v[184:187]
ds_read_b128 v[64:67], v4 offset:0
v_mfma_f32_16x16x32_bf16 v[188:191], v[60:63], v[28:31], v[188:191]
ds_read_b128 v[68:71], v4 offset:2048
v_mfma_f32_16x16x32_bf16 v[192:195], v[48:51], v[32:35], v[192:195]
s_add_u32 m0, s37, 67584
s_add_u32 s43, s33, 17024
buffer_load_dwordx4 v11, s[8:11], s43 offen lds
v_mfma_f32_16x16x32_bf16 v[196:199], v[52:55], v[32:35], v[196:199]
ds_read_b128 v[72:75], v4 offset:4096
v_mfma_f32_16x16x32_bf16 v[200:203], v[56:59], v[32:35], v[200:203]
v_mfma_f32_16x16x32_bf16 v[204:207], v[60:63], v[32:35], v[204:207]
ds_read_b128 v[76:79], v4 offset:6144
v_mfma_f32_16x16x32_bf16 v[208:211], v[48:51], v[36:39], v[208:211]
v_mfma_f32_16x16x32_bf16 v[212:215], v[52:55], v[36:39], v[212:215]
ds_read_b128 v[80:83], v4 offset:8192
v_mfma_f32_16x16x32_bf16 v[216:219], v[56:59], v[36:39], v[216:219]
ds_read_b128 v[84:87], v4 offset:10240
v_mfma_f32_16x16x32_bf16 v[220:223], v[60:63], v[36:39], v[220:223]
s_add_u32 m0, s37, 68608
s_add_u32 s43, s33, 25216
buffer_load_dwordx4 v12, s[8:11], s43 offen lds
v_mfma_f32_16x16x32_bf16 v[224:227], v[48:51], v[40:43], v[224:227]
ds_read_b128 v[88:91], v4 offset:12288
v_mfma_f32_16x16x32_bf16 v[228:231], v[52:55], v[40:43], v[228:231]
v_mfma_f32_16x16x32_bf16 v[232:235], v[56:59], v[40:43], v[232:235]
ds_read_b128 v[92:95], v4 offset:14336
v_mfma_f32_16x16x32_bf16 v[236:239], v[60:63], v[40:43], v[236:239]
v_mfma_f32_16x16x32_bf16 v[240:243], v[48:51], v[44:47], v[240:243]
v_mfma_f32_16x16x32_bf16 v[244:247], v[52:55], v[44:47], v[244:247]
v_mfma_f32_16x16x32_bf16 v[248:251], v[56:59], v[44:47], v[248:251]
v_mfma_f32_16x16x32_bf16 v[252:255], v[60:63], v[44:47], v[252:255]
s_waitcnt vmcnt(8) lgkmcnt(0)
s_barrier
v_mfma_f32_16x16x32_bf16 v[128:131], v[96:99], v[64:67], v[128:131]
ds_read_b64_tr_b16 v[48:49], v7 offset:0
v_mfma_f32_16x16x32_bf16 v[132:135], v[100:103], v[64:67], v[132:135]
ds_read_b64_tr_b16 v[50:51], v7 offset:1024
v_mfma_f32_16x16x32_bf16 v[136:139], v[104:107], v[64:67], v[136:139]
s_add_u32 m0, s38, 147456
s_add_u32 s43, s35, 2883584
buffer_load_dwordx4 v13, s[12:15], s43 offen lds
v_mfma_f32_16x16x32_bf16 v[140:143], v[108:111], v[64:67], v[140:143]
ds_read_b64_tr_b16 v[52:53], v8 offset:0
v_mfma_f32_16x16x32_bf16 v[144:147], v[96:99], v[68:71], v[144:147]
v_mfma_f32_16x16x32_bf16 v[148:151], v[100:103], v[68:71], v[148:151]
ds_read_b64_tr_b16 v[54:55], v8 offset:1024
v_mfma_f32_16x16x32_bf16 v[152:155], v[104:107], v[68:71], v[152:155]
v_mfma_f32_16x16x32_bf16 v[156:159], v[108:111], v[68:71], v[156:159]
ds_read_b64_tr_b16 v[56:57], v9 offset:0
v_mfma_f32_16x16x32_bf16 v[160:163], v[96:99], v[72:75], v[160:163]
ds_read_b64_tr_b16 v[58:59], v9 offset:1024
v_mfma_f32_16x16x32_bf16 v[164:167], v[100:103], v[72:75], v[164:167]
s_add_u32 m0, s38, 148480
s_add_u32 s43, s35, 2916352
buffer_load_dwordx4 v13, s[12:15], s43 offen lds
v_mfma_f32_16x16x32_bf16 v[168:171], v[104:107], v[72:75], v[168:171]
ds_read_b64_tr_b16 v[60:61], v10 offset:0
v_mfma_f32_16x16x32_bf16 v[172:175], v[108:111], v[72:75], v[172:175]
v_mfma_f32_16x16x32_bf16 v[176:179], v[96:99], v[76:79], v[176:179]
ds_read_b64_tr_b16 v[62:63], v10 offset:1024
v_mfma_f32_16x16x32_bf16 v[180:183], v[100:103], v[76:79], v[180:183]
v_mfma_f32_16x16x32_bf16 v[184:187], v[104:107], v[76:79], v[184:187]
ds_read_b128 v[16:19], v3 offset:32768
v_mfma_f32_16x16x32_bf16 v[188:191], v[108:111], v[76:79], v[188:191]
ds_read_b128 v[20:23], v3 offset:34816
v_mfma_f32_16x16x32_bf16 v[192:195], v[96:99], v[80:83], v[192:195]
s_add_u32 m0, s37, 0
s_add_u32 s43, s33, 768
buffer_load_dwordx4 v11, s[8:11], s43 offen lds
v_mfma_f32_16x16x32_bf16 v[196:199], v[100:103], v[80:83], v[196:199]
ds_read_b128 v[24:27], v3 offset:36864
v_mfma_f32_16x16x32_bf16 v[200:203], v[104:107], v[80:83], v[200:203]
v_mfma_f32_16x16x32_bf16 v[204:207], v[108:111], v[80:83], v[204:207]
ds_read_b128 v[28:31], v3 offset:38912
v_mfma_f32_16x16x32_bf16 v[208:211], v[96:99], v[84:87], v[208:211]
v_mfma_f32_16x16x32_bf16 v[212:215], v[100:103], v[84:87], v[212:215]
ds_read_b128 v[32:35], v3 offset:40960
v_lshrrev_b32 v14, 1, v1
v_lshlrev_b32 v14, 13, v14
v_and_b32 v15, 1, v1
v_lshlrev_b32 v15, 7, v15
v_add_u32 v124, v14, v15
s_and_b32 s41, s32, 1
s_lshl_b32 s41, s41, 18
s_lshl_b32 s42, s31, 19
s_add_u32 s41, s41, s42
s_lshl_b32 s42, s30, 8
s_add_u32 s51, s41, s42
v_mfma_f32_16x16x32_bf16 v[216:219], v[104:107], v[84:87], v[216:219]
ds_read_b128 v[36:39], v3 offset:43008
v_mfma_f32_16x16x32_bf16 v[220:223], v[108:111], v[84:87], v[220:223]
s_add_u32 m0, s37, 1024
s_add_u32 s43, s33, 8960
buffer_load_dwordx4 v12, s[8:11], s43 offen lds
v_mfma_f32_16x16x32_bf16 v[224:227], v[96:99], v[88:91], v[224:227]
ds_read_b128 v[40:43], v3 offset:45056
v_mfma_f32_16x16x32_bf16 v[228:231], v[100:103], v[88:91], v[228:231]
v_mfma_f32_16x16x32_bf16 v[232:235], v[104:107], v[88:91], v[232:235]
ds_read_b128 v[44:47], v3 offset:47104
v_mfma_f32_16x16x32_bf16 v[236:239], v[108:111], v[88:91], v[236:239]
v_mfma_f32_16x16x32_bf16 v[240:243], v[96:99], v[92:95], v[240:243]
v_mfma_f32_16x16x32_bf16 v[244:247], v[100:103], v[92:95], v[244:247]
v_mfma_f32_16x16x32_bf16 v[248:251], v[104:107], v[92:95], v[248:251]
v_mfma_f32_16x16x32_bf16 v[252:255], v[108:111], v[92:95], v[252:255]
s_waitcnt vmcnt(10) lgkmcnt(0)
s_barrier
v_mfma_f32_16x16x32_bf16 v[128:131], v[48:51], v[16:19], v[128:131]
ds_read_b64_tr_b16 v[96:97], v7 offset:16384
v_mfma_f32_16x16x32_bf16 v[132:135], v[52:55], v[16:19], v[132:135]
ds_read_b64_tr_b16 v[98:99], v7 offset:17408
v_mfma_f32_16x16x32_bf16 v[136:139], v[56:59], v[16:19], v[136:139]
s_add_u32 m0, s38, 98304
s_add_u32 s43, s35, 3145728
buffer_load_dwordx4 v13, s[12:15], s43 offen lds
v_mfma_f32_16x16x32_bf16 v[140:143], v[60:63], v[16:19], v[140:143]
ds_read_b64_tr_b16 v[100:101], v8 offset:16384
v_mfma_f32_16x16x32_bf16 v[144:147], v[48:51], v[20:23], v[144:147]
v_mfma_f32_16x16x32_bf16 v[148:151], v[52:55], v[20:23], v[148:151]
ds_read_b64_tr_b16 v[102:103], v8 offset:17408
v_mfma_f32_16x16x32_bf16 v[152:155], v[56:59], v[20:23], v[152:155]
v_mfma_f32_16x16x32_bf16 v[156:159], v[60:63], v[20:23], v[156:159]
ds_read_b64_tr_b16 v[104:105], v9 offset:16384
v_mfma_f32_16x16x32_bf16 v[160:163], v[48:51], v[24:27], v[160:163]
ds_read_b64_tr_b16 v[106:107], v9 offset:17408
v_mfma_f32_16x16x32_bf16 v[164:167], v[52:55], v[24:27], v[164:167]
s_add_u32 m0, s38, 99328
s_add_u32 s43, s35, 3178496
buffer_load_dwordx4 v13, s[12:15], s43 offen lds
v_mfma_f32_16x16x32_bf16 v[168:171], v[56:59], v[24:27], v[168:171]
ds_read_b64_tr_b16 v[108:109], v10 offset:16384
v_mfma_f32_16x16x32_bf16 v[172:175], v[60:63], v[24:27], v[172:175]
v_mfma_f32_16x16x32_bf16 v[176:179], v[48:51], v[28:31], v[176:179]
ds_read_b64_tr_b16 v[110:111], v10 offset:17408
v_mfma_f32_16x16x32_bf16 v[180:183], v[52:55], v[28:31], v[180:183]
v_mfma_f32_16x16x32_bf16 v[184:187], v[56:59], v[28:31], v[184:187]
ds_read_b128 v[64:67], v4 offset:32768
v_mfma_f32_16x16x32_bf16 v[188:191], v[60:63], v[28:31], v[188:191]
ds_read_b128 v[68:71], v4 offset:34816
v_mfma_f32_16x16x32_bf16 v[192:195], v[48:51], v[32:35], v[192:195]
s_add_u32 m0, s37, 2048
s_add_u32 s43, s33, 17152
buffer_load_dwordx4 v11, s[8:11], s43 offen lds
v_mfma_f32_16x16x32_bf16 v[196:199], v[52:55], v[32:35], v[196:199]
ds_read_b128 v[72:75], v4 offset:36864
v_mfma_f32_16x16x32_bf16 v[200:203], v[56:59], v[32:35], v[200:203]
v_mfma_f32_16x16x32_bf16 v[204:207], v[60:63], v[32:35], v[204:207]
ds_read_b128 v[76:79], v4 offset:38912
v_mfma_f32_16x16x32_bf16 v[208:211], v[48:51], v[36:39], v[208:211]
v_mfma_f32_16x16x32_bf16 v[212:215], v[52:55], v[36:39], v[212:215]
ds_read_b128 v[80:83], v4 offset:40960
s_cmp_ge_u32 s32, 2
s_cbranch_scc1 L_pfwq
buffer_load_dword v125, v124, s[16:19], s51 offen
L_pfwq:
v_mfma_f32_16x16x32_bf16 v[216:219], v[56:59], v[36:39], v[216:219]
ds_read_b128 v[84:87], v4 offset:43008
v_mfma_f32_16x16x32_bf16 v[220:223], v[60:63], v[36:39], v[220:223]
s_add_u32 m0, s37, 3072
s_add_u32 s43, s33, 25344
buffer_load_dwordx4 v12, s[8:11], s43 offen lds
v_mfma_f32_16x16x32_bf16 v[224:227], v[48:51], v[40:43], v[224:227]
ds_read_b128 v[88:91], v4 offset:45056
v_mfma_f32_16x16x32_bf16 v[228:231], v[52:55], v[40:43], v[228:231]
v_mfma_f32_16x16x32_bf16 v[232:235], v[56:59], v[40:43], v[232:235]
ds_read_b128 v[92:95], v4 offset:47104
v_mfma_f32_16x16x32_bf16 v[236:239], v[60:63], v[40:43], v[236:239]
v_mfma_f32_16x16x32_bf16 v[240:243], v[48:51], v[44:47], v[240:243]
v_mfma_f32_16x16x32_bf16 v[244:247], v[52:55], v[44:47], v[244:247]
v_mfma_f32_16x16x32_bf16 v[248:251], v[56:59], v[44:47], v[248:251]
v_mfma_f32_16x16x32_bf16 v[252:255], v[60:63], v[44:47], v[252:255]
s_waitcnt vmcnt(8) lgkmcnt(0)
s_barrier
v_mfma_f32_16x16x32_bf16 v[128:131], v[96:99], v[64:67], v[128:131]
ds_read_b64_tr_b16 v[48:49], v7 offset:32768
v_mfma_f32_16x16x32_bf16 v[132:135], v[100:103], v[64:67], v[132:135]
ds_read_b64_tr_b16 v[50:51], v7 offset:33792
v_mfma_f32_16x16x32_bf16 v[136:139], v[104:107], v[64:67], v[136:139]
s_add_u32 m0, s38, 114688
s_add_u32 s43, s35, 3407872
buffer_load_dwordx4 v13, s[12:15], s43 offen lds
v_mfma_f32_16x16x32_bf16 v[140:143], v[108:111], v[64:67], v[140:143]
ds_read_b64_tr_b16 v[52:53], v8 offset:32768
v_mfma_f32_16x16x32_bf16 v[144:147], v[96:99], v[68:71], v[144:147]
v_mfma_f32_16x16x32_bf16 v[148:151], v[100:103], v[68:71], v[148:151]
ds_read_b64_tr_b16 v[54:55], v8 offset:33792
v_mfma_f32_16x16x32_bf16 v[152:155], v[104:107], v[68:71], v[152:155]
v_mfma_f32_16x16x32_bf16 v[156:159], v[108:111], v[68:71], v[156:159]
ds_read_b64_tr_b16 v[56:57], v9 offset:32768
v_mfma_f32_16x16x32_bf16 v[160:163], v[96:99], v[72:75], v[160:163]
ds_read_b64_tr_b16 v[58:59], v9 offset:33792
v_mfma_f32_16x16x32_bf16 v[164:167], v[100:103], v[72:75], v[164:167]
s_add_u32 m0, s38, 115712
s_add_u32 s43, s35, 3440640
buffer_load_dwordx4 v13, s[12:15], s43 offen lds
v_mfma_f32_16x16x32_bf16 v[168:171], v[104:107], v[72:75], v[168:171]
ds_read_b64_tr_b16 v[60:61], v10 offset:32768
v_mfma_f32_16x16x32_bf16 v[172:175], v[108:111], v[72:75], v[172:175]
v_mfma_f32_16x16x32_bf16 v[176:179], v[96:99], v[76:79], v[176:179]
ds_read_b64_tr_b16 v[62:63], v10 offset:33792
v_mfma_f32_16x16x32_bf16 v[180:183], v[100:103], v[76:79], v[180:183]
v_mfma_f32_16x16x32_bf16 v[184:187], v[104:107], v[76:79], v[184:187]
ds_read_b128 v[16:19], v5 offset:0
v_mfma_f32_16x16x32_bf16 v[188:191], v[108:111], v[76:79], v[188:191]
ds_read_b128 v[20:23], v5 offset:2048
v_mfma_f32_16x16x32_bf16 v[192:195], v[96:99], v[80:83], v[192:195]
s_add_u32 m0, s37, 32768
s_add_u32 s43, s33, 896
buffer_load_dwordx4 v11, s[8:11], s43 offen lds
v_mfma_f32_16x16x32_bf16 v[196:199], v[100:103], v[80:83], v[196:199]
ds_read_b128 v[24:27], v5 offset:4096
v_mfma_f32_16x16x32_bf16 v[200:203], v[104:107], v[80:83], v[200:203]
v_mfma_f32_16x16x32_bf16 v[204:207], v[108:111], v[80:83], v[204:207]
ds_read_b128 v[28:31], v5 offset:6144
v_mfma_f32_16x16x32_bf16 v[208:211], v[96:99], v[84:87], v[208:211]
v_mfma_f32_16x16x32_bf16 v[212:215], v[100:103], v[84:87], v[212:215]
ds_read_b128 v[32:35], v5 offset:8192
s_sub_u32 s41, s73, 128
v_mov_b32 v15, s41
global_load_dword v126, v15, s[28:29]
v_mfma_f32_16x16x32_bf16 v[216:219], v[104:107], v[84:87], v[216:219]
ds_read_b128 v[36:39], v5 offset:10240
v_mfma_f32_16x16x32_bf16 v[220:223], v[108:111], v[84:87], v[220:223]
s_add_u32 m0, s37, 33792
s_add_u32 s43, s33, 9088
buffer_load_dwordx4 v12, s[8:11], s43 offen lds
v_mfma_f32_16x16x32_bf16 v[224:227], v[96:99], v[88:91], v[224:227]
ds_read_b128 v[40:43], v5 offset:12288
v_mfma_f32_16x16x32_bf16 v[228:231], v[100:103], v[88:91], v[228:231]
v_mfma_f32_16x16x32_bf16 v[232:235], v[104:107], v[88:91], v[232:235]
ds_read_b128 v[44:47], v5 offset:14336
v_mfma_f32_16x16x32_bf16 v[236:239], v[108:111], v[88:91], v[236:239]
v_mfma_f32_16x16x32_bf16 v[240:243], v[96:99], v[92:95], v[240:243]
v_mfma_f32_16x16x32_bf16 v[244:247], v[100:103], v[92:95], v[244:247]
v_mfma_f32_16x16x32_bf16 v[248:251], v[104:107], v[92:95], v[248:251]
v_mfma_f32_16x16x32_bf16 v[252:255], v[108:111], v[92:95], v[252:255]
s_waitcnt vmcnt(11) lgkmcnt(0)
s_barrier
v_mfma_f32_16x16x32_bf16 v[128:131], v[48:51], v[16:19], v[128:131]
ds_read_b64_tr_b16 v[96:97], v7 offset:49152
v_mfma_f32_16x16x32_bf16 v[132:135], v[52:55], v[16:19], v[132:135]
ds_read_b64_tr_b16 v[98:99], v7 offset:50176
v_mfma_f32_16x16x32_bf16 v[136:139], v[56:59], v[16:19], v[136:139]
s_add_u32 m0, s38, 131072
s_add_u32 s43, s35, 3670016
buffer_load_dwordx4 v13, s[12:15], s43 offen lds
v_mfma_f32_16x16x32_bf16 v[140:143], v[60:63], v[16:19], v[140:143]
ds_read_b64_tr_b16 v[100:101], v8 offset:49152
v_mfma_f32_16x16x32_bf16 v[144:147], v[48:51], v[20:23], v[144:147]
v_mfma_f32_16x16x32_bf16 v[148:151], v[52:55], v[20:23], v[148:151]
ds_read_b64_tr_b16 v[102:103], v8 offset:50176
v_mfma_f32_16x16x32_bf16 v[152:155], v[56:59], v[20:23], v[152:155]
v_mfma_f32_16x16x32_bf16 v[156:159], v[60:63], v[20:23], v[156:159]
ds_read_b64_tr_b16 v[104:105], v9 offset:49152
v_mfma_f32_16x16x32_bf16 v[160:163], v[48:51], v[24:27], v[160:163]
ds_read_b64_tr_b16 v[106:107], v9 offset:50176
v_mfma_f32_16x16x32_bf16 v[164:167], v[52:55], v[24:27], v[164:167]
s_add_u32 m0, s38, 132096
s_add_u32 s43, s35, 3702784
buffer_load_dwordx4 v13, s[12:15], s43 offen lds
v_mfma_f32_16x16x32_bf16 v[168:171], v[56:59], v[24:27], v[168:171]
ds_read_b64_tr_b16 v[108:109], v10 offset:49152
v_mfma_f32_16x16x32_bf16 v[172:175], v[60:63], v[24:27], v[172:175]
v_mfma_f32_16x16x32_bf16 v[176:179], v[48:51], v[28:31], v[176:179]
ds_read_b64_tr_b16 v[110:111], v10 offset:50176
v_mfma_f32_16x16x32_bf16 v[180:183], v[52:55], v[28:31], v[180:183]
v_mfma_f32_16x16x32_bf16 v[184:187], v[56:59], v[28:31], v[184:187]
ds_read_b128 v[64:67], v6 offset:0
v_mfma_f32_16x16x32_bf16 v[188:191], v[60:63], v[28:31], v[188:191]
ds_read_b128 v[68:71], v6 offset:2048
v_mfma_f32_16x16x32_bf16 v[192:195], v[48:51], v[32:35], v[192:195]
s_add_u32 m0, s37, 34816
s_add_u32 s43, s33, 17280
buffer_load_dwordx4 v11, s[8:11], s43 offen lds
v_mfma_f32_16x16x32_bf16 v[196:199], v[52:55], v[32:35], v[196:199]
ds_read_b128 v[72:75], v6 offset:4096
v_mfma_f32_16x16x32_bf16 v[200:203], v[56:59], v[32:35], v[200:203]
v_mfma_f32_16x16x32_bf16 v[204:207], v[60:63], v[32:35], v[204:207]
ds_read_b128 v[76:79], v6 offset:6144
v_mfma_f32_16x16x32_bf16 v[208:211], v[48:51], v[36:39], v[208:211]
v_mfma_f32_16x16x32_bf16 v[212:215], v[52:55], v[36:39], v[212:215]
ds_read_b128 v[80:83], v6 offset:8192
v_mfma_f32_16x16x32_bf16 v[216:219], v[56:59], v[36:39], v[216:219]
ds_read_b128 v[84:87], v6 offset:10240
v_mfma_f32_16x16x32_bf16 v[220:223], v[60:63], v[36:39], v[220:223]
s_add_u32 m0, s37, 35840
s_add_u32 s43, s33, 25472
buffer_load_dwordx4 v12, s[8:11], s43 offen lds
v_mfma_f32_16x16x32_bf16 v[224:227], v[48:51], v[40:43], v[224:227]
ds_read_b128 v[88:91], v6 offset:12288
v_mfma_f32_16x16x32_bf16 v[228:231], v[52:55], v[40:43], v[228:231]
v_mfma_f32_16x16x32_bf16 v[232:235], v[56:59], v[40:43], v[232:235]
ds_read_b128 v[92:95], v6 offset:14336
v_mfma_f32_16x16x32_bf16 v[236:239], v[60:63], v[40:43], v[236:239]
v_mfma_f32_16x16x32_bf16 v[240:243], v[48:51], v[44:47], v[240:243]
v_mfma_f32_16x16x32_bf16 v[244:247], v[52:55], v[44:47], v[244:247]
v_mfma_f32_16x16x32_bf16 v[248:251], v[56:59], v[44:47], v[248:251]
v_mfma_f32_16x16x32_bf16 v[252:255], v[60:63], v[44:47], v[252:255]
s_waitcnt vmcnt(9) lgkmcnt(0)
s_barrier
v_mfma_f32_16x16x32_bf16 v[128:131], v[96:99], v[64:67], v[128:131]
ds_read_b64_tr_b16 v[48:49], v7 offset:0
v_mfma_f32_16x16x32_bf16 v[132:135], v[100:103], v[64:67], v[132:135]
ds_read_b64_tr_b16 v[50:51], v7 offset:1024
v_mfma_f32_16x16x32_bf16 v[136:139], v[104:107], v[64:67], v[136:139]
s_add_u32 m0, s38, 147456
s_add_u32 s43, s35, 3932160
buffer_load_dwordx4 v13, s[12:15], s43 offen lds
v_mfma_f32_16x16x32_bf16 v[140:143], v[108:111], v[64:67], v[140:143]
ds_read_b64_tr_b16 v[52:53], v8 offset:0
v_mfma_f32_16x16x32_bf16 v[144:147], v[96:99], v[68:71], v[144:147]
v_mfma_f32_16x16x32_bf16 v[148:151], v[100:103], v[68:71], v[148:151]
ds_read_b64_tr_b16 v[54:55], v8 offset:1024
v_mfma_f32_16x16x32_bf16 v[152:155], v[104:107], v[68:71], v[152:155]
v_mfma_f32_16x16x32_bf16 v[156:159], v[108:111], v[68:71], v[156:159]
ds_read_b64_tr_b16 v[56:57], v9 offset:0
v_mfma_f32_16x16x32_bf16 v[160:163], v[96:99], v[72:75], v[160:163]
ds_read_b64_tr_b16 v[58:59], v9 offset:1024
v_mfma_f32_16x16x32_bf16 v[164:167], v[100:103], v[72:75], v[164:167]
s_add_u32 m0, s38, 148480
s_add_u32 s43, s35, 3964928
buffer_load_dwordx4 v13, s[12:15], s43 offen lds
v_mfma_f32_16x16x32_bf16 v[168:171], v[104:107], v[72:75], v[168:171]
ds_read_b64_tr_b16 v[60:61], v10 offset:0
v_mfma_f32_16x16x32_bf16 v[172:175], v[108:111], v[72:75], v[172:175]
v_mfma_f32_16x16x32_bf16 v[176:179], v[96:99], v[76:79], v[176:179]
ds_read_b64_tr_b16 v[62:63], v10 offset:1024
v_mfma_f32_16x16x32_bf16 v[180:183], v[100:103], v[76:79], v[180:183]
v_mfma_f32_16x16x32_bf16 v[184:187], v[104:107], v[76:79], v[184:187]
ds_read_b128 v[16:19], v3 offset:0
v_mfma_f32_16x16x32_bf16 v[188:191], v[108:111], v[76:79], v[188:191]
ds_read_b128 v[20:23], v3 offset:2048
v_mfma_f32_16x16x32_bf16 v[192:195], v[96:99], v[80:83], v[192:195]
s_add_u32 m0, s37, 65536
s_add_u32 s43, s34, 0
buffer_load_dwordx4 v11, s[4:7], s43 offen lds
v_mfma_f32_16x16x32_bf16 v[196:199], v[100:103], v[80:83], v[196:199]
ds_read_b128 v[24:27], v3 offset:4096
v_mfma_f32_16x16x32_bf16 v[200:203], v[104:107], v[80:83], v[200:203]
v_mfma_f32_16x16x32_bf16 v[204:207], v[108:111], v[80:83], v[204:207]
ds_read_b128 v[28:31], v3 offset:6144
v_mfma_f32_16x16x32_bf16 v[208:211], v[96:99], v[84:87], v[208:211]
v_mfma_f32_16x16x32_bf16 v[212:215], v[100:103], v[84:87], v[212:215]
ds_read_b128 v[32:35], v3 offset:8192
s_sub_u32 s41, s31, 2
s_cmp_ge_u32 s41, 2
s_cbranch_scc1 L_pfmo01
s_and_b32 s42, s32, 3
s_cmp_eq_u32 s42, 3
s_cbranch_scc1 L_pfmo01
s_lshl_b32 s41, s41, 5
s_add_u32 s41, s41, s30
s_lshl_b32 s41, s41, 1
s_add_u32 s41, s41, 0
s_cmp_ge_u32 s41, 112
s_cbranch_scc1 L_pfmo01
s_lshl_b32 s43, s42, 3
s_add_u32 s43, s43, 64
s_load_dwordx2 s[70:71], s[0:1], s43
s_cmp_eq_u32 s42, 2
s_cbranch_scc1 L_pfmo01d
s_mul_hi_u32 s42, s41, 0x0924924a
s_mul_i32 s43, s42, 28
s_sub_u32 s43, s41, s43
s_lshl_b32 s43, s43, 7
s_mul_i32 s42, s42, 458752
s_add_u32 s42, s42, s43
s_add_u32 s42, s42, 229376
s_movk_i32 s43, 3584
v_mul_lo_u32 v15, v1, s43
s_branch L_pfmo01e
L_pfmo01d:
s_lshl_b32 s42, s41, 14
s_add_u32 s42, s42, 8192
v_lshlrev_b32 v15, 7, v1
L_pfmo01e:
v_add_u32 v15, s42, v15
s_waitcnt lgkmcnt(0)
global_load_dword v125, v15, s[70:71]
L_pfmo01:
v_mfma_f32_16x16x32_bf16 v[216:219], v[104:107], v[84:87], v[216:219]
ds_read_b128 v[36:39], v3 offset:10240
v_mfma_f32_16x16x32_bf16 v[220:223], v[108:111], v[84:87], v[220:223]
s_add_u32 m0, s37, 66560
s_add_u32 s43, s34, 8192
buffer_load_dwordx4 v12, s[4:7], s43 offen lds
v_mfma_f32_16x16x32_bf16 v[224:227], v[96:99], v[88:91], v[224:227]
ds_read_b128 v[40:43], v3 offset:12288
v_mfma_f32_16x16x32_bf16 v[228:231], v[100:103], v[88:91], v[228:231]
v_mfma_f32_16x16x32_bf16 v[232:235], v[104:107], v[88:91], v[232:235]
ds_read_b128 v[44:47], v3 offset:14336
v_mfma_f32_16x16x32_bf16 v[236:239], v[108:111], v[88:91], v[236:239]
v_mfma_f32_16x16x32_bf16 v[240:243], v[96:99], v[92:95], v[240:243]
v_mfma_f32_16x16x32_bf16 v[244:247], v[100:103], v[92:95], v[244:247]
v_mfma_f32_16x16x32_bf16 v[248:251], v[104:107], v[92:95], v[248:251]
v_mfma_f32_16x16x32_bf16 v[252:255], v[108:111], v[92:95], v[252:255]
s_waitcnt vmcnt(11) lgkmcnt(0)
s_barrier
v_mfma_f32_16x16x32_bf16 v[128:131], v[48:51], v[16:19], v[128:131]
ds_read_b64_tr_b16 v[96:97], v7 offset:16384
v_mfma_f32_16x16x32_bf16 v[132:135], v[52:55], v[16:19], v[132:135]
ds_read_b64_tr_b16 v[98:99], v7 offset:17408
v_mfma_f32_16x16x32_bf16 v[136:139], v[56:59], v[16:19], v[136:139]
s_add_u32 m0, s38, 98304
s_add_u32 s43, s36, 0
buffer_load_dwordx4 v13, s[16:19], s43 offen lds
v_mfma_f32_16x16x32_bf16 v[140:143], v[60:63], v[16:19], v[140:143]
ds_read_b64_tr_b16 v[100:101], v8 offset:16384
v_mfma_f32_16x16x32_bf16 v[144:147], v[48:51], v[20:23], v[144:147]
v_mfma_f32_16x16x32_bf16 v[148:151], v[52:55], v[20:23], v[148:151]
ds_read_b64_tr_b16 v[102:103], v8 offset:17408
v_mfma_f32_16x16x32_bf16 v[152:155], v[56:59], v[20:23], v[152:155]
v_mfma_f32_16x16x32_bf16 v[156:159], v[60:63], v[20:23], v[156:159]
ds_read_b64_tr_b16 v[104:105], v9 offset:16384
v_mfma_f32_16x16x32_bf16 v[160:163], v[48:51], v[24:27], v[160:163]
ds_read_b64_tr_b16 v[106:107], v9 offset:17408
v_mfma_f32_16x16x32_bf16 v[164:167], v[52:55], v[24:27], v[164:167]
s_add_u32 m0, s38, 99328
s_add_u32 s43, s36, 32768
buffer_load_dwordx4 v13, s[16:19], s43 offen lds
v_mfma_f32_16x16x32_bf16 v[168:171], v[56:59], v[24:27], v[168:171]
ds_read_b64_tr_b16 v[108:109], v10 offset:16384
v_mfma_f32_16x16x32_bf16 v[172:175], v[60:63], v[24:27], v[172:175]
v_mfma_f32_16x16x32_bf16 v[176:179], v[48:51], v[28:31], v[176:179]
ds_read_b64_tr_b16 v[110:111], v10 offset:17408
v_mfma_f32_16x16x32_bf16 v[180:183], v[52:55], v[28:31], v[180:183]
v_mfma_f32_16x16x32_bf16 v[184:187], v[56:59], v[28:31], v[184:187]
ds_read_b128 v[64:67], v4 offset:0
v_mfma_f32_16x16x32_bf16 v[188:191], v[60:63], v[28:31], v[188:191]
ds_read_b128 v[68:71], v4 offset:2048
v_mfma_f32_16x16x32_bf16 v[192:195], v[48:51], v[32:35], v[192:195]
s_add_u32 m0, s37, 67584
s_add_u32 s43, s34, 16384
buffer_load_dwordx4 v11, s[4:7], s43 offen lds
v_mfma_f32_16x16x32_bf16 v[196:199], v[52:55], v[32:35], v[196:199]
ds_read_b128 v[72:75], v4 offset:4096
v_mfma_f32_16x16x32_bf16 v[200:203], v[56:59], v[32:35], v[200:203]
v_mfma_f32_16x16x32_bf16 v[204:207], v[60:63], v[32:35], v[204:207]
ds_read_b128 v[76:79], v4 offset:6144
v_mfma_f32_16x16x32_bf16 v[208:211], v[48:51], v[36:39], v[208:211]
v_mfma_f32_16x16x32_bf16 v[212:215], v[52:55], v[36:39], v[212:215]
ds_read_b128 v[80:83], v4 offset:8192
s_waitcnt vmcnt(12)
v_readfirstlane_b32 s41, v126
s_lshl_b32 s42, 1, s72
s_or_b32 s42, s42, 0x800
s_and_b32 s41, s41, 0xfff
s_cmp_eq_u32 s41, s42
s_cselect_b32 s3, 1, 0
v_mfma_f32_16x16x32_bf16 v[216:219], v[56:59], v[36:39], v[216:219]
ds_read_b128 v[84:87], v4 offset:10240
v_mfma_f32_16x16x32_bf16 v[220:223], v[60:63], v[36:39], v[220:223]
s_add_u32 m0, s37, 68608
s_add_u32 s43, s34, 24576
buffer_load_dwordx4 v12, s[4:7], s43 offen lds
v_mfma_f32_16x16x32_bf16 v[224:227], v[48:51], v[40:43], v[224:227]
ds_read_b128 v[88:91], v4 offset:12288
v_mfma_f32_16x16x32_bf16 v[228:231], v[52:55], v[40:43], v[228:231]
v_mfma_f32_16x16x32_bf16 v[232:235], v[56:59], v[40:43], v[232:235]
ds_read_b128 v[92:95], v4 offset:14336
v_mfma_f32_16x16x32_bf16 v[236:239], v[60:63], v[40:43], v[236:239]
v_mfma_f32_16x16x32_bf16 v[240:243], v[48:51], v[44:47], v[240:243]
v_mfma_f32_16x16x32_bf16 v[244:247], v[52:55], v[44:47], v[244:247]
v_mfma_f32_16x16x32_bf16 v[248:251], v[56:59], v[44:47], v[248:251]
v_mfma_f32_16x16x32_bf16 v[252:255], v[60:63], v[44:47], v[252:255]
s_waitcnt vmcnt(8) lgkmcnt(0)
s_barrier
v_mfma_f32_16x16x32_bf16 v[128:131], v[96:99], v[64:67], v[128:131]
ds_read_b64_tr_b16 v[48:49], v7 offset:32768
v_mfma_f32_16x16x32_bf16 v[132:135], v[100:103], v[64:67], v[132:135]
ds_read_b64_tr_b16 v[50:51], v7 offset:33792
v_mfma_f32_16x16x32_bf16 v[136:139], v[104:107], v[64:67], v[136:139]
s_add_u32 m0, s38, 114688
s_add_u32 s43, s36, 524288
buffer_load_dwordx4 v13, s[16:19], s43 offen lds
v_mfma_f32_16x16x32_bf16 v[140:143], v[108:111], v[64:67], v[140:143]
ds_read_b64_tr_b16 v[52:53], v8 offset:32768
v_mfma_f32_16x16x32_bf16 v[144:147], v[96:99], v[68:71], v[144:147]
v_mfma_f32_16x16x32_bf16 v[148:151], v[100:103], v[68:71], v[148:151]
ds_read_b64_tr_b16 v[54:55], v8 offset:33792
v_mfma_f32_16x16x32_bf16 v[152:155], v[104:107], v[68:71], v[152:155]
v_mfma_f32_16x16x32_bf16 v[156:159], v[108:111], v[68:71], v[156:159]
ds_read_b64_tr_b16 v[56:57], v9 offset:32768
v_mfma_f32_16x16x32_bf16 v[160:163], v[96:99], v[72:75], v[160:163]
ds_read_b64_tr_b16 v[58:59], v9 offset:33792
v_mfma_f32_16x16x32_bf16 v[164:167], v[100:103], v[72:75], v[164:167]
s_add_u32 m0, s38, 115712
s_add_u32 s43, s36, 557056
buffer_load_dwordx4 v13, s[16:19], s43 offen lds
v_mfma_f32_16x16x32_bf16 v[168:171], v[104:107], v[72:75], v[168:171]
ds_read_b64_tr_b16 v[60:61], v10 offset:32768
v_mfma_f32_16x16x32_bf16 v[172:175], v[108:111], v[72:75], v[172:175]
v_mfma_f32_16x16x32_bf16 v[176:179], v[96:99], v[76:79], v[176:179]
ds_read_b64_tr_b16 v[62:63], v10 offset:33792
v_mfma_f32_16x16x32_bf16 v[180:183], v[100:103], v[76:79], v[180:183]
v_mfma_f32_16x16x32_bf16 v[184:187], v[104:107], v[76:79], v[184:187]
ds_read_b128 v[16:19], v3 offset:32768
v_mfma_f32_16x16x32_bf16 v[188:191], v[108:111], v[76:79], v[188:191]
ds_read_b128 v[20:23], v3 offset:34816
v_mfma_f32_16x16x32_bf16 v[192:195], v[96:99], v[80:83], v[192:195]
s_add_u32 m0, s37, 0
s_add_u32 s43, s34, 128
buffer_load_dwordx4 v11, s[4:7], s43 offen lds
v_mfma_f32_16x16x32_bf16 v[196:199], v[100:103], v[80:83], v[196:199]
ds_read_b128 v[24:27], v3 offset:36864
v_mfma_f32_16x16x32_bf16 v[200:203], v[104:107], v[80:83], v[200:203]
v_mfma_f32_16x16x32_bf16 v[204:207], v[108:111], v[80:83], v[204:207]
ds_read_b128 v[28:31], v3 offset:38912
v_mfma_f32_16x16x32_bf16 v[208:211], v[96:99], v[84:87], v[208:211]
v_mfma_f32_16x16x32_bf16 v[212:215], v[100:103], v[84:87], v[212:215]
ds_read_b128 v[32:35], v3 offset:40960
v_and_b32 v14, 15, v1
v_lshrrev_b32 v15, 4, v1
v_lshrrev_b32 v124, 1, v14
v_xor_b32 v124, v124, v15
v_mfma_f32_16x16x32_bf16 v[216:219], v[104:107], v[84:87], v[216:219]
ds_read_b128 v[36:39], v3 offset:43008
v_lshlrev_b32 v124, 4, v124
v_lshlrev_b32 v127, 7, v14
v_add_u32 v127, s37, v127
v_mfma_f32_16x16x32_bf16 v[220:223], v[108:111], v[84:87], v[220:223]
s_add_u32 m0, s37, 1024
s_add_u32 s43, s34, 8320
buffer_load_dwordx4 v12, s[4:7], s43 offen lds
v_add_u32 v112, v127, v124
v_xor_b32 v124, 64, v124
v_add_u32 v113, v127, v124
v_mfma_f32_16x16x32_bf16 v[224:227], v[96:99], v[88:91], v[224:227]
ds_read_b128 v[40:43], v3 offset:45056
v_add_u32 v114, 0x10000, v112
v_add_u32 v115, 0x10000, v113
v_lshrrev_b32 v14, 2, v14
v_and_b32 v124, 1, v15
v_mfma_f32_16x16x32_bf16 v[228:231], v[100:103], v[88:91], v[228:231]
v_lshlrev_b32 v124, 2, v124
v_or_b32 v124, v124, v14
v_lshlrev_b32 v124, 5, v124
v_mfma_f32_16x16x32_bf16 v[232:235], v[104:107], v[88:91], v[232:235]
ds_read_b128 v[44:47], v3 offset:47104
v_lshlrev_b32 v15, 3, v15
v_add_u32 v15, v15, v14
v_lshlrev_b32 v15, 8, v15
v_mfma_f32_16x16x32_bf16 v[236:239], v[108:111], v[88:91], v[236:239]
v_and_b32 v14, 3, v1
v_lshlrev_b32 v14, 3, v14
v_add_u32 v15, v15, v14
v_add_u32 v15, v15, v124
v_mfma_f32_16x16x32_bf16 v[240:243], v[96:99], v[92:95], v[240:243]
v_add_u32 v15, 98304, v15
v_xor_b32 v116, 0, v15
v_xor_b32 v117, 32, v15
v_mfma_f32_16x16x32_bf16 v[244:247], v[100:103], v[92:95], v[244:247]
v_xor_b32 v118, 64, v15
v_xor_b32 v119, 96, v15
v_xor_b32 v120, 128, v15
v_mfma_f32_16x16x32_bf16 v[248:251], v[104:107], v[92:95], v[248:251]
v_xor_b32 v121, 160, v15
v_xor_b32 v122, 192, v15
v_xor_b32 v123, 224, v15
v_mfma_f32_16x16x32_bf16 v[252:255], v[108:111], v[92:95], v[252:255]
s_waitcnt vmcnt(10) lgkmcnt(0)
s_barrier
v_mfma_f32_16x16x32_bf16 v[128:131], v[48:51], v[16:19], v[128:131]
ds_read_b64_tr_b16 v[96:97], v7 offset:49152
v_mfma_f32_16x16x32_bf16 v[132:135], v[52:55], v[16:19], v[132:135]
ds_read_b64_tr_b16 v[98:99], v7 offset:50176
v_mfma_f32_16x16x32_bf16 v[136:139], v[56:59], v[16:19], v[136:139]
s_add_u32 m0, s38, 131072
s_add_u32 s43, s36, 1048576
buffer_load_dwordx4 v13, s[16:19], s43 offen lds
v_mfma_f32_16x16x32_bf16 v[140:143], v[60:63], v[16:19], v[140:143]
ds_read_b64_tr_b16 v[100:101], v8 offset:49152
v_mfma_f32_16x16x32_bf16 v[144:147], v[48:51], v[20:23], v[144:147]
v_mfma_f32_16x16x32_bf16 v[148:151], v[52:55], v[20:23], v[148:151]
ds_read_b64_tr_b16 v[102:103], v8 offset:50176
v_mfma_f32_16x16x32_bf16 v[152:155], v[56:59], v[20:23], v[152:155]
v_mfma_f32_16x16x32_bf16 v[156:159], v[60:63], v[20:23], v[156:159]
ds_read_b64_tr_b16 v[104:105], v9 offset:49152
v_mfma_f32_16x16x32_bf16 v[160:163], v[48:51], v[24:27], v[160:163]
ds_read_b64_tr_b16 v[106:107], v9 offset:50176
v_mfma_f32_16x16x32_bf16 v[164:167], v[52:55], v[24:27], v[164:167]
s_add_u32 m0, s38, 132096
s_add_u32 s43, s36, 1081344
buffer_load_dwordx4 v13, s[16:19], s43 offen lds
v_mfma_f32_16x16x32_bf16 v[168:171], v[56:59], v[24:27], v[168:171]
ds_read_b64_tr_b16 v[108:109], v10 offset:49152
v_mfma_f32_16x16x32_bf16 v[172:175], v[60:63], v[24:27], v[172:175]
v_mfma_f32_16x16x32_bf16 v[176:179], v[48:51], v[28:31], v[176:179]
ds_read_b64_tr_b16 v[110:111], v10 offset:50176
v_mfma_f32_16x16x32_bf16 v[180:183], v[52:55], v[28:31], v[180:183]
v_mfma_f32_16x16x32_bf16 v[184:187], v[56:59], v[28:31], v[184:187]
ds_read_b128 v[64:67], v4 offset:32768
v_mfma_f32_16x16x32_bf16 v[188:191], v[60:63], v[28:31], v[188:191]
ds_read_b128 v[68:71], v4 offset:34816
v_mfma_f32_16x16x32_bf16 v[192:195], v[48:51], v[32:35], v[192:195]
s_add_u32 m0, s37, 2048
s_add_u32 s43, s34, 16512
buffer_load_dwordx4 v11, s[4:7], s43 offen lds
v_mfma_f32_16x16x32_bf16 v[196:199], v[52:55], v[32:35], v[196:199]
ds_read_b128 v[72:75], v4 offset:36864
v_mfma_f32_16x16x32_bf16 v[200:203], v[56:59], v[32:35], v[200:203]
v_mfma_f32_16x16x32_bf16 v[204:207], v[60:63], v[32:35], v[204:207]
ds_read_b128 v[76:79], v4 offset:38912
v_mfma_f32_16x16x32_bf16 v[208:211], v[48:51], v[36:39], v[208:211]
v_mfma_f32_16x16x32_bf16 v[212:215], v[52:55], v[36:39], v[212:215]
ds_read_b128 v[80:83], v4 offset:40960
v_mfma_f32_16x16x32_bf16 v[216:219], v[56:59], v[36:39], v[216:219]
ds_read_b128 v[84:87], v4 offset:43008
v_mfma_f32_16x16x32_bf16 v[220:223], v[60:63], v[36:39], v[220:223]
s_add_u32 m0, s37, 3072
s_add_u32 s43, s34, 24704
buffer_load_dwordx4 v12, s[4:7], s43 offen lds
v_mfma_f32_16x16x32_bf16 v[224:227], v[48:51], v[40:43], v[224:227]
ds_read_b128 v[88:91], v4 offset:45056
v_mfma_f32_16x16x32_bf16 v[228:231], v[52:55], v[40:43], v[228:231]
v_mfma_f32_16x16x32_bf16 v[232:235], v[56:59], v[40:43], v[232:235]
ds_read_b128 v[92:95], v4 offset:47104
v_mfma_f32_16x16x32_bf16 v[236:239], v[60:63], v[40:43], v[236:239]
v_mfma_f32_16x16x32_bf16 v[240:243], v[48:51], v[44:47], v[240:243]
v_mfma_f32_16x16x32_bf16 v[244:247], v[52:55], v[44:47], v[244:247]
v_mfma_f32_16x16x32_bf16 v[248:251], v[56:59], v[44:47], v[248:251]
v_mfma_f32_16x16x32_bf16 v[252:255], v[60:63], v[44:47], v[252:255]
s_cmp_ge_u32 s31, 2
s_cbranch_scc1 L_qlateA
s_waitcnt vmcnt(8) lgkmcnt(0)
s_barrier
v_mfma_f32_16x16x32_bf16 v[128:131], v[96:99], v[64:67], v[128:131]
ds_read_b128 v[48:51], v114 offset:0
v_mfma_f32_16x16x32_bf16 v[132:135], v[100:103], v[64:67], v[132:135]
ds_read_b128 v[52:55], v114 offset:2048
v_mfma_f32_16x16x32_bf16 v[136:139], v[104:107], v[64:67], v[136:139]
ds_read_b64_tr_b16 v[16:17], v116 offset:0
s_add_u32 m0, s37, 32768
s_add_u32 s43, s34, 256
buffer_load_dwordx4 v11, s[4:7], s43 offen lds
v_mfma_f32_16x16x32_bf16 v[140:143], v[108:111], v[64:67], v[140:143]
ds_read_b64_tr_b16 v[18:19], v116 offset:1024
v_mfma_f32_16x16x32_bf16 v[144:147], v[96:99], v[68:71], v[144:147]
ds_read_b64_tr_b16 v[20:21], v117 offset:0
v_mfma_f32_16x16x32_bf16 v[148:151], v[100:103], v[68:71], v[148:151]
ds_read_b64_tr_b16 v[22:23], v117 offset:1024
v_mfma_f32_16x16x32_bf16 v[152:155], v[104:107], v[68:71], v[152:155]
ds_read_b64_tr_b16 v[24:25], v118 offset:0
s_add_u32 m0, s37, 33792
s_add_u32 s43, s34, 8448
buffer_load_dwordx4 v12, s[4:7], s43 offen lds
v_mfma_f32_16x16x32_bf16 v[156:159], v[108:111], v[68:71], v[156:159]
ds_read_b64_tr_b16 v[26:27], v118 offset:1024
v_mfma_f32_16x16x32_bf16 v[160:163], v[96:99], v[72:75], v[160:163]
ds_read_b64_tr_b16 v[28:29], v119 offset:0
v_mfma_f32_16x16x32_bf16 v[164:167], v[100:103], v[72:75], v[164:167]
v_mfma_f32_16x16x32_bf16 v[168:171], v[104:107], v[72:75], v[168:171]
ds_read_b64_tr_b16 v[30:31], v119 offset:1024
v_mul_f32 v128, s74, v128
v_mul_f32 v129, s74, v129
v_mul_f32 v130, s74, v130
v_mul_f32 v131, s74, v131
v_mul_f32 v132, s74, v132
v_mul_f32 v133, s74, v133
v_mul_f32 v134, s74, v134
v_mul_f32 v135, s74, v135
v_cvt_pk_bf16_f32 v128, v128, v129
v_cvt_pk_bf16_f32 v129, v130, v131
v_cvt_pk_bf16_f32 v130, v132, v133
v_cvt_pk_bf16_f32 v131, v134, v135
v_mfma_f32_16x16x32_bf16 v[172:175], v[108:111], v[72:75], v[172:175]
ds_read_b64_tr_b16 v[32:33], v120 offset:0
s_add_u32 m0, s37, 34816
s_add_u32 s43, s34, 16640
buffer_load_dwordx4 v11, s[4:7], s43 offen lds
v_mul_f32 v136, s74, v136
v_mul_f32 v137, s74, v137
v_mul_f32 v138, s74, v138
v_mul_f32 v139, s74, v139
v_mul_f32 v140, s74, v140
v_mul_f32 v141, s74, v141
v_mul_f32 v142, s74, v142
v_mul_f32 v143, s74, v143
v_cvt_pk_bf16_f32 v132, v136, v137
v_cvt_pk_bf16_f32 v133, v138, v139
v_cvt_pk_bf16_f32 v134, v140, v141
v_cvt_pk_bf16_f32 v135, v142, v143
v_mfma_f32_16x16x32_bf16 v[176:179], v[96:99], v[76:79], v[176:179]
ds_read_b64_tr_b16 v[34:35], v120 offset:1024
v_mul_f32 v144, s74, v144
v_mul_f32 v145, s74, v145
v_mul_f32 v146, s74, v146
v_mul_f32 v147, s74, v147
v_mul_f32 v148, s74, v148
v_mul_f32 v149, s74, v149
v_mul_f32 v150, s74, v150
v_mul_f32 v151, s74, v151
v_cvt_pk_bf16_f32 v136, v144, v145
v_cvt_pk_bf16_f32 v137, v146, v147
v_cvt_pk_bf16_f32 v138, v148, v149
v_cvt_pk_bf16_f32 v139, v150, v151
v_mfma_f32_16x16x32_bf16 v[180:183], v[100:103], v[76:79], v[180:183]
ds_read_b64_tr_b16 v[36:37], v121 offset:0
v_mul_f32 v152, s74, v152
v_mul_f32 v153, s74, v153
v_mul_f32 v154, s74, v154
v_mul_f32 v155, s74, v155
v_mul_f32 v156, s74, v156
v_mul_f32 v157, s74, v157
v_mul_f32 v158, s74, v158
v_mul_f32 v159, s74, v159
v_cvt_pk_bf16_f32 v140, v152, v153
v_cvt_pk_bf16_f32 v141, v154, v155
v_cvt_pk_bf16_f32 v142, v156, v157
v_cvt_pk_bf16_f32 v143, v158, v159
v_mfma_f32_16x16x32_bf16 v[184:187], v[104:107], v[76:79], v[184:187]
ds_read_b64_tr_b16 v[38:39], v121 offset:1024
v_mfma_f32_16x16x32_bf16 v[188:191], v[108:111], v[76:79], v[188:191]
ds_read_b64_tr_b16 v[40:41], v122 offset:0
v_mfma_f32_16x16x32_bf16 v[192:195], v[96:99], v[80:83], v[192:195]
ds_read_b64_tr_b16 v[42:43], v122 offset:1024
s_add_u32 m0, s37, 35840
s_add_u32 s43, s34, 24832
buffer_load_dwordx4 v12, s[4:7], s43 offen lds
v_mfma_f32_16x16x32_bf16 v[196:199], v[100:103], v[80:83], v[196:199]
ds_read_b64_tr_b16 v[44:45], v123 offset:0
v_mfma_f32_16x16x32_bf16 v[200:203], v[104:107], v[80:83], v[200:203]
ds_read_b64_tr_b16 v[46:47], v123 offset:1024
v_mul_f32 v160, s74, v160
v_mul_f32 v161, s74, v161
v_mul_f32 v162, s74, v162
v_mul_f32 v163, s74, v163
v_mul_f32 v164, s74, v164
v_mul_f32 v165, s74, v165
v_mul_f32 v166, s74, v166
v_mul_f32 v167, s74, v167
v_cvt_pk_bf16_f32 v144, v160, v161
v_cvt_pk_bf16_f32 v145, v162, v163
v_cvt_pk_bf16_f32 v146, v164, v165
v_cvt_pk_bf16_f32 v147, v166, v167
v_mfma_f32_16x16x32_bf16 v[204:207], v[108:111], v[80:83], v[204:207]
v_mul_f32 v168, s74, v168
v_mul_f32 v169, s74, v169
v_mul_f32 v170, s74, v170
v_mul_f32 v171, s74, v171
v_mul_f32 v172, s74, v172
v_mul_f32 v173, s74, v173
v_mul_f32 v174, s74, v174
v_mul_f32 v175, s74, v175
v_cvt_pk_bf16_f32 v148, v168, v169
v_cvt_pk_bf16_f32 v149, v170, v171
v_cvt_pk_bf16_f32 v150, v172, v173
v_cvt_pk_bf16_f32 v151, v174, v175
v_mfma_f32_16x16x32_bf16 v[208:211], v[96:99], v[84:87], v[208:211]
s_add_u32 m0, s38, 147456
s_add_u32 s43, s36, 1572864
buffer_load_dwordx4 v13, s[16:19], s43 offen lds
v_mul_f32 v176, s74, v176
v_mul_f32 v177, s74, v177
v_mul_f32 v178, s74, v178
v_mul_f32 v179, s74, v179
v_mul_f32 v180, s74, v180
v_mul_f32 v181, s74, v181
v_mul_f32 v182, s74, v182
v_mul_f32 v183, s74, v183
v_cvt_pk_bf16_f32 v152, v176, v177
v_cvt_pk_bf16_f32 v153, v178, v179
v_cvt_pk_bf16_f32 v154, v180, v181
v_cvt_pk_bf16_f32 v155, v182, v183
v_mfma_f32_16x16x32_bf16 v[212:215], v[100:103], v[84:87], v[212:215]
v_mul_f32 v184, s74, v184
v_mul_f32 v185, s74, v185
v_mul_f32 v186, s74, v186
v_mul_f32 v187, s74, v187
v_mul_f32 v188, s74, v188
v_mul_f32 v189, s74, v189
v_mul_f32 v190, s74, v190
v_mul_f32 v191, s74, v191
v_cvt_pk_bf16_f32 v156, v184, v185
v_cvt_pk_bf16_f32 v157, v186, v187
v_cvt_pk_bf16_f32 v158, v188, v189
v_cvt_pk_bf16_f32 v159, v190, v191
v_mfma_f32_16x16x32_bf16 v[216:219], v[104:107], v[84:87], v[216:219]
v_mfma_f32_16x16x32_bf16 v[220:223], v[108:111], v[84:87], v[220:223]
v_mfma_f32_16x16x32_bf16 v[224:227], v[96:99], v[88:91], v[224:227]
v_mfma_f32_16x16x32_bf16 v[228:231], v[100:103], v[88:91], v[228:231]
s_add_u32 m0, s38, 148480
s_add_u32 s43, s36, 1605632
buffer_load_dwordx4 v13, s[16:19], s43 offen lds
v_mfma_f32_16x16x32_bf16 v[232:235], v[104:107], v[88:91], v[232:235]
v_mul_f32 v192, s74, v192
v_mul_f32 v193, s74, v193
v_mul_f32 v194, s74, v194
v_mul_f32 v195, s74, v195
v_mul_f32 v196, s74, v196
v_mul_f32 v197, s74, v197
v_mul_f32 v198, s74, v198
v_mul_f32 v199, s74, v199
v_cvt_pk_bf16_f32 v160, v192, v193
v_cvt_pk_bf16_f32 v161, v194, v195
v_cvt_pk_bf16_f32 v162, v196, v197
v_cvt_pk_bf16_f32 v163, v198, v199
v_mfma_f32_16x16x32_bf16 v[236:239], v[108:111], v[88:91], v[236:239]
v_mul_f32 v200, s74, v200
v_mul_f32 v201, s74, v201
v_mul_f32 v202, s74, v202
v_mul_f32 v203, s74, v203
v_mul_f32 v204, s74, v204
v_mul_f32 v205, s74, v205
v_mul_f32 v206, s74, v206
v_mul_f32 v207, s74, v207
v_cvt_pk_bf16_f32 v164, v200, v201
v_cvt_pk_bf16_f32 v165, v202, v203
v_cvt_pk_bf16_f32 v166, v204, v205
v_cvt_pk_bf16_f32 v167, v206, v207
v_mfma_f32_16x16x32_bf16 v[240:243], v[96:99], v[92:95], v[240:243]
v_mul_f32 v208, s74, v208
v_mul_f32 v209, s74, v209
v_mul_f32 v210, s74, v210
v_mul_f32 v211, s74, v211
v_mul_f32 v212, s74, v212
v_mul_f32 v213, s74, v213
v_mul_f32 v214, s74, v214
v_mul_f32 v215, s74, v215
v_cvt_pk_bf16_f32 v168, v208, v209
v_cvt_pk_bf16_f32 v169, v210, v211
v_cvt_pk_bf16_f32 v170, v212, v213
v_cvt_pk_bf16_f32 v171, v214, v215
v_mfma_f32_16x16x32_bf16 v[244:247], v[100:103], v[92:95], v[244:247]
v_mul_f32 v216, s74, v216
v_mul_f32 v217, s74, v217
v_mul_f32 v218, s74, v218
v_mul_f32 v219, s74, v219
v_mul_f32 v220, s74, v220
v_mul_f32 v221, s74, v221
v_mul_f32 v222, s74, v222
v_mul_f32 v223, s74, v223
v_cvt_pk_bf16_f32 v172, v216, v217
v_cvt_pk_bf16_f32 v173, v218, v219
v_cvt_pk_bf16_f32 v174, v220, v221
v_cvt_pk_bf16_f32 v175, v222, v223
v_mfma_f32_16x16x32_bf16 v[248:251], v[104:107], v[92:95], v[248:251]
v_mfma_f32_16x16x32_bf16 v[252:255], v[108:111], v[92:95], v[252:255]
s_nop 7
v_mul_f32 v224, s74, v224
v_mul_f32 v225, s74, v225
v_mul_f32 v226, s74, v226
v_mul_f32 v227, s74, v227
v_mul_f32 v228, s74, v228
v_mul_f32 v229, s74, v229
v_mul_f32 v230, s74, v230
v_mul_f32 v231, s74, v231
v_cvt_pk_bf16_f32 v176, v224, v225
v_cvt_pk_bf16_f32 v177, v226, v227
v_cvt_pk_bf16_f32 v178, v228, v229
v_cvt_pk_bf16_f32 v179, v230, v231
v_mul_f32 v232, s74, v232
v_mul_f32 v233, s74, v233
v_mul_f32 v234, s74, v234
v_mul_f32 v235, s74, v235
v_mul_f32 v236, s74, v236
v_mul_f32 v237, s74, v237
v_mul_f32 v238, s74, v238
v_mul_f32 v239, s74, v239
v_cvt_pk_bf16_f32 v180, v232, v233
v_cvt_pk_bf16_f32 v181, v234, v235
v_cvt_pk_bf16_f32 v182, v236, v237
v_cvt_pk_bf16_f32 v183, v238, v239
v_mul_f32 v240, s74, v240
v_mul_f32 v241, s74, v241
v_mul_f32 v242, s74, v242
v_mul_f32 v243, s74, v243
v_mul_f32 v244, s74, v244
v_mul_f32 v245, s74, v245
v_mul_f32 v246, s74, v246
v_mul_f32 v247, s74, v247
v_cvt_pk_bf16_f32 v184, v240, v241
v_cvt_pk_bf16_f32 v185, v242, v243
v_cvt_pk_bf16_f32 v186, v244, v245
v_cvt_pk_bf16_f32 v187, v246, v247
v_mul_f32 v248, s74, v248
v_mul_f32 v249, s74, v249
v_mul_f32 v250, s74, v250
v_mul_f32 v251, s74, v251
v_mul_f32 v252, s74, v252
v_mul_f32 v253, s74, v253
v_mul_f32 v254, s74, v254
v_mul_f32 v255, s74, v255
v_cvt_pk_bf16_f32 v188, v248, v249
v_cvt_pk_bf16_f32 v189, v250, v251
v_cvt_pk_bf16_f32 v190, v252, v253
v_cvt_pk_bf16_f32 v191, v254, v255
s_waitcnt lgkmcnt(14)
v_mfma_f32_16x16x32_bf16 v[192:195], v[16:19], v[48:51], 0
ds_read_b128 v[96:99], v115 offset:0
ds_read_b128 v[100:103], v115 offset:2048
v_mfma_f32_16x16x32_bf16 v[224:227], v[16:19], v[52:55], 0
ds_read_b64_tr_b16 v[64:65], v116 offset:8192
s_add_u32 s44, s40, 0
s_cmp_eq_u32 s3, 0
s_cbranch_scc1 L_sst0
buffer_store_dwordx4 v[128:131], v2, s[20:23], s44 offen offset:0
L_sstr0:
s_waitcnt lgkmcnt(15)
v_mfma_f32_16x16x32_bf16 v[196:199], v[20:23], v[48:51], 0
ds_read_b64_tr_b16 v[66:67], v116 offset:9216
v_mfma_f32_16x16x32_bf16 v[228:231], v[20:23], v[52:55], 0
ds_read_b64_tr_b16 v[68:69], v117 offset:8192
ds_read_b64_tr_b16 v[70:71], v117 offset:9216
s_add_u32 s44, s40, 0
s_cmp_eq_u32 s3, 0
s_cbranch_scc1 L_sst1
buffer_store_dwordx4 v[132:135], v2, s[20:23], s44 offen offset:1024
L_sstr1:
s_waitcnt lgkmcnt(15)
v_mfma_f32_16x16x32_bf16 v[200:203], v[24:27], v[48:51], 0
ds_read_b64_tr_b16 v[72:73], v118 offset:8192
v_mfma_f32_16x16x32_bf16 v[232:235], v[24:27], v[52:55], 0
ds_read_b64_tr_b16 v[74:75], v118 offset:9216
s_waitcnt lgkmcnt(15)
v_mfma_f32_16x16x32_bf16 v[204:207], v[28:31], v[48:51], 0
ds_read_b64_tr_b16 v[76:77], v119 offset:8192
s_add_u32 s44, s40, 4096
s_cmp_eq_u32 s3, 0
s_cbranch_scc1 L_sst2
buffer_store_dwordx4 v[136:139], v2, s[20:23], s44 offen offset:0
L_sstr2:
v_mfma_f32_16x16x32_bf16 v[236:239], v[28:31], v[52:55], 0
ds_read_b64_tr_b16 v[78:79], v119 offset:9216
ds_read_b64_tr_b16 v[80:81], v120 offset:8192
s_waitcnt lgkmcnt(15)
v_mfma_f32_16x16x32_bf16 v[208:211], v[32:35], v[48:51], 0
ds_read_b64_tr_b16 v[82:83], v120 offset:9216
s_add_u32 s44, s40, 4096
s_cmp_eq_u32 s3, 0
s_cbranch_scc1 L_sst3
buffer_store_dwordx4 v[140:143], v2, s[20:23], s44 offen offset:1024
L_sstr3:
v_mfma_f32_16x16x32_bf16 v[240:243], v[32:35], v[52:55], 0
ds_read_b64_tr_b16 v[84:85], v121 offset:8192
v_mfma_f32_16x16x32_bf16 v[212:215], v[36:39], v[48:51], 0
ds_read_b64_tr_b16 v[86:87], v121 offset:9216
ds_read_b64_tr_b16 v[88:89], v122 offset:8192
v_mfma_f32_16x16x32_bf16 v[244:247], v[36:39], v[52:55], 0
ds_read_b64_tr_b16 v[90:91], v122 offset:9216
s_add_u32 s44, s40, 8192
s_cmp_eq_u32 s3, 0
s_cbranch_scc1 L_sst4
buffer_store_dwordx4 v[144:147], v2, s[20:23], s44 offen offset:0
L_sstr4:
s_waitcnt lgkmcnt(15)
v_mfma_f32_16x16x32_bf16 v[216:219], v[40:43], v[48:51], 0
ds_read_b64_tr_b16 v[92:93], v123 offset:8192
v_mfma_f32_16x16x32_bf16 v[248:251], v[40:43], v[52:55], 0
ds_read_b64_tr_b16 v[94:95], v123 offset:9216
s_add_u32 s44, s40, 8192
s_cmp_eq_u32 s3, 0
s_cbranch_scc1 L_sst5
buffer_store_dwordx4 v[148:151], v2, s[20:23], s44 offen offset:1024
L_sstr5:
v_mfma_f32_16x16x32_bf16 v[220:223], v[44:47], v[48:51], 0
v_mfma_f32_16x16x32_bf16 v[252:255], v[44:47], v[52:55], 0
s_waitcnt vmcnt(12) lgkmcnt(0)
s_barrier
v_mfma_f32_16x16x32_bf16 v[192:195], v[64:67], v[96:99], v[192:195]
ds_read_b128 v[48:51], v112 offset:0
ds_read_b128 v[52:55], v112 offset:2048
s_add_u32 m0, s37, 65536
s_add_u32 s43, s34, 384
buffer_load_dwordx4 v11, s[4:7], s43 offen lds
v_mov_b32 v128, 0
v_mov_b32 v129, 0
v_mov_b32 v130, 0
v_mov_b32 v131, 0
v_mfma_f32_16x16x32_bf16 v[224:227], v[64:67], v[100:103], v[224:227]
ds_read_b64_tr_b16 v[16:17], v116 offset:16384
v_mfma_f32_16x16x32_bf16 v[196:199], v[68:71], v[96:99], v[196:199]
ds_read_b64_tr_b16 v[18:19], v116 offset:17408
s_add_u32 m0, s37, 66560
s_add_u32 s43, s34, 8576
buffer_load_dwordx4 v12, s[4:7], s43 offen lds
v_mov_b32 v132, 0
v_mov_b32 v133, 0
v_mov_b32 v134, 0
v_mov_b32 v135, 0
v_mfma_f32_16x16x32_bf16 v[228:231], v[68:71], v[100:103], v[228:231]
ds_read_b64_tr_b16 v[20:21], v117 offset:16384
ds_read_b64_tr_b16 v[22:23], v117 offset:17408
v_mfma_f32_16x16x32_bf16 v[200:203], v[72:75], v[96:99], v[200:203]
ds_read_b64_tr_b16 v[24:25], v118 offset:16384
v_mfma_f32_16x16x32_bf16 v[232:235], v[72:75], v[100:103], v[232:235]
ds_read_b64_tr_b16 v[26:27], v118 offset:17408
s_add_u32 m0, s37, 67584
s_add_u32 s43, s34, 16768
buffer_load_dwordx4 v11, s[4:7], s43 offen lds
v_mov_b32 v136, 0
v_mov_b32 v137, 0
v_mov_b32 v138, 0
v_mov_b32 v139, 0
v_mfma_f32_16x16x32_bf16 v[204:207], v[76:79], v[96:99], v[204:207]
ds_read_b64_tr_b16 v[28:29], v119 offset:16384
v_mfma_f32_16x16x32_bf16 v[236:239], v[76:79], v[100:103], v[236:239]
ds_read_b64_tr_b16 v[30:31], v119 offset:17408
ds_read_b64_tr_b16 v[32:33], v120 offset:16384
v_mfma_f32_16x16x32_bf16 v[208:211], v[80:83], v[96:99], v[208:211]
ds_read_b64_tr_b16 v[34:35], v120 offset:17408
s_add_u32 m0, s37, 68608
s_add_u32 s43, s34, 24960
buffer_load_dwordx4 v12, s[4:7], s43 offen lds
v_mov_b32 v140, 0
v_mov_b32 v141, 0
v_mov_b32 v142, 0
v_mov_b32 v143, 0
v_mfma_f32_16x16x32_bf16 v[240:243], v[80:83], v[100:103], v[240:243]
ds_read_b64_tr_b16 v[36:37], v121 offset:16384
v_mfma_f32_16x16x32_bf16 v[212:215], v[84:87], v[96:99], v[212:215]
ds_read_b64_tr_b16 v[38:39], v121 offset:17408
ds_read_b64_tr_b16 v[40:41], v122 offset:16384
s_add_u32 m0, s38, 98304
s_add_u32 s43, s36, 2097152
buffer_load_dwordx4 v13, s[16:19], s43 offen lds
v_mov_b32 v144, 0
v_mov_b32 v145, 0
v_mov_b32 v146, 0
v_mov_b32 v147, 0
v_mfma_f32_16x16x32_bf16 v[244:247], v[84:87], v[100:103], v[244:247]
ds_read_b64_tr_b16 v[42:43], v122 offset:17408
v_mfma_f32_16x16x32_bf16 v[216:219], v[88:91], v[96:99], v[216:219]
ds_read_b64_tr_b16 v[44:45], v123 offset:16384
v_mfma_f32_16x16x32_bf16 v[248:251], v[88:91], v[100:103], v[248:251]
ds_read_b64_tr_b16 v[46:47], v123 offset:17408
s_add_u32 m0, s38, 99328
s_add_u32 s43, s36, 2129920
buffer_load_dwordx4 v13, s[16:19], s43 offen lds
v_mov_b32 v148, 0
v_mov_b32 v149, 0
v_mov_b32 v150, 0
v_mov_b32 v151, 0
v_mfma_f32_16x16x32_bf16 v[220:223], v[92:95], v[96:99], v[220:223]
v_mfma_f32_16x16x32_bf16 v[252:255], v[92:95], v[100:103], v[252:255]
s_waitcnt lgkmcnt(14)
v_mfma_f32_16x16x32_bf16 v[192:195], v[16:19], v[48:51], v[192:195]
ds_read_b128 v[96:99], v113 offset:0
ds_read_b128 v[100:103], v113 offset:2048
s_add_u32 s44, s40, 12288
s_cmp_eq_u32 s3, 0
s_cbranch_scc1 L_sst6
buffer_store_dwordx4 v[152:155], v2, s[20:23], s44 offen offset:0
L_sstr6:
v_mfma_f32_16x16x32_bf16 v[224:227], v[16:19], v[52:55], v[224:227]
ds_read_b64_tr_b16 v[64:65], v116 offset:24576
s_waitcnt lgkmcnt(15)
v_mfma_f32_16x16x32_bf16 v[196:199], v[20:23], v[48:51], v[196:199]
ds_read_b64_tr_b16 v[66:67], v116 offset:25600
v_mfma_f32_16x16x32_bf16 v[228:231], v[20:23], v[52:55], v[228:231]
ds_read_b64_tr_b16 v[68:69], v117 offset:24576
ds_read_b64_tr_b16 v[70:71], v117 offset:25600
s_add_u32 s44, s40, 12288
s_cmp_eq_u32 s3, 0
s_cbranch_scc1 L_sst7
buffer_store_dwordx4 v[156:159], v2, s[20:23], s44 offen offset:1024
L_sstr7:
s_waitcnt lgkmcnt(15)
v_mfma_f32_16x16x32_bf16 v[200:203], v[24:27], v[48:51], v[200:203]
ds_read_b64_tr_b16 v[72:73], v118 offset:24576
v_mfma_f32_16x16x32_bf16 v[232:235], v[24:27], v[52:55], v[232:235]
ds_read_b64_tr_b16 v[74:75], v118 offset:25600
s_waitcnt lgkmcnt(15)
v_mfma_f32_16x16x32_bf16 v[204:207], v[28:31], v[48:51], v[204:207]
ds_read_b64_tr_b16 v[76:77], v119 offset:24576
s_add_u32 s44, s40, 16384
s_cmp_eq_u32 s3, 0
s_cbranch_scc1 L_sst8
buffer_store_dwordx4 v[160:163], v2, s[20:23], s44 offen offset:0
L_sstr8:
v_mfma_f32_16x16x32_bf16 v[236:239], v[28:31], v[52:55], v[236:239]
ds_read_b64_tr_b16 v[78:79], v119 offset:25600
ds_read_b64_tr_b16 v[80:81], v120 offset:24576
s_waitcnt lgkmcnt(15)
v_mfma_f32_16x16x32_bf16 v[208:211], v[32:35], v[48:51], v[208:211]
ds_read_b64_tr_b16 v[82:83], v120 offset:25600
v_mfma_f32_16x16x32_bf16 v[240:243], v[32:35], v[52:55], v[240:243]
ds_read_b64_tr_b16 v[84:85], v121 offset:24576
s_add_u32 s44, s40, 16384
s_cmp_eq_u32 s3, 0
s_cbranch_scc1 L_sst9
buffer_store_dwordx4 v[164:167], v2, s[20:23], s44 offen offset:1024
L_sstr9:
v_mfma_f32_16x16x32_bf16 v[212:215], v[36:39], v[48:51], v[212:215]
ds_read_b64_tr_b16 v[86:87], v121 offset:25600
ds_read_b64_tr_b16 v[88:89], v122 offset:24576
v_mfma_f32_16x16x32_bf16 v[244:247], v[36:39], v[52:55], v[244:247]
ds_read_b64_tr_b16 v[90:91], v122 offset:25600
s_waitcnt lgkmcnt(15)
v_mfma_f32_16x16x32_bf16 v[216:219], v[40:43], v[48:51], v[216:219]
ds_read_b64_tr_b16 v[92:93], v123 offset:24576
s_add_u32 s44, s40, 20480
s_cmp_eq_u32 s3, 0
s_cbranch_scc1 L_sst10
buffer_store_dwordx4 v[168:171], v2, s[20:23], s44 offen offset:0
L_sstr10:
v_mfma_f32_16x16x32_bf16 v[248:251], v[40:43], v[52:55], v[248:251]
ds_read_b64_tr_b16 v[94:95], v123 offset:25600
v_mfma_f32_16x16x32_bf16 v[220:223], v[44:47], v[48:51], v[220:223]
v_mfma_f32_16x16x32_bf16 v[252:255], v[44:47], v[52:55], v[252:255]
s_waitcnt vmcnt(19) lgkmcnt(0)
s_barrier
v_mfma_f32_16x16x32_bf16 v[192:195], v[64:67], v[96:99], v[192:195]
ds_read_b128 v[48:51], v112 offset:32768
ds_read_b128 v[52:55], v112 offset:34816
s_add_u32 m0, s37, 0
s_add_u32 s43, s34, 512
buffer_load_dwordx4 v11, s[4:7], s43 offen lds
v_mov_b32 v152, 0
v_mov_b32 v153, 0
v_mov_b32 v154, 0
v_mov_b32 v155, 0
v_mfma_f32_16x16x32_bf16 v[224:227], v[64:67], v[100:103], v[224:227]
ds_read_b64_tr_b16 v[16:17], v116 offset:32768
v_mfma_f32_16x16x32_bf16 v[196:199], v[68:71], v[96:99], v[196:199]
ds_read_b64_tr_b16 v[18:19], v116 offset:33792
s_add_u32 m0, s37, 1024
s_add_u32 s43, s34, 8704
buffer_load_dwordx4 v12, s[4:7], s43 offen lds
v_mfma_f32_16x16x32_bf16 v[228:231], v[68:71], v[100:103], v[228:231]
ds_read_b64_tr_b16 v[20:21], v117 offset:32768
ds_read_b64_tr_b16 v[22:23], v117 offset:33792
v_mov_b32 v156, 0
v_mov_b32 v157, 0
v_mov_b32 v158, 0
v_mov_b32 v159, 0
v_mfma_f32_16x16x32_bf16 v[200:203], v[72:75], v[96:99], v[200:203]
ds_read_b64_tr_b16 v[24:25], v118 offset:32768
v_mfma_f32_16x16x32_bf16 v[232:235], v[72:75], v[100:103], v[232:235]
ds_read_b64_tr_b16 v[26:27], v118 offset:33792
s_add_u32 m0, s37, 2048
s_add_u32 s43, s34, 16896
buffer_load_dwordx4 v11, s[4:7], s43 offen lds
v_mfma_f32_16x16x32_bf16 v[204:207], v[76:79], v[96:99], v[204:207]
ds_read_b64_tr_b16 v[28:29], v119 offset:32768
v_mov_b32 v160, 0
v_mov_b32 v161, 0
v_mov_b32 v162, 0
v_mov_b32 v163, 0
v_mfma_f32_16x16x32_bf16 v[236:239], v[76:79], v[100:103], v[236:239]
ds_read_b64_tr_b16 v[30:31], v119 offset:33792
ds_read_b64_tr_b16 v[32:33], v120 offset:32768
v_mfma_f32_16x16x32_bf16 v[208:211], v[80:83], v[96:99], v[208:211]
ds_read_b64_tr_b16 v[34:35], v120 offset:33792
s_add_u32 m0, s37, 3072
s_add_u32 s43, s34, 25088
buffer_load_dwordx4 v12, s[4:7], s43 offen lds
v_mfma_f32_16x16x32_bf16 v[240:243], v[80:83], v[100:103], v[240:243]
ds_read_b64_tr_b16 v[36:37], v121 offset:32768
v_mov_b32 v164, 0
v_mov_b32 v165, 0
v_mov_b32 v166, 0
v_mov_b32 v167, 0
v_mfma_f32_16x16x32_bf16 v[212:215], v[84:87], v[96:99], v[212:215]
ds_read_b64_tr_b16 v[38:39], v121 offset:33792
ds_read_b64_tr_b16 v[40:41], v122 offset:32768
s_add_u32 m0, s38, 114688
s_add_u32 s43, s36, 2621440
buffer_load_dwordx4 v13, s[16:19], s43 offen lds
v_mfma_f32_16x16x32_bf16 v[244:247], v[84:87], v[100:103], v[244:247]
ds_read_b64_tr_b16 v[42:43], v122 offset:33792
v_mfma_f32_16x16x32_bf16 v[216:219], v[88:91], v[96:99], v[216:219]
ds_read_b64_tr_b16 v[44:45], v123 offset:32768
v_mov_b32 v168, 0
v_mov_b32 v169, 0
v_mov_b32 v170, 0
v_mov_b32 v171, 0
v_mfma_f32_16x16x32_bf16 v[248:251], v[88:91], v[100:103], v[248:251]
ds_read_b64_tr_b16 v[46:47], v123 offset:33792
s_add_u32 m0, s38, 115712
s_add_u32 s43, s36, 2654208
buffer_load_dwordx4 v13, s[16:19], s43 offen lds
v_mfma_f32_16x16x32_bf16 v[220:223], v[92:95], v[96:99], v[220:223]
v_mfma_f32_16x16x32_bf16 v[252:255], v[92:95], v[100:103], v[252:255]
s_waitcnt lgkmcnt(14)
v_mfma_f32_16x16x32_bf16 v[192:195], v[16:19], v[48:51], v[192:195]
ds_read_b128 v[96:99], v113 offset:32768
ds_read_b128 v[100:103], v113 offset:34816
s_add_u32 s44, s40, 20480
s_cmp_eq_u32 s3, 0
s_cbranch_scc1 L_sst11
buffer_store_dwordx4 v[172:175], v2, s[20:23], s44 offen offset:1024
L_sstr11:
v_mfma_f32_16x16x32_bf16 v[224:227], v[16:19], v[52:55], v[224:227]
ds_read_b64_tr_b16 v[64:65], v116 offset:40960
s_waitcnt lgkmcnt(15)
v_mfma_f32_16x16x32_bf16 v[196:199], v[20:23], v[48:51], v[196:199]
ds_read_b64_tr_b16 v[66:67], v116 offset:41984
v_mfma_f32_16x16x32_bf16 v[228:231], v[20:23], v[52:55], v[228:231]
ds_read_b64_tr_b16 v[68:69], v117 offset:40960
ds_read_b64_tr_b16 v[70:71], v117 offset:41984
s_add_u32 s44, s40, 24576
s_cmp_eq_u32 s3, 0
s_cbranch_scc1 L_sst12
buffer_store_dwordx4 v[176:179], v2, s[20:23], s44 offen offset:0
L_sstr12:
s_waitcnt lgkmcnt(15)
v_mfma_f32_16x16x32_bf16 v[200:203], v[24:27], v[48:51], v[200:203]
ds_read_b64_tr_b16 v[72:73], v118 offset:40960
v_mfma_f32_16x16x32_bf16 v[232:235], v[24:27], v[52:55], v[232:235]
ds_read_b64_tr_b16 v[74:75], v118 offset:41984
s_waitcnt lgkmcnt(15)
v_mfma_f32_16x16x32_bf16 v[204:207], v[28:31], v[48:51], v[204:207]
ds_read_b64_tr_b16 v[76:77], v119 offset:40960
s_add_u32 s44, s40, 24576
s_cmp_eq_u32 s3, 0
s_cbranch_scc1 L_sst13
buffer_store_dwordx4 v[180:183], v2, s[20:23], s44 offen offset:1024
L_sstr13:
v_mfma_f32_16x16x32_bf16 v[236:239], v[28:31], v[52:55], v[236:239]
ds_read_b64_tr_b16 v[78:79], v119 offset:41984
ds_read_b64_tr_b16 v[80:81], v120 offset:40960
s_waitcnt lgkmcnt(15)
v_mfma_f32_16x16x32_bf16 v[208:211], v[32:35], v[48:51], v[208:211]
ds_read_b64_tr_b16 v[82:83], v120 offset:41984
v_mfma_f32_16x16x32_bf16 v[240:243], v[32:35], v[52:55], v[240:243]
ds_read_b64_tr_b16 v[84:85], v121 offset:40960
s_add_u32 s44, s40, 28672
s_cmp_eq_u32 s3, 0
s_cbranch_scc1 L_sst14
buffer_store_dwordx4 v[184:187], v2, s[20:23], s44 offen offset:0
L_sstr14:
v_mfma_f32_16x16x32_bf16 v[212:215], v[36:39], v[48:51], v[212:215]
ds_read_b64_tr_b16 v[86:87], v121 offset:41984
ds_read_b64_tr_b16 v[88:89], v122 offset:40960
v_mfma_f32_16x16x32_bf16 v[244:247], v[36:39], v[52:55], v[244:247]
ds_read_b64_tr_b16 v[90:91], v122 offset:41984
s_waitcnt lgkmcnt(15)
v_mfma_f32_16x16x32_bf16 v[216:219], v[40:43], v[48:51], v[216:219]
ds_read_b64_tr_b16 v[92:93], v123 offset:40960
s_add_u32 s44, s40, 28672
s_cmp_eq_u32 s3, 0
s_cbranch_scc1 L_sst15
buffer_store_dwordx4 v[188:191], v2, s[20:23], s44 offen offset:1024
L_sstr15:
v_mfma_f32_16x16x32_bf16 v[248:251], v[40:43], v[52:55], v[248:251]
ds_read_b64_tr_b16 v[94:95], v123 offset:41984
v_mfma_f32_16x16x32_bf16 v[220:223], v[44:47], v[48:51], v[220:223]
v_mfma_f32_16x16x32_bf16 v[252:255], v[44:47], v[52:55], v[252:255]
s_waitcnt vmcnt(18) lgkmcnt(0)
s_barrier
v_mfma_f32_16x16x32_bf16 v[192:195], v[64:67], v[96:99], v[192:195]
ds_read_b128 v[48:51], v114 offset:0
ds_read_b128 v[52:55], v114 offset:2048
s_add_u32 m0, s37, 32768
s_add_u32 s43, s34, 640
buffer_load_dwordx4 v11, s[4:7], s43 offen lds
v_mov_b32 v172, 0
v_mov_b32 v173, 0
v_mov_b32 v174, 0
v_mov_b32 v175, 0
v_mfma_f32_16x16x32_bf16 v[224:227], v[64:67], v[100:103], v[224:227]
ds_read_b64_tr_b16 v[16:17], v116 offset:49152
v_mfma_f32_16x16x32_bf16 v[196:199], v[68:71], v[96:99], v[196:199]
ds_read_b64_tr_b16 v[18:19], v116 offset:50176
v_mfma_f32_16x16x32_bf16 v[228:231], v[68:71], v[100:103], v[228:231]
ds_read_b64_tr_b16 v[20:21], v117 offset:49152
ds_read_b64_tr_b16 v[22:23], v117 offset:50176
v_mov_b32 v176, 0
v_mov_b32 v177, 0
v_mov_b32 v178, 0
v_mov_b32 v179, 0
v_mfma_f32_16x16x32_bf16 v[200:203], v[72:75], v[96:99], v[200:203]
ds_read_b64_tr_b16 v[24:25], v118 offset:49152
v_mfma_f32_16x16x32_bf16 v[232:235], v[72:75], v[100:103], v[232:235]
ds_read_b64_tr_b16 v[26:27], v118 offset:50176
s_add_u32 m0, s37, 33792
s_add_u32 s43, s34, 8832
buffer_load_dwordx4 v12, s[4:7], s43 offen lds
v_mfma_f32_16x16x32_bf16 v[204:207], v[76:79], v[96:99], v[204:207]
ds_read_b64_tr_b16 v[28:29], v119 offset:49152
v_mov_b32 v180, 0
v_mov_b32 v181, 0
v_mov_b32 v182, 0
v_mov_b32 v183, 0
v_mfma_f32_16x16x32_bf16 v[236:239], v[76:79], v[100:103], v[236:239]
ds_read_b64_tr_b16 v[30:31], v119 offset:50176
ds_read_b64_tr_b16 v[32:33], v120 offset:49152
v_mfma_f32_16x16x32_bf16 v[208:211], v[80:83], v[96:99], v[208:211]
ds_read_b64_tr_b16 v[34:35], v120 offset:50176
v_mfma_f32_16x16x32_bf16 v[240:243], v[80:83], v[100:103], v[240:243]
ds_read_b64_tr_b16 v[36:37], v121 offset:49152
v_mov_b32 v184, 0
v_mov_b32 v185, 0
v_mov_b32 v186, 0
v_mov_b32 v187, 0
v_mfma_f32_16x16x32_bf16 v[212:215], v[84:87], v[96:99], v[212:215]
ds_read_b64_tr_b16 v[38:39], v121 offset:50176
ds_read_b64_tr_b16 v[40:41], v122 offset:49152
s_add_u32 m0, s37, 34816
s_add_u32 s43, s34, 17024
buffer_load_dwordx4 v11, s[4:7], s43 offen lds
v_mfma_f32_16x16x32_bf16 v[244:247], v[84:87], v[100:103], v[244:247]
ds_read_b64_tr_b16 v[42:43], v122 offset:50176
v_mfma_f32_16x16x32_bf16 v[216:219], v[88:91], v[96:99], v[216:219]
ds_read_b64_tr_b16 v[44:45], v123 offset:49152
v_mov_b32 v188, 0
v_mov_b32 v189, 0
v_mov_b32 v190, 0
v_mov_b32 v191, 0
v_mfma_f32_16x16x32_bf16 v[248:251], v[88:91], v[100:103], v[248:251]
ds_read_b64_tr_b16 v[46:47], v123 offset:50176
v_mfma_f32_16x16x32_bf16 v[220:223], v[92:95], v[96:99], v[220:223]
v_mfma_f32_16x16x32_bf16 v[252:255], v[92:95], v[100:103], v[252:255]
s_waitcnt lgkmcnt(14)
v_mfma_f32_16x16x32_bf16 v[192:195], v[16:19], v[48:51], v[192:195]
ds_read_b128 v[96:99], v115 offset:0
ds_read_b128 v[100:103], v115 offset:2048
s_add_u32 m0, s37, 35840
s_add_u32 s43, s34, 25216
buffer_load_dwordx4 v12, s[4:7], s43 offen lds
v_mfma_f32_16x16x32_bf16 v[224:227], v[16:19], v[52:55], v[224:227]
ds_read_b64_tr_b16 v[64:65], v116 offset:57344
s_waitcnt lgkmcnt(15)
v_mfma_f32_16x16x32_bf16 v[196:199], v[20:23], v[48:51], v[196:199]
ds_read_b64_tr_b16 v[66:67], v116 offset:58368
v_mfma_f32_16x16x32_bf16 v[228:231], v[20:23], v[52:55], v[228:231]
ds_read_b64_tr_b16 v[68:69], v117 offset:57344
ds_read_b64_tr_b16 v[70:71], v117 offset:58368
s_waitcnt lgkmcnt(15)
v_mfma_f32_16x16x32_bf16 v[200:203], v[24:27], v[48:51], v[200:203]
ds_read_b64_tr_b16 v[72:73], v118 offset:57344
v_mfma_f32_16x16x32_bf16 v[232:235], v[24:27], v[52:55], v[232:235]
ds_read_b64_tr_b16 v[74:75], v118 offset:58368
s_add_u32 m0, s38, 131072
s_add_u32 s43, s36, 3145728
buffer_load_dwordx4 v13, s[16:19], s43 offen lds
s_waitcnt lgkmcnt(15)
v_mfma_f32_16x16x32_bf16 v[204:207], v[28:31], v[48:51], v[204:207]
ds_read_b64_tr_b16 v[76:77], v119 offset:57344
v_mfma_f32_16x16x32_bf16 v[236:239], v[28:31], v[52:55], v[236:239]
ds_read_b64_tr_b16 v[78:79], v119 offset:58368
ds_read_b64_tr_b16 v[80:81], v120 offset:57344
s_waitcnt lgkmcnt(15)
v_mfma_f32_16x16x32_bf16 v[208:211], v[32:35], v[48:51], v[208:211]
ds_read_b64_tr_b16 v[82:83], v120 offset:58368
v_mfma_f32_16x16x32_bf16 v[240:243], v[32:35], v[52:55], v[240:243]
ds_read_b64_tr_b16 v[84:85], v121 offset:57344
v_mfma_f32_16x16x32_bf16 v[212:215], v[36:39], v[48:51], v[212:215]
ds_read_b64_tr_b16 v[86:87], v121 offset:58368
ds_read_b64_tr_b16 v[88:89], v122 offset:57344
s_add_u32 m0, s38, 132096
s_add_u32 s43, s36, 3178496
buffer_load_dwordx4 v13, s[16:19], s43 offen lds
v_mfma_f32_16x16x32_bf16 v[244:247], v[36:39], v[52:55], v[244:247]
ds_read_b64_tr_b16 v[90:91], v122 offset:58368
s_waitcnt lgkmcnt(15)
v_mfma_f32_16x16x32_bf16 v[216:219], v[40:43], v[48:51], v[216:219]
ds_read_b64_tr_b16 v[92:93], v123 offset:57344
v_mfma_f32_16x16x32_bf16 v[248:251], v[40:43], v[52:55], v[248:251]
ds_read_b64_tr_b16 v[94:95], v123 offset:58368
v_mfma_f32_16x16x32_bf16 v[220:223], v[44:47], v[48:51], v[220:223]
v_mfma_f32_16x16x32_bf16 v[252:255], v[44:47], v[52:55], v[252:255]
s_waitcnt vmcnt(6) lgkmcnt(0)
s_barrier
s_cmp_lg_u32 s32, 0
s_cbranch_scc1 L_pke
v_mov_b32 v6, s73
v_mov_b32 v7, s39
s_mov_b64 exec, 1
global_atomic_add v6, v7, s[28:29]
s_mov_b64 exec, -1
L_pke:
v_mfma_f32_16x16x32_bf16 v[192:195], v[64:67], v[96:99], v[192:195]
ds_read_b128 v[48:51], v112 offset:0
ds_read_b128 v[52:55], v112 offset:2048
s_add_u32 m0, s37, 65536
s_add_u32 s43, s34, 768
buffer_load_dwordx4 v11, s[4:7], s43 offen lds
v_mfma_f32_16x16x32_bf16 v[224:227], v[64:67], v[100:103], v[224:227]
ds_read_b64_tr_b16 v[16:17], v116 offset:0
v_mfma_f32_16x16x32_bf16 v[196:199], v[68:71], v[96:99], v[196:199]
ds_read_b64_tr_b16 v[18:19], v116 offset:1024
v_mfma_f32_16x16x32_bf16 v[228:231], v[68:71], v[100:103], v[228:231]
ds_read_b64_tr_b16 v[20:21], v117 offset:0
ds_read_b64_tr_b16 v[22:23], v117 offset:1024
v_mfma_f32_16x16x32_bf16 v[200:203], v[72:75], v[96:99], v[200:203]
ds_read_b64_tr_b16 v[24:25], v118 offset:0
v_mfma_f32_16x16x32_bf16 v[232:235], v[72:75], v[100:103], v[232:235]
ds_read_b64_tr_b16 v[26:27], v118 offset:1024
s_add_u32 m0, s37, 66560
s_add_u32 s43, s34, 8960
buffer_load_dwordx4 v12, s[4:7], s43 offen lds
v_mfma_f32_16x16x32_bf16 v[204:207], v[76:79], v[96:99], v[204:207]
ds_read_b64_tr_b16 v[28:29], v119 offset:0
v_mfma_f32_16x16x32_bf16 v[236:239], v[76:79], v[100:103], v[236:239]
ds_read_b64_tr_b16 v[30:31], v119 offset:1024
ds_read_b64_tr_b16 v[32:33], v120 offset:0
v_mfma_f32_16x16x32_bf16 v[208:211], v[80:83], v[96:99], v[208:211]
ds_read_b64_tr_b16 v[34:35], v120 offset:1024
v_mfma_f32_16x16x32_bf16 v[240:243], v[80:83], v[100:103], v[240:243]
ds_read_b64_tr_b16 v[36:37], v121 offset:0
v_mfma_f32_16x16x32_bf16 v[212:215], v[84:87], v[96:99], v[212:215]
ds_read_b64_tr_b16 v[38:39], v121 offset:1024
ds_read_b64_tr_b16 v[40:41], v122 offset:0
s_add_u32 m0, s37, 67584
s_add_u32 s43, s34, 17152
buffer_load_dwordx4 v11, s[4:7], s43 offen lds
v_mfma_f32_16x16x32_bf16 v[244:247], v[84:87], v[100:103], v[244:247]
ds_read_b64_tr_b16 v[42:43], v122 offset:1024
v_mfma_f32_16x16x32_bf16 v[216:219], v[88:91], v[96:99], v[216:219]
ds_read_b64_tr_b16 v[44:45], v123 offset:0
v_mfma_f32_16x16x32_bf16 v[248:251], v[88:91], v[100:103], v[248:251]
ds_read_b64_tr_b16 v[46:47], v123 offset:1024
v_mfma_f32_16x16x32_bf16 v[220:223], v[92:95], v[96:99], v[220:223]
v_mfma_f32_16x16x32_bf16 v[252:255], v[92:95], v[100:103], v[252:255]
s_waitcnt lgkmcnt(14)
v_mfma_f32_16x16x32_bf16 v[192:195], v[16:19], v[48:51], v[192:195]
ds_read_b128 v[96:99], v113 offset:0
ds_read_b128 v[100:103], v113 offset:2048
s_add_u32 m0, s37, 68608
s_add_u32 s43, s34, 25344
buffer_load_dwordx4 v12, s[4:7], s43 offen lds
v_mfma_f32_16x16x32_bf16 v[224:227], v[16:19], v[52:55], v[224:227]
ds_read_b64_tr_b16 v[64:65], v116 offset:8192
s_waitcnt lgkmcnt(15)
v_mfma_f32_16x16x32_bf16 v[196:199], v[20:23], v[48:51], v[196:199]
ds_read_b64_tr_b16 v[66:67], v116 offset:9216
v_mfma_f32_16x16x32_bf16 v[228:231], v[20:23], v[52:55], v[228:231]
ds_read_b64_tr_b16 v[68:69], v117 offset:8192
ds_read_b64_tr_b16 v[70:71], v117 offset:9216
s_waitcnt lgkmcnt(15)
v_mfma_f32_16x16x32_bf16 v[200:203], v[24:27], v[48:51], v[200:203]
ds_read_b64_tr_b16 v[72:73], v118 offset:8192
v_mfma_f32_16x16x32_bf16 v[232:235], v[24:27], v[52:55], v[232:235]
ds_read_b64_tr_b16 v[74:75], v118 offset:9216
s_add_u32 m0, s38, 147456
s_add_u32 s43, s36, 3670016
buffer_load_dwordx4 v13, s[16:19], s43 offen lds
s_waitcnt lgkmcnt(15)
v_mfma_f32_16x16x32_bf16 v[204:207], v[28:31], v[48:51], v[204:207]
ds_read_b64_tr_b16 v[76:77], v119 offset:8192
v_mfma_f32_16x16x32_bf16 v[236:239], v[28:31], v[52:55], v[236:239]
ds_read_b64_tr_b16 v[78:79], v119 offset:9216
ds_read_b64_tr_b16 v[80:81], v120 offset:8192
s_waitcnt lgkmcnt(15)
v_mfma_f32_16x16x32_bf16 v[208:211], v[32:35], v[48:51], v[208:211]
ds_read_b64_tr_b16 v[82:83], v120 offset:9216
v_mfma_f32_16x16x32_bf16 v[240:243], v[32:35], v[52:55], v[240:243]
ds_read_b64_tr_b16 v[84:85], v121 offset:8192
v_mfma_f32_16x16x32_bf16 v[212:215], v[36:39], v[48:51], v[212:215]
ds_read_b64_tr_b16 v[86:87], v121 offset:9216
ds_read_b64_tr_b16 v[88:89], v122 offset:8192
s_add_u32 m0, s38, 148480
s_add_u32 s43, s36, 3702784
buffer_load_dwordx4 v13, s[16:19], s43 offen lds
v_mfma_f32_16x16x32_bf16 v[244:247], v[36:39], v[52:55], v[244:247]
ds_read_b64_tr_b16 v[90:91], v122 offset:9216
s_waitcnt lgkmcnt(15)
v_mfma_f32_16x16x32_bf16 v[216:219], v[40:43], v[48:51], v[216:219]
ds_read_b64_tr_b16 v[92:93], v123 offset:8192
v_mfma_f32_16x16x32_bf16 v[248:251], v[40:43], v[52:55], v[248:251]
ds_read_b64_tr_b16 v[94:95], v123 offset:9216
v_mfma_f32_16x16x32_bf16 v[220:223], v[44:47], v[48:51], v[220:223]
v_mfma_f32_16x16x32_bf16 v[252:255], v[44:47], v[52:55], v[252:255]
s_waitcnt vmcnt(8) lgkmcnt(0)
s_barrier
v_mfma_f32_16x16x32_bf16 v[192:195], v[64:67], v[96:99], v[192:195]
ds_read_b128 v[48:51], v112 offset:32768
ds_read_b128 v[52:55], v112 offset:34816
s_add_u32 m0, s37, 0
s_add_u32 s43, s34, 896
buffer_load_dwordx4 v11, s[4:7], s43 offen lds
v_mfma_f32_16x16x32_bf16 v[224:227], v[64:67], v[100:103], v[224:227]
ds_read_b64_tr_b16 v[16:17], v116 offset:16384
v_mfma_f32_16x16x32_bf16 v[196:199], v[68:71], v[96:99], v[196:199]
ds_read_b64_tr_b16 v[18:19], v116 offset:17408
v_mfma_f32_16x16x32_bf16 v[228:231], v[68:71], v[100:103], v[228:231]
ds_read_b64_tr_b16 v[20:21], v117 offset:16384
ds_read_b64_tr_b16 v[22:23], v117 offset:17408
v_mfma_f32_16x16x32_bf16 v[200:203], v[72:75], v[96:99], v[200:203]
ds_read_b64_tr_b16 v[24:25], v118 offset:16384
v_mfma_f32_16x16x32_bf16 v[232:235], v[72:75], v[100:103], v[232:235]
ds_read_b64_tr_b16 v[26:27], v118 offset:17408
v_mfma_f32_16x16x32_bf16 v[204:207], v[76:79], v[96:99], v[204:207]
ds_read_b64_tr_b16 v[28:29], v119 offset:16384
v_mfma_f32_16x16x32_bf16 v[236:239], v[76:79], v[100:103], v[236:239]
ds_read_b64_tr_b16 v[30:31], v119 offset:17408
ds_read_b64_tr_b16 v[32:33], v120 offset:16384
v_mfma_f32_16x16x32_bf16 v[208:211], v[80:83], v[96:99], v[208:211]
ds_read_b64_tr_b16 v[34:35], v120 offset:17408
s_add_u32 m0, s37, 1024
s_add_u32 s43, s34, 9088
buffer_load_dwordx4 v12, s[4:7], s43 offen lds
v_mfma_f32_16x16x32_bf16 v[240:243], v[80:83], v[100:103], v[240:243]
ds_read_b64_tr_b16 v[36:37], v121 offset:16384
v_mfma_f32_16x16x32_bf16 v[212:215], v[84:87], v[96:99], v[212:215]
ds_read_b64_tr_b16 v[38:39], v121 offset:17408
ds_read_b64_tr_b16 v[40:41], v122 offset:16384
v_mfma_f32_16x16x32_bf16 v[244:247], v[84:87], v[100:103], v[244:247]
ds_read_b64_tr_b16 v[42:43], v122 offset:17408
v_mfma_f32_16x16x32_bf16 v[216:219], v[88:91], v[96:99], v[216:219]
ds_read_b64_tr_b16 v[44:45], v123 offset:16384
v_mfma_f32_16x16x32_bf16 v[248:251], v[88:91], v[100:103], v[248:251]
ds_read_b64_tr_b16 v[46:47], v123 offset:17408
v_mfma_f32_16x16x32_bf16 v[220:223], v[92:95], v[96:99], v[220:223]
v_mfma_f32_16x16x32_bf16 v[252:255], v[92:95], v[100:103], v[252:255]
s_waitcnt lgkmcnt(14)
v_mfma_f32_16x16x32_bf16 v[192:195], v[16:19], v[48:51], v[192:195]
ds_read_b128 v[96:99], v113 offset:32768
ds_read_b128 v[100:103], v113 offset:34816
s_add_u32 m0, s37, 2048
s_add_u32 s43, s34, 17280
buffer_load_dwordx4 v11, s[4:7], s43 offen lds
v_mfma_f32_16x16x32_bf16 v[224:227], v[16:19], v[52:55], v[224:227]
ds_read_b64_tr_b16 v[64:65], v116 offset:24576
s_waitcnt lgkmcnt(15)
v_mfma_f32_16x16x32_bf16 v[196:199], v[20:23], v[48:51], v[196:199]
ds_read_b64_tr_b16 v[66:67], v116 offset:25600
v_mfma_f32_16x16x32_bf16 v[228:231], v[20:23], v[52:55], v[228:231]
ds_read_b64_tr_b16 v[68:69], v117 offset:24576
ds_read_b64_tr_b16 v[70:71], v117 offset:25600
s_waitcnt lgkmcnt(15)
v_mfma_f32_16x16x32_bf16 v[200:203], v[24:27], v[48:51], v[200:203]
ds_read_b64_tr_b16 v[72:73], v118 offset:24576
v_mfma_f32_16x16x32_bf16 v[232:235], v[24:27], v[52:55], v[232:235]
ds_read_b64_tr_b16 v[74:75], v118 offset:25600
s_waitcnt lgkmcnt(15)
v_mfma_f32_16x16x32_bf16 v[204:207], v[28:31], v[48:51], v[204:207]
ds_read_b64_tr_b16 v[76:77], v119 offset:24576
v_mfma_f32_16x16x32_bf16 v[236:239], v[28:31], v[52:55], v[236:239]
ds_read_b64_tr_b16 v[78:79], v119 offset:25600
ds_read_b64_tr_b16 v[80:81], v120 offset:24576
s_waitcnt lgkmcnt(15)
v_mfma_f32_16x16x32_bf16 v[208:211], v[32:35], v[48:51], v[208:211]
ds_read_b64_tr_b16 v[82:83], v120 offset:25600
s_add_u32 m0, s37, 3072
s_add_u32 s43, s34, 25472
buffer_load_dwordx4 v12, s[4:7], s43 offen lds
v_mfma_f32_16x16x32_bf16 v[240:243], v[32:35], v[52:55], v[240:243]
ds_read_b64_tr_b16 v[84:85], v121 offset:24576
v_mfma_f32_16x16x32_bf16 v[212:215], v[36:39], v[48:51], v[212:215]
ds_read_b64_tr_b16 v[86:87], v121 offset:25600
ds_read_b64_tr_b16 v[88:89], v122 offset:24576
v_mfma_f32_16x16x32_bf16 v[244:247], v[36:39], v[52:55], v[244:247]
ds_read_b64_tr_b16 v[90:91], v122 offset:25600
s_waitcnt lgkmcnt(15)
v_mfma_f32_16x16x32_bf16 v[216:219], v[40:43], v[48:51], v[216:219]
ds_read_b64_tr_b16 v[92:93], v123 offset:24576
v_mfma_f32_16x16x32_bf16 v[248:251], v[40:43], v[52:55], v[248:251]
ds_read_b64_tr_b16 v[94:95], v123 offset:25600
v_mfma_f32_16x16x32_bf16 v[220:223], v[44:47], v[48:51], v[220:223]
v_mfma_f32_16x16x32_bf16 v[252:255], v[44:47], v[52:55], v[252:255]
s_waitcnt vmcnt(6) lgkmcnt(0)
s_barrier
v_mfma_f32_16x16x32_bf16 v[192:195], v[64:67], v[96:99], v[192:195]
ds_read_b128 v[48:51], v114 offset:0
ds_read_b128 v[52:55], v114 offset:2048
v_mfma_f32_16x16x32_bf16 v[224:227], v[64:67], v[100:103], v[224:227]
ds_read_b64_tr_b16 v[16:17], v116 offset:32768
v_mfma_f32_16x16x32_bf16 v[196:199], v[68:71], v[96:99], v[196:199]
ds_read_b64_tr_b16 v[18:19], v116 offset:33792
v_mfma_f32_16x16x32_bf16 v[228:231], v[68:71], v[100:103], v[228:231]
ds_read_b64_tr_b16 v[20:21], v117 offset:32768
ds_read_b64_tr_b16 v[22:23], v117 offset:33792
v_mfma_f32_16x16x32_bf16 v[200:203], v[72:75], v[96:99], v[200:203]
ds_read_b64_tr_b16 v[24:25], v118 offset:32768
v_mfma_f32_16x16x32_bf16 v[232:235], v[72:75], v[100:103], v[232:235]
ds_read_b64_tr_b16 v[26:27], v118 offset:33792
v_mfma_f32_16x16x32_bf16 v[204:207], v[76:79], v[96:99], v[204:207]
ds_read_b64_tr_b16 v[28:29], v119 offset:32768
v_mfma_f32_16x16x32_bf16 v[236:239], v[76:79], v[100:103], v[236:239]
ds_read_b64_tr_b16 v[30:31], v119 offset:33792
ds_read_b64_tr_b16 v[32:33], v120 offset:32768
v_mfma_f32_16x16x32_bf16 v[208:211], v[80:83], v[96:99], v[208:211]
ds_read_b64_tr_b16 v[34:35], v120 offset:33792
v_mfma_f32_16x16x32_bf16 v[240:243], v[80:83], v[100:103], v[240:243]
ds_read_b64_tr_b16 v[36:37], v121 offset:32768
v_mfma_f32_16x16x32_bf16 v[212:215], v[84:87], v[96:99], v[212:215]
ds_read_b64_tr_b16 v[38:39], v121 offset:33792
ds_read_b64_tr_b16 v[40:41], v122 offset:32768
v_mfma_f32_16x16x32_bf16 v[244:247], v[84:87], v[100:103], v[244:247]
ds_read_b64_tr_b16 v[42:43], v122 offset:33792
v_mfma_f32_16x16x32_bf16 v[216:219], v[88:91], v[96:99], v[216:219]
ds_read_b64_tr_b16 v[44:45], v123 offset:32768
v_mfma_f32_16x16x32_bf16 v[248:251], v[88:91], v[100:103], v[248:251]
ds_read_b64_tr_b16 v[46:47], v123 offset:33792
v_mfma_f32_16x16x32_bf16 v[220:223], v[92:95], v[96:99], v[220:223]
v_mfma_f32_16x16x32_bf16 v[252:255], v[92:95], v[100:103], v[252:255]
s_waitcnt lgkmcnt(14)
v_mfma_f32_16x16x32_bf16 v[192:195], v[16:19], v[48:51], v[192:195]
ds_read_b128 v[96:99], v115 offset:0
ds_read_b128 v[100:103], v115 offset:2048
v_mfma_f32_16x16x32_bf16 v[224:227], v[16:19], v[52:55], v[224:227]
ds_read_b64_tr_b16 v[64:65], v116 offset:40960
s_waitcnt lgkmcnt(15)
v_mfma_f32_16x16x32_bf16 v[196:199], v[20:23], v[48:51], v[196:199]
ds_read_b64_tr_b16 v[66:67], v116 offset:41984
v_mfma_f32_16x16x32_bf16 v[228:231], v[20:23], v[52:55], v[228:231]
ds_read_b64_tr_b16 v[68:69], v117 offset:40960
ds_read_b64_tr_b16 v[70:71], v117 offset:41984
s_waitcnt lgkmcnt(15)
v_mfma_f32_16x16x32_bf16 v[200:203], v[24:27], v[48:51], v[200:203]
ds_read_b64_tr_b16 v[72:73], v118 offset:40960
v_mfma_f32_16x16x32_bf16 v[232:235], v[24:27], v[52:55], v[232:235]
ds_read_b64_tr_b16 v[74:75], v118 offset:41984
s_waitcnt lgkmcnt(15)
v_mfma_f32_16x16x32_bf16 v[204:207], v[28:31], v[48:51], v[204:207]
ds_read_b64_tr_b16 v[76:77], v119 offset:40960
v_mfma_f32_16x16x32_bf16 v[236:239], v[28:31], v[52:55], v[236:239]
ds_read_b64_tr_b16 v[78:79], v119 offset:41984
ds_read_b64_tr_b16 v[80:81], v120 offset:40960
s_waitcnt lgkmcnt(15)
v_mfma_f32_16x16x32_bf16 v[208:211], v[32:35], v[48:51], v[208:211]
ds_read_b64_tr_b16 v[82:83], v120 offset:41984
v_mfma_f32_16x16x32_bf16 v[240:243], v[32:35], v[52:55], v[240:243]
ds_read_b64_tr_b16 v[84:85], v121 offset:40960
v_mfma_f32_16x16x32_bf16 v[212:215], v[36:39], v[48:51], v[212:215]
ds_read_b64_tr_b16 v[86:87], v121 offset:41984
ds_read_b64_tr_b16 v[88:89], v122 offset:40960
v_mfma_f32_16x16x32_bf16 v[244:247], v[36:39], v[52:55], v[244:247]
ds_read_b64_tr_b16 v[90:91], v122 offset:41984
s_waitcnt lgkmcnt(15)
v_mfma_f32_16x16x32_bf16 v[216:219], v[40:43], v[48:51], v[216:219]
ds_read_b64_tr_b16 v[92:93], v123 offset:40960
v_mfma_f32_16x16x32_bf16 v[248:251], v[40:43], v[52:55], v[248:251]
ds_read_b64_tr_b16 v[94:95], v123 offset:41984
v_mfma_f32_16x16x32_bf16 v[220:223], v[44:47], v[48:51], v[220:223]
v_mfma_f32_16x16x32_bf16 v[252:255], v[44:47], v[52:55], v[252:255]
s_waitcnt vmcnt(0) lgkmcnt(0)
s_barrier
v_mfma_f32_16x16x32_bf16 v[192:195], v[64:67], v[96:99], v[192:195]
ds_read_b128 v[48:51], v112 offset:0
ds_read_b128 v[52:55], v112 offset:2048
v_mfma_f32_16x16x32_bf16 v[224:227], v[64:67], v[100:103], v[224:227]
ds_read_b64_tr_b16 v[16:17], v116 offset:49152
v_mfma_f32_16x16x32_bf16 v[196:199], v[68:71], v[96:99], v[196:199]
ds_read_b64_tr_b16 v[18:19], v116 offset:50176
v_mfma_f32_16x16x32_bf16 v[228:231], v[68:71], v[100:103], v[228:231]
ds_read_b64_tr_b16 v[20:21], v117 offset:49152
ds_read_b64_tr_b16 v[22:23], v117 offset:50176
v_mfma_f32_16x16x32_bf16 v[200:203], v[72:75], v[96:99], v[200:203]
ds_read_b64_tr_b16 v[24:25], v118 offset:49152
v_mfma_f32_16x16x32_bf16 v[232:235], v[72:75], v[100:103], v[232:235]
ds_read_b64_tr_b16 v[26:27], v118 offset:50176
v_mfma_f32_16x16x32_bf16 v[204:207], v[76:79], v[96:99], v[204:207]
ds_read_b64_tr_b16 v[28:29], v119 offset:49152
v_mfma_f32_16x16x32_bf16 v[236:239], v[76:79], v[100:103], v[236:239]
ds_read_b64_tr_b16 v[30:31], v119 offset:50176
ds_read_b64_tr_b16 v[32:33], v120 offset:49152
v_mfma_f32_16x16x32_bf16 v[208:211], v[80:83], v[96:99], v[208:211]
ds_read_b64_tr_b16 v[34:35], v120 offset:50176
v_mfma_f32_16x16x32_bf16 v[240:243], v[80:83], v[100:103], v[240:243]
ds_read_b64_tr_b16 v[36:37], v121 offset:49152
v_mfma_f32_16x16x32_bf16 v[212:215], v[84:87], v[96:99], v[212:215]
ds_read_b64_tr_b16 v[38:39], v121 offset:50176
ds_read_b64_tr_b16 v[40:41], v122 offset:49152
v_mfma_f32_16x16x32_bf16 v[244:247], v[84:87], v[100:103], v[244:247]
ds_read_b64_tr_b16 v[42:43], v122 offset:50176
v_mfma_f32_16x16x32_bf16 v[216:219], v[88:91], v[96:99], v[216:219]
ds_read_b64_tr_b16 v[44:45], v123 offset:49152
v_mfma_f32_16x16x32_bf16 v[248:251], v[88:91], v[100:103], v[248:251]
ds_read_b64_tr_b16 v[46:47], v123 offset:50176
v_mfma_f32_16x16x32_bf16 v[220:223], v[92:95], v[96:99], v[220:223]
v_mfma_f32_16x16x32_bf16 v[252:255], v[92:95], v[100:103], v[252:255]
s_waitcnt lgkmcnt(14)
v_mfma_f32_16x16x32_bf16 v[192:195], v[16:19], v[48:51], v[192:195]
ds_read_b128 v[96:99], v113 offset:0
ds_read_b128 v[100:103], v113 offset:2048
v_mfma_f32_16x16x32_bf16 v[224:227], v[16:19], v[52:55], v[224:227]
ds_read_b64_tr_b16 v[64:65], v116 offset:57344
s_waitcnt lgkmcnt(15)
v_mfma_f32_16x16x32_bf16 v[196:199], v[20:23], v[48:51], v[196:199]
ds_read_b64_tr_b16 v[66:67], v116 offset:58368
v_mfma_f32_16x16x32_bf16 v[228:231], v[20:23], v[52:55], v[228:231]
ds_read_b64_tr_b16 v[68:69], v117 offset:57344
ds_read_b64_tr_b16 v[70:71], v117 offset:58368
s_waitcnt lgkmcnt(15)
v_mfma_f32_16x16x32_bf16 v[200:203], v[24:27], v[48:51], v[200:203]
ds_read_b64_tr_b16 v[72:73], v118 offset:57344
v_mfma_f32_16x16x32_bf16 v[232:235], v[24:27], v[52:55], v[232:235]
ds_read_b64_tr_b16 v[74:75], v118 offset:58368
s_waitcnt lgkmcnt(15)
v_mfma_f32_16x16x32_bf16 v[204:207], v[28:31], v[48:51], v[204:207]
ds_read_b64_tr_b16 v[76:77], v119 offset:57344
v_mfma_f32_16x16x32_bf16 v[236:239], v[28:31], v[52:55], v[236:239]
ds_read_b64_tr_b16 v[78:79], v119 offset:58368
ds_read_b64_tr_b16 v[80:81], v120 offset:57344
s_waitcnt lgkmcnt(15)
v_mfma_f32_16x16x32_bf16 v[208:211], v[32:35], v[48:51], v[208:211]
ds_read_b64_tr_b16 v[82:83], v120 offset:58368
v_mfma_f32_16x16x32_bf16 v[240:243], v[32:35], v[52:55], v[240:243]
ds_read_b64_tr_b16 v[84:85], v121 offset:57344
v_mfma_f32_16x16x32_bf16 v[212:215], v[36:39], v[48:51], v[212:215]
ds_read_b64_tr_b16 v[86:87], v121 offset:58368
ds_read_b64_tr_b16 v[88:89], v122 offset:57344
v_mfma_f32_16x16x32_bf16 v[244:247], v[36:39], v[52:55], v[244:247]
ds_read_b64_tr_b16 v[90:91], v122 offset:58368
s_waitcnt lgkmcnt(15)
v_mfma_f32_16x16x32_bf16 v[216:219], v[40:43], v[48:51], v[216:219]
ds_read_b64_tr_b16 v[92:93], v123 offset:57344
v_mfma_f32_16x16x32_bf16 v[248:251], v[40:43], v[52:55], v[248:251]
ds_read_b64_tr_b16 v[94:95], v123 offset:58368
v_mfma_f32_16x16x32_bf16 v[220:223], v[44:47], v[48:51], v[220:223]
v_mfma_f32_16x16x32_bf16 v[252:255], v[44:47], v[52:55], v[252:255]
s_branch L_qjoinA
L_qlateA:
s_waitcnt vmcnt(8) lgkmcnt(0)
s_barrier
v_mfma_f32_16x16x32_bf16 v[128:131], v[96:99], v[64:67], v[128:131]
ds_read_b128 v[48:51], v114 offset:0
v_mfma_f32_16x16x32_bf16 v[132:135], v[100:103], v[64:67], v[132:135]
ds_read_b128 v[52:55], v114 offset:2048
v_mfma_f32_16x16x32_bf16 v[136:139], v[104:107], v[64:67], v[136:139]
ds_read_b64_tr_b16 v[16:17], v116 offset:0
s_add_u32 m0, s37, 32768
s_add_u32 s43, s34, 256
buffer_load_dwordx4 v11, s[4:7], s43 offen lds
v_mfma_f32_16x16x32_bf16 v[140:143], v[108:111], v[64:67], v[140:143]
ds_read_b64_tr_b16 v[18:19], v116 offset:1024
v_mfma_f32_16x16x32_bf16 v[144:147], v[96:99], v[68:71], v[144:147]
ds_read_b64_tr_b16 v[20:21], v117 offset:0
v_mfma_f32_16x16x32_bf16 v[148:151], v[100:103], v[68:71], v[148:151]
ds_read_b64_tr_b16 v[22:23], v117 offset:1024
v_mfma_f32_16x16x32_bf16 v[152:155], v[104:107], v[68:71], v[152:155]
ds_read_b64_tr_b16 v[24:25], v118 offset:0
s_add_u32 m0, s37, 33792
s_add_u32 s43, s34, 8448
buffer_load_dwordx4 v12, s[4:7], s43 offen lds
v_mfma_f32_16x16x32_bf16 v[156:159], v[108:111], v[68:71], v[156:159]
ds_read_b64_tr_b16 v[26:27], v118 offset:1024
v_mfma_f32_16x16x32_bf16 v[160:163], v[96:99], v[72:75], v[160:163]
ds_read_b64_tr_b16 v[28:29], v119 offset:0
v_mfma_f32_16x16x32_bf16 v[164:167], v[100:103], v[72:75], v[164:167]
v_mfma_f32_16x16x32_bf16 v[168:171], v[104:107], v[72:75], v[168:171]
ds_read_b64_tr_b16 v[30:31], v119 offset:1024
v_mul_f32 v128, s74, v128
v_mul_f32 v129, s74, v129
v_mul_f32 v130, s74, v130
v_mul_f32 v131, s74, v131
v_mul_f32 v132, s74, v132
v_mul_f32 v133, s74, v133
v_mul_f32 v134, s74, v134
v_mul_f32 v135, s74, v135
v_cvt_pk_bf16_f32 v128, v128, v129
v_cvt_pk_bf16_f32 v129, v130, v131
v_cvt_pk_bf16_f32 v130, v132, v133
v_cvt_pk_bf16_f32 v131, v134, v135
v_mfma_f32_16x16x32_bf16 v[172:175], v[108:111], v[72:75], v[172:175]
ds_read_b64_tr_b16 v[32:33], v120 offset:0
s_add_u32 m0, s37, 34816
s_add_u32 s43, s34, 16640
buffer_load_dwordx4 v11, s[4:7], s43 offen lds
v_mul_f32 v136, s74, v136
v_mul_f32 v137, s74, v137
v_mul_f32 v138, s74, v138
v_mul_f32 v139, s74, v139
v_mul_f32 v140, s74, v140
v_mul_f32 v141, s74, v141
v_mul_f32 v142, s74, v142
v_mul_f32 v143, s74, v143
v_cvt_pk_bf16_f32 v132, v136, v137
v_cvt_pk_bf16_f32 v133, v138, v139
v_cvt_pk_bf16_f32 v134, v140, v141
v_cvt_pk_bf16_f32 v135, v142, v143
v_mfma_f32_16x16x32_bf16 v[176:179], v[96:99], v[76:79], v[176:179]
ds_read_b64_tr_b16 v[34:35], v120 offset:1024
v_mul_f32 v144, s74, v144
v_mul_f32 v145, s74, v145
v_mul_f32 v146, s74, v146
v_mul_f32 v147, s74, v147
v_mul_f32 v148, s74, v148
v_mul_f32 v149, s74, v149
v_mul_f32 v150, s74, v150
v_mul_f32 v151, s74, v151
v_cvt_pk_bf16_f32 v136, v144, v145
v_cvt_pk_bf16_f32 v137, v146, v147
v_cvt_pk_bf16_f32 v138, v148, v149
v_cvt_pk_bf16_f32 v139, v150, v151
v_mfma_f32_16x16x32_bf16 v[180:183], v[100:103], v[76:79], v[180:183]
ds_read_b64_tr_b16 v[36:37], v121 offset:0
v_mul_f32 v152, s74, v152
v_mul_f32 v153, s74, v153
v_mul_f32 v154, s74, v154
v_mul_f32 v155, s74, v155
v_mul_f32 v156, s74, v156
v_mul_f32 v157, s74, v157
v_mul_f32 v158, s74, v158
v_mul_f32 v159, s74, v159
v_cvt_pk_bf16_f32 v140, v152, v153
v_cvt_pk_bf16_f32 v141, v154, v155
v_cvt_pk_bf16_f32 v142, v156, v157
v_cvt_pk_bf16_f32 v143, v158, v159
v_mfma_f32_16x16x32_bf16 v[184:187], v[104:107], v[76:79], v[184:187]
ds_read_b64_tr_b16 v[38:39], v121 offset:1024
v_mfma_f32_16x16x32_bf16 v[188:191], v[108:111], v[76:79], v[188:191]
ds_read_b64_tr_b16 v[40:41], v122 offset:0
v_mfma_f32_16x16x32_bf16 v[192:195], v[96:99], v[80:83], v[192:195]
ds_read_b64_tr_b16 v[42:43], v122 offset:1024
s_add_u32 m0, s37, 35840
s_add_u32 s43, s34, 24832
buffer_load_dwordx4 v12, s[4:7], s43 offen lds
v_mfma_f32_16x16x32_bf16 v[196:199], v[100:103], v[80:83], v[196:199]
ds_read_b64_tr_b16 v[44:45], v123 offset:0
v_mfma_f32_16x16x32_bf16 v[200:203], v[104:107], v[80:83], v[200:203]
ds_read_b64_tr_b16 v[46:47], v123 offset:1024
v_mul_f32 v160, s74, v160
v_mul_f32 v161, s74, v161
v_mul_f32 v162, s74, v162
v_mul_f32 v163, s74, v163
v_mul_f32 v164, s74, v164
v_mul_f32 v165, s74, v165
v_mul_f32 v166, s74, v166
v_mul_f32 v167, s74, v167
v_cvt_pk_bf16_f32 v144, v160, v161
v_cvt_pk_bf16_f32 v145, v162, v163
v_cvt_pk_bf16_f32 v146, v164, v165
v_cvt_pk_bf16_f32 v147, v166, v167
v_mfma_f32_16x16x32_bf16 v[204:207], v[108:111], v[80:83], v[204:207]
v_mul_f32 v168, s74, v168
v_mul_f32 v169, s74, v169
v_mul_f32 v170, s74, v170
v_mul_f32 v171, s74, v171
v_mul_f32 v172, s74, v172
v_mul_f32 v173, s74, v173
v_mul_f32 v174, s74, v174
v_mul_f32 v175, s74, v175
v_cvt_pk_bf16_f32 v148, v168, v169
v_cvt_pk_bf16_f32 v149, v170, v171
v_cvt_pk_bf16_f32 v150, v172, v173
v_cvt_pk_bf16_f32 v151, v174, v175
v_mfma_f32_16x16x32_bf16 v[208:211], v[96:99], v[84:87], v[208:211]
s_add_u32 m0, s38, 147456
s_add_u32 s43, s36, 1572864
buffer_load_dwordx4 v13, s[16:19], s43 offen lds
v_mul_f32 v176, s74, v176
v_mul_f32 v177, s74, v177
v_mul_f32 v178, s74, v178
v_mul_f32 v179, s74, v179
v_mul_f32 v180, s74, v180
v_mul_f32 v181, s74, v181
v_mul_f32 v182, s74, v182
v_mul_f32 v183, s74, v183
v_cvt_pk_bf16_f32 v152, v176, v177
v_cvt_pk_bf16_f32 v153, v178, v179
v_cvt_pk_bf16_f32 v154, v180, v181
v_cvt_pk_bf16_f32 v155, v182, v183
v_mfma_f32_16x16x32_bf16 v[212:215], v[100:103], v[84:87], v[212:215]
v_mul_f32 v184, s74, v184
v_mul_f32 v185, s74, v185
v_mul_f32 v186, s74, v186
v_mul_f32 v187, s74, v187
v_mul_f32 v188, s74, v188
v_mul_f32 v189, s74, v189
v_mul_f32 v190, s74, v190
v_mul_f32 v191, s74, v191
v_cvt_pk_bf16_f32 v156, v184, v185
v_cvt_pk_bf16_f32 v157, v186, v187
v_cvt_pk_bf16_f32 v158, v188, v189
v_cvt_pk_bf16_f32 v159, v190, v191
v_mfma_f32_16x16x32_bf16 v[216:219], v[104:107], v[84:87], v[216:219]
v_mfma_f32_16x16x32_bf16 v[220:223], v[108:111], v[84:87], v[220:223]
v_mfma_f32_16x16x32_bf16 v[224:227], v[96:99], v[88:91], v[224:227]
v_mfma_f32_16x16x32_bf16 v[228:231], v[100:103], v[88:91], v[228:231]
s_add_u32 m0, s38, 148480
s_add_u32 s43, s36, 1605632
buffer_load_dwordx4 v13, s[16:19], s43 offen lds
v_mfma_f32_16x16x32_bf16 v[232:235], v[104:107], v[88:91], v[232:235]
v_mul_f32 v192, s74, v192
v_mul_f32 v193, s74, v193
v_mul_f32 v194, s74, v194
v_mul_f32 v195, s74, v195
v_mul_f32 v196, s74, v196
v_mul_f32 v197, s74, v197
v_mul_f32 v198, s74, v198
v_mul_f32 v199, s74, v199
v_cvt_pk_bf16_f32 v160, v192, v193
v_cvt_pk_bf16_f32 v161, v194, v195
v_cvt_pk_bf16_f32 v162, v196, v197
v_cvt_pk_bf16_f32 v163, v198, v199
v_mfma_f32_16x16x32_bf16 v[236:239], v[108:111], v[88:91], v[236:239]
v_mul_f32 v200, s74, v200
v_mul_f32 v201, s74, v201
v_mul_f32 v202, s74, v202
v_mul_f32 v203, s74, v203
v_mul_f32 v204, s74, v204
v_mul_f32 v205, s74, v205
v_mul_f32 v206, s74, v206
v_mul_f32 v207, s74, v207
v_cvt_pk_bf16_f32 v164, v200, v201
v_cvt_pk_bf16_f32 v165, v202, v203
v_cvt_pk_bf16_f32 v166, v204, v205
v_cvt_pk_bf16_f32 v167, v206, v207
v_mfma_f32_16x16x32_bf16 v[240:243], v[96:99], v[92:95], v[240:243]
v_mul_f32 v208, s74, v208
v_mul_f32 v209, s74, v209
v_mul_f32 v210, s74, v210
v_mul_f32 v211, s74, v211
v_mul_f32 v212, s74, v212
v_mul_f32 v213, s74, v213
v_mul_f32 v214, s74, v214
v_mul_f32 v215, s74, v215
v_cvt_pk_bf16_f32 v168, v208, v209
v_cvt_pk_bf16_f32 v169, v210, v211
v_cvt_pk_bf16_f32 v170, v212, v213
v_cvt_pk_bf16_f32 v171, v214, v215
v_mfma_f32_16x16x32_bf16 v[244:247], v[100:103], v[92:95], v[244:247]
v_mul_f32 v216, s74, v216
v_mul_f32 v217, s74, v217
v_mul_f32 v218, s74, v218
v_mul_f32 v219, s74, v219
v_mul_f32 v220, s74, v220
v_mul_f32 v221, s74, v221
v_mul_f32 v222, s74, v222
v_mul_f32 v223, s74, v223
v_cvt_pk_bf16_f32 v172, v216, v217
v_cvt_pk_bf16_f32 v173, v218, v219
v_cvt_pk_bf16_f32 v174, v220, v221
v_cvt_pk_bf16_f32 v175, v222, v223
v_mfma_f32_16x16x32_bf16 v[248:251], v[104:107], v[92:95], v[248:251]
v_mfma_f32_16x16x32_bf16 v[252:255], v[108:111], v[92:95], v[252:255]
s_nop 7
v_mul_f32 v224, s74, v224
v_mul_f32 v225, s74, v225
v_mul_f32 v226, s74, v226
v_mul_f32 v227, s74, v227
v_mul_f32 v228, s74, v228
v_mul_f32 v229, s74, v229
v_mul_f32 v230, s74, v230
v_mul_f32 v231, s74, v231
v_cvt_pk_bf16_f32 v176, v224, v225
v_cvt_pk_bf16_f32 v177, v226, v227
v_cvt_pk_bf16_f32 v178, v228, v229
v_cvt_pk_bf16_f32 v179, v230, v231
v_mul_f32 v232, s74, v232
v_mul_f32 v233, s74, v233
v_mul_f32 v234, s74, v234
v_mul_f32 v235, s74, v235
v_mul_f32 v236, s74, v236
v_mul_f32 v237, s74, v237
v_mul_f32 v238, s74, v238
v_mul_f32 v239, s74, v239
v_cvt_pk_bf16_f32 v180, v232, v233
v_cvt_pk_bf16_f32 v181, v234, v235
v_cvt_pk_bf16_f32 v182, v236, v237
v_cvt_pk_bf16_f32 v183, v238, v239
v_mul_f32 v240, s74, v240
v_mul_f32 v241, s74, v241
v_mul_f32 v242, s74, v242
v_mul_f32 v243, s74, v243
v_mul_f32 v244, s74, v244
v_mul_f32 v245, s74, v245
v_mul_f32 v246, s74, v246
v_mul_f32 v247, s74, v247
v_cvt_pk_bf16_f32 v184, v240, v241
v_cvt_pk_bf16_f32 v185, v242, v243
v_cvt_pk_bf16_f32 v186, v244, v245
v_cvt_pk_bf16_f32 v187, v246, v247
v_mul_f32 v248, s74, v248
v_mul_f32 v249, s74, v249
v_mul_f32 v250, s74, v250
v_mul_f32 v251, s74, v251
v_mul_f32 v252, s74, v252
v_mul_f32 v253, s74, v253
v_mul_f32 v254, s74, v254
v_mul_f32 v255, s74, v255
v_cvt_pk_bf16_f32 v188, v248, v249
v_cvt_pk_bf16_f32 v189, v250, v251
v_cvt_pk_bf16_f32 v190, v252, v253
v_cvt_pk_bf16_f32 v191, v254, v255
s_waitcnt lgkmcnt(14)
v_mfma_f32_16x16x32_bf16 v[192:195], v[16:19], v[48:51], 0
ds_read_b128 v[96:99], v115 offset:0
ds_read_b128 v[100:103], v115 offset:2048
v_mfma_f32_16x16x32_bf16 v[224:227], v[16:19], v[52:55], 0
ds_read_b64_tr_b16 v[64:65], v116 offset:8192
s_waitcnt lgkmcnt(15)
v_mfma_f32_16x16x32_bf16 v[196:199], v[20:23], v[48:51], 0
ds_read_b64_tr_b16 v[66:67], v116 offset:9216
v_mfma_f32_16x16x32_bf16 v[228:231], v[20:23], v[52:55], 0
ds_read_b64_tr_b16 v[68:69], v117 offset:8192
ds_read_b64_tr_b16 v[70:71], v117 offset:9216
s_waitcnt lgkmcnt(15)
v_mfma_f32_16x16x32_bf16 v[200:203], v[24:27], v[48:51], 0
ds_read_b64_tr_b16 v[72:73], v118 offset:8192
v_mfma_f32_16x16x32_bf16 v[232:235], v[24:27], v[52:55], 0
ds_read_b64_tr_b16 v[74:75], v118 offset:9216
s_waitcnt lgkmcnt(15)
v_mfma_f32_16x16x32_bf16 v[204:207], v[28:31], v[48:51], 0
ds_read_b64_tr_b16 v[76:77], v119 offset:8192
v_mfma_f32_16x16x32_bf16 v[236:239], v[28:31], v[52:55], 0
ds_read_b64_tr_b16 v[78:79], v119 offset:9216
ds_read_b64_tr_b16 v[80:81], v120 offset:8192
s_waitcnt lgkmcnt(15)
v_mfma_f32_16x16x32_bf16 v[208:211], v[32:35], v[48:51], 0
ds_read_b64_tr_b16 v[82:83], v120 offset:9216
v_mfma_f32_16x16x32_bf16 v[240:243], v[32:35], v[52:55], 0
ds_read_b64_tr_b16 v[84:85], v121 offset:8192
v_mfma_f32_16x16x32_bf16 v[212:215], v[36:39], v[48:51], 0
ds_read_b64_tr_b16 v[86:87], v121 offset:9216
ds_read_b64_tr_b16 v[88:89], v122 offset:8192
v_mfma_f32_16x16x32_bf16 v[244:247], v[36:39], v[52:55], 0
ds_read_b64_tr_b16 v[90:91], v122 offset:9216
s_waitcnt lgkmcnt(15)
v_mfma_f32_16x16x32_bf16 v[216:219], v[40:43], v[48:51], 0
ds_read_b64_tr_b16 v[92:93], v123 offset:8192
v_mfma_f32_16x16x32_bf16 v[248:251], v[40:43], v[52:55], 0
ds_read_b64_tr_b16 v[94:95], v123 offset:9216
v_mfma_f32_16x16x32_bf16 v[220:223], v[44:47], v[48:51], 0
v_mfma_f32_16x16x32_bf16 v[252:255], v[44:47], v[52:55], 0
s_waitcnt vmcnt(6) lgkmcnt(0)
s_barrier
v_mfma_f32_16x16x32_bf16 v[192:195], v[64:67], v[96:99], v[192:195]
ds_read_b128 v[48:51], v112 offset:0
ds_read_b128 v[52:55], v112 offset:2048
s_add_u32 m0, s37, 65536
s_add_u32 s43, s34, 384
buffer_load_dwordx4 v11, s[4:7], s43 offen lds
v_mfma_f32_16x16x32_bf16 v[224:227], v[64:67], v[100:103], v[224:227]
ds_read_b64_tr_b16 v[16:17], v116 offset:16384
v_mfma_f32_16x16x32_bf16 v[196:199], v[68:71], v[96:99], v[196:199]
ds_read_b64_tr_b16 v[18:19], v116 offset:17408
v_mfma_f32_16x16x32_bf16 v[228:231], v[68:71], v[100:103], v[228:231]
ds_read_b64_tr_b16 v[20:21], v117 offset:16384
ds_read_b64_tr_b16 v[22:23], v117 offset:17408
v_mfma_f32_16x16x32_bf16 v[200:203], v[72:75], v[96:99], v[200:203]
ds_read_b64_tr_b16 v[24:25], v118 offset:16384
s_add_u32 m0, s37, 66560
s_add_u32 s43, s34, 8576
buffer_load_dwordx4 v12, s[4:7], s43 offen lds
v_mfma_f32_16x16x32_bf16 v[232:235], v[72:75], v[100:103], v[232:235]
ds_read_b64_tr_b16 v[26:27], v118 offset:17408
v_mfma_f32_16x16x32_bf16 v[204:207], v[76:79], v[96:99], v[204:207]
ds_read_b64_tr_b16 v[28:29], v119 offset:16384
v_mfma_f32_16x16x32_bf16 v[236:239], v[76:79], v[100:103], v[236:239]
ds_read_b64_tr_b16 v[30:31], v119 offset:17408
ds_read_b64_tr_b16 v[32:33], v120 offset:16384
v_mfma_f32_16x16x32_bf16 v[208:211], v[80:83], v[96:99], v[208:211]
ds_read_b64_tr_b16 v[34:35], v120 offset:17408
s_add_u32 m0, s37, 67584
s_add_u32 s43, s34, 16768
buffer_load_dwordx4 v11, s[4:7], s43 offen lds
v_mfma_f32_16x16x32_bf16 v[240:243], v[80:83], v[100:103], v[240:243]
ds_read_b64_tr_b16 v[36:37], v121 offset:16384
v_mfma_f32_16x16x32_bf16 v[212:215], v[84:87], v[96:99], v[212:215]
ds_read_b64_tr_b16 v[38:39], v121 offset:17408
ds_read_b64_tr_b16 v[40:41], v122 offset:16384
v_mfma_f32_16x16x32_bf16 v[244:247], v[84:87], v[100:103], v[244:247]
ds_read_b64_tr_b16 v[42:43], v122 offset:17408
v_mfma_f32_16x16x32_bf16 v[216:219], v[88:91], v[96:99], v[216:219]
ds_read_b64_tr_b16 v[44:45], v123 offset:16384
s_add_u32 m0, s37, 68608
s_add_u32 s43, s34, 24960
buffer_load_dwordx4 v12, s[4:7], s43 offen lds
v_mfma_f32_16x16x32_bf16 v[248:251], v[88:91], v[100:103], v[248:251]
ds_read_b64_tr_b16 v[46:47], v123 offset:17408
v_mfma_f32_16x16x32_bf16 v[220:223], v[92:95], v[96:99], v[220:223]
v_mfma_f32_16x16x32_bf16 v[252:255], v[92:95], v[100:103], v[252:255]
s_waitcnt lgkmcnt(14)
v_mfma_f32_16x16x32_bf16 v[192:195], v[16:19], v[48:51], v[192:195]
ds_read_b128 v[96:99], v113 offset:0
ds_read_b128 v[100:103], v113 offset:2048
s_add_u32 m0, s38, 98304
s_add_u32 s43, s36, 2097152
buffer_load_dwordx4 v13, s[16:19], s43 offen lds
v_mfma_f32_16x16x32_bf16 v[224:227], v[16:19], v[52:55], v[224:227]
ds_read_b64_tr_b16 v[64:65], v116 offset:24576
s_waitcnt lgkmcnt(15)
v_mfma_f32_16x16x32_bf16 v[196:199], v[20:23], v[48:51], v[196:199]
ds_read_b64_tr_b16 v[66:67], v116 offset:25600
v_mfma_f32_16x16x32_bf16 v[228:231], v[20:23], v[52:55], v[228:231]
ds_read_b64_tr_b16 v[68:69], v117 offset:24576
ds_read_b64_tr_b16 v[70:71], v117 offset:25600
s_waitcnt lgkmcnt(15)
v_mfma_f32_16x16x32_bf16 v[200:203], v[24:27], v[48:51], v[200:203]
ds_read_b64_tr_b16 v[72:73], v118 offset:24576
s_add_u32 m0, s38, 99328
s_add_u32 s43, s36, 2129920
buffer_load_dwordx4 v13, s[16:19], s43 offen lds
v_mfma_f32_16x16x32_bf16 v[232:235], v[24:27], v[52:55], v[232:235]
ds_read_b64_tr_b16 v[74:75], v118 offset:25600
s_waitcnt lgkmcnt(15)
v_mfma_f32_16x16x32_bf16 v[204:207], v[28:31], v[48:51], v[204:207]
ds_read_b64_tr_b16 v[76:77], v119 offset:24576
v_mfma_f32_16x16x32_bf16 v[236:239], v[28:31], v[52:55], v[236:239]
ds_read_b64_tr_b16 v[78:79], v119 offset:25600
ds_read_b64_tr_b16 v[80:81], v120 offset:24576
s_waitcnt lgkmcnt(15)
v_mfma_f32_16x16x32_bf16 v[208:211], v[32:35], v[48:51], v[208:211]
ds_read_b64_tr_b16 v[82:83], v120 offset:25600
s_add_u32 s44, s40, 0
s_cmp_eq_u32 s3, 0
s_cbranch_scc1 L_sst16
buffer_store_dwordx4 v[128:131], v2, s[20:23], s44 offen offset:0
L_sstr16:
v_mfma_f32_16x16x32_bf16 v[240:243], v[32:35], v[52:55], v[240:243]
ds_read_b64_tr_b16 v[84:85], v121 offset:24576
v_mfma_f32_16x16x32_bf16 v[212:215], v[36:39], v[48:51], v[212:215]
ds_read_b64_tr_b16 v[86:87], v121 offset:25600
ds_read_b64_tr_b16 v[88:89], v122 offset:24576
v_mfma_f32_16x16x32_bf16 v[244:247], v[36:39], v[52:55], v[244:247]
ds_read_b64_tr_b16 v[90:91], v122 offset:25600
s_waitcnt lgkmcnt(15)
v_mfma_f32_16x16x32_bf16 v[216:219], v[40:43], v[48:51], v[216:219]
ds_read_b64_tr_b16 v[92:93], v123 offset:24576
s_add_u32 s44, s40, 0
s_cmp_eq_u32 s3, 0
s_cbranch_scc1 L_sst17
buffer_store_dwordx4 v[132:135], v2, s[20:23], s44 offen offset:1024
L_sstr17:
v_mfma_f32_16x16x32_bf16 v[248:251], v[40:43], v[52:55], v[248:251]
ds_read_b64_tr_b16 v[94:95], v123 offset:25600
v_mfma_f32_16x16x32_bf16 v[220:223], v[44:47], v[48:51], v[220:223]
v_mfma_f32_16x16x32_bf16 v[252:255], v[44:47], v[52:55], v[252:255]
s_waitcnt vmcnt(10) lgkmcnt(0)
s_barrier
v_mfma_f32_16x16x32_bf16 v[192:195], v[64:67], v[96:99], v[192:195]
ds_read_b128 v[48:51], v112 offset:32768
ds_read_b128 v[52:55], v112 offset:34816
s_add_u32 m0, s37, 0
s_add_u32 s43, s34, 512
buffer_load_dwordx4 v11, s[4:7], s43 offen lds
v_mov_b32 v128, 0
v_mov_b32 v129, 0
v_mov_b32 v130, 0
v_mov_b32 v131, 0
v_mfma_f32_16x16x32_bf16 v[224:227], v[64:67], v[100:103], v[224:227]
ds_read_b64_tr_b16 v[16:17], v116 offset:32768
v_mfma_f32_16x16x32_bf16 v[196:199], v[68:71], v[96:99], v[196:199]
ds_read_b64_tr_b16 v[18:19], v116 offset:33792
v_mfma_f32_16x16x32_bf16 v[228:231], v[68:71], v[100:103], v[228:231]
ds_read_b64_tr_b16 v[20:21], v117 offset:32768
ds_read_b64_tr_b16 v[22:23], v117 offset:33792
s_add_u32 m0, s37, 1024
s_add_u32 s43, s34, 8704
buffer_load_dwordx4 v12, s[4:7], s43 offen lds
v_mfma_f32_16x16x32_bf16 v[200:203], v[72:75], v[96:99], v[200:203]
ds_read_b64_tr_b16 v[24:25], v118 offset:32768
v_mfma_f32_16x16x32_bf16 v[232:235], v[72:75], v[100:103], v[232:235]
ds_read_b64_tr_b16 v[26:27], v118 offset:33792
v_mfma_f32_16x16x32_bf16 v[204:207], v[76:79], v[96:99], v[204:207]
ds_read_b64_tr_b16 v[28:29], v119 offset:32768
s_add_u32 m0, s37, 2048
s_add_u32 s43, s34, 16896
buffer_load_dwordx4 v11, s[4:7], s43 offen lds
v_mfma_f32_16x16x32_bf16 v[236:239], v[76:79], v[100:103], v[236:239]
ds_read_b64_tr_b16 v[30:31], v119 offset:33792
ds_read_b64_tr_b16 v[32:33], v120 offset:32768
v_mfma_f32_16x16x32_bf16 v[208:211], v[80:83], v[96:99], v[208:211]
ds_read_b64_tr_b16 v[34:35], v120 offset:33792
v_mov_b32 v132, 0
v_mov_b32 v133, 0
v_mov_b32 v134, 0
v_mov_b32 v135, 0
v_mfma_f32_16x16x32_bf16 v[240:243], v[80:83], v[100:103], v[240:243]
ds_read_b64_tr_b16 v[36:37], v121 offset:32768
s_add_u32 m0, s37, 3072
s_add_u32 s43, s34, 25088
buffer_load_dwordx4 v12, s[4:7], s43 offen lds
v_mfma_f32_16x16x32_bf16 v[212:215], v[84:87], v[96:99], v[212:215]
ds_read_b64_tr_b16 v[38:39], v121 offset:33792
ds_read_b64_tr_b16 v[40:41], v122 offset:32768
v_mfma_f32_16x16x32_bf16 v[244:247], v[84:87], v[100:103], v[244:247]
ds_read_b64_tr_b16 v[42:43], v122 offset:33792
v_mfma_f32_16x16x32_bf16 v[216:219], v[88:91], v[96:99], v[216:219]
ds_read_b64_tr_b16 v[44:45], v123 offset:32768
s_add_u32 m0, s38, 114688
s_add_u32 s43, s36, 2621440
buffer_load_dwordx4 v13, s[16:19], s43 offen lds
v_mfma_f32_16x16x32_bf16 v[248:251], v[88:91], v[100:103], v[248:251]
ds_read_b64_tr_b16 v[46:47], v123 offset:33792
v_mfma_f32_16x16x32_bf16 v[220:223], v[92:95], v[96:99], v[220:223]
v_mfma_f32_16x16x32_bf16 v[252:255], v[92:95], v[100:103], v[252:255]
s_waitcnt lgkmcnt(14)
v_mfma_f32_16x16x32_bf16 v[192:195], v[16:19], v[48:51], v[192:195]
ds_read_b128 v[96:99], v113 offset:32768
ds_read_b128 v[100:103], v113 offset:34816
s_add_u32 m0, s38, 115712
s_add_u32 s43, s36, 2654208
buffer_load_dwordx4 v13, s[16:19], s43 offen lds
v_mfma_f32_16x16x32_bf16 v[224:227], v[16:19], v[52:55], v[224:227]
ds_read_b64_tr_b16 v[64:65], v116 offset:40960
s_waitcnt lgkmcnt(15)
v_mfma_f32_16x16x32_bf16 v[196:199], v[20:23], v[48:51], v[196:199]
ds_read_b64_tr_b16 v[66:67], v116 offset:41984
v_mfma_f32_16x16x32_bf16 v[228:231], v[20:23], v[52:55], v[228:231]
ds_read_b64_tr_b16 v[68:69], v117 offset:40960
ds_read_b64_tr_b16 v[70:71], v117 offset:41984
s_waitcnt lgkmcnt(15)
v_mfma_f32_16x16x32_bf16 v[200:203], v[24:27], v[48:51], v[200:203]
ds_read_b64_tr_b16 v[72:73], v118 offset:40960
s_add_u32 s44, s40, 4096
s_cmp_eq_u32 s3, 0
s_cbranch_scc1 L_sst18
buffer_store_dwordx4 v[136:139], v2, s[20:23], s44 offen offset:0
L_sstr18:
v_mfma_f32_16x16x32_bf16 v[232:235], v[24:27], v[52:55], v[232:235]
ds_read_b64_tr_b16 v[74:75], v118 offset:41984
s_waitcnt lgkmcnt(15)
v_mfma_f32_16x16x32_bf16 v[204:207], v[28:31], v[48:51], v[204:207]
ds_read_b64_tr_b16 v[76:77], v119 offset:40960
v_mfma_f32_16x16x32_bf16 v[236:239], v[28:31], v[52:55], v[236:239]
ds_read_b64_tr_b16 v[78:79], v119 offset:41984
ds_read_b64_tr_b16 v[80:81], v120 offset:40960
s_waitcnt lgkmcnt(15)
v_mfma_f32_16x16x32_bf16 v[208:211], v[32:35], v[48:51], v[208:211]
ds_read_b64_tr_b16 v[82:83], v120 offset:41984
s_add_u32 s44, s40, 4096
s_cmp_eq_u32 s3, 0
s_cbranch_scc1 L_sst19
buffer_store_dwordx4 v[140:143], v2, s[20:23], s44 offen offset:1024
L_sstr19:
v_mfma_f32_16x16x32_bf16 v[240:243], v[32:35], v[52:55], v[240:243]
ds_read_b64_tr_b16 v[84:85], v121 offset:40960
v_mfma_f32_16x16x32_bf16 v[212:215], v[36:39], v[48:51], v[212:215]
ds_read_b64_tr_b16 v[86:87], v121 offset:41984
ds_read_b64_tr_b16 v[88:89], v122 offset:40960
v_mfma_f32_16x16x32_bf16 v[244:247], v[36:39], v[52:55], v[244:247]
ds_read_b64_tr_b16 v[90:91], v122 offset:41984
s_waitcnt lgkmcnt(15)
v_mfma_f32_16x16x32_bf16 v[216:219], v[40:43], v[48:51], v[216:219]
ds_read_b64_tr_b16 v[92:93], v123 offset:40960
s_add_u32 s44, s40, 8192
s_cmp_eq_u32 s3, 0
s_cbranch_scc1 L_sst20
buffer_store_dwordx4 v[144:147], v2, s[20:23], s44 offen offset:0
L_sstr20:
v_mfma_f32_16x16x32_bf16 v[248:251], v[40:43], v[52:55], v[248:251]
ds_read_b64_tr_b16 v[94:95], v123 offset:41984
v_mfma_f32_16x16x32_bf16 v[220:223], v[44:47], v[48:51], v[220:223]
v_mfma_f32_16x16x32_bf16 v[252:255], v[44:47], v[52:55], v[252:255]
s_waitcnt vmcnt(13) lgkmcnt(0)
s_barrier
v_mfma_f32_16x16x32_bf16 v[192:195], v[64:67], v[96:99], v[192:195]
ds_read_b128 v[48:51], v114 offset:0
ds_read_b128 v[52:55], v114 offset:2048
s_add_u32 m0, s37, 32768
s_add_u32 s43, s34, 640
buffer_load_dwordx4 v11, s[4:7], s43 offen lds
v_mov_b32 v136, 0
v_mov_b32 v137, 0
v_mov_b32 v138, 0
v_mov_b32 v139, 0
v_mfma_f32_16x16x32_bf16 v[224:227], v[64:67], v[100:103], v[224:227]
ds_read_b64_tr_b16 v[16:17], v116 offset:49152
v_mfma_f32_16x16x32_bf16 v[196:199], v[68:71], v[96:99], v[196:199]
ds_read_b64_tr_b16 v[18:19], v116 offset:50176
v_mfma_f32_16x16x32_bf16 v[228:231], v[68:71], v[100:103], v[228:231]
ds_read_b64_tr_b16 v[20:21], v117 offset:49152
ds_read_b64_tr_b16 v[22:23], v117 offset:50176
s_add_u32 m0, s37, 33792
s_add_u32 s43, s34, 8832
buffer_load_dwordx4 v12, s[4:7], s43 offen lds
v_mfma_f32_16x16x32_bf16 v[200:203], v[72:75], v[96:99], v[200:203]
ds_read_b64_tr_b16 v[24:25], v118 offset:49152
v_mfma_f32_16x16x32_bf16 v[232:235], v[72:75], v[100:103], v[232:235]
ds_read_b64_tr_b16 v[26:27], v118 offset:50176
v_mov_b32 v140, 0
v_mov_b32 v141, 0
v_mov_b32 v142, 0
v_mov_b32 v143, 0
v_mfma_f32_16x16x32_bf16 v[204:207], v[76:79], v[96:99], v[204:207]
ds_read_b64_tr_b16 v[28:29], v119 offset:49152
s_add_u32 m0, s37, 34816
s_add_u32 s43, s34, 17024
buffer_load_dwordx4 v11, s[4:7], s43 offen lds
v_mfma_f32_16x16x32_bf16 v[236:239], v[76:79], v[100:103], v[236:239]
ds_read_b64_tr_b16 v[30:31], v119 offset:50176
ds_read_b64_tr_b16 v[32:33], v120 offset:49152
v_mfma_f32_16x16x32_bf16 v[208:211], v[80:83], v[96:99], v[208:211]
ds_read_b64_tr_b16 v[34:35], v120 offset:50176
v_mfma_f32_16x16x32_bf16 v[240:243], v[80:83], v[100:103], v[240:243]
ds_read_b64_tr_b16 v[36:37], v121 offset:49152
s_add_u32 m0, s37, 35840
s_add_u32 s43, s34, 25216
buffer_load_dwordx4 v12, s[4:7], s43 offen lds
v_mfma_f32_16x16x32_bf16 v[212:215], v[84:87], v[96:99], v[212:215]
ds_read_b64_tr_b16 v[38:39], v121 offset:50176
ds_read_b64_tr_b16 v[40:41], v122 offset:49152
v_mov_b32 v144, 0
v_mov_b32 v145, 0
v_mov_b32 v146, 0
v_mov_b32 v147, 0
v_mfma_f32_16x16x32_bf16 v[244:247], v[84:87], v[100:103], v[244:247]
ds_read_b64_tr_b16 v[42:43], v122 offset:50176
v_mfma_f32_16x16x32_bf16 v[216:219], v[88:91], v[96:99], v[216:219]
ds_read_b64_tr_b16 v[44:45], v123 offset:49152
s_add_u32 m0, s38, 131072
s_add_u32 s43, s36, 3145728
buffer_load_dwordx4 v13, s[16:19], s43 offen lds
v_mfma_f32_16x16x32_bf16 v[248:251], v[88:91], v[100:103], v[248:251]
ds_read_b64_tr_b16 v[46:47], v123 offset:50176
v_mfma_f32_16x16x32_bf16 v[220:223], v[92:95], v[96:99], v[220:223]
v_mfma_f32_16x16x32_bf16 v[252:255], v[92:95], v[100:103], v[252:255]
s_waitcnt lgkmcnt(14)
v_mfma_f32_16x16x32_bf16 v[192:195], v[16:19], v[48:51], v[192:195]
ds_read_b128 v[96:99], v115 offset:0
ds_read_b128 v[100:103], v115 offset:2048
s_add_u32 m0, s38, 132096
s_add_u32 s43, s36, 3178496
buffer_load_dwordx4 v13, s[16:19], s43 offen lds
v_mfma_f32_16x16x32_bf16 v[224:227], v[16:19], v[52:55], v[224:227]
ds_read_b64_tr_b16 v[64:65], v116 offset:57344
s_waitcnt lgkmcnt(15)
v_mfma_f32_16x16x32_bf16 v[196:199], v[20:23], v[48:51], v[196:199]
ds_read_b64_tr_b16 v[66:67], v116 offset:58368
v_mfma_f32_16x16x32_bf16 v[228:231], v[20:23], v[52:55], v[228:231]
ds_read_b64_tr_b16 v[68:69], v117 offset:57344
ds_read_b64_tr_b16 v[70:71], v117 offset:58368
s_waitcnt lgkmcnt(15)
v_mfma_f32_16x16x32_bf16 v[200:203], v[24:27], v[48:51], v[200:203]
ds_read_b64_tr_b16 v[72:73], v118 offset:57344
s_add_u32 s44, s40, 8192
s_cmp_eq_u32 s3, 0
s_cbranch_scc1 L_sst21
buffer_store_dwordx4 v[148:151], v2, s[20:23], s44 offen offset:1024
L_sstr21:
v_mfma_f32_16x16x32_bf16 v[232:235], v[24:27], v[52:55], v[232:235]
ds_read_b64_tr_b16 v[74:75], v118 offset:58368
s_waitcnt lgkmcnt(15)
v_mfma_f32_16x16x32_bf16 v[204:207], v[28:31], v[48:51], v[204:207]
ds_read_b64_tr_b16 v[76:77], v119 offset:57344
v_mfma_f32_16x16x32_bf16 v[236:239], v[28:31], v[52:55], v[236:239]
ds_read_b64_tr_b16 v[78:79], v119 offset:58368
ds_read_b64_tr_b16 v[80:81], v120 offset:57344
s_waitcnt lgkmcnt(15)
v_mfma_f32_16x16x32_bf16 v[208:211], v[32:35], v[48:51], v[208:211]
ds_read_b64_tr_b16 v[82:83], v120 offset:58368
s_add_u32 s44, s40, 12288
s_cmp_eq_u32 s3, 0
s_cbranch_scc1 L_sst22
buffer_store_dwordx4 v[152:155], v2, s[20:23], s44 offen offset:0
L_sstr22:
v_mfma_f32_16x16x32_bf16 v[240:243], v[32:35], v[52:55], v[240:243]
ds_read_b64_tr_b16 v[84:85], v121 offset:57344
v_mfma_f32_16x16x32_bf16 v[212:215], v[36:39], v[48:51], v[212:215]
ds_read_b64_tr_b16 v[86:87], v121 offset:58368
ds_read_b64_tr_b16 v[88:89], v122 offset:57344
v_mfma_f32_16x16x32_bf16 v[244:247], v[36:39], v[52:55], v[244:247]
ds_read_b64_tr_b16 v[90:91], v122 offset:58368
s_waitcnt lgkmcnt(15)
v_mfma_f32_16x16x32_bf16 v[216:219], v[40:43], v[48:51], v[216:219]
ds_read_b64_tr_b16 v[92:93], v123 offset:57344
s_add_u32 s44, s40, 12288
s_cmp_eq_u32 s3, 0
s_cbranch_scc1 L_sst23
buffer_store_dwordx4 v[156:159], v2, s[20:23], s44 offen offset:1024
L_sstr23:
v_mfma_f32_16x16x32_bf16 v[248:251], v[40:43], v[52:55], v[248:251]
ds_read_b64_tr_b16 v[94:95], v123 offset:58368
v_mfma_f32_16x16x32_bf16 v[220:223], v[44:47], v[48:51], v[220:223]
v_mfma_f32_16x16x32_bf16 v[252:255], v[44:47], v[52:55], v[252:255]
s_waitcnt vmcnt(14) lgkmcnt(0)
s_barrier
v_mfma_f32_16x16x32_bf16 v[192:195], v[64:67], v[96:99], v[192:195]
ds_read_b128 v[48:51], v112 offset:0
ds_read_b128 v[52:55], v112 offset:2048
s_add_u32 m0, s37, 65536
s_add_u32 s43, s34, 768
buffer_load_dwordx4 v11, s[4:7], s43 offen lds
v_mov_b32 v148, 0
v_mov_b32 v149, 0
v_mov_b32 v150, 0
v_mov_b32 v151, 0
v_mfma_f32_16x16x32_bf16 v[224:227], v[64:67], v[100:103], v[224:227]
ds_read_b64_tr_b16 v[16:17], v116 offset:0
v_mfma_f32_16x16x32_bf16 v[196:199], v[68:71], v[96:99], v[196:199]
ds_read_b64_tr_b16 v[18:19], v116 offset:1024
v_mfma_f32_16x16x32_bf16 v[228:231], v[68:71], v[100:103], v[228:231]
ds_read_b64_tr_b16 v[20:21], v117 offset:0
ds_read_b64_tr_b16 v[22:23], v117 offset:1024
s_add_u32 m0, s37, 66560
s_add_u32 s43, s34, 8960
buffer_load_dwordx4 v12, s[4:7], s43 offen lds
v_mfma_f32_16x16x32_bf16 v[200:203], v[72:75], v[96:99], v[200:203]
ds_read_b64_tr_b16 v[24:25], v118 offset:0
v_mfma_f32_16x16x32_bf16 v[232:235], v[72:75], v[100:103], v[232:235]
ds_read_b64_tr_b16 v[26:27], v118 offset:1024
v_mov_b32 v152, 0
v_mov_b32 v153, 0
v_mov_b32 v154, 0
v_mov_b32 v155, 0
v_mfma_f32_16x16x32_bf16 v[204:207], v[76:79], v[96:99], v[204:207]
ds_read_b64_tr_b16 v[28:29], v119 offset:0
s_add_u32 m0, s37, 67584
s_add_u32 s43, s34, 17152
buffer_load_dwordx4 v11, s[4:7], s43 offen lds
v_mfma_f32_16x16x32_bf16 v[236:239], v[76:79], v[100:103], v[236:239]
ds_read_b64_tr_b16 v[30:31], v119 offset:1024
ds_read_b64_tr_b16 v[32:33], v120 offset:0
v_mfma_f32_16x16x32_bf16 v[208:211], v[80:83], v[96:99], v[208:211]
ds_read_b64_tr_b16 v[34:35], v120 offset:1024
v_mfma_f32_16x16x32_bf16 v[240:243], v[80:83], v[100:103], v[240:243]
ds_read_b64_tr_b16 v[36:37], v121 offset:0
s_add_u32 m0, s37, 68608
s_add_u32 s43, s34, 25344
buffer_load_dwordx4 v12, s[4:7], s43 offen lds
v_mfma_f32_16x16x32_bf16 v[212:215], v[84:87], v[96:99], v[212:215]
ds_read_b64_tr_b16 v[38:39], v121 offset:1024
ds_read_b64_tr_b16 v[40:41], v122 offset:0
v_mov_b32 v156, 0
v_mov_b32 v157, 0
v_mov_b32 v158, 0
v_mov_b32 v159, 0
v_mfma_f32_16x16x32_bf16 v[244:247], v[84:87], v[100:103], v[244:247]
ds_read_b64_tr_b16 v[42:43], v122 offset:1024
v_mfma_f32_16x16x32_bf16 v[216:219], v[88:91], v[96:99], v[216:219]
ds_read_b64_tr_b16 v[44:45], v123 offset:0
s_add_u32 m0, s38, 147456
s_add_u32 s43, s36, 3670016
buffer_load_dwordx4 v13, s[16:19], s43 offen lds
v_mfma_f32_16x16x32_bf16 v[248:251], v[88:91], v[100:103], v[248:251]
ds_read_b64_tr_b16 v[46:47], v123 offset:1024
v_mfma_f32_16x16x32_bf16 v[220:223], v[92:95], v[96:99], v[220:223]
v_mfma_f32_16x16x32_bf16 v[252:255], v[92:95], v[100:103], v[252:255]
s_waitcnt lgkmcnt(14)
v_mfma_f32_16x16x32_bf16 v[192:195], v[16:19], v[48:51], v[192:195]
ds_read_b128 v[96:99], v113 offset:0
ds_read_b128 v[100:103], v113 offset:2048
s_add_u32 m0, s38, 148480
s_add_u32 s43, s36, 3702784
buffer_load_dwordx4 v13, s[16:19], s43 offen lds
v_mfma_f32_16x16x32_bf16 v[224:227], v[16:19], v[52:55], v[224:227]
ds_read_b64_tr_b16 v[64:65], v116 offset:8192
s_waitcnt lgkmcnt(15)
v_mfma_f32_16x16x32_bf16 v[196:199], v[20:23], v[48:51], v[196:199]
ds_read_b64_tr_b16 v[66:67], v116 offset:9216
v_mfma_f32_16x16x32_bf16 v[228:231], v[20:23], v[52:55], v[228:231]
ds_read_b64_tr_b16 v[68:69], v117 offset:8192
ds_read_b64_tr_b16 v[70:71], v117 offset:9216
s_waitcnt lgkmcnt(15)
v_mfma_f32_16x16x32_bf16 v[200:203], v[24:27], v[48:51], v[200:203]
ds_read_b64_tr_b16 v[72:73], v118 offset:8192
s_add_u32 s44, s40, 16384
s_cmp_eq_u32 s3, 0
s_cbranch_scc1 L_sst24
buffer_store_dwordx4 v[160:163], v2, s[20:23], s44 offen offset:0
L_sstr24:
v_mfma_f32_16x16x32_bf16 v[232:235], v[24:27], v[52:55], v[232:235]
ds_read_b64_tr_b16 v[74:75], v118 offset:9216
s_waitcnt lgkmcnt(15)
v_mfma_f32_16x16x32_bf16 v[204:207], v[28:31], v[48:51], v[204:207]
ds_read_b64_tr_b16 v[76:77], v119 offset:8192
v_mfma_f32_16x16x32_bf16 v[236:239], v[28:31], v[52:55], v[236:239]
ds_read_b64_tr_b16 v[78:79], v119 offset:9216
ds_read_b64_tr_b16 v[80:81], v120 offset:8192
s_waitcnt lgkmcnt(15)
v_mfma_f32_16x16x32_bf16 v[208:211], v[32:35], v[48:51], v[208:211]
ds_read_b64_tr_b16 v[82:83], v120 offset:9216
s_add_u32 s44, s40, 16384
s_cmp_eq_u32 s3, 0
s_cbranch_scc1 L_sst25
buffer_store_dwordx4 v[164:167], v2, s[20:23], s44 offen offset:1024
L_sstr25:
v_mfma_f32_16x16x32_bf16 v[240:243], v[32:35], v[52:55], v[240:243]
ds_read_b64_tr_b16 v[84:85], v121 offset:8192
v_mfma_f32_16x16x32_bf16 v[212:215], v[36:39], v[48:51], v[212:215]
ds_read_b64_tr_b16 v[86:87], v121 offset:9216
ds_read_b64_tr_b16 v[88:89], v122 offset:8192
v_mfma_f32_16x16x32_bf16 v[244:247], v[36:39], v[52:55], v[244:247]
ds_read_b64_tr_b16 v[90:91], v122 offset:9216
s_waitcnt lgkmcnt(15)
v_mfma_f32_16x16x32_bf16 v[216:219], v[40:43], v[48:51], v[216:219]
ds_read_b64_tr_b16 v[92:93], v123 offset:8192
s_add_u32 s44, s40, 20480
s_cmp_eq_u32 s3, 0
s_cbranch_scc1 L_sst26
buffer_store_dwordx4 v[168:171], v2, s[20:23], s44 offen offset:0
L_sstr26:
v_mfma_f32_16x16x32_bf16 v[248:251], v[40:43], v[52:55], v[248:251]
ds_read_b64_tr_b16 v[94:95], v123 offset:9216
v_mfma_f32_16x16x32_bf16 v[220:223], v[44:47], v[48:51], v[220:223]
v_mfma_f32_16x16x32_bf16 v[252:255], v[44:47], v[52:55], v[252:255]
s_waitcnt vmcnt(14) lgkmcnt(0)
s_barrier
v_mfma_f32_16x16x32_bf16 v[192:195], v[64:67], v[96:99], v[192:195]
ds_read_b128 v[48:51], v112 offset:32768
ds_read_b128 v[52:55], v112 offset:34816
s_add_u32 m0, s37, 0
s_add_u32 s43, s34, 896
buffer_load_dwordx4 v11, s[4:7], s43 offen lds
v_mov_b32 v160, 0
v_mov_b32 v161, 0
v_mov_b32 v162, 0
v_mov_b32 v163, 0
v_mfma_f32_16x16x32_bf16 v[224:227], v[64:67], v[100:103], v[224:227]
ds_read_b64_tr_b16 v[16:17], v116 offset:16384
v_mfma_f32_16x16x32_bf16 v[196:199], v[68:71], v[96:99], v[196:199]
ds_read_b64_tr_b16 v[18:19], v116 offset:17408
v_mfma_f32_16x16x32_bf16 v[228:231], v[68:71], v[100:103], v[228:231]
ds_read_b64_tr_b16 v[20:21], v117 offset:16384
ds_read_b64_tr_b16 v[22:23], v117 offset:17408
v_mfma_f32_16x16x32_bf16 v[200:203], v[72:75], v[96:99], v[200:203]
ds_read_b64_tr_b16 v[24:25], v118 offset:16384
s_add_u32 m0, s37, 1024
s_add_u32 s43, s34, 9088
buffer_load_dwordx4 v12, s[4:7], s43 offen lds
v_mfma_f32_16x16x32_bf16 v[232:235], v[72:75], v[100:103], v[232:235]
ds_read_b64_tr_b16 v[26:27], v118 offset:17408
v_mov_b32 v164, 0
v_mov_b32 v165, 0
v_mov_b32 v166, 0
v_mov_b32 v167, 0
v_mfma_f32_16x16x32_bf16 v[204:207], v[76:79], v[96:99], v[204:207]
ds_read_b64_tr_b16 v[28:29], v119 offset:16384
v_mfma_f32_16x16x32_bf16 v[236:239], v[76:79], v[100:103], v[236:239]
ds_read_b64_tr_b16 v[30:31], v119 offset:17408
ds_read_b64_tr_b16 v[32:33], v120 offset:16384
v_mfma_f32_16x16x32_bf16 v[208:211], v[80:83], v[96:99], v[208:211]
ds_read_b64_tr_b16 v[34:35], v120 offset:17408
s_add_u32 m0, s37, 2048
s_add_u32 s43, s34, 17280
buffer_load_dwordx4 v11, s[4:7], s43 offen lds
v_mfma_f32_16x16x32_bf16 v[240:243], v[80:83], v[100:103], v[240:243]
ds_read_b64_tr_b16 v[36:37], v121 offset:16384
v_mfma_f32_16x16x32_bf16 v[212:215], v[84:87], v[96:99], v[212:215]
ds_read_b64_tr_b16 v[38:39], v121 offset:17408
ds_read_b64_tr_b16 v[40:41], v122 offset:16384
v_mov_b32 v168, 0
v_mov_b32 v169, 0
v_mov_b32 v170, 0
v_mov_b32 v171, 0
v_mfma_f32_16x16x32_bf16 v[244:247], v[84:87], v[100:103], v[244:247]
ds_read_b64_tr_b16 v[42:43], v122 offset:17408
v_mfma_f32_16x16x32_bf16 v[216:219], v[88:91], v[96:99], v[216:219]
ds_read_b64_tr_b16 v[44:45], v123 offset:16384
s_add_u32 m0, s37, 3072
s_add_u32 s43, s34, 25472
buffer_load_dwordx4 v12, s[4:7], s43 offen lds
v_mfma_f32_16x16x32_bf16 v[248:251], v[88:91], v[100:103], v[248:251]
ds_read_b64_tr_b16 v[46:47], v123 offset:17408
v_mfma_f32_16x16x32_bf16 v[220:223], v[92:95], v[96:99], v[220:223]
v_mfma_f32_16x16x32_bf16 v[252:255], v[92:95], v[100:103], v[252:255]
s_waitcnt lgkmcnt(14)
v_mfma_f32_16x16x32_bf16 v[192:195], v[16:19], v[48:51], v[192:195]
ds_read_b128 v[96:99], v113 offset:32768
ds_read_b128 v[100:103], v113 offset:34816
s_add_u32 s44, s40, 20480
s_cmp_eq_u32 s3, 0
s_cbranch_scc1 L_sst27
buffer_store_dwordx4 v[172:175], v2, s[20:23], s44 offen offset:1024
L_sstr27:
v_mfma_f32_16x16x32_bf16 v[224:227], v[16:19], v[52:55], v[224:227]
ds_read_b64_tr_b16 v[64:65], v116 offset:24576
s_waitcnt lgkmcnt(15)
v_mfma_f32_16x16x32_bf16 v[196:199], v[20:23], v[48:51], v[196:199]
ds_read_b64_tr_b16 v[66:67], v116 offset:25600
v_mfma_f32_16x16x32_bf16 v[228:231], v[20:23], v[52:55], v[228:231]
ds_read_b64_tr_b16 v[68:69], v117 offset:24576
ds_read_b64_tr_b16 v[70:71], v117 offset:25600
s_waitcnt lgkmcnt(15)
v_mfma_f32_16x16x32_bf16 v[200:203], v[24:27], v[48:51], v[200:203]
ds_read_b64_tr_b16 v[72:73], v118 offset:24576
v_mfma_f32_16x16x32_bf16 v[232:235], v[24:27], v[52:55], v[232:235]
ds_read_b64_tr_b16 v[74:75], v118 offset:25600
s_add_u32 s44, s40, 24576
s_cmp_eq_u32 s3, 0
s_cbranch_scc1 L_sst28
buffer_store_dwordx4 v[176:179], v2, s[20:23], s44 offen offset:0
L_sstr28:
s_waitcnt lgkmcnt(15)
v_mfma_f32_16x16x32_bf16 v[204:207], v[28:31], v[48:51], v[204:207]
ds_read_b64_tr_b16 v[76:77], v119 offset:24576
v_mfma_f32_16x16x32_bf16 v[236:239], v[28:31], v[52:55], v[236:239]
ds_read_b64_tr_b16 v[78:79], v119 offset:25600
ds_read_b64_tr_b16 v[80:81], v120 offset:24576
s_waitcnt lgkmcnt(15)
v_mfma_f32_16x16x32_bf16 v[208:211], v[32:35], v[48:51], v[208:211]
ds_read_b64_tr_b16 v[82:83], v120 offset:25600
v_mfma_f32_16x16x32_bf16 v[240:243], v[32:35], v[52:55], v[240:243]
ds_read_b64_tr_b16 v[84:85], v121 offset:24576
v_mfma_f32_16x16x32_bf16 v[212:215], v[36:39], v[48:51], v[212:215]
ds_read_b64_tr_b16 v[86:87], v121 offset:25600
ds_read_b64_tr_b16 v[88:89], v122 offset:24576
s_add_u32 s44, s40, 24576
s_cmp_eq_u32 s3, 0
s_cbranch_scc1 L_sst29
buffer_store_dwordx4 v[180:183], v2, s[20:23], s44 offen offset:1024
L_sstr29:
v_mfma_f32_16x16x32_bf16 v[244:247], v[36:39], v[52:55], v[244:247]
ds_read_b64_tr_b16 v[90:91], v122 offset:25600
s_waitcnt lgkmcnt(15)
v_mfma_f32_16x16x32_bf16 v[216:219], v[40:43], v[48:51], v[216:219]
ds_read_b64_tr_b16 v[92:93], v123 offset:24576
v_mfma_f32_16x16x32_bf16 v[248:251], v[40:43], v[52:55], v[248:251]
ds_read_b64_tr_b16 v[94:95], v123 offset:25600
v_mfma_f32_16x16x32_bf16 v[220:223], v[44:47], v[48:51], v[220:223]
v_mfma_f32_16x16x32_bf16 v[252:255], v[44:47], v[52:55], v[252:255]
s_waitcnt vmcnt(12) lgkmcnt(0)
s_barrier
v_mfma_f32_16x16x32_bf16 v[192:195], v[64:67], v[96:99], v[192:195]
ds_read_b128 v[48:51], v114 offset:0
ds_read_b128 v[52:55], v114 offset:2048
s_add_u32 s44, s40, 28672
s_cmp_eq_u32 s3, 0
s_cbranch_scc1 L_sst30
buffer_store_dwordx4 v[184:187], v2, s[20:23], s44 offen offset:0
L_sstr30:
v_mov_b32 v172, 0
v_mov_b32 v173, 0
v_mov_b32 v174, 0
v_mov_b32 v175, 0
v_mfma_f32_16x16x32_bf16 v[224:227], v[64:67], v[100:103], v[224:227]
ds_read_b64_tr_b16 v[16:17], v116 offset:32768
v_mfma_f32_16x16x32_bf16 v[196:199], v[68:71], v[96:99], v[196:199]
ds_read_b64_tr_b16 v[18:19], v116 offset:33792
v_mfma_f32_16x16x32_bf16 v[228:231], v[68:71], v[100:103], v[228:231]
ds_read_b64_tr_b16 v[20:21], v117 offset:32768
ds_read_b64_tr_b16 v[22:23], v117 offset:33792
v_mfma_f32_16x16x32_bf16 v[200:203], v[72:75], v[96:99], v[200:203]
ds_read_b64_tr_b16 v[24:25], v118 offset:32768
v_mfma_f32_16x16x32_bf16 v[232:235], v[72:75], v[100:103], v[232:235]
ds_read_b64_tr_b16 v[26:27], v118 offset:33792
v_mov_b32 v176, 0
v_mov_b32 v177, 0
v_mov_b32 v178, 0
v_mov_b32 v179, 0
v_mfma_f32_16x16x32_bf16 v[204:207], v[76:79], v[96:99], v[204:207]
ds_read_b64_tr_b16 v[28:29], v119 offset:32768
v_mfma_f32_16x16x32_bf16 v[236:239], v[76:79], v[100:103], v[236:239]
ds_read_b64_tr_b16 v[30:31], v119 offset:33792
ds_read_b64_tr_b16 v[32:33], v120 offset:32768
v_mfma_f32_16x16x32_bf16 v[208:211], v[80:83], v[96:99], v[208:211]
ds_read_b64_tr_b16 v[34:35], v120 offset:33792
v_mfma_f32_16x16x32_bf16 v[240:243], v[80:83], v[100:103], v[240:243]
ds_read_b64_tr_b16 v[36:37], v121 offset:32768
v_mfma_f32_16x16x32_bf16 v[212:215], v[84:87], v[96:99], v[212:215]
ds_read_b64_tr_b16 v[38:39], v121 offset:33792
ds_read_b64_tr_b16 v[40:41], v122 offset:32768
v_mov_b32 v180, 0
v_mov_b32 v181, 0
v_mov_b32 v182, 0
v_mov_b32 v183, 0
v_mfma_f32_16x16x32_bf16 v[244:247], v[84:87], v[100:103], v[244:247]
ds_read_b64_tr_b16 v[42:43], v122 offset:33792
v_mfma_f32_16x16x32_bf16 v[216:219], v[88:91], v[96:99], v[216:219]
ds_read_b64_tr_b16 v[44:45], v123 offset:32768
v_mfma_f32_16x16x32_bf16 v[248:251], v[88:91], v[100:103], v[248:251]
ds_read_b64_tr_b16 v[46:47], v123 offset:33792
v_mfma_f32_16x16x32_bf16 v[220:223], v[92:95], v[96:99], v[220:223]
v_mfma_f32_16x16x32_bf16 v[252:255], v[92:95], v[100:103], v[252:255]
s_waitcnt lgkmcnt(14)
v_mfma_f32_16x16x32_bf16 v[192:195], v[16:19], v[48:51], v[192:195]
ds_read_b128 v[96:99], v115 offset:0
ds_read_b128 v[100:103], v115 offset:2048
s_add_u32 s44, s40, 28672
s_cmp_eq_u32 s3, 0
s_cbranch_scc1 L_sst31
buffer_store_dwordx4 v[188:191], v2, s[20:23], s44 offen offset:1024
L_sstr31:
v_mfma_f32_16x16x32_bf16 v[224:227], v[16:19], v[52:55], v[224:227]
ds_read_b64_tr_b16 v[64:65], v116 offset:40960
s_waitcnt lgkmcnt(15)
v_mfma_f32_16x16x32_bf16 v[196:199], v[20:23], v[48:51], v[196:199]
ds_read_b64_tr_b16 v[66:67], v116 offset:41984
v_mfma_f32_16x16x32_bf16 v[228:231], v[20:23], v[52:55], v[228:231]
ds_read_b64_tr_b16 v[68:69], v117 offset:40960
ds_read_b64_tr_b16 v[70:71], v117 offset:41984
s_waitcnt lgkmcnt(15)
v_mfma_f32_16x16x32_bf16 v[200:203], v[24:27], v[48:51], v[200:203]
ds_read_b64_tr_b16 v[72:73], v118 offset:40960
v_mfma_f32_16x16x32_bf16 v[232:235], v[24:27], v[52:55], v[232:235]
ds_read_b64_tr_b16 v[74:75], v118 offset:41984
s_waitcnt lgkmcnt(15)
v_mfma_f32_16x16x32_bf16 v[204:207], v[28:31], v[48:51], v[204:207]
ds_read_b64_tr_b16 v[76:77], v119 offset:40960
v_mfma_f32_16x16x32_bf16 v[236:239], v[28:31], v[52:55], v[236:239]
ds_read_b64_tr_b16 v[78:79], v119 offset:41984
ds_read_b64_tr_b16 v[80:81], v120 offset:40960
s_waitcnt lgkmcnt(15)
v_mfma_f32_16x16x32_bf16 v[208:211], v[32:35], v[48:51], v[208:211]
ds_read_b64_tr_b16 v[82:83], v120 offset:41984
v_mfma_f32_16x16x32_bf16 v[240:243], v[32:35], v[52:55], v[240:243]
ds_read_b64_tr_b16 v[84:85], v121 offset:40960
v_mfma_f32_16x16x32_bf16 v[212:215], v[36:39], v[48:51], v[212:215]
ds_read_b64_tr_b16 v[86:87], v121 offset:41984
ds_read_b64_tr_b16 v[88:89], v122 offset:40960
v_mfma_f32_16x16x32_bf16 v[244:247], v[36:39], v[52:55], v[244:247]
ds_read_b64_tr_b16 v[90:91], v122 offset:41984
s_waitcnt lgkmcnt(15)
v_mfma_f32_16x16x32_bf16 v[216:219], v[40:43], v[48:51], v[216:219]
ds_read_b64_tr_b16 v[92:93], v123 offset:40960
v_mfma_f32_16x16x32_bf16 v[248:251], v[40:43], v[52:55], v[248:251]
ds_read_b64_tr_b16 v[94:95], v123 offset:41984
v_mfma_f32_16x16x32_bf16 v[220:223], v[44:47], v[48:51], v[220:223]
v_mfma_f32_16x16x32_bf16 v[252:255], v[44:47], v[52:55], v[252:255]
s_waitcnt vmcnt(5) lgkmcnt(0)
s_barrier
v_mfma_f32_16x16x32_bf16 v[192:195], v[64:67], v[96:99], v[192:195]
ds_read_b128 v[48:51], v112 offset:0
ds_read_b128 v[52:55], v112 offset:2048
v_mov_b32 v184, 0
v_mov_b32 v185, 0
v_mov_b32 v186, 0
v_mov_b32 v187, 0
v_mfma_f32_16x16x32_bf16 v[224:227], v[64:67], v[100:103], v[224:227]
ds_read_b64_tr_b16 v[16:17], v116 offset:49152
v_mfma_f32_16x16x32_bf16 v[196:199], v[68:71], v[96:99], v[196:199]
ds_read_b64_tr_b16 v[18:19], v116 offset:50176
v_mfma_f32_16x16x32_bf16 v[228:231], v[68:71], v[100:103], v[228:231]
ds_read_b64_tr_b16 v[20:21], v117 offset:49152
ds_read_b64_tr_b16 v[22:23], v117 offset:50176
v_mfma_f32_16x16x32_bf16 v[200:203], v[72:75], v[96:99], v[200:203]
ds_read_b64_tr_b16 v[24:25], v118 offset:49152
v_mfma_f32_16x16x32_bf16 v[232:235], v[72:75], v[100:103], v[232:235]
ds_read_b64_tr_b16 v[26:27], v118 offset:50176
v_mfma_f32_16x16x32_bf16 v[204:207], v[76:79], v[96:99], v[204:207]
ds_read_b64_tr_b16 v[28:29], v119 offset:49152
v_mfma_f32_16x16x32_bf16 v[236:239], v[76:79], v[100:103], v[236:239]
ds_read_b64_tr_b16 v[30:31], v119 offset:50176
ds_read_b64_tr_b16 v[32:33], v120 offset:49152
v_mfma_f32_16x16x32_bf16 v[208:211], v[80:83], v[96:99], v[208:211]
ds_read_b64_tr_b16 v[34:35], v120 offset:50176
v_mov_b32 v188, 0
v_mov_b32 v189, 0
v_mov_b32 v190, 0
v_mov_b32 v191, 0
v_mfma_f32_16x16x32_bf16 v[240:243], v[80:83], v[100:103], v[240:243]
ds_read_b64_tr_b16 v[36:37], v121 offset:49152
v_mfma_f32_16x16x32_bf16 v[212:215], v[84:87], v[96:99], v[212:215]
ds_read_b64_tr_b16 v[38:39], v121 offset:50176
ds_read_b64_tr_b16 v[40:41], v122 offset:49152
v_mfma_f32_16x16x32_bf16 v[244:247], v[84:87], v[100:103], v[244:247]
ds_read_b64_tr_b16 v[42:43], v122 offset:50176
v_mfma_f32_16x16x32_bf16 v[216:219], v[88:91], v[96:99], v[216:219]
ds_read_b64_tr_b16 v[44:45], v123 offset:49152
v_mfma_f32_16x16x32_bf16 v[248:251], v[88:91], v[100:103], v[248:251]
ds_read_b64_tr_b16 v[46:47], v123 offset:50176
v_mfma_f32_16x16x32_bf16 v[220:223], v[92:95], v[96:99], v[220:223]
v_mfma_f32_16x16x32_bf16 v[252:255], v[92:95], v[100:103], v[252:255]
s_waitcnt lgkmcnt(14)
v_mfma_f32_16x16x32_bf16 v[192:195], v[16:19], v[48:51], v[192:195]
ds_read_b128 v[96:99], v113 offset:0
ds_read_b128 v[100:103], v113 offset:2048
v_mfma_f32_16x16x32_bf16 v[224:227], v[16:19], v[52:55], v[224:227]
ds_read_b64_tr_b16 v[64:65], v116 offset:57344
s_waitcnt lgkmcnt(15)
v_mfma_f32_16x16x32_bf16 v[196:199], v[20:23], v[48:51], v[196:199]
ds_read_b64_tr_b16 v[66:67], v116 offset:58368
v_mfma_f32_16x16x32_bf16 v[228:231], v[20:23], v[52:55], v[228:231]
ds_read_b64_tr_b16 v[68:69], v117 offset:57344
ds_read_b64_tr_b16 v[70:71], v117 offset:58368
s_waitcnt lgkmcnt(15)
v_mfma_f32_16x16x32_bf16 v[200:203], v[24:27], v[48:51], v[200:203]
ds_read_b64_tr_b16 v[72:73], v118 offset:57344
v_mfma_f32_16x16x32_bf16 v[232:235], v[24:27], v[52:55], v[232:235]
ds_read_b64_tr_b16 v[74:75], v118 offset:58368
s_waitcnt lgkmcnt(15)
v_mfma_f32_16x16x32_bf16 v[204:207], v[28:31], v[48:51], v[204:207]
ds_read_b64_tr_b16 v[76:77], v119 offset:57344
v_mfma_f32_16x16x32_bf16 v[236:239], v[28:31], v[52:55], v[236:239]
ds_read_b64_tr_b16 v[78:79], v119 offset:58368
ds_read_b64_tr_b16 v[80:81], v120 offset:57344
s_waitcnt lgkmcnt(15)
v_mfma_f32_16x16x32_bf16 v[208:211], v[32:35], v[48:51], v[208:211]
ds_read_b64_tr_b16 v[82:83], v120 offset:58368
v_mfma_f32_16x16x32_bf16 v[240:243], v[32:35], v[52:55], v[240:243]
ds_read_b64_tr_b16 v[84:85], v121 offset:57344
v_mfma_f32_16x16x32_bf16 v[212:215], v[36:39], v[48:51], v[212:215]
ds_read_b64_tr_b16 v[86:87], v121 offset:58368
ds_read_b64_tr_b16 v[88:89], v122 offset:57344
v_mfma_f32_16x16x32_bf16 v[244:247], v[36:39], v[52:55], v[244:247]
ds_read_b64_tr_b16 v[90:91], v122 offset:58368
s_waitcnt lgkmcnt(15)
v_mfma_f32_16x16x32_bf16 v[216:219], v[40:43], v[48:51], v[216:219]
ds_read_b64_tr_b16 v[92:93], v123 offset:57344
v_mfma_f32_16x16x32_bf16 v[248:251], v[40:43], v[52:55], v[248:251]
ds_read_b64_tr_b16 v[94:95], v123 offset:58368
v_mfma_f32_16x16x32_bf16 v[220:223], v[44:47], v[48:51], v[220:223]
v_mfma_f32_16x16x32_bf16 v[252:255], v[44:47], v[52:55], v[252:255]
L_qjoinA:
s_waitcnt lgkmcnt(0)
s_barrier
v_add_u32 v3, 40960, v2
v_mfma_f32_16x16x32_bf16 v[192:195], v[64:67], v[96:99], v[192:195]
ds_read_b128 v[16:19], v3 offset:0
v_mov_b32 v112, 0
v_mov_b32 v113, 0
v_mfma_f32_16x16x32_bf16 v[224:227], v[64:67], v[100:103], v[224:227]
ds_read_b128 v[20:23], v3 offset:1024
v_mov_b32 v114, 0
v_mfma_f32_16x16x32_bf16 v[196:199], v[68:71], v[96:99], v[196:199]
ds_read_b128 v[24:27], v3 offset:2048
v_mov_b32 v115, 0
v_mfma_f32_16x16x32_bf16 v[228:231], v[68:71], v[100:103], v[228:231]
ds_read_b128 v[28:31], v3 offset:3072
v_mov_b32 v116, 0
v_mfma_f32_16x16x32_bf16 v[200:203], v[72:75], v[96:99], v[200:203]
ds_read_b128 v[32:35], v3 offset:4096
v_mov_b32 v117, 0
v_mov_b32 v118, 0
v_mfma_f32_16x16x32_bf16 v[232:235], v[72:75], v[100:103], v[232:235]
ds_read_b128 v[36:39], v3 offset:5120
v_mov_b32 v119, 0
v_mfma_f32_16x16x32_bf16 v[204:207], v[76:79], v[96:99], v[204:207]
ds_read_b128 v[40:43], v3 offset:6144
v_mov_b32 v120, 0
v_mfma_f32_16x16x32_bf16 v[236:239], v[76:79], v[100:103], v[236:239]
ds_read_b128 v[44:47], v3 offset:7168
v_mov_b32 v121, 0
v_mfma_f32_16x16x32_bf16 v[208:211], v[80:83], v[96:99], v[208:211]
v_mov_b32 v122, 0
v_mov_b32 v123, 0
v_mfma_f32_16x16x32_bf16 v[240:243], v[80:83], v[100:103], v[240:243]
v_mov_b32 v124, 0
v_mfma_f32_16x16x32_bf16 v[212:215], v[84:87], v[96:99], v[212:215]
v_mov_b32 v125, 0
v_mfma_f32_16x16x32_bf16 v[244:247], v[84:87], v[100:103], v[244:247]
v_mov_b32 v126, 0
v_mfma_f32_16x16x32_bf16 v[216:219], v[88:91], v[96:99], v[216:219]
v_mov_b32 v127, 0
v_mov_b32 v8, 0x3f803f80
v_mfma_f32_16x16x32_bf16 v[248:251], v[88:91], v[100:103], v[248:251]
v_mov_b32 v9, 0x3f803f80
v_mfma_f32_16x16x32_bf16 v[220:223], v[92:95], v[96:99], v[220:223]
v_mov_b32 v10, 0x3f803f80
v_mfma_f32_16x16x32_bf16 v[252:255], v[92:95], v[100:103], v[252:255]
v_mov_b32 v11, 0x3f803f80
s_mov_b32 s64, 0x4e800000
s_lshr_b32 s55, s34, 15
s_lshl_b32 s41, s31, 1
s_sub_u32 s67, 31, s41
s_mov_b32 s65, 3
s_mov_b32 s66, 1
s_mov_b32 s72, 1
s_lshl_b32 s41, s32, 8
s_add_u32 s41, s41, 131072
v_lshlrev_b32 v0, 2, v1
v_add_u32 v0, s41, v0
v_and_b32 v1, 3, v1
v_lshlrev_b32 v1, 8, v1
v_add_u32 v1, 131072, v1
s_mov_b32 s48, 65536
v_mov_b32 v88, 0
v_mov_b32 v89, 0
v_mov_b32 v90, 0
v_mov_b32 v91, 0
v_mov_b32 v92, 0
v_mov_b32 v93, 0
v_mov_b32 v94, 0
v_mov_b32 v95, 0
v_cvt_pk_bf16_f32 v192, v192, v193
v_cvt_pk_bf16_f32 v193, v194, v195
v_cvt_pk_bf16_f32 v194, v196, v197
v_cvt_pk_bf16_f32 v195, v198, v199
v_cvt_pk_bf16_f32 v196, v200, v201
v_cvt_pk_bf16_f32 v197, v202, v203
v_cvt_pk_bf16_f32 v198, v204, v205
v_cvt_pk_bf16_f32 v199, v206, v207
v_cvt_pk_bf16_f32 v200, v208, v209
v_cvt_pk_bf16_f32 v201, v210, v211
v_cvt_pk_bf16_f32 v202, v212, v213
v_cvt_pk_bf16_f32 v203, v214, v215
v_cvt_pk_bf16_f32 v204, v216, v217
v_cvt_pk_bf16_f32 v205, v218, v219
v_cvt_pk_bf16_f32 v206, v220, v221
v_cvt_pk_bf16_f32 v207, v222, v223
v_cvt_pk_bf16_f32 v208, v224, v225
v_cvt_pk_bf16_f32 v209, v226, v227
v_cvt_pk_bf16_f32 v210, v228, v229
v_cvt_pk_bf16_f32 v211, v230, v231
v_cvt_pk_bf16_f32 v212, v232, v233
v_cvt_pk_bf16_f32 v213, v234, v235
v_cvt_pk_bf16_f32 v214, v236, v237
v_cvt_pk_bf16_f32 v215, v238, v239
v_cvt_pk_bf16_f32 v216, v240, v241
v_cvt_pk_bf16_f32 v217, v242, v243
v_cvt_pk_bf16_f32 v218, v244, v245
v_cvt_pk_bf16_f32 v219, v246, v247
v_cvt_pk_bf16_f32 v220, v248, v249
v_cvt_pk_bf16_f32 v221, v250, v251
v_cvt_pk_bf16_f32 v222, v252, v253
v_cvt_pk_bf16_f32 v223, v254, v255
s_sub_u32 s45, s55, 1
s_mov_b32 s46, 0
s_cmp_lg_u32 s55, 0
s_cbranch_scc1 L_nmA
v_mov_b32 v7, 0xf149f2ca
v_cndmask_b32 v112, v112, v7, s[56:57]
v_cndmask_b32 v124, v124, v7, s[56:57]
v_mov_b32 v116, v7
v_cndmask_b32 v113, v113, v7, s[58:59]
v_cndmask_b32 v125, v125, v7, s[58:59]
v_mov_b32 v117, v7
v_cndmask_b32 v114, v114, v7, s[60:61]
v_cndmask_b32 v126, v126, v7, s[60:61]
v_mov_b32 v118, v7
v_cndmask_b32 v115, v115, v7, s[62:63]
v_cndmask_b32 v127, v127, v7, s[62:63]
v_mov_b32 v119, v7
s_nop 1
s_mov_b32 s45, 0
s_mov_b32 s46, 1
L_nmA:
s_nop 1
s_waitcnt lgkmcnt(7)
v_mfma_f32_16x16x32_bf16 v[224:227], v[16:19], v[192:195], v[112:115]
v_mfma_f32_16x16x32_bf16 v[232:235], v[16:19], v[208:211], v[120:123]
s_waitcnt lgkmcnt(6)
v_mfma_f32_16x16x32_bf16 v[224:227], v[20:23], v[196:199], v[224:227]
v_mfma_f32_16x16x32_bf16 v[232:235], v[20:23], v[212:215], v[232:235]
s_waitcnt lgkmcnt(5)
v_mfma_f32_16x16x32_bf16 v[224:227], v[24:27], v[200:203], v[224:227]
v_mfma_f32_16x16x32_bf16 v[232:235], v[24:27], v[216:219], v[232:235]
s_waitcnt lgkmcnt(4)
v_mfma_f32_16x16x32_bf16 v[224:227], v[28:31], v[204:207], v[224:227]
v_mfma_f32_16x16x32_bf16 v[232:235], v[28:31], v[220:223], v[232:235]
s_waitcnt lgkmcnt(3)
v_mfma_f32_16x16x32_bf16 v[228:231], v[32:35], v[192:195], v[116:119]
v_mfma_f32_16x16x32_bf16 v[236:239], v[32:35], v[208:211], v[124:127]
s_waitcnt lgkmcnt(2)
v_mfma_f32_16x16x32_bf16 v[228:231], v[36:39], v[196:199], v[228:231]
v_mfma_f32_16x16x32_bf16 v[236:239], v[36:39], v[212:215], v[236:239]
s_waitcnt lgkmcnt(1)
v_mfma_f32_16x16x32_bf16 v[228:231], v[40:43], v[200:203], v[228:231]
v_mfma_f32_16x16x32_bf16 v[236:239], v[40:43], v[216:219], v[236:239]
s_waitcnt lgkmcnt(0)
v_mfma_f32_16x16x32_bf16 v[228:231], v[44:47], v[204:207], v[228:231]
v_mfma_f32_16x16x32_bf16 v[236:239], v[44:47], v[220:223], v[236:239]
s_nop 5
v_max3_f32 v5, v224, v225, v226
v_max3_f32 v6, v232, v233, v234
v_max3_f32 v5, v5, v227, v228
v_max3_f32 v6, v6, v235, v236
v_max3_f32 v5, v5, v229, v230
v_max3_f32 v6, v6, v237, v238
v_max_f32 v5, v5, v231
v_max_f32 v6, v6, v239
v_mov_b32 v7, v5
v_mov_b32 v15, v6
s_nop 0
v_permlane16_swap_b32 v5, v7
v_permlane16_swap_b32 v6, v15
s_nop 0
v_max_f32 v5, v5, v7
v_max_f32 v6, v6, v15
v_mov_b32 v7, v5
v_mov_b32 v15, v6
s_nop 0
v_permlane32_swap_b32 v5, v7
v_permlane32_swap_b32 v6, v15
s_nop 0
v_max_f32 v5, v5, v7
v_max_f32 v6, v6, v15
v_ceil_f32 v5, v5
v_ceil_f32 v6, v6
v_sub_f32 v224, v224, v5
v_sub_f32 v225, v225, v5
v_sub_f32 v226, v226, v5
v_sub_f32 v227, v227, v5
v_sub_f32 v228, v228, v5
v_sub_f32 v229, v229, v5
v_sub_f32 v230, v230, v5
v_sub_f32 v231, v231, v5
v_sub_f32 v232, v232, v6
v_sub_f32 v233, v233, v6
v_sub_f32 v234, v234, v6
v_sub_f32 v235, v235, v6
v_sub_f32 v236, v236, v6
v_sub_f32 v237, v237, v6
v_sub_f32 v238, v238, v6
v_sub_f32 v239, v239, v6
v_exp_f32 v12, v224
v_exp_f32 v13, v225
v_sub_f32 v112, v112, v5
v_sub_f32 v113, v113, v5
v_cvt_pk_bf16_f32 v96, v12, v13
v_exp_f32 v14, v226
v_exp_f32 v15, v227
v_sub_f32 v114, v114, v5
v_sub_f32 v115, v115, v5
v_cvt_pk_bf16_f32 v97, v14, v15
v_exp_f32 v12, v228
v_exp_f32 v13, v229
v_sub_f32 v116, v116, v5
v_sub_f32 v117, v117, v5
v_cvt_pk_bf16_f32 v98, v12, v13
v_exp_f32 v14, v230
v_exp_f32 v15, v231
v_sub_f32 v118, v118, v5
v_sub_f32 v119, v119, v5
v_cvt_pk_bf16_f32 v99, v14, v15
v_exp_f32 v12, v232
v_exp_f32 v13, v233
v_sub_f32 v120, v120, v6
v_sub_f32 v121, v121, v6
v_cvt_pk_bf16_f32 v100, v12, v13
v_exp_f32 v14, v234
v_sub_f32 v122, v122, v6
v_sub_f32 v123, v123, v6
v_sub_f32 v124, v124, v6
v_sub_f32 v125, v125, v6
v_sub_f32 v126, v126, v6
v_sub_f32 v127, v127, v6
v_mov_b32 v5, 1
ds_write_b32 v0, v5
s_waitcnt vmcnt(0)
s_waitcnt lgkmcnt(0)
s_barrier
s_cmp_lt_u32 s31, 2
s_cbranch_scc1 L_lpA
s_cmp_lg_u32 s32, 0
s_cbranch_scc1 L_lqA
v_mov_b32 v6, s73
v_mov_b32 v7, s39
s_mov_b64 exec, 1
global_atomic_add v6, v7, s[28:29]
s_mov_b64 exec, -1
L_lqA:
L_lpA:
v_add_u32 v3, s48, v2
ds_read_b128 v[16:19], v3 offset:0
ds_read_b128 v[20:23], v3 offset:1024
ds_read_b128 v[24:27], v3 offset:2048
ds_read_b128 v[28:31], v3 offset:3072
ds_read_b128 v[32:35], v3 offset:4096
ds_read_b128 v[36:39], v3 offset:5120
ds_read_b128 v[40:43], v3 offset:6144
ds_read_b128 v[44:47], v3 offset:7168
s_cmp_ge_u32 s32, 2
s_cbranch_scc1 L_pfwo
s_load_dwordx2 s[68:69], s[0:1], 40
s_lshl_b32 s41, s2, 14
s_and_b32 s42, s32, 1
s_lshl_b32 s42, s42, 13
s_add_u32 s41, s41, s42
v_lshlrev_b32 v6, 3, v2
v_add_u32 v6, s41, v6
s_waitcnt lgkmcnt(0)
global_load_dword v4, v6, s[68:69]
L_pfwo:
L_loopA:
s_sub_u32 s45, s45, 1
s_cbranch_scc1 L_X0A
L_it0A:
s_waitcnt lgkmcnt(4)
v_mfma_f32_16x16x32_bf16 v[240:243], v[16:19], v[192:195], v[112:115]
ds_read_b128 v[48:51], v3 offset:16384
v_exp_f32 v15, v235
v_mfma_f32_16x16x32_bf16 v[248:251], v[16:19], v[208:211], v[120:123]
v_cvt_pk_bf16_f32 v101, v14, v15
v_mfma_f32_16x16x32_bf16 v[80:83], v[8:11], v[96:99], v[88:91]
v_exp_f32 v12, v236
v_mfma_f32_16x16x32_bf16 v[240:243], v[20:23], v[196:199], v[240:243]
ds_read_b128 v[52:55], v3 offset:17408
v_mfma_f32_16x16x32_bf16 v[248:251], v[20:23], v[212:215], v[248:251]
v_exp_f32 v13, v237
v_mfma_f32_16x16x32_bf16 v[240:243], v[24:27], v[200:203], v[240:243]
ds_read_b128 v[56:59], v3 offset:18432
v_cvt_pk_bf16_f32 v102, v12, v13
v_mfma_f32_16x16x32_bf16 v[248:251], v[24:27], v[216:219], v[248:251]
v_exp_f32 v14, v238
v_mfma_f32_16x16x32_bf16 v[240:243], v[28:31], v[204:207], v[240:243]
ds_read_b128 v[60:63], v3 offset:19456
v_mfma_f32_16x16x32_bf16 v[248:251], v[28:31], v[220:223], v[248:251]
v_exp_f32 v15, v239
s_waitcnt lgkmcnt(4)
v_mfma_f32_16x16x32_bf16 v[244:247], v[32:35], v[192:195], v[116:119]
ds_read_b128 v[64:67], v3 offset:20480
v_cvt_pk_bf16_f32 v103, v14, v15
v_mfma_f32_16x16x32_bf16 v[252:255], v[32:35], v[208:211], v[124:127]
v_mfma_f32_16x16x32_bf16 v[244:247], v[36:39], v[196:199], v[244:247]
ds_read_b128 v[68:71], v3 offset:21504
v_exp_f32 v12, v240
v_mfma_f32_16x16x32_bf16 v[84:87], v[8:11], v[100:103], v[92:95]
v_mfma_f32_16x16x32_bf16 v[252:255], v[36:39], v[212:215], v[252:255]
v_exp_f32 v13, v241
v_mfma_f32_16x16x32_bf16 v[244:247], v[40:43], v[200:203], v[244:247]
ds_read_b128 v[72:75], v3 offset:22528
v_cvt_pk_bf16_f32 v104, v12, v13
v_mfma_f32_16x16x32_bf16 v[252:255], v[40:43], v[216:219], v[252:255]
v_exp_f32 v14, v242
v_mfma_f32_16x16x32_bf16 v[244:247], v[44:47], v[204:207], v[244:247]
ds_read_b128 v[76:79], v3 offset:23552
v_max_f32 v5, v80, v84
v_cmp_lt_f32 vcc, s64, v5
v_mfma_f32_16x16x32_bf16 v[252:255], v[44:47], v[220:223], v[252:255]
v_exp_f32 v15, v243
s_cbranch_vccnz L_slow0A
L_ret0A:
s_waitcnt lgkmcnt(4)
v_mfma_f32_16x16x32_bf16 v[128:131], v[48:51], v[96:99], v[128:131]
ds_read_b128 v[16:19], v3 offset:8192
v_cvt_pk_bf16_f32 v105, v14, v15
v_mfma_f32_16x16x32_bf16 v[160:163], v[48:51], v[100:103], v[160:163]
v_exp_f32 v12, v244
v_mfma_f32_16x16x32_bf16 v[132:135], v[52:55], v[96:99], v[132:135]
ds_read_b128 v[20:23], v3 offset:9216
v_mfma_f32_16x16x32_bf16 v[164:167], v[52:55], v[100:103], v[164:167]
v_exp_f32 v13, v245
v_mfma_f32_16x16x32_bf16 v[136:139], v[56:59], v[96:99], v[136:139]
ds_read_b128 v[24:27], v3 offset:10240
v_cvt_pk_bf16_f32 v106, v12, v13
v_mfma_f32_16x16x32_bf16 v[168:171], v[56:59], v[100:103], v[168:171]
v_exp_f32 v14, v246
v_mfma_f32_16x16x32_bf16 v[140:143], v[60:63], v[96:99], v[140:143]
ds_read_b128 v[28:31], v3 offset:11264
v_mfma_f32_16x16x32_bf16 v[172:175], v[60:63], v[100:103], v[172:175]
v_exp_f32 v15, v247
s_waitcnt lgkmcnt(4)
v_mfma_f32_16x16x32_bf16 v[144:147], v[64:67], v[96:99], v[144:147]
ds_read_b128 v[32:35], v3 offset:12288
v_cvt_pk_bf16_f32 v107, v14, v15
v_mfma_f32_16x16x32_bf16 v[176:179], v[64:67], v[100:103], v[176:179]
v_exp_f32 v12, v248
v_mfma_f32_16x16x32_bf16 v[148:151], v[68:71], v[96:99], v[148:151]
ds_read_b128 v[36:39], v3 offset:13312
v_mfma_f32_16x16x32_bf16 v[180:183], v[68:71], v[100:103], v[180:183]
v_exp_f32 v13, v249
v_mfma_f32_16x16x32_bf16 v[152:155], v[72:75], v[96:99], v[152:155]
ds_read_b128 v[40:43], v3 offset:14336
v_cvt_pk_bf16_f32 v108, v12, v13
v_mfma_f32_16x16x32_bf16 v[184:187], v[72:75], v[100:103], v[184:187]
v_exp_f32 v14, v250
v_mfma_f32_16x16x32_bf16 v[156:159], v[76:79], v[96:99], v[156:159]
ds_read_b128 v[44:47], v3 offset:15360
v_mfma_f32_16x16x32_bf16 v[188:191], v[76:79], v[100:103], v[188:191]
s_sub_u32 s45, s45, 1
s_cbranch_scc1 L_X1A
L_it1A:
s_waitcnt lgkmcnt(4)
v_mfma_f32_16x16x32_bf16 v[224:227], v[16:19], v[192:195], v[112:115]
ds_read_b128 v[48:51], v3 offset:24576
v_exp_f32 v15, v251
v_mfma_f32_16x16x32_bf16 v[232:235], v[16:19], v[208:211], v[120:123]
v_cvt_pk_bf16_f32 v109, v14, v15
v_mfma_f32_16x16x32_bf16 v[88:91], v[8:11], v[104:107], v[80:83]
v_exp_f32 v12, v252
v_mfma_f32_16x16x32_bf16 v[224:227], v[20:23], v[196:199], v[224:227]
ds_read_b128 v[52:55], v3 offset:25600
v_mfma_f32_16x16x32_bf16 v[232:235], v[20:23], v[212:215], v[232:235]
v_exp_f32 v13, v253
ds_read_b32 v5, v1 offset:2048
v_mfma_f32_16x16x32_bf16 v[224:227], v[24:27], v[200:203], v[224:227]
ds_read_b128 v[56:59], v3 offset:26624
v_cvt_pk_bf16_f32 v110, v12, v13
v_mfma_f32_16x16x32_bf16 v[232:235], v[24:27], v[216:219], v[232:235]
v_exp_f32 v14, v254
v_mfma_f32_16x16x32_bf16 v[224:227], v[28:31], v[204:207], v[224:227]
ds_read_b128 v[60:63], v3 offset:27648
v_mfma_f32_16x16x32_bf16 v[232:235], v[28:31], v[220:223], v[232:235]
v_exp_f32 v15, v255
s_waitcnt lgkmcnt(5)
v_mfma_f32_16x16x32_bf16 v[228:231], v[32:35], v[192:195], v[116:119]
ds_read_b128 v[64:67], v3 offset:28672
v_cvt_pk_bf16_f32 v111, v14, v15
v_mfma_f32_16x16x32_bf16 v[236:239], v[32:35], v[208:211], v[124:127]
v_mfma_f32_16x16x32_bf16 v[228:231], v[36:39], v[196:199], v[228:231]
ds_read_b128 v[68:71], v3 offset:29696
v_exp_f32 v12, v224
v_mfma_f32_16x16x32_bf16 v[92:95], v[8:11], v[108:111], v[84:87]
v_mfma_f32_16x16x32_bf16 v[236:239], v[36:39], v[212:215], v[236:239]
v_exp_f32 v13, v225
s_waitcnt lgkmcnt(4)
v_cmp_gt_u32 s[68:69], s65, v5
v_mfma_f32_16x16x32_bf16 v[228:231], v[40:43], v[200:203], v[228:231]
ds_read_b128 v[72:75], v3 offset:30720
v_cvt_pk_bf16_f32 v96, v12, v13
v_mfma_f32_16x16x32_bf16 v[236:239], v[40:43], v[216:219], v[236:239]
v_exp_f32 v14, v226
v_mfma_f32_16x16x32_bf16 v[228:231], v[44:47], v[204:207], v[228:231]
ds_read_b128 v[76:79], v3 offset:31744
v_max_f32 v5, v88, v92
v_cmp_lt_f32 vcc, s64, v5
v_mfma_f32_16x16x32_bf16 v[236:239], v[44:47], v[220:223], v[236:239]
v_exp_f32 v15, v227
s_or_b64 vcc, vcc, s[68:69]
s_cbranch_scc1 L_slow1A
L_ret1A:
s_add_u32 s48, s48, 32768
s_and_b32 s48, s48, 0x1ffff
v_add_u32 v3, s48, v2
s_waitcnt lgkmcnt(4)
v_mfma_f32_16x16x32_bf16 v[128:131], v[48:51], v[104:107], v[128:131]
ds_read_b128 v[16:19], v3 offset:0
v_cvt_pk_bf16_f32 v97, v14, v15
v_mfma_f32_16x16x32_bf16 v[160:163], v[48:51], v[108:111], v[160:163]
v_exp_f32 v12, v228
v_mfma_f32_16x16x32_bf16 v[132:135], v[52:55], v[104:107], v[132:135]
ds_read_b128 v[20:23], v3 offset:1024
v_mfma_f32_16x16x32_bf16 v[164:167], v[52:55], v[108:111], v[164:167]
v_exp_f32 v13, v229
v_mfma_f32_16x16x32_bf16 v[136:139], v[56:59], v[104:107], v[136:139]
ds_read_b128 v[24:27], v3 offset:2048
v_cvt_pk_bf16_f32 v98, v12, v13
v_mfma_f32_16x16x32_bf16 v[168:171], v[56:59], v[108:111], v[168:171]
v_exp_f32 v14, v230
v_mfma_f32_16x16x32_bf16 v[140:143], v[60:63], v[104:107], v[140:143]
ds_read_b128 v[28:31], v3 offset:3072
v_mfma_f32_16x16x32_bf16 v[172:175], v[60:63], v[108:111], v[172:175]
v_exp_f32 v15, v231
s_waitcnt lgkmcnt(4)
v_mfma_f32_16x16x32_bf16 v[144:147], v[64:67], v[104:107], v[144:147]
ds_read_b128 v[32:35], v3 offset:4096
s_sub_u32 s41, s65, 1
v_mov_b32 v6, s41
ds_write_b32 v0, v6
s_add_u32 s65, s65, 1
v_cvt_pk_bf16_f32 v99, v14, v15
v_mfma_f32_16x16x32_bf16 v[176:179], v[64:67], v[108:111], v[176:179]
v_exp_f32 v12, v232
v_mfma_f32_16x16x32_bf16 v[148:151], v[68:71], v[104:107], v[148:151]
ds_read_b128 v[36:39], v3 offset:5120
v_mfma_f32_16x16x32_bf16 v[180:183], v[68:71], v[108:111], v[180:183]
v_exp_f32 v13, v233
v_mfma_f32_16x16x32_bf16 v[152:155], v[72:75], v[104:107], v[152:155]
ds_read_b128 v[40:43], v3 offset:6144
v_cvt_pk_bf16_f32 v100, v12, v13
v_mfma_f32_16x16x32_bf16 v[184:187], v[72:75], v[108:111], v[184:187]
v_exp_f32 v14, v234
v_mfma_f32_16x16x32_bf16 v[156:159], v[76:79], v[104:107], v[156:159]
ds_read_b128 v[44:47], v3 offset:7168
v_mfma_f32_16x16x32_bf16 v[188:191], v[76:79], v[108:111], v[188:191]
s_sub_u32 s45, s45, 1
s_cbranch_scc1 L_X2A
L_it2A:
s_waitcnt lgkmcnt(5)
v_mfma_f32_16x16x32_bf16 v[240:243], v[16:19], v[192:195], v[112:115]
ds_read_b128 v[48:51], v3 offset:16384
v_exp_f32 v15, v235
v_mfma_f32_16x16x32_bf16 v[248:251], v[16:19], v[208:211], v[120:123]
v_cvt_pk_bf16_f32 v101, v14, v15
v_mfma_f32_16x16x32_bf16 v[80:83], v[8:11], v[96:99], v[88:91]
v_exp_f32 v12, v236
v_mfma_f32_16x16x32_bf16 v[240:243], v[20:23], v[196:199], v[240:243]
ds_read_b128 v[52:55], v3 offset:17408
v_mfma_f32_16x16x32_bf16 v[248:251], v[20:23], v[212:215], v[248:251]
v_exp_f32 v13, v237
v_mfma_f32_16x16x32_bf16 v[240:243], v[24:27], v[200:203], v[240:243]
ds_read_b128 v[56:59], v3 offset:18432
v_cvt_pk_bf16_f32 v102, v12, v13
v_mfma_f32_16x16x32_bf16 v[248:251], v[24:27], v[216:219], v[248:251]
v_exp_f32 v14, v238
v_mfma_f32_16x16x32_bf16 v[240:243], v[28:31], v[204:207], v[240:243]
ds_read_b128 v[60:63], v3 offset:19456
v_mfma_f32_16x16x32_bf16 v[248:251], v[28:31], v[220:223], v[248:251]
v_exp_f32 v15, v239
s_waitcnt lgkmcnt(4)
v_mfma_f32_16x16x32_bf16 v[244:247], v[32:35], v[192:195], v[116:119]
ds_read_b128 v[64:67], v3 offset:20480
v_cvt_pk_bf16_f32 v103, v14, v15
v_mfma_f32_16x16x32_bf16 v[252:255], v[32:35], v[208:211], v[124:127]
v_mfma_f32_16x16x32_bf16 v[244:247], v[36:39], v[196:199], v[244:247]
ds_read_b128 v[68:71], v3 offset:21504
v_exp_f32 v12, v240
v_mfma_f32_16x16x32_bf16 v[84:87], v[8:11], v[100:103], v[92:95]
v_mfma_f32_16x16x32_bf16 v[252:255], v[36:39], v[212:215], v[252:255]
v_exp_f32 v13, v241
v_mfma_f32_16x16x32_bf16 v[244:247], v[40:43], v[200:203], v[244:247]
ds_read_b128 v[72:75], v3 offset:22528
v_cvt_pk_bf16_f32 v104, v12, v13
v_mfma_f32_16x16x32_bf16 v[252:255], v[40:43], v[216:219], v[252:255]
v_exp_f32 v14, v242
v_mfma_f32_16x16x32_bf16 v[244:247], v[44:47], v[204:207], v[244:247]
ds_read_b128 v[76:79], v3 offset:23552
v_max_f32 v5, v80, v84
v_cmp_lt_f32 vcc, s64, v5
v_mfma_f32_16x16x32_bf16 v[252:255], v[44:47], v[220:223], v[252:255]
v_exp_f32 v15, v243
s_cbranch_vccnz L_slow2A
L_ret2A:
s_waitcnt lgkmcnt(4)
v_mfma_f32_16x16x32_bf16 v[128:131], v[48:51], v[96:99], v[128:131]
ds_read_b128 v[16:19], v3 offset:8192
v_cvt_pk_bf16_f32 v105, v14, v15
v_mfma_f32_16x16x32_bf16 v[160:163], v[48:51], v[100:103], v[160:163]
v_exp_f32 v12, v244
v_mfma_f32_16x16x32_bf16 v[132:135], v[52:55], v[96:99], v[132:135]
ds_read_b128 v[20:23], v3 offset:9216
v_mfma_f32_16x16x32_bf16 v[164:167], v[52:55], v[100:103], v[164:167]
v_exp_f32 v13, v245
v_mfma_f32_16x16x32_bf16 v[136:139], v[56:59], v[96:99], v[136:139]
ds_read_b128 v[24:27], v3 offset:10240
v_cvt_pk_bf16_f32 v106, v12, v13
v_mfma_f32_16x16x32_bf16 v[168:171], v[56:59], v[100:103], v[168:171]
v_exp_f32 v14, v246
v_mfma_f32_16x16x32_bf16 v[140:143], v[60:63], v[96:99], v[140:143]
ds_read_b128 v[28:31], v3 offset:11264
v_mfma_f32_16x16x32_bf16 v[172:175], v[60:63], v[100:103], v[172:175]
v_exp_f32 v15, v247
s_waitcnt lgkmcnt(4)
v_mfma_f32_16x16x32_bf16 v[144:147], v[64:67], v[96:99], v[144:147]
ds_read_b128 v[32:35], v3 offset:12288
v_cvt_pk_bf16_f32 v107, v14, v15
v_mfma_f32_16x16x32_bf16 v[176:179], v[64:67], v[100:103], v[176:179]
v_exp_f32 v12, v248
v_mfma_f32_16x16x32_bf16 v[148:151], v[68:71], v[96:99], v[148:151]
ds_read_b128 v[36:39], v3 offset:13312
v_mfma_f32_16x16x32_bf16 v[180:183], v[68:71], v[100:103], v[180:183]
v_exp_f32 v13, v249
v_mfma_f32_16x16x32_bf16 v[152:155], v[72:75], v[96:99], v[152:155]
ds_read_b128 v[40:43], v3 offset:14336
v_cvt_pk_bf16_f32 v108, v12, v13
v_mfma_f32_16x16x32_bf16 v[184:187], v[72:75], v[100:103], v[184:187]
v_exp_f32 v14, v250
v_mfma_f32_16x16x32_bf16 v[156:159], v[76:79], v[96:99], v[156:159]
ds_read_b128 v[44:47], v3 offset:15360
v_mfma_f32_16x16x32_bf16 v[188:191], v[76:79], v[100:103], v[188:191]
s_sub_u32 s45, s45, 1
s_cbranch_scc1 L_X3A
L_it3A:
s_waitcnt lgkmcnt(4)
v_mfma_f32_16x16x32_bf16 v[224:227], v[16:19], v[192:195], v[112:115]
ds_read_b128 v[48:51], v3 offset:24576
v_exp_f32 v15, v251
v_mfma_f32_16x16x32_bf16 v[232:235], v[16:19], v[208:211], v[120:123]
v_cvt_pk_bf16_f32 v109, v14, v15
v_mfma_f32_16x16x32_bf16 v[88:91], v[8:11], v[104:107], v[80:83]
v_exp_f32 v12, v252
v_mfma_f32_16x16x32_bf16 v[224:227], v[20:23], v[196:199], v[224:227]
ds_read_b128 v[52:55], v3 offset:25600
v_mfma_f32_16x16x32_bf16 v[232:235], v[20:23], v[212:215], v[232:235]
v_exp_f32 v13, v253
ds_read_b32 v5, v1 offset:2048
v_mfma_f32_16x16x32_bf16 v[224:227], v[24:27], v[200:203], v[224:227]
ds_read_b128 v[56:59], v3 offset:26624
v_cvt_pk_bf16_f32 v110, v12, v13
v_mfma_f32_16x16x32_bf16 v[232:235], v[24:27], v[216:219], v[232:235]
v_exp_f32 v14, v254
v_mfma_f32_16x16x32_bf16 v[224:227], v[28:31], v[204:207], v[224:227]
ds_read_b128 v[60:63], v3 offset:27648
v_mfma_f32_16x16x32_bf16 v[232:235], v[28:31], v[220:223], v[232:235]
v_exp_f32 v15, v255
s_waitcnt lgkmcnt(5)
v_mfma_f32_16x16x32_bf16 v[228:231], v[32:35], v[192:195], v[116:119]
ds_read_b128 v[64:67], v3 offset:28672
v_cvt_pk_bf16_f32 v111, v14, v15
v_mfma_f32_16x16x32_bf16 v[236:239], v[32:35], v[208:211], v[124:127]
v_mfma_f32_16x16x32_bf16 v[228:231], v[36:39], v[196:199], v[228:231]
ds_read_b128 v[68:71], v3 offset:29696
v_exp_f32 v12, v224
v_mfma_f32_16x16x32_bf16 v[92:95], v[8:11], v[108:111], v[84:87]
v_mfma_f32_16x16x32_bf16 v[236:239], v[36:39], v[212:215], v[236:239]
v_exp_f32 v13, v225
s_waitcnt lgkmcnt(4)
v_cmp_gt_u32 s[68:69], s65, v5
v_mfma_f32_16x16x32_bf16 v[228:231], v[40:43], v[200:203], v[228:231]
ds_read_b128 v[72:75], v3 offset:30720
v_cvt_pk_bf16_f32 v96, v12, v13
v_mfma_f32_16x16x32_bf16 v[236:239], v[40:43], v[216:219], v[236:239]
v_exp_f32 v14, v226
v_mfma_f32_16x16x32_bf16 v[228:231], v[44:47], v[204:207], v[228:231]
ds_read_b128 v[76:79], v3 offset:31744
v_max_f32 v5, v88, v92
v_cmp_lt_f32 vcc, s64, v5
v_mfma_f32_16x16x32_bf16 v[236:239], v[44:47], v[220:223], v[236:239]
v_exp_f32 v15, v227
s_or_b64 vcc, vcc, s[68:69]
s_cbranch_scc1 L_slow3A
L_ret3A:
s_add_u32 s48, s48, 32768
s_and_b32 s48, s48, 0x1ffff
v_add_u32 v3, s48, v2
s_waitcnt lgkmcnt(4)
v_mfma_f32_16x16x32_bf16 v[128:131], v[48:51], v[104:107], v[128:131]
ds_read_b128 v[16:19], v3 offset:0
v_cvt_pk_bf16_f32 v97, v14, v15
v_mfma_f32_16x16x32_bf16 v[160:163], v[48:51], v[108:111], v[160:163]
v_exp_f32 v12, v228
v_mfma_f32_16x16x32_bf16 v[132:135], v[52:55], v[104:107], v[132:135]
ds_read_b128 v[20:23], v3 offset:1024
v_mfma_f32_16x16x32_bf16 v[164:167], v[52:55], v[108:111], v[164:167]
v_exp_f32 v13, v229
v_mfma_f32_16x16x32_bf16 v[136:139], v[56:59], v[104:107], v[136:139]
ds_read_b128 v[24:27], v3 offset:2048
v_cvt_pk_bf16_f32 v98, v12, v13
v_mfma_f32_16x16x32_bf16 v[168:171], v[56:59], v[108:111], v[168:171]
v_exp_f32 v14, v230
v_mfma_f32_16x16x32_bf16 v[140:143], v[60:63], v[104:107], v[140:143]
ds_read_b128 v[28:31], v3 offset:3072
v_mfma_f32_16x16x32_bf16 v[172:175], v[60:63], v[108:111], v[172:175]
v_exp_f32 v15, v231
s_waitcnt lgkmcnt(4)
v_mfma_f32_16x16x32_bf16 v[144:147], v[64:67], v[104:107], v[144:147]
ds_read_b128 v[32:35], v3 offset:4096
s_sub_u32 s41, s65, 1
v_mov_b32 v6, s41
ds_write_b32 v0, v6
s_add_u32 s65, s65, 1
v_cvt_pk_bf16_f32 v99, v14, v15
v_mfma_f32_16x16x32_bf16 v[176:179], v[64:67], v[108:111], v[176:179]
v_exp_f32 v12, v232
v_mfma_f32_16x16x32_bf16 v[148:151], v[68:71], v[104:107], v[148:151]
ds_read_b128 v[36:39], v3 offset:5120
v_mfma_f32_16x16x32_bf16 v[180:183], v[68:71], v[108:111], v[180:183]
v_exp_f32 v13, v233
v_mfma_f32_16x16x32_bf16 v[152:155], v[72:75], v[104:107], v[152:155]
ds_read_b128 v[40:43], v3 offset:6144
v_cvt_pk_bf16_f32 v100, v12, v13
v_mfma_f32_16x16x32_bf16 v[184:187], v[72:75], v[108:111], v[184:187]
v_exp_f32 v14, v234
v_mfma_f32_16x16x32_bf16 v[156:159], v[76:79], v[104:107], v[156:159]
ds_read_b128 v[44:47], v3 offset:7168
v_mfma_f32_16x16x32_bf16 v[188:191], v[76:79], v[108:111], v[188:191]
s_branch L_loopA
L_slow0A:
s_call_b64 s[52:53], L_rh0
s_branch L_ret0A
L_X0A:
s_cmp_lg_u32 s46, 0
s_cbranch_scc1 L_tail0
v_mov_b32 v7, 0xf149f2ca
v_cndmask_b32 v112, v112, v7, s[56:57]
v_cndmask_b32 v124, v124, v7, s[56:57]
v_mov_b32 v116, v7
v_cndmask_b32 v113, v113, v7, s[58:59]
v_cndmask_b32 v125, v125, v7, s[58:59]
v_mov_b32 v117, v7
v_cndmask_b32 v114, v114, v7, s[60:61]
v_cndmask_b32 v126, v126, v7, s[60:61]
v_mov_b32 v118, v7
v_cndmask_b32 v115, v115, v7, s[62:63]
v_cndmask_b32 v127, v127, v7, s[62:63]
v_mov_b32 v119, v7
s_nop 1
s_mov_b32 s46, 1
s_mov_b32 s45, 0
s_branch L_it0A
L_slow1A:
v_max_f32 v5, v88, v92
v_cmp_lt_f32 vcc, s64, v5
s_nop 1
s_cbranch_vccz L_sl1Aa
s_call_b64 s[52:53], L_rh1
L_sl1Aa:
s_mov_b32 s44, 0
L_sl1Ab:
ds_read_b32 v6, v1 offset:2048
s_waitcnt lgkmcnt(0)
v_cmp_gt_u32 vcc, s65, v6
s_nop 1
s_cbranch_vccz L_sl1Abx
s_sleep 1
s_add_u32 s44, s44, 1
s_cmp_lt_u32 s44, 0x200000
s_cbranch_scc1 L_sl1Ab
L_sl1Abx:
s_branch L_ret1A
L_X1A:
s_cmp_lg_u32 s46, 0
s_cbranch_scc1 L_tail1
v_mov_b32 v7, 0xf149f2ca
v_cndmask_b32 v112, v112, v7, s[56:57]
v_cndmask_b32 v124, v124, v7, s[56:57]
v_mov_b32 v116, v7
v_cndmask_b32 v113, v113, v7, s[58:59]
v_cndmask_b32 v125, v125, v7, s[58:59]
v_mov_b32 v117, v7
v_cndmask_b32 v114, v114, v7, s[60:61]
v_cndmask_b32 v126, v126, v7, s[60:61]
v_mov_b32 v118, v7
v_cndmask_b32 v115, v115, v7, s[62:63]
v_cndmask_b32 v127, v127, v7, s[62:63]
v_mov_b32 v119, v7
s_nop 1
s_mov_b32 s46, 1
s_mov_b32 s45, 0
s_branch L_it1A
L_slow2A:
s_call_b64 s[52:53], L_rh0
s_branch L_ret2A
L_X2A:
s_cmp_lg_u32 s46, 0
s_cbranch_scc1 L_tail0
v_mov_b32 v7, 0xf149f2ca
v_cndmask_b32 v112, v112, v7, s[56:57]
v_cndmask_b32 v124, v124, v7, s[56:57]
v_mov_b32 v116, v7
v_cndmask_b32 v113, v113, v7, s[58:59]
v_cndmask_b32 v125, v125, v7, s[58:59]
v_mov_b32 v117, v7
v_cndmask_b32 v114, v114, v7, s[60:61]
v_cndmask_b32 v126, v126, v7, s[60:61]
v_mov_b32 v118, v7
v_cndmask_b32 v115, v115, v7, s[62:63]
v_cndmask_b32 v127, v127, v7, s[62:63]
v_mov_b32 v119, v7
s_nop 1
s_mov_b32 s46, 1
s_mov_b32 s45, 0
s_branch L_it2A
L_slow3A:
v_max_f32 v5, v88, v92
v_cmp_lt_f32 vcc, s64, v5
s_nop 1
s_cbranch_vccz L_sl3Aa
s_call_b64 s[52:53], L_rh1
L_sl3Aa:
s_mov_b32 s44, 0
L_sl3Ab:
ds_read_b32 v6, v1 offset:2048
s_waitcnt lgkmcnt(0)
v_cmp_gt_u32 vcc, s65, v6
s_nop 1
s_cbranch_vccz L_sl3Abx
s_sleep 1
s_add_u32 s44, s44, 1
s_cmp_lt_u32 s44, 0x200000
s_cbranch_scc1 L_sl3Ab
L_sl3Abx:
s_branch L_ret3A
L_X3A:
s_cmp_lg_u32 s46, 0
s_cbranch_scc1 L_tail1
v_mov_b32 v7, 0xf149f2ca
v_cndmask_b32 v112, v112, v7, s[56:57]
v_cndmask_b32 v124, v124, v7, s[56:57]
v_mov_b32 v116, v7
v_cndmask_b32 v113, v113, v7, s[58:59]
v_cndmask_b32 v125, v125, v7, s[58:59]
v_mov_b32 v117, v7
v_cndmask_b32 v114, v114, v7, s[60:61]
v_cndmask_b32 v126, v126, v7, s[60:61]
v_mov_b32 v118, v7
v_cndmask_b32 v115, v115, v7, s[62:63]
v_cndmask_b32 v127, v127, v7, s[62:63]
v_mov_b32 v119, v7
s_nop 1
s_mov_b32 s46, 1
s_mov_b32 s45, 0
s_branch L_it3A
L_vwaves:
s_waitcnt vmcnt(12) lgkmcnt(0)
s_barrier
ds_read_b64_tr_b16 v[48:49], v7 offset:0
ds_read_b64_tr_b16 v[50:51], v7 offset:1024
ds_read_b64_tr_b16 v[52:53], v8 offset:0
ds_read_b64_tr_b16 v[54:55], v8 offset:1024
ds_read_b64_tr_b16 v[56:57], v9 offset:0
ds_read_b64_tr_b16 v[58:59], v9 offset:1024
ds_read_b64_tr_b16 v[60:61], v10 offset:0
ds_read_b64_tr_b16 v[62:63], v10 offset:1024
ds_read_b128 v[16:19], v3 offset:0
ds_read_b128 v[20:23], v3 offset:2048
ds_read_b128 v[24:27], v3 offset:4096
ds_read_b128 v[28:31], v3 offset:6144
ds_read_b128 v[32:35], v3 offset:8192
ds_read_b128 v[36:39], v3 offset:10240
ds_read_b128 v[40:43], v3 offset:12288
ds_read_b128 v[44:47], v3 offset:14336
s_add_u32 m0, s38, 147456
s_add_u32 s43, s35, 786432
buffer_load_dwordx4 v13, s[12:15], s43 offen lds
s_add_u32 m0, s38, 148480
s_add_u32 s43, s35, 819200
buffer_load_dwordx4 v13, s[12:15], s43 offen lds
s_waitcnt vmcnt(12) lgkmcnt(0)
s_barrier
v_mfma_f32_16x16x32_bf16 v[128:131], v[16:19], v[48:51], 0
ds_read_b64_tr_b16 v[96:97], v7 offset:16384
v_mfma_f32_16x16x32_bf16 v[136:139], v[16:19], v[52:55], 0
ds_read_b64_tr_b16 v[98:99], v7 offset:17408
v_mfma_f32_16x16x32_bf16 v[144:147], v[16:19], v[56:59], 0
v_mfma_f32_16x16x32_bf16 v[152:155], v[16:19], v[60:63], 0
ds_read_b64_tr_b16 v[100:101], v8 offset:16384
v_mfma_f32_16x16x32_bf16 v[132:135], v[20:23], v[48:51], 0
v_mfma_f32_16x16x32_bf16 v[140:143], v[20:23], v[52:55], 0
ds_read_b64_tr_b16 v[102:103], v8 offset:17408
v_mfma_f32_16x16x32_bf16 v[148:151], v[20:23], v[56:59], 0
s_add_u32 m0, s38, 98304
s_add_u32 s43, s35, 1048576
buffer_load_dwordx4 v13, s[12:15], s43 offen lds
v_mfma_f32_16x16x32_bf16 v[156:159], v[20:23], v[60:63], 0
ds_read_b64_tr_b16 v[104:105], v9 offset:16384
v_mfma_f32_16x16x32_bf16 v[160:163], v[24:27], v[48:51], 0
ds_read_b64_tr_b16 v[106:107], v9 offset:17408
v_mfma_f32_16x16x32_bf16 v[168:171], v[24:27], v[52:55], 0
v_mfma_f32_16x16x32_bf16 v[176:179], v[24:27], v[56:59], 0
ds_read_b64_tr_b16 v[108:109], v10 offset:16384
v_mfma_f32_16x16x32_bf16 v[184:187], v[24:27], v[60:63], 0
v_mfma_f32_16x16x32_bf16 v[164:167], v[28:31], v[48:51], 0
ds_read_b64_tr_b16 v[110:111], v10 offset:17408
v_mfma_f32_16x16x32_bf16 v[172:175], v[28:31], v[52:55], 0
v_mfma_f32_16x16x32_bf16 v[180:183], v[28:31], v[56:59], 0
ds_read_b128 v[64:67], v4 offset:0
v_mfma_f32_16x16x32_bf16 v[188:191], v[28:31], v[60:63], 0
ds_read_b128 v[68:71], v4 offset:2048
v_mfma_f32_16x16x32_bf16 v[192:195], v[32:35], v[48:51], 0
v_mfma_f32_16x16x32_bf16 v[200:203], v[32:35], v[52:55], 0
ds_read_b128 v[72:75], v4 offset:4096
v_mfma_f32_16x16x32_bf16 v[208:211], v[32:35], v[56:59], 0
v_mfma_f32_16x16x32_bf16 v[216:219], v[32:35], v[60:63], 0
ds_read_b128 v[76:79], v4 offset:6144
v_mfma_f32_16x16x32_bf16 v[196:199], v[36:39], v[48:51], 0
s_add_u32 m0, s38, 99328
s_add_u32 s43, s35, 1081344
buffer_load_dwordx4 v13, s[12:15], s43 offen lds
v_mfma_f32_16x16x32_bf16 v[204:207], v[36:39], v[52:55], 0
ds_read_b128 v[80:83], v4 offset:8192
v_lshlrev_b32 v14, 16, v112
v_lshlrev_b32 v15, 16, v116
v_lshlrev_b32 v127, 16, v120
v_mfma_f32_16x16x32_bf16 v[212:215], v[36:39], v[56:59], 0
ds_read_b128 v[84:87], v4 offset:10240
v_mul_f32 v124, v14, v15
v_mul_f32 v126, v14, v127
v_and_b32 v14, 0xffff0000, v112
v_mfma_f32_16x16x32_bf16 v[220:223], v[36:39], v[60:63], 0
v_and_b32 v15, 0xffff0000, v116
v_and_b32 v127, 0xffff0000, v120
v_fmac_f32 v124, v14, v15
v_mfma_f32_16x16x32_bf16 v[224:227], v[40:43], v[48:51], 0
ds_read_b128 v[88:91], v4 offset:12288
v_fmac_f32 v126, v14, v127
v_lshlrev_b32 v14, 16, v113
v_lshlrev_b32 v15, 16, v117
v_mfma_f32_16x16x32_bf16 v[232:235], v[40:43], v[52:55], 0
v_lshlrev_b32 v127, 16, v121
v_fmac_f32 v124, v14, v15
v_fmac_f32 v126, v14, v127
v_mfma_f32_16x16x32_bf16 v[240:243], v[40:43], v[56:59], 0
ds_read_b128 v[92:95], v4 offset:14336
v_and_b32 v14, 0xffff0000, v113
v_and_b32 v15, 0xffff0000, v117
v_and_b32 v127, 0xffff0000, v121
v_mfma_f32_16x16x32_bf16 v[248:251], v[40:43], v[60:63], 0
v_fmac_f32 v124, v14, v15
v_fmac_f32 v126, v14, v127
v_lshlrev_b32 v14, 16, v114
v_mfma_f32_16x16x32_bf16 v[228:231], v[44:47], v[48:51], 0
v_lshlrev_b32 v15, 16, v118
v_lshlrev_b32 v127, 16, v122
v_fmac_f32 v124, v14, v15
v_mfma_f32_16x16x32_bf16 v[236:239], v[44:47], v[52:55], 0
v_fmac_f32 v126, v14, v127
v_and_b32 v14, 0xffff0000, v114
v_and_b32 v15, 0xffff0000, v118
v_mfma_f32_16x16x32_bf16 v[244:247], v[44:47], v[56:59], 0
v_and_b32 v127, 0xffff0000, v122
v_fmac_f32 v124, v14, v15
v_fmac_f32 v126, v14, v127
v_mfma_f32_16x16x32_bf16 v[252:255], v[44:47], v[60:63], 0
s_waitcnt vmcnt(8) lgkmcnt(0)
s_barrier
v_mfma_f32_16x16x32_bf16 v[128:131], v[64:67], v[96:99], v[128:131]
ds_read_b64_tr_b16 v[48:49], v7 offset:32768
v_mfma_f32_16x16x32_bf16 v[136:139], v[64:67], v[100:103], v[136:139]
ds_read_b64_tr_b16 v[50:51], v7 offset:33792
v_mfma_f32_16x16x32_bf16 v[144:147], v[64:67], v[104:107], v[144:147]
v_mfma_f32_16x16x32_bf16 v[152:155], v[64:67], v[108:111], v[152:155]
ds_read_b64_tr_b16 v[52:53], v8 offset:32768
v_mfma_f32_16x16x32_bf16 v[132:135], v[68:71], v[96:99], v[132:135]
v_mfma_f32_16x16x32_bf16 v[140:143], v[68:71], v[100:103], v[140:143]
ds_read_b64_tr_b16 v[54:55], v8 offset:33792
v_mfma_f32_16x16x32_bf16 v[148:151], v[68:71], v[104:107], v[148:151]
s_add_u32 m0, s38, 114688
s_add_u32 s43, s35, 1310720
buffer_load_dwordx4 v13, s[12:15], s43 offen lds
v_mfma_f32_16x16x32_bf16 v[156:159], v[68:71], v[108:111], v[156:159]
ds_read_b64_tr_b16 v[56:57], v9 offset:32768
v_mfma_f32_16x16x32_bf16 v[160:163], v[72:75], v[96:99], v[160:163]
ds_read_b64_tr_b16 v[58:59], v9 offset:33792
v_mfma_f32_16x16x32_bf16 v[168:171], v[72:75], v[100:103], v[168:171]
v_mfma_f32_16x16x32_bf16 v[176:179], v[72:75], v[104:107], v[176:179]
ds_read_b64_tr_b16 v[60:61], v10 offset:32768
v_mfma_f32_16x16x32_bf16 v[184:187], v[72:75], v[108:111], v[184:187]
v_mfma_f32_16x16x32_bf16 v[164:167], v[76:79], v[96:99], v[164:167]
ds_read_b64_tr_b16 v[62:63], v10 offset:33792
v_mfma_f32_16x16x32_bf16 v[172:175], v[76:79], v[100:103], v[172:175]
s_add_u32 m0, s38, 115712
s_add_u32 s43, s35, 1343488
buffer_load_dwordx4 v13, s[12:15], s43 offen lds
v_mfma_f32_16x16x32_bf16 v[180:183], v[76:79], v[104:107], v[180:183]
ds_read_b128 v[16:19], v3 offset:32768
v_mfma_f32_16x16x32_bf16 v[188:191], v[76:79], v[108:111], v[188:191]
ds_read_b128 v[20:23], v3 offset:34816
v_mfma_f32_16x16x32_bf16 v[192:195], v[80:83], v[96:99], v[192:195]
v_mfma_f32_16x16x32_bf16 v[200:203], v[80:83], v[100:103], v[200:203]
ds_read_b128 v[24:27], v3 offset:36864
v_mfma_f32_16x16x32_bf16 v[208:211], v[80:83], v[104:107], v[208:211]
v_mfma_f32_16x16x32_bf16 v[216:219], v[80:83], v[108:111], v[216:219]
ds_read_b128 v[28:31], v3 offset:38912
v_mfma_f32_16x16x32_bf16 v[196:199], v[84:87], v[96:99], v[196:199]
s_add_u32 m0, s37, 0
s_add_u32 s43, s33, 384
buffer_load_dwordx4 v11, s[8:11], s43 offen lds
v_mfma_f32_16x16x32_bf16 v[204:207], v[84:87], v[100:103], v[204:207]
ds_read_b128 v[32:35], v3 offset:40960
s_sub_u32 s41, s31, 2
s_cmp_ge_u32 s41, 2
s_cbranch_scc1 L_pfmo10
s_and_b32 s42, s32, 3
s_cmp_eq_u32 s42, 3
s_cbranch_scc1 L_pfmo10
s_lshl_b32 s41, s41, 5
s_add_u32 s41, s41, s30
s_lshl_b32 s41, s41, 1
s_add_u32 s41, s41, 1
s_cmp_ge_u32 s41, 112
s_cbranch_scc1 L_pfmo10
s_lshl_b32 s43, s42, 3
s_add_u32 s43, s43, 64
s_load_dwordx2 s[70:71], s[0:1], s43
s_cmp_eq_u32 s42, 2
s_cbranch_scc1 L_pfmo10d
s_mul_hi_u32 s42, s41, 0x0924924a
s_mul_i32 s43, s42, 28
s_sub_u32 s43, s41, s43
s_lshl_b32 s43, s43, 7
s_mul_i32 s42, s42, 458752
s_add_u32 s42, s42, s43
s_add_u32 s42, s42, 0
s_movk_i32 s43, 3584
v_mul_lo_u32 v15, v1, s43
s_branch L_pfmo10e
L_pfmo10d:
s_lshl_b32 s42, s41, 14
s_add_u32 s42, s42, 0
v_lshlrev_b32 v15, 7, v1
L_pfmo10e:
v_add_u32 v15, s42, v15
s_waitcnt lgkmcnt(0)
global_load_dword v125, v15, s[70:71]
L_pfmo10:
v_lshlrev_b32 v14, 16, v115
v_lshlrev_b32 v15, 16, v119
v_mfma_f32_16x16x32_bf16 v[212:215], v[84:87], v[104:107], v[212:215]
ds_read_b128 v[36:39], v3 offset:43008
v_lshlrev_b32 v127, 16, v123
v_fmac_f32 v124, v14, v15
v_fmac_f32 v126, v14, v127
v_mfma_f32_16x16x32_bf16 v[220:223], v[84:87], v[108:111], v[220:223]
v_and_b32 v14, 0xffff0000, v115
v_and_b32 v15, 0xffff0000, v119
v_mfma_f32_16x16x32_bf16 v[224:227], v[88:91], v[96:99], v[224:227]
ds_read_b128 v[40:43], v3 offset:45056
v_and_b32 v127, 0xffff0000, v123
v_fmac_f32 v124, v14, v15
v_fmac_f32 v126, v14, v127
v_mfma_f32_16x16x32_bf16 v[232:235], v[88:91], v[100:103], v[232:235]
s_nop 1
v_add_f32 v124, v124, v124 row_ror:8 row_mask:0xf bank_mask:0xf
v_mfma_f32_16x16x32_bf16 v[240:243], v[88:91], v[104:107], v[240:243]
ds_read_b128 v[44:47], v3 offset:47104
v_add_f32 v126, v126, v126 row_ror:8 row_mask:0xf bank_mask:0xf
s_nop 1
v_add_f32 v124, v124, v124 row_ror:4 row_mask:0xf bank_mask:0xf
v_mfma_f32_16x16x32_bf16 v[248:251], v[88:91], v[108:111], v[248:251]
s_add_u32 m0, s37, 1024
s_add_u32 s43, s33, 8576
buffer_load_dwordx4 v12, s[8:11], s43 offen lds
v_add_f32 v126, v126, v126 row_ror:4 row_mask:0xf bank_mask:0xf
s_nop 1
v_add_f32 v124, v124, v124 row_ror:2 row_mask:0xf bank_mask:0xf
v_mfma_f32_16x16x32_bf16 v[228:231], v[92:95], v[96:99], v[228:231]
v_add_f32 v126, v126, v126 row_ror:2 row_mask:0xf bank_mask:0xf
s_nop 1
v_mfma_f32_16x16x32_bf16 v[236:239], v[92:95], v[100:103], v[236:239]
v_add_f32 v124, v124, v124 row_ror:1 row_mask:0xf bank_mask:0xf
v_add_f32 v126, v126, v126 row_ror:1 row_mask:0xf bank_mask:0xf
v_mov_b32 v14, v124
v_mov_b32 v15, v126
s_nop 1
v_permlane16_swap_b32 v124, v14
v_permlane16_swap_b32 v126, v15
s_nop 1
v_add_f32 v124, v124, v14
v_add_f32 v126, v126, v15
v_mfma_f32_16x16x32_bf16 v[244:247], v[92:95], v[104:107], v[244:247]
v_mov_b32 v14, v124
v_mov_b32 v15, v126
s_nop 1
v_permlane32_swap_b32 v124, v14
v_permlane32_swap_b32 v126, v15
s_nop 1
v_add_f32 v124, v124, v14
v_add_f32 v126, v126, v15
v_mul_f32 v14, 0x3fb8aa3b, v126
v_sub_f32 v14, 0, v14
v_exp_f32 v14, v14
s_nop 0
v_add_f32 v14, 1.0, v14
v_rcp_f32 v126, v14
s_nop 0
v_mov_b32 v14, s45
s_mov_b32 s41, 50331648
s_mov_b32 s42, 50339840
s_mov_b64 exec, 1
buffer_store_dword v124, v14, s[20:23], s41 offen sc1
buffer_store_dword v126, v14, s[20:23], s42 offen sc1
s_mov_b64 exec, -1
s_and_b32 s41, s30, 3
s_or_b32 s41, s41, s32
s_lshl_b32 s42, s31, 3
s_lshr_b32 s43, s30, 2
s_add_u32 s42, s42, s43
s_lshl_b32 s42, s42, 7
s_add_u32 s42, s42, 50372608
s_cmp_eq_u32 s41, 0
s_cselect_b32 s42, s42, 0x10000000
v_mov_b32 v14, s42
v_mov_b32 v15, 0
s_mov_b64 exec, 1
buffer_store_dword v15, v14, s[20:23], 0 offen sc1
s_mov_b64 exec, -1
v_mfma_f32_16x16x32_bf16 v[252:255], v[92:95], v[108:111], v[252:255]
s_waitcnt vmcnt(9) lgkmcnt(0)
s_barrier
v_mfma_f32_16x16x32_bf16 v[128:131], v[16:19], v[48:51], v[128:131]
ds_read_b64_tr_b16 v[96:97], v7 offset:49152
v_mfma_f32_16x16x32_bf16 v[136:139], v[16:19], v[52:55], v[136:139]
ds_read_b64_tr_b16 v[98:99], v7 offset:50176
v_mfma_f32_16x16x32_bf16 v[144:147], v[16:19], v[56:59], v[144:147]
v_mfma_f32_16x16x32_bf16 v[152:155], v[16:19], v[60:63], v[152:155]
ds_read_b64_tr_b16 v[100:101], v8 offset:49152
v_mfma_f32_16x16x32_bf16 v[132:135], v[20:23], v[48:51], v[132:135]
v_mfma_f32_16x16x32_bf16 v[140:143], v[20:23], v[52:55], v[140:143]
ds_read_b64_tr_b16 v[102:103], v8 offset:50176
v_mfma_f32_16x16x32_bf16 v[148:151], v[20:23], v[56:59], v[148:151]
s_add_u32 m0, s38, 131072
s_add_u32 s43, s35, 1572864
buffer_load_dwordx4 v13, s[12:15], s43 offen lds
v_mfma_f32_16x16x32_bf16 v[156:159], v[20:23], v[60:63], v[156:159]
ds_read_b64_tr_b16 v[104:105], v9 offset:49152
v_mfma_f32_16x16x32_bf16 v[160:163], v[24:27], v[48:51], v[160:163]
ds_read_b64_tr_b16 v[106:107], v9 offset:50176
v_mfma_f32_16x16x32_bf16 v[168:171], v[24:27], v[52:55], v[168:171]
v_mfma_f32_16x16x32_bf16 v[176:179], v[24:27], v[56:59], v[176:179]
ds_read_b64_tr_b16 v[108:109], v10 offset:49152
v_mfma_f32_16x16x32_bf16 v[184:187], v[24:27], v[60:63], v[184:187]
v_mfma_f32_16x16x32_bf16 v[164:167], v[28:31], v[48:51], v[164:167]
ds_read_b64_tr_b16 v[110:111], v10 offset:50176
v_mfma_f32_16x16x32_bf16 v[172:175], v[28:31], v[52:55], v[172:175]
s_add_u32 m0, s38, 132096
s_add_u32 s43, s35, 1605632
buffer_load_dwordx4 v13, s[12:15], s43 offen lds
v_mfma_f32_16x16x32_bf16 v[180:183], v[28:31], v[56:59], v[180:183]
ds_read_b128 v[64:67], v4 offset:32768
v_mfma_f32_16x16x32_bf16 v[188:191], v[28:31], v[60:63], v[188:191]
ds_read_b128 v[68:71], v4 offset:34816
v_mfma_f32_16x16x32_bf16 v[192:195], v[32:35], v[48:51], v[192:195]
v_mfma_f32_16x16x32_bf16 v[200:203], v[32:35], v[52:55], v[200:203]
ds_read_b128 v[72:75], v4 offset:36864
v_mfma_f32_16x16x32_bf16 v[208:211], v[32:35], v[56:59], v[208:211]
v_mfma_f32_16x16x32_bf16 v[216:219], v[32:35], v[60:63], v[216:219]
ds_read_b128 v[76:79], v4 offset:38912
v_mfma_f32_16x16x32_bf16 v[196:199], v[36:39], v[48:51], v[196:199]
s_add_u32 m0, s37, 2048
s_add_u32 s43, s33, 16768
buffer_load_dwordx4 v11, s[8:11], s43 offen lds
v_mfma_f32_16x16x32_bf16 v[204:207], v[36:39], v[52:55], v[204:207]
ds_read_b128 v[80:83], v4 offset:40960
v_mfma_f32_16x16x32_bf16 v[212:215], v[36:39], v[56:59], v[212:215]
ds_read_b128 v[84:87], v4 offset:43008
v_mfma_f32_16x16x32_bf16 v[220:223], v[36:39], v[60:63], v[220:223]
v_mfma_f32_16x16x32_bf16 v[224:227], v[40:43], v[48:51], v[224:227]
ds_read_b128 v[88:91], v4 offset:45056
v_mfma_f32_16x16x32_bf16 v[232:235], v[40:43], v[52:55], v[232:235]
v_mfma_f32_16x16x32_bf16 v[240:243], v[40:43], v[56:59], v[240:243]
ds_read_b128 v[92:95], v4 offset:47104
v_mfma_f32_16x16x32_bf16 v[248:251], v[40:43], v[60:63], v[248:251]
s_add_u32 m0, s37, 3072
s_add_u32 s43, s33, 24960
buffer_load_dwordx4 v12, s[8:11], s43 offen lds
v_mfma_f32_16x16x32_bf16 v[228:231], v[44:47], v[48:51], v[228:231]
v_mfma_f32_16x16x32_bf16 v[236:239], v[44:47], v[52:55], v[236:239]
v_mfma_f32_16x16x32_bf16 v[244:247], v[44:47], v[56:59], v[244:247]
v_mfma_f32_16x16x32_bf16 v[252:255], v[44:47], v[60:63], v[252:255]
s_waitcnt vmcnt(11) lgkmcnt(0)
s_barrier
v_mfma_f32_16x16x32_bf16 v[128:131], v[64:67], v[96:99], v[128:131]
ds_read_b64_tr_b16 v[48:49], v7 offset:0
v_mfma_f32_16x16x32_bf16 v[136:139], v[64:67], v[100:103], v[136:139]
ds_read_b64_tr_b16 v[50:51], v7 offset:1024
v_mfma_f32_16x16x32_bf16 v[144:147], v[64:67], v[104:107], v[144:147]
v_mfma_f32_16x16x32_bf16 v[152:155], v[64:67], v[108:111], v[152:155]
ds_read_b64_tr_b16 v[52:53], v8 offset:0
v_mfma_f32_16x16x32_bf16 v[132:135], v[68:71], v[96:99], v[132:135]
v_mfma_f32_16x16x32_bf16 v[140:143], v[68:71], v[100:103], v[140:143]
ds_read_b64_tr_b16 v[54:55], v8 offset:1024
v_mfma_f32_16x16x32_bf16 v[148:151], v[68:71], v[104:107], v[148:151]
s_add_u32 m0, s38, 147456
s_add_u32 s43, s35, 1835008
buffer_load_dwordx4 v13, s[12:15], s43 offen lds
v_mfma_f32_16x16x32_bf16 v[156:159], v[68:71], v[108:111], v[156:159]
ds_read_b64_tr_b16 v[56:57], v9 offset:0
v_mfma_f32_16x16x32_bf16 v[160:163], v[72:75], v[96:99], v[160:163]
ds_read_b64_tr_b16 v[58:59], v9 offset:1024
v_mfma_f32_16x16x32_bf16 v[168:171], v[72:75], v[100:103], v[168:171]
v_mfma_f32_16x16x32_bf16 v[176:179], v[72:75], v[104:107], v[176:179]
ds_read_b64_tr_b16 v[60:61], v10 offset:0
v_mfma_f32_16x16x32_bf16 v[184:187], v[72:75], v[108:111], v[184:187]
v_mfma_f32_16x16x32_bf16 v[164:167], v[76:79], v[96:99], v[164:167]
ds_read_b64_tr_b16 v[62:63], v10 offset:1024
v_mfma_f32_16x16x32_bf16 v[172:175], v[76:79], v[100:103], v[172:175]
s_add_u32 m0, s38, 148480
s_add_u32 s43, s35, 1867776
buffer_load_dwordx4 v13, s[12:15], s43 offen lds
v_mfma_f32_16x16x32_bf16 v[180:183], v[76:79], v[104:107], v[180:183]
ds_read_b128 v[16:19], v5 offset:0
v_mfma_f32_16x16x32_bf16 v[188:191], v[76:79], v[108:111], v[188:191]
ds_read_b128 v[20:23], v5 offset:2048
v_mfma_f32_16x16x32_bf16 v[192:195], v[80:83], v[96:99], v[192:195]
v_mfma_f32_16x16x32_bf16 v[200:203], v[80:83], v[100:103], v[200:203]
ds_read_b128 v[24:27], v5 offset:4096
v_mfma_f32_16x16x32_bf16 v[208:211], v[80:83], v[104:107], v[208:211]
v_mfma_f32_16x16x32_bf16 v[216:219], v[80:83], v[108:111], v[216:219]
ds_read_b128 v[28:31], v5 offset:6144
v_mfma_f32_16x16x32_bf16 v[196:199], v[84:87], v[96:99], v[196:199]
s_add_u32 m0, s37, 32768
s_add_u32 s43, s33, 512
buffer_load_dwordx4 v11, s[8:11], s43 offen lds
v_mfma_f32_16x16x32_bf16 v[204:207], v[84:87], v[100:103], v[204:207]
ds_read_b128 v[32:35], v5 offset:8192
s_sub_u32 s41, s31, 2
s_cmp_ge_u32 s41, 2
s_cbranch_scc1 L_pfmo11
s_and_b32 s42, s32, 3
s_cmp_eq_u32 s42, 3
s_cbranch_scc1 L_pfmo11
s_lshl_b32 s41, s41, 5
s_add_u32 s41, s41, s30
s_lshl_b32 s41, s41, 1
s_add_u32 s41, s41, 1
s_cmp_ge_u32 s41, 112
s_cbranch_scc1 L_pfmo11
s_lshl_b32 s43, s42, 3
s_add_u32 s43, s43, 64
s_load_dwordx2 s[70:71], s[0:1], s43
s_cmp_eq_u32 s42, 2
s_cbranch_scc1 L_pfmo11d
s_mul_hi_u32 s42, s41, 0x0924924a
s_mul_i32 s43, s42, 28
s_sub_u32 s43, s41, s43
s_lshl_b32 s43, s43, 7
s_mul_i32 s42, s42, 458752
s_add_u32 s42, s42, s43
s_add_u32 s42, s42, 229376
s_movk_i32 s43, 3584
v_mul_lo_u32 v15, v1, s43
s_branch L_pfmo11e
L_pfmo11d:
s_lshl_b32 s42, s41, 14
s_add_u32 s42, s42, 8192
v_lshlrev_b32 v15, 7, v1
L_pfmo11e:
v_add_u32 v15, s42, v15
s_waitcnt lgkmcnt(0)
global_load_dword v125, v15, s[70:71]
L_pfmo11:
v_mfma_f32_16x16x32_bf16 v[212:215], v[84:87], v[104:107], v[212:215]
ds_read_b128 v[36:39], v5 offset:10240
v_mfma_f32_16x16x32_bf16 v[220:223], v[84:87], v[108:111], v[220:223]
v_mfma_f32_16x16x32_bf16 v[224:227], v[88:91], v[96:99], v[224:227]
ds_read_b128 v[40:43], v5 offset:12288
v_mfma_f32_16x16x32_bf16 v[232:235], v[88:91], v[100:103], v[232:235]
v_mfma_f32_16x16x32_bf16 v[240:243], v[88:91], v[104:107], v[240:243]
ds_read_b128 v[44:47], v5 offset:14336
v_mfma_f32_16x16x32_bf16 v[248:251], v[88:91], v[108:111], v[248:251]
s_add_u32 m0, s37, 33792
s_add_u32 s43, s33, 8704
buffer_load_dwordx4 v12, s[8:11], s43 offen lds
v_mfma_f32_16x16x32_bf16 v[228:231], v[92:95], v[96:99], v[228:231]
v_mfma_f32_16x16x32_bf16 v[236:239], v[92:95], v[100:103], v[236:239]
v_mfma_f32_16x16x32_bf16 v[244:247], v[92:95], v[104:107], v[244:247]
v_mfma_f32_16x16x32_bf16 v[252:255], v[92:95], v[108:111], v[252:255]
s_waitcnt vmcnt(8) lgkmcnt(0)
s_barrier
v_mfma_f32_16x16x32_bf16 v[128:131], v[16:19], v[48:51], v[128:131]
ds_read_b64_tr_b16 v[96:97], v7 offset:16384
v_mfma_f32_16x16x32_bf16 v[136:139], v[16:19], v[52:55], v[136:139]
ds_read_b64_tr_b16 v[98:99], v7 offset:17408
v_mfma_f32_16x16x32_bf16 v[144:147], v[16:19], v[56:59], v[144:147]
v_mfma_f32_16x16x32_bf16 v[152:155], v[16:19], v[60:63], v[152:155]
ds_read_b64_tr_b16 v[100:101], v8 offset:16384
v_mfma_f32_16x16x32_bf16 v[132:135], v[20:23], v[48:51], v[132:135]
v_mfma_f32_16x16x32_bf16 v[140:143], v[20:23], v[52:55], v[140:143]
ds_read_b64_tr_b16 v[102:103], v8 offset:17408
v_mfma_f32_16x16x32_bf16 v[148:151], v[20:23], v[56:59], v[148:151]
s_add_u32 m0, s38, 98304
s_add_u32 s43, s35, 2097152
buffer_load_dwordx4 v13, s[12:15], s43 offen lds
v_mfma_f32_16x16x32_bf16 v[156:159], v[20:23], v[60:63], v[156:159]
ds_read_b64_tr_b16 v[104:105], v9 offset:16384
v_mfma_f32_16x16x32_bf16 v[160:163], v[24:27], v[48:51], v[160:163]
ds_read_b64_tr_b16 v[106:107], v9 offset:17408
v_mfma_f32_16x16x32_bf16 v[168:171], v[24:27], v[52:55], v[168:171]
v_mfma_f32_16x16x32_bf16 v[176:179], v[24:27], v[56:59], v[176:179]
ds_read_b64_tr_b16 v[108:109], v10 offset:16384
v_mfma_f32_16x16x32_bf16 v[184:187], v[24:27], v[60:63], v[184:187]
v_mfma_f32_16x16x32_bf16 v[164:167], v[28:31], v[48:51], v[164:167]
ds_read_b64_tr_b16 v[110:111], v10 offset:17408
v_mfma_f32_16x16x32_bf16 v[172:175], v[28:31], v[52:55], v[172:175]
s_add_u32 m0, s38, 99328
s_add_u32 s43, s35, 2129920
buffer_load_dwordx4 v13, s[12:15], s43 offen lds
v_mfma_f32_16x16x32_bf16 v[180:183], v[28:31], v[56:59], v[180:183]
ds_read_b128 v[64:67], v6 offset:0
v_mfma_f32_16x16x32_bf16 v[188:191], v[28:31], v[60:63], v[188:191]
ds_read_b128 v[68:71], v6 offset:2048
v_mfma_f32_16x16x32_bf16 v[192:195], v[32:35], v[48:51], v[192:195]
v_mfma_f32_16x16x32_bf16 v[200:203], v[32:35], v[52:55], v[200:203]
ds_read_b128 v[72:75], v6 offset:4096
v_mfma_f32_16x16x32_bf16 v[208:211], v[32:35], v[56:59], v[208:211]
v_mfma_f32_16x16x32_bf16 v[216:219], v[32:35], v[60:63], v[216:219]
ds_read_b128 v[76:79], v6 offset:6144
v_mfma_f32_16x16x32_bf16 v[196:199], v[36:39], v[48:51], v[196:199]
s_add_u32 m0, s37, 34816
s_add_u32 s43, s33, 16896
buffer_load_dwordx4 v11, s[8:11], s43 offen lds
v_mfma_f32_16x16x32_bf16 v[204:207], v[36:39], v[52:55], v[204:207]
ds_read_b128 v[80:83], v6 offset:8192
v_mfma_f32_16x16x32_bf16 v[212:215], v[36:39], v[56:59], v[212:215]
ds_read_b128 v[84:87], v6 offset:10240
v_mfma_f32_16x16x32_bf16 v[220:223], v[36:39], v[60:63], v[220:223]
v_mfma_f32_16x16x32_bf16 v[224:227], v[40:43], v[48:51], v[224:227]
ds_read_b128 v[88:91], v6 offset:12288
v_mfma_f32_16x16x32_bf16 v[232:235], v[40:43], v[52:55], v[232:235]
v_mfma_f32_16x16x32_bf16 v[240:243], v[40:43], v[56:59], v[240:243]
ds_read_b128 v[92:95], v6 offset:14336
v_mfma_f32_16x16x32_bf16 v[248:251], v[40:43], v[60:63], v[248:251]
s_add_u32 m0, s37, 35840
s_add_u32 s43, s33, 25088
buffer_load_dwordx4 v12, s[8:11], s43 offen lds
v_mfma_f32_16x16x32_bf16 v[228:231], v[44:47], v[48:51], v[228:231]
v_mfma_f32_16x16x32_bf16 v[236:239], v[44:47], v[52:55], v[236:239]
v_mfma_f32_16x16x32_bf16 v[244:247], v[44:47], v[56:59], v[244:247]
v_mfma_f32_16x16x32_bf16 v[252:255], v[44:47], v[60:63], v[252:255]
s_waitcnt vmcnt(8) lgkmcnt(0)
s_barrier
v_mfma_f32_16x16x32_bf16 v[128:131], v[64:67], v[96:99], v[128:131]
ds_read_b64_tr_b16 v[48:49], v7 offset:32768
v_mfma_f32_16x16x32_bf16 v[136:139], v[64:67], v[100:103], v[136:139]
ds_read_b64_tr_b16 v[50:51], v7 offset:33792
v_mfma_f32_16x16x32_bf16 v[144:147], v[64:67], v[104:107], v[144:147]
v_mfma_f32_16x16x32_bf16 v[152:155], v[64:67], v[108:111], v[152:155]
ds_read_b64_tr_b16 v[52:53], v8 offset:32768
v_mfma_f32_16x16x32_bf16 v[132:135], v[68:71], v[96:99], v[132:135]
v_mfma_f32_16x16x32_bf16 v[140:143], v[68:71], v[100:103], v[140:143]
ds_read_b64_tr_b16 v[54:55], v8 offset:33792
v_mfma_f32_16x16x32_bf16 v[148:151], v[68:71], v[104:107], v[148:151]
s_add_u32 m0, s38, 114688
s_add_u32 s43, s35, 2359296
buffer_load_dwordx4 v13, s[12:15], s43 offen lds
v_mfma_f32_16x16x32_bf16 v[156:159], v[68:71], v[108:111], v[156:159]
ds_read_b64_tr_b16 v[56:57], v9 offset:32768
v_mfma_f32_16x16x32_bf16 v[160:163], v[72:75], v[96:99], v[160:163]
ds_read_b64_tr_b16 v[58:59], v9 offset:33792
v_mfma_f32_16x16x32_bf16 v[168:171], v[72:75], v[100:103], v[168:171]
v_mfma_f32_16x16x32_bf16 v[176:179], v[72:75], v[104:107], v[176:179]
ds_read_b64_tr_b16 v[60:61], v10 offset:32768
v_mfma_f32_16x16x32_bf16 v[184:187], v[72:75], v[108:111], v[184:187]
v_mfma_f32_16x16x32_bf16 v[164:167], v[76:79], v[96:99], v[164:167]
ds_read_b64_tr_b16 v[62:63], v10 offset:33792
v_mfma_f32_16x16x32_bf16 v[172:175], v[76:79], v[100:103], v[172:175]
s_add_u32 m0, s38, 115712
s_add_u32 s43, s35, 2392064
buffer_load_dwordx4 v13, s[12:15], s43 offen lds
v_mfma_f32_16x16x32_bf16 v[180:183], v[76:79], v[104:107], v[180:183]
ds_read_b128 v[16:19], v3 offset:0
v_mfma_f32_16x16x32_bf16 v[188:191], v[76:79], v[108:111], v[188:191]
ds_read_b128 v[20:23], v3 offset:2048
v_mfma_f32_16x16x32_bf16 v[192:195], v[80:83], v[96:99], v[192:195]
v_mfma_f32_16x16x32_bf16 v[200:203], v[80:83], v[100:103], v[200:203]
ds_read_b128 v[24:27], v3 offset:4096
v_mfma_f32_16x16x32_bf16 v[208:211], v[80:83], v[104:107], v[208:211]
v_mfma_f32_16x16x32_bf16 v[216:219], v[80:83], v[108:111], v[216:219]
ds_read_b128 v[28:31], v3 offset:6144
v_mfma_f32_16x16x32_bf16 v[196:199], v[84:87], v[96:99], v[196:199]
s_add_u32 m0, s37, 65536
s_add_u32 s43, s33, 640
buffer_load_dwordx4 v11, s[8:11], s43 offen lds
v_mfma_f32_16x16x32_bf16 v[204:207], v[84:87], v[100:103], v[204:207]
ds_read_b128 v[32:35], v3 offset:8192
v_mfma_f32_16x16x32_bf16 v[212:215], v[84:87], v[104:107], v[212:215]
ds_read_b128 v[36:39], v3 offset:10240
v_mfma_f32_16x16x32_bf16 v[220:223], v[84:87], v[108:111], v[220:223]
v_mfma_f32_16x16x32_bf16 v[224:227], v[88:91], v[96:99], v[224:227]
ds_read_b128 v[40:43], v3 offset:12288
v_mfma_f32_16x16x32_bf16 v[232:235], v[88:91], v[100:103], v[232:235]
v_mfma_f32_16x16x32_bf16 v[240:243], v[88:91], v[104:107], v[240:243]
ds_read_b128 v[44:47], v3 offset:14336
v_mfma_f32_16x16x32_bf16 v[248:251], v[88:91], v[108:111], v[248:251]
s_add_u32 m0, s37, 66560
s_add_u32 s43, s33, 8832
buffer_load_dwordx4 v12, s[8:11], s43 offen lds
v_mfma_f32_16x16x32_bf16 v[228:231], v[92:95], v[96:99], v[228:231]
v_mfma_f32_16x16x32_bf16 v[236:239], v[92:95], v[100:103], v[236:239]
v_mfma_f32_16x16x32_bf16 v[244:247], v[92:95], v[104:107], v[244:247]
v_mfma_f32_16x16x32_bf16 v[252:255], v[92:95], v[108:111], v[252:255]
s_waitcnt vmcnt(10) lgkmcnt(0)
s_barrier
v_mfma_f32_16x16x32_bf16 v[128:131], v[16:19], v[48:51], v[128:131]
ds_read_b64_tr_b16 v[96:97], v7 offset:49152
v_mfma_f32_16x16x32_bf16 v[136:139], v[16:19], v[52:55], v[136:139]
ds_read_b64_tr_b16 v[98:99], v7 offset:50176
v_mfma_f32_16x16x32_bf16 v[144:147], v[16:19], v[56:59], v[144:147]
v_mfma_f32_16x16x32_bf16 v[152:155], v[16:19], v[60:63], v[152:155]
ds_read_b64_tr_b16 v[100:101], v8 offset:49152
v_mfma_f32_16x16x32_bf16 v[132:135], v[20:23], v[48:51], v[132:135]
v_mfma_f32_16x16x32_bf16 v[140:143], v[20:23], v[52:55], v[140:143]
ds_read_b64_tr_b16 v[102:103], v8 offset:50176
v_mfma_f32_16x16x32_bf16 v[148:151], v[20:23], v[56:59], v[148:151]
s_add_u32 m0, s38, 131072
s_add_u32 s43, s35, 2621440
buffer_load_dwordx4 v13, s[12:15], s43 offen lds
v_mfma_f32_16x16x32_bf16 v[156:159], v[20:23], v[60:63], v[156:159]
ds_read_b64_tr_b16 v[104:105], v9 offset:49152
v_mfma_f32_16x16x32_bf16 v[160:163], v[24:27], v[48:51], v[160:163]
ds_read_b64_tr_b16 v[106:107], v9 offset:50176
v_mfma_f32_16x16x32_bf16 v[168:171], v[24:27], v[52:55], v[168:171]
v_mfma_f32_16x16x32_bf16 v[176:179], v[24:27], v[56:59], v[176:179]
ds_read_b64_tr_b16 v[108:109], v10 offset:49152
v_mfma_f32_16x16x32_bf16 v[184:187], v[24:27], v[60:63], v[184:187]
v_mfma_f32_16x16x32_bf16 v[164:167], v[28:31], v[48:51], v[164:167]
ds_read_b64_tr_b16 v[110:111], v10 offset:50176
v_mfma_f32_16x16x32_bf16 v[172:175], v[28:31], v[52:55], v[172:175]
s_add_u32 m0, s38, 132096
s_add_u32 s43, s35, 2654208
buffer_load_dwordx4 v13, s[12:15], s43 offen lds
v_mfma_f32_16x16x32_bf16 v[180:183], v[28:31], v[56:59], v[180:183]
ds_read_b128 v[64:67], v4 offset:0
v_mfma_f32_16x16x32_bf16 v[188:191], v[28:31], v[60:63], v[188:191]
ds_read_b128 v[68:71], v4 offset:2048
v_mfma_f32_16x16x32_bf16 v[192:195], v[32:35], v[48:51], v[192:195]
v_mfma_f32_16x16x32_bf16 v[200:203], v[32:35], v[52:55], v[200:203]
ds_read_b128 v[72:75], v4 offset:4096
v_mfma_f32_16x16x32_bf16 v[208:211], v[32:35], v[56:59], v[208:211]
v_mfma_f32_16x16x32_bf16 v[216:219], v[32:35], v[60:63], v[216:219]
ds_read_b128 v[76:79], v4 offset:6144
v_mfma_f32_16x16x32_bf16 v[196:199], v[36:39], v[48:51], v[196:199]
s_add_u32 m0, s37, 67584
s_add_u32 s43, s33, 17024
buffer_load_dwordx4 v11, s[8:11], s43 offen lds
v_mfma_f32_16x16x32_bf16 v[204:207], v[36:39], v[52:55], v[204:207]
ds_read_b128 v[80:83], v4 offset:8192
v_lshlrev_b32 v15, 7, v1
s_and_b32 s41, s32, 3
s_lshl_b32 s42, s41, 15
s_sub_u32 s42, s34, s42
s_lshl_b32 s41, s41, 13
s_add_u32 s42, s42, s41
s_and_b32 s41, s30, 3
s_lshl_b32 s41, s41, 15
s_add_u32 s42, s42, s41
buffer_load_dword v125, v15, s[4:7], s42 offen
v_mfma_f32_16x16x32_bf16 v[212:215], v[36:39], v[56:59], v[212:215]
ds_read_b128 v[84:87], v4 offset:10240
v_mfma_f32_16x16x32_bf16 v[220:223], v[36:39], v[60:63], v[220:223]
v_mfma_f32_16x16x32_bf16 v[224:227], v[40:43], v[48:51], v[224:227]
ds_read_b128 v[88:91], v4 offset:12288
v_mfma_f32_16x16x32_bf16 v[232:235], v[40:43], v[52:55], v[232:235]
v_mfma_f32_16x16x32_bf16 v[240:243], v[40:43], v[56:59], v[240:243]
ds_read_b128 v[92:95], v4 offset:14336
v_mfma_f32_16x16x32_bf16 v[248:251], v[40:43], v[60:63], v[248:251]
s_add_u32 m0, s37, 68608
s_add_u32 s43, s33, 25216
buffer_load_dwordx4 v12, s[8:11], s43 offen lds
v_mfma_f32_16x16x32_bf16 v[228:231], v[44:47], v[48:51], v[228:231]
v_mfma_f32_16x16x32_bf16 v[236:239], v[44:47], v[52:55], v[236:239]
v_mfma_f32_16x16x32_bf16 v[244:247], v[44:47], v[56:59], v[244:247]
v_mfma_f32_16x16x32_bf16 v[252:255], v[44:47], v[60:63], v[252:255]
s_waitcnt vmcnt(9) lgkmcnt(0)
s_barrier
v_mfma_f32_16x16x32_bf16 v[128:131], v[64:67], v[96:99], v[128:131]
ds_read_b64_tr_b16 v[48:49], v7 offset:0
v_mfma_f32_16x16x32_bf16 v[136:139], v[64:67], v[100:103], v[136:139]
ds_read_b64_tr_b16 v[50:51], v7 offset:1024
v_mfma_f32_16x16x32_bf16 v[144:147], v[64:67], v[104:107], v[144:147]
v_mfma_f32_16x16x32_bf16 v[152:155], v[64:67], v[108:111], v[152:155]
ds_read_b64_tr_b16 v[52:53], v8 offset:0
v_mfma_f32_16x16x32_bf16 v[132:135], v[68:71], v[96:99], v[132:135]
v_mfma_f32_16x16x32_bf16 v[140:143], v[68:71], v[100:103], v[140:143]
ds_read_b64_tr_b16 v[54:55], v8 offset:1024
v_mfma_f32_16x16x32_bf16 v[148:151], v[68:71], v[104:107], v[148:151]
s_add_u32 m0, s38, 147456
s_add_u32 s43, s35, 2883584
buffer_load_dwordx4 v13, s[12:15], s43 offen lds
v_mfma_f32_16x16x32_bf16 v[156:159], v[68:71], v[108:111], v[156:159]
ds_read_b64_tr_b16 v[56:57], v9 offset:0
v_mfma_f32_16x16x32_bf16 v[160:163], v[72:75], v[96:99], v[160:163]
ds_read_b64_tr_b16 v[58:59], v9 offset:1024
v_mfma_f32_16x16x32_bf16 v[168:171], v[72:75], v[100:103], v[168:171]
v_mfma_f32_16x16x32_bf16 v[176:179], v[72:75], v[104:107], v[176:179]
ds_read_b64_tr_b16 v[60:61], v10 offset:0
v_mfma_f32_16x16x32_bf16 v[184:187], v[72:75], v[108:111], v[184:187]
v_mfma_f32_16x16x32_bf16 v[164:167], v[76:79], v[96:99], v[164:167]
ds_read_b64_tr_b16 v[62:63], v10 offset:1024
v_mfma_f32_16x16x32_bf16 v[172:175], v[76:79], v[100:103], v[172:175]
s_add_u32 m0, s38, 148480
s_add_u32 s43, s35, 2916352
buffer_load_dwordx4 v13, s[12:15], s43 offen lds
v_mfma_f32_16x16x32_bf16 v[180:183], v[76:79], v[104:107], v[180:183]
ds_read_b128 v[16:19], v3 offset:32768
v_mfma_f32_16x16x32_bf16 v[188:191], v[76:79], v[108:111], v[188:191]
ds_read_b128 v[20:23], v3 offset:34816
v_mfma_f32_16x16x32_bf16 v[192:195], v[80:83], v[96:99], v[192:195]
v_mfma_f32_16x16x32_bf16 v[200:203], v[80:83], v[100:103], v[200:203]
ds_read_b128 v[24:27], v3 offset:36864
v_mfma_f32_16x16x32_bf16 v[208:211], v[80:83], v[104:107], v[208:211]
v_mfma_f32_16x16x32_bf16 v[216:219], v[80:83], v[108:111], v[216:219]
ds_read_b128 v[28:31], v3 offset:38912
v_mfma_f32_16x16x32_bf16 v[196:199], v[84:87], v[96:99], v[196:199]
s_add_u32 m0, s37, 0
s_add_u32 s43, s33, 768
buffer_load_dwordx4 v11, s[8:11], s43 offen lds
v_mfma_f32_16x16x32_bf16 v[204:207], v[84:87], v[100:103], v[204:207]
ds_read_b128 v[32:35], v3 offset:40960
v_lshrrev_b32 v14, 1, v1
v_lshlrev_b32 v14, 13, v14
v_and_b32 v15, 1, v1
v_lshlrev_b32 v15, 7, v15
v_add_u32 v124, v14, v15
s_and_b32 s41, s32, 1
s_lshl_b32 s41, s41, 18
s_lshl_b32 s42, s31, 19
s_add_u32 s41, s41, s42
s_lshl_b32 s42, s30, 8
s_add_u32 s51, s41, s42
v_mfma_f32_16x16x32_bf16 v[212:215], v[84:87], v[104:107], v[212:215]
ds_read_b128 v[36:39], v3 offset:43008
v_mfma_f32_16x16x32_bf16 v[220:223], v[84:87], v[108:111], v[220:223]
v_mfma_f32_16x16x32_bf16 v[224:227], v[88:91], v[96:99], v[224:227]
ds_read_b128 v[40:43], v3 offset:45056
v_mfma_f32_16x16x32_bf16 v[232:235], v[88:91], v[100:103], v[232:235]
v_mfma_f32_16x16x32_bf16 v[240:243], v[88:91], v[104:107], v[240:243]
ds_read_b128 v[44:47], v3 offset:47104
v_mfma_f32_16x16x32_bf16 v[248:251], v[88:91], v[108:111], v[248:251]
s_add_u32 m0, s37, 1024
s_add_u32 s43, s33, 8960
buffer_load_dwordx4 v12, s[8:11], s43 offen lds
v_mfma_f32_16x16x32_bf16 v[228:231], v[92:95], v[96:99], v[228:231]
v_mfma_f32_16x16x32_bf16 v[236:239], v[92:95], v[100:103], v[236:239]
v_mfma_f32_16x16x32_bf16 v[244:247], v[92:95], v[104:107], v[244:247]
v_mfma_f32_16x16x32_bf16 v[252:255], v[92:95], v[108:111], v[252:255]
s_waitcnt vmcnt(11) lgkmcnt(0)
s_barrier
v_mfma_f32_16x16x32_bf16 v[128:131], v[16:19], v[48:51], v[128:131]
ds_read_b64_tr_b16 v[96:97], v7 offset:16384
v_mfma_f32_16x16x32_bf16 v[136:139], v[16:19], v[52:55], v[136:139]
ds_read_b64_tr_b16 v[98:99], v7 offset:17408
v_mfma_f32_16x16x32_bf16 v[144:147], v[16:19], v[56:59], v[144:147]
v_mfma_f32_16x16x32_bf16 v[152:155], v[16:19], v[60:63], v[152:155]
ds_read_b64_tr_b16 v[100:101], v8 offset:16384
v_mfma_f32_16x16x32_bf16 v[132:135], v[20:23], v[48:51], v[132:135]
v_mfma_f32_16x16x32_bf16 v[140:143], v[20:23], v[52:55], v[140:143]
ds_read_b64_tr_b16 v[102:103], v8 offset:17408
v_mfma_f32_16x16x32_bf16 v[148:151], v[20:23], v[56:59], v[148:151]
s_add_u32 m0, s38, 98304
s_add_u32 s43, s35, 3145728
buffer_load_dwordx4 v13, s[12:15], s43 offen lds
v_mfma_f32_16x16x32_bf16 v[156:159], v[20:23], v[60:63], v[156:159]
ds_read_b64_tr_b16 v[104:105], v9 offset:16384
v_mfma_f32_16x16x32_bf16 v[160:163], v[24:27], v[48:51], v[160:163]
ds_read_b64_tr_b16 v[106:107], v9 offset:17408
v_mfma_f32_16x16x32_bf16 v[168:171], v[24:27], v[52:55], v[168:171]
v_mfma_f32_16x16x32_bf16 v[176:179], v[24:27], v[56:59], v[176:179]
ds_read_b64_tr_b16 v[108:109], v10 offset:16384
v_mfma_f32_16x16x32_bf16 v[184:187], v[24:27], v[60:63], v[184:187]
v_mfma_f32_16x16x32_bf16 v[164:167], v[28:31], v[48:51], v[164:167]
ds_read_b64_tr_b16 v[110:111], v10 offset:17408
v_mfma_f32_16x16x32_bf16 v[172:175], v[28:31], v[52:55], v[172:175]
s_add_u32 m0, s38, 99328
s_add_u32 s43, s35, 3178496
buffer_load_dwordx4 v13, s[12:15], s43 offen lds
v_mfma_f32_16x16x32_bf16 v[180:183], v[28:31], v[56:59], v[180:183]
ds_read_b128 v[64:67], v4 offset:32768
v_mfma_f32_16x16x32_bf16 v[188:191], v[28:31], v[60:63], v[188:191]
ds_read_b128 v[68:71], v4 offset:34816
v_mfma_f32_16x16x32_bf16 v[192:195], v[32:35], v[48:51], v[192:195]
v_mfma_f32_16x16x32_bf16 v[200:203], v[32:35], v[52:55], v[200:203]
ds_read_b128 v[72:75], v4 offset:36864
v_mfma_f32_16x16x32_bf16 v[208:211], v[32:35], v[56:59], v[208:211]
v_mfma_f32_16x16x32_bf16 v[216:219], v[32:35], v[60:63], v[216:219]
ds_read_b128 v[76:79], v4 offset:38912
v_mfma_f32_16x16x32_bf16 v[196:199], v[36:39], v[48:51], v[196:199]
s_add_u32 m0, s37, 2048
s_add_u32 s43, s33, 17152
buffer_load_dwordx4 v11, s[8:11], s43 offen lds
v_mfma_f32_16x16x32_bf16 v[204:207], v[36:39], v[52:55], v[204:207]
ds_read_b128 v[80:83], v4 offset:40960
v_mfma_f32_16x16x32_bf16 v[212:215], v[36:39], v[56:59], v[212:215]
ds_read_b128 v[84:87], v4 offset:43008
v_mfma_f32_16x16x32_bf16 v[220:223], v[36:39], v[60:63], v[220:223]
v_mfma_f32_16x16x32_bf16 v[224:227], v[40:43], v[48:51], v[224:227]
ds_read_b128 v[88:91], v4 offset:45056
v_mfma_f32_16x16x32_bf16 v[232:235], v[40:43], v[52:55], v[232:235]
v_mfma_f32_16x16x32_bf16 v[240:243], v[40:43], v[56:59], v[240:243]
ds_read_b128 v[92:95], v4 offset:47104
v_mfma_f32_16x16x32_bf16 v[248:251], v[40:43], v[60:63], v[248:251]
s_add_u32 m0, s37, 3072
s_add_u32 s43, s33, 25344
buffer_load_dwordx4 v12, s[8:11], s43 offen lds
v_mfma_f32_16x16x32_bf16 v[228:231], v[44:47], v[48:51], v[228:231]
v_mfma_f32_16x16x32_bf16 v[236:239], v[44:47], v[52:55], v[236:239]
v_mfma_f32_16x16x32_bf16 v[244:247], v[44:47], v[56:59], v[244:247]
v_mfma_f32_16x16x32_bf16 v[252:255], v[44:47], v[60:63], v[252:255]
s_waitcnt vmcnt(8) lgkmcnt(0)
s_barrier
v_mfma_f32_16x16x32_bf16 v[128:131], v[64:67], v[96:99], v[128:131]
ds_read_b64_tr_b16 v[48:49], v7 offset:32768
v_mfma_f32_16x16x32_bf16 v[136:139], v[64:67], v[100:103], v[136:139]
ds_read_b64_tr_b16 v[50:51], v7 offset:33792
v_mfma_f32_16x16x32_bf16 v[144:147], v[64:67], v[104:107], v[144:147]
v_mfma_f32_16x16x32_bf16 v[152:155], v[64:67], v[108:111], v[152:155]
ds_read_b64_tr_b16 v[52:53], v8 offset:32768
v_mfma_f32_16x16x32_bf16 v[132:135], v[68:71], v[96:99], v[132:135]
v_mfma_f32_16x16x32_bf16 v[140:143], v[68:71], v[100:103], v[140:143]
ds_read_b64_tr_b16 v[54:55], v8 offset:33792
v_mfma_f32_16x16x32_bf16 v[148:151], v[68:71], v[104:107], v[148:151]
s_add_u32 m0, s38, 114688
s_add_u32 s43, s35, 3407872
buffer_load_dwordx4 v13, s[12:15], s43 offen lds
v_mfma_f32_16x16x32_bf16 v[156:159], v[68:71], v[108:111], v[156:159]
ds_read_b64_tr_b16 v[56:57], v9 offset:32768
v_mfma_f32_16x16x32_bf16 v[160:163], v[72:75], v[96:99], v[160:163]
ds_read_b64_tr_b16 v[58:59], v9 offset:33792
v_mfma_f32_16x16x32_bf16 v[168:171], v[72:75], v[100:103], v[168:171]
v_mfma_f32_16x16x32_bf16 v[176:179], v[72:75], v[104:107], v[176:179]
ds_read_b64_tr_b16 v[60:61], v10 offset:32768
v_mfma_f32_16x16x32_bf16 v[184:187], v[72:75], v[108:111], v[184:187]
v_mfma_f32_16x16x32_bf16 v[164:167], v[76:79], v[96:99], v[164:167]
ds_read_b64_tr_b16 v[62:63], v10 offset:33792
v_mfma_f32_16x16x32_bf16 v[172:175], v[76:79], v[100:103], v[172:175]
s_add_u32 m0, s38, 115712
s_add_u32 s43, s35, 3440640
buffer_load_dwordx4 v13, s[12:15], s43 offen lds
v_mfma_f32_16x16x32_bf16 v[180:183], v[76:79], v[104:107], v[180:183]
ds_read_b128 v[16:19], v5 offset:0
v_mfma_f32_16x16x32_bf16 v[188:191], v[76:79], v[108:111], v[188:191]
ds_read_b128 v[20:23], v5 offset:2048
v_mfma_f32_16x16x32_bf16 v[192:195], v[80:83], v[96:99], v[192:195]
v_mfma_f32_16x16x32_bf16 v[200:203], v[80:83], v[100:103], v[200:203]
ds_read_b128 v[24:27], v5 offset:4096
v_mfma_f32_16x16x32_bf16 v[208:211], v[80:83], v[104:107], v[208:211]
v_mfma_f32_16x16x32_bf16 v[216:219], v[80:83], v[108:111], v[216:219]
ds_read_b128 v[28:31], v5 offset:6144
v_mfma_f32_16x16x32_bf16 v[196:199], v[84:87], v[96:99], v[196:199]
s_add_u32 m0, s37, 32768
s_add_u32 s43, s33, 896
buffer_load_dwordx4 v11, s[8:11], s43 offen lds
v_mfma_f32_16x16x32_bf16 v[204:207], v[84:87], v[100:103], v[204:207]
ds_read_b128 v[32:35], v5 offset:8192
s_sub_u32 s41, s73, 128
v_mov_b32 v15, s41
global_load_dword v126, v15, s[28:29]
v_mfma_f32_16x16x32_bf16 v[212:215], v[84:87], v[104:107], v[212:215]
ds_read_b128 v[36:39], v5 offset:10240
v_mfma_f32_16x16x32_bf16 v[220:223], v[84:87], v[108:111], v[220:223]
v_mfma_f32_16x16x32_bf16 v[224:227], v[88:91], v[96:99], v[224:227]
ds_read_b128 v[40:43], v5 offset:12288
v_mfma_f32_16x16x32_bf16 v[232:235], v[88:91], v[100:103], v[232:235]
v_mfma_f32_16x16x32_bf16 v[240:243], v[88:91], v[104:107], v[240:243]
ds_read_b128 v[44:47], v5 offset:14336
v_mfma_f32_16x16x32_bf16 v[248:251], v[88:91], v[108:111], v[248:251]
s_add_u32 m0, s37, 33792
s_add_u32 s43, s33, 9088
buffer_load_dwordx4 v12, s[8:11], s43 offen lds
v_mfma_f32_16x16x32_bf16 v[228:231], v[92:95], v[96:99], v[228:231]
v_mfma_f32_16x16x32_bf16 v[236:239], v[92:95], v[100:103], v[236:239]
v_mfma_f32_16x16x32_bf16 v[244:247], v[92:95], v[104:107], v[244:247]
v_mfma_f32_16x16x32_bf16 v[252:255], v[92:95], v[108:111], v[252:255]
s_waitcnt vmcnt(11) lgkmcnt(0)
s_barrier
v_mfma_f32_16x16x32_bf16 v[128:131], v[16:19], v[48:51], v[128:131]
ds_read_b64_tr_b16 v[96:97], v7 offset:49152
v_mfma_f32_16x16x32_bf16 v[136:139], v[16:19], v[52:55], v[136:139]
ds_read_b64_tr_b16 v[98:99], v7 offset:50176
v_mfma_f32_16x16x32_bf16 v[144:147], v[16:19], v[56:59], v[144:147]
v_mfma_f32_16x16x32_bf16 v[152:155], v[16:19], v[60:63], v[152:155]
ds_read_b64_tr_b16 v[100:101], v8 offset:49152
v_mfma_f32_16x16x32_bf16 v[132:135], v[20:23], v[48:51], v[132:135]
v_mfma_f32_16x16x32_bf16 v[140:143], v[20:23], v[52:55], v[140:143]
ds_read_b64_tr_b16 v[102:103], v8 offset:50176
v_mfma_f32_16x16x32_bf16 v[148:151], v[20:23], v[56:59], v[148:151]
s_add_u32 m0, s38, 131072
s_add_u32 s43, s35, 3670016
buffer_load_dwordx4 v13, s[12:15], s43 offen lds
v_mfma_f32_16x16x32_bf16 v[156:159], v[20:23], v[60:63], v[156:159]
ds_read_b64_tr_b16 v[104:105], v9 offset:49152
v_mfma_f32_16x16x32_bf16 v[160:163], v[24:27], v[48:51], v[160:163]
ds_read_b64_tr_b16 v[106:107], v9 offset:50176
v_mfma_f32_16x16x32_bf16 v[168:171], v[24:27], v[52:55], v[168:171]
v_mfma_f32_16x16x32_bf16 v[176:179], v[24:27], v[56:59], v[176:179]
ds_read_b64_tr_b16 v[108:109], v10 offset:49152
v_mfma_f32_16x16x32_bf16 v[184:187], v[24:27], v[60:63], v[184:187]
v_mfma_f32_16x16x32_bf16 v[164:167], v[28:31], v[48:51], v[164:167]
ds_read_b64_tr_b16 v[110:111], v10 offset:50176
v_mfma_f32_16x16x32_bf16 v[172:175], v[28:31], v[52:55], v[172:175]
s_add_u32 m0, s38, 132096
s_add_u32 s43, s35, 3702784
buffer_load_dwordx4 v13, s[12:15], s43 offen lds
v_mfma_f32_16x16x32_bf16 v[180:183], v[28:31], v[56:59], v[180:183]
ds_read_b128 v[64:67], v6 offset:0
v_mfma_f32_16x16x32_bf16 v[188:191], v[28:31], v[60:63], v[188:191]
ds_read_b128 v[68:71], v6 offset:2048
v_mfma_f32_16x16x32_bf16 v[192:195], v[32:35], v[48:51], v[192:195]
v_mfma_f32_16x16x32_bf16 v[200:203], v[32:35], v[52:55], v[200:203]
ds_read_b128 v[72:75], v6 offset:4096
v_mfma_f32_16x16x32_bf16 v[208:211], v[32:35], v[56:59], v[208:211]
v_mfma_f32_16x16x32_bf16 v[216:219], v[32:35], v[60:63], v[216:219]
ds_read_b128 v[76:79], v6 offset:6144
v_mfma_f32_16x16x32_bf16 v[196:199], v[36:39], v[48:51], v[196:199]
s_add_u32 m0, s37, 34816
s_add_u32 s43, s33, 17280
buffer_load_dwordx4 v11, s[8:11], s43 offen lds
v_mfma_f32_16x16x32_bf16 v[204:207], v[36:39], v[52:55], v[204:207]
ds_read_b128 v[80:83], v6 offset:8192
v_mfma_f32_16x16x32_bf16 v[212:215], v[36:39], v[56:59], v[212:215]
ds_read_b128 v[84:87], v6 offset:10240
v_mfma_f32_16x16x32_bf16 v[220:223], v[36:39], v[60:63], v[220:223]
v_mfma_f32_16x16x32_bf16 v[224:227], v[40:43], v[48:51], v[224:227]
ds_read_b128 v[88:91], v6 offset:12288
v_mfma_f32_16x16x32_bf16 v[232:235], v[40:43], v[52:55], v[232:235]
v_mfma_f32_16x16x32_bf16 v[240:243], v[40:43], v[56:59], v[240:243]
ds_read_b128 v[92:95], v6 offset:14336
v_mfma_f32_16x16x32_bf16 v[248:251], v[40:43], v[60:63], v[248:251]
s_add_u32 m0, s37, 35840
s_add_u32 s43, s33, 25472
buffer_load_dwordx4 v12, s[8:11], s43 offen lds
v_mfma_f32_16x16x32_bf16 v[228:231], v[44:47], v[48:51], v[228:231]
v_mfma_f32_16x16x32_bf16 v[236:239], v[44:47], v[52:55], v[236:239]
v_mfma_f32_16x16x32_bf16 v[244:247], v[44:47], v[56:59], v[244:247]
v_mfma_f32_16x16x32_bf16 v[252:255], v[44:47], v[60:63], v[252:255]
s_waitcnt vmcnt(9) lgkmcnt(0)
s_barrier
v_mfma_f32_16x16x32_bf16 v[128:131], v[64:67], v[96:99], v[128:131]
ds_read_b64_tr_b16 v[48:49], v7 offset:0
v_mfma_f32_16x16x32_bf16 v[136:139], v[64:67], v[100:103], v[136:139]
ds_read_b64_tr_b16 v[50:51], v7 offset:1024
v_mfma_f32_16x16x32_bf16 v[144:147], v[64:67], v[104:107], v[144:147]
v_mfma_f32_16x16x32_bf16 v[152:155], v[64:67], v[108:111], v[152:155]
ds_read_b64_tr_b16 v[52:53], v8 offset:0
v_mfma_f32_16x16x32_bf16 v[132:135], v[68:71], v[96:99], v[132:135]
v_mfma_f32_16x16x32_bf16 v[140:143], v[68:71], v[100:103], v[140:143]
ds_read_b64_tr_b16 v[54:55], v8 offset:1024
v_mfma_f32_16x16x32_bf16 v[148:151], v[68:71], v[104:107], v[148:151]
s_add_u32 m0, s38, 147456
s_add_u32 s43, s35, 3932160
buffer_load_dwordx4 v13, s[12:15], s43 offen lds
v_mfma_f32_16x16x32_bf16 v[156:159], v[68:71], v[108:111], v[156:159]
ds_read_b64_tr_b16 v[56:57], v9 offset:0
v_mfma_f32_16x16x32_bf16 v[160:163], v[72:75], v[96:99], v[160:163]
ds_read_b64_tr_b16 v[58:59], v9 offset:1024
v_mfma_f32_16x16x32_bf16 v[168:171], v[72:75], v[100:103], v[168:171]
v_mfma_f32_16x16x32_bf16 v[176:179], v[72:75], v[104:107], v[176:179]
ds_read_b64_tr_b16 v[60:61], v10 offset:0
v_mfma_f32_16x16x32_bf16 v[184:187], v[72:75], v[108:111], v[184:187]
v_mfma_f32_16x16x32_bf16 v[164:167], v[76:79], v[96:99], v[164:167]
ds_read_b64_tr_b16 v[62:63], v10 offset:1024
v_mfma_f32_16x16x32_bf16 v[172:175], v[76:79], v[100:103], v[172:175]
s_add_u32 m0, s38, 148480
s_add_u32 s43, s35, 3964928
buffer_load_dwordx4 v13, s[12:15], s43 offen lds
v_mfma_f32_16x16x32_bf16 v[180:183], v[76:79], v[104:107], v[180:183]
ds_read_b128 v[16:19], v3 offset:0
v_mfma_f32_16x16x32_bf16 v[188:191], v[76:79], v[108:111], v[188:191]
ds_read_b128 v[20:23], v3 offset:2048
v_mfma_f32_16x16x32_bf16 v[192:195], v[80:83], v[96:99], v[192:195]
v_mfma_f32_16x16x32_bf16 v[200:203], v[80:83], v[100:103], v[200:203]
ds_read_b128 v[24:27], v3 offset:4096
v_mfma_f32_16x16x32_bf16 v[208:211], v[80:83], v[104:107], v[208:211]
v_mfma_f32_16x16x32_bf16 v[216:219], v[80:83], v[108:111], v[216:219]
ds_read_b128 v[28:31], v3 offset:6144
v_mfma_f32_16x16x32_bf16 v[196:199], v[84:87], v[96:99], v[196:199]
s_add_u32 m0, s37, 65536
s_add_u32 s43, s34, 0
buffer_load_dwordx4 v11, s[4:7], s43 offen lds
v_mfma_f32_16x16x32_bf16 v[204:207], v[84:87], v[100:103], v[204:207]
ds_read_b128 v[32:35], v3 offset:8192
v_mfma_f32_16x16x32_bf16 v[212:215], v[84:87], v[104:107], v[212:215]
ds_read_b128 v[36:39], v3 offset:10240
v_mfma_f32_16x16x32_bf16 v[220:223], v[84:87], v[108:111], v[220:223]
v_mfma_f32_16x16x32_bf16 v[224:227], v[88:91], v[96:99], v[224:227]
ds_read_b128 v[40:43], v3 offset:12288
v_mfma_f32_16x16x32_bf16 v[232:235], v[88:91], v[100:103], v[232:235]
v_mfma_f32_16x16x32_bf16 v[240:243], v[88:91], v[104:107], v[240:243]
ds_read_b128 v[44:47], v3 offset:14336
v_mfma_f32_16x16x32_bf16 v[248:251], v[88:91], v[108:111], v[248:251]
s_add_u32 m0, s37, 66560
s_add_u32 s43, s34, 8192
buffer_load_dwordx4 v12, s[4:7], s43 offen lds
v_mfma_f32_16x16x32_bf16 v[228:231], v[92:95], v[96:99], v[228:231]
v_mfma_f32_16x16x32_bf16 v[236:239], v[92:95], v[100:103], v[236:239]
v_mfma_f32_16x16x32_bf16 v[244:247], v[92:95], v[104:107], v[244:247]
v_mfma_f32_16x16x32_bf16 v[252:255], v[92:95], v[108:111], v[252:255]
s_waitcnt vmcnt(11) lgkmcnt(0)
s_barrier
v_mfma_f32_16x16x32_bf16 v[128:131], v[16:19], v[48:51], v[128:131]
ds_read_b64_tr_b16 v[96:97], v7 offset:16384
v_mfma_f32_16x16x32_bf16 v[136:139], v[16:19], v[52:55], v[136:139]
ds_read_b64_tr_b16 v[98:99], v7 offset:17408
v_mfma_f32_16x16x32_bf16 v[144:147], v[16:19], v[56:59], v[144:147]
v_mfma_f32_16x16x32_bf16 v[152:155], v[16:19], v[60:63], v[152:155]
ds_read_b64_tr_b16 v[100:101], v8 offset:16384
v_mfma_f32_16x16x32_bf16 v[132:135], v[20:23], v[48:51], v[132:135]
v_mfma_f32_16x16x32_bf16 v[140:143], v[20:23], v[52:55], v[140:143]
ds_read_b64_tr_b16 v[102:103], v8 offset:17408
v_mfma_f32_16x16x32_bf16 v[148:151], v[20:23], v[56:59], v[148:151]
s_add_u32 m0, s38, 98304
s_add_u32 s43, s36, 0
buffer_load_dwordx4 v13, s[16:19], s43 offen lds
v_mfma_f32_16x16x32_bf16 v[156:159], v[20:23], v[60:63], v[156:159]
ds_read_b64_tr_b16 v[104:105], v9 offset:16384
v_mfma_f32_16x16x32_bf16 v[160:163], v[24:27], v[48:51], v[160:163]
ds_read_b64_tr_b16 v[106:107], v9 offset:17408
v_mfma_f32_16x16x32_bf16 v[168:171], v[24:27], v[52:55], v[168:171]
v_mfma_f32_16x16x32_bf16 v[176:179], v[24:27], v[56:59], v[176:179]
ds_read_b64_tr_b16 v[108:109], v10 offset:16384
v_mfma_f32_16x16x32_bf16 v[184:187], v[24:27], v[60:63], v[184:187]
v_mfma_f32_16x16x32_bf16 v[164:167], v[28:31], v[48:51], v[164:167]
ds_read_b64_tr_b16 v[110:111], v10 offset:17408
v_mfma_f32_16x16x32_bf16 v[172:175], v[28:31], v[52:55], v[172:175]
s_add_u32 m0, s38, 99328
s_add_u32 s43, s36, 32768
buffer_load_dwordx4 v13, s[16:19], s43 offen lds
v_mfma_f32_16x16x32_bf16 v[180:183], v[28:31], v[56:59], v[180:183]
ds_read_b128 v[64:67], v4 offset:0
v_mfma_f32_16x16x32_bf16 v[188:191], v[28:31], v[60:63], v[188:191]
ds_read_b128 v[68:71], v4 offset:2048
v_mfma_f32_16x16x32_bf16 v[192:195], v[32:35], v[48:51], v[192:195]
v_mfma_f32_16x16x32_bf16 v[200:203], v[32:35], v[52:55], v[200:203]
ds_read_b128 v[72:75], v4 offset:4096
v_mfma_f32_16x16x32_bf16 v[208:211], v[32:35], v[56:59], v[208:211]
v_mfma_f32_16x16x32_bf16 v[216:219], v[32:35], v[60:63], v[216:219]
ds_read_b128 v[76:79], v4 offset:6144
v_mfma_f32_16x16x32_bf16 v[196:199], v[36:39], v[48:51], v[196:199]
s_add_u32 m0, s37, 67584
s_add_u32 s43, s34, 16384
buffer_load_dwordx4 v11, s[4:7], s43 offen lds
v_mfma_f32_16x16x32_bf16 v[204:207], v[36:39], v[52:55], v[204:207]
ds_read_b128 v[80:83], v4 offset:8192
s_waitcnt vmcnt(12)
v_readfirstlane_b32 s41, v126
s_lshl_b32 s42, 1, s72
s_or_b32 s42, s42, 0x800
s_and_b32 s41, s41, 0xfff
s_cmp_eq_u32 s41, s42
s_cselect_b32 s3, 1, 0
v_mfma_f32_16x16x32_bf16 v[212:215], v[36:39], v[56:59], v[212:215]
ds_read_b128 v[84:87], v4 offset:10240
v_mfma_f32_16x16x32_bf16 v[220:223], v[36:39], v[60:63], v[220:223]
v_mfma_f32_16x16x32_bf16 v[224:227], v[40:43], v[48:51], v[224:227]
ds_read_b128 v[88:91], v4 offset:12288
v_mfma_f32_16x16x32_bf16 v[232:235], v[40:43], v[52:55], v[232:235]
v_mfma_f32_16x16x32_bf16 v[240:243], v[40:43], v[56:59], v[240:243]
ds_read_b128 v[92:95], v4 offset:14336
v_mfma_f32_16x16x32_bf16 v[248:251], v[40:43], v[60:63], v[248:251]
s_add_u32 m0, s37, 68608
s_add_u32 s43, s34, 24576
buffer_load_dwordx4 v12, s[4:7], s43 offen lds
v_mfma_f32_16x16x32_bf16 v[228:231], v[44:47], v[48:51], v[228:231]
v_mfma_f32_16x16x32_bf16 v[236:239], v[44:47], v[52:55], v[236:239]
v_mfma_f32_16x16x32_bf16 v[244:247], v[44:47], v[56:59], v[244:247]
v_mfma_f32_16x16x32_bf16 v[252:255], v[44:47], v[60:63], v[252:255]
s_waitcnt vmcnt(8) lgkmcnt(0)
s_barrier
v_mfma_f32_16x16x32_bf16 v[128:131], v[64:67], v[96:99], v[128:131]
ds_read_b64_tr_b16 v[48:49], v7 offset:32768
v_mfma_f32_16x16x32_bf16 v[136:139], v[64:67], v[100:103], v[136:139]
ds_read_b64_tr_b16 v[50:51], v7 offset:33792
v_mfma_f32_16x16x32_bf16 v[144:147], v[64:67], v[104:107], v[144:147]
v_mfma_f32_16x16x32_bf16 v[152:155], v[64:67], v[108:111], v[152:155]
ds_read_b64_tr_b16 v[52:53], v8 offset:32768
v_mfma_f32_16x16x32_bf16 v[132:135], v[68:71], v[96:99], v[132:135]
v_mfma_f32_16x16x32_bf16 v[140:143], v[68:71], v[100:103], v[140:143]
ds_read_b64_tr_b16 v[54:55], v8 offset:33792
v_mfma_f32_16x16x32_bf16 v[148:151], v[68:71], v[104:107], v[148:151]
s_add_u32 m0, s38, 114688
s_add_u32 s43, s36, 524288
buffer_load_dwordx4 v13, s[16:19], s43 offen lds
v_mfma_f32_16x16x32_bf16 v[156:159], v[68:71], v[108:111], v[156:159]
ds_read_b64_tr_b16 v[56:57], v9 offset:32768
v_mfma_f32_16x16x32_bf16 v[160:163], v[72:75], v[96:99], v[160:163]
ds_read_b64_tr_b16 v[58:59], v9 offset:33792
v_mfma_f32_16x16x32_bf16 v[168:171], v[72:75], v[100:103], v[168:171]
v_mfma_f32_16x16x32_bf16 v[176:179], v[72:75], v[104:107], v[176:179]
ds_read_b64_tr_b16 v[60:61], v10 offset:32768
v_mfma_f32_16x16x32_bf16 v[184:187], v[72:75], v[108:111], v[184:187]
v_mfma_f32_16x16x32_bf16 v[164:167], v[76:79], v[96:99], v[164:167]
ds_read_b64_tr_b16 v[62:63], v10 offset:33792
v_mfma_f32_16x16x32_bf16 v[172:175], v[76:79], v[100:103], v[172:175]
s_add_u32 m0, s38, 115712
s_add_u32 s43, s36, 557056
buffer_load_dwordx4 v13, s[16:19], s43 offen lds
v_mfma_f32_16x16x32_bf16 v[180:183], v[76:79], v[104:107], v[180:183]
ds_read_b128 v[16:19], v3 offset:32768
v_mfma_f32_16x16x32_bf16 v[188:191], v[76:79], v[108:111], v[188:191]
ds_read_b128 v[20:23], v3 offset:34816
v_mfma_f32_16x16x32_bf16 v[192:195], v[80:83], v[96:99], v[192:195]
v_mfma_f32_16x16x32_bf16 v[200:203], v[80:83], v[100:103], v[200:203]
ds_read_b128 v[24:27], v3 offset:36864
v_mfma_f32_16x16x32_bf16 v[208:211], v[80:83], v[104:107], v[208:211]
v_mfma_f32_16x16x32_bf16 v[216:219], v[80:83], v[108:111], v[216:219]
ds_read_b128 v[28:31], v3 offset:38912
v_mfma_f32_16x16x32_bf16 v[196:199], v[84:87], v[96:99], v[196:199]
s_add_u32 m0, s37, 0
s_add_u32 s43, s34, 128
buffer_load_dwordx4 v11, s[4:7], s43 offen lds
v_mfma_f32_16x16x32_bf16 v[204:207], v[84:87], v[100:103], v[204:207]
ds_read_b128 v[32:35], v3 offset:40960
v_and_b32 v14, 15, v1
v_lshrrev_b32 v15, 4, v1
v_lshrrev_b32 v124, 1, v14
v_xor_b32 v124, v124, v15
v_mfma_f32_16x16x32_bf16 v[212:215], v[84:87], v[104:107], v[212:215]
ds_read_b128 v[36:39], v3 offset:43008
v_lshlrev_b32 v124, 4, v124
v_lshlrev_b32 v127, 7, v14
v_add_u32 v127, s37, v127
v_mfma_f32_16x16x32_bf16 v[220:223], v[84:87], v[108:111], v[220:223]
v_add_u32 v112, v127, v124
v_xor_b32 v124, 64, v124
v_add_u32 v113, v127, v124
v_mfma_f32_16x16x32_bf16 v[224:227], v[88:91], v[96:99], v[224:227]
ds_read_b128 v[40:43], v3 offset:45056
v_add_u32 v114, 0x10000, v112
v_add_u32 v115, 0x10000, v113
v_lshrrev_b32 v14, 2, v14
v_and_b32 v124, 1, v15
v_mfma_f32_16x16x32_bf16 v[232:235], v[88:91], v[100:103], v[232:235]
v_lshlrev_b32 v124, 2, v124
v_or_b32 v124, v124, v14
v_lshlrev_b32 v124, 5, v124
v_mfma_f32_16x16x32_bf16 v[240:243], v[88:91], v[104:107], v[240:243]
ds_read_b128 v[44:47], v3 offset:47104
v_lshlrev_b32 v15, 3, v15
v_add_u32 v15, v15, v14
v_lshlrev_b32 v15, 8, v15
v_mfma_f32_16x16x32_bf16 v[248:251], v[88:91], v[108:111], v[248:251]
s_add_u32 m0, s37, 1024
s_add_u32 s43, s34, 8320
buffer_load_dwordx4 v12, s[4:7], s43 offen lds
v_and_b32 v14, 3, v1
v_lshlrev_b32 v14, 3, v14
v_add_u32 v15, v15, v14
v_add_u32 v15, v15, v124
v_mfma_f32_16x16x32_bf16 v[228:231], v[92:95], v[96:99], v[228:231]
v_add_u32 v15, 98304, v15
v_xor_b32 v116, 0, v15
v_xor_b32 v117, 32, v15
v_mfma_f32_16x16x32_bf16 v[236:239], v[92:95], v[100:103], v[236:239]
v_xor_b32 v118, 64, v15
v_xor_b32 v119, 96, v15
v_xor_b32 v120, 128, v15
v_mfma_f32_16x16x32_bf16 v[244:247], v[92:95], v[104:107], v[244:247]
v_xor_b32 v121, 160, v15
v_xor_b32 v122, 192, v15
v_xor_b32 v123, 224, v15
v_mfma_f32_16x16x32_bf16 v[252:255], v[92:95], v[108:111], v[252:255]
s_waitcnt vmcnt(10) lgkmcnt(0)
s_barrier
v_mfma_f32_16x16x32_bf16 v[128:131], v[16:19], v[48:51], v[128:131]
ds_read_b64_tr_b16 v[96:97], v7 offset:49152
v_mfma_f32_16x16x32_bf16 v[136:139], v[16:19], v[52:55], v[136:139]
ds_read_b64_tr_b16 v[98:99], v7 offset:50176
v_mfma_f32_16x16x32_bf16 v[144:147], v[16:19], v[56:59], v[144:147]
v_mfma_f32_16x16x32_bf16 v[152:155], v[16:19], v[60:63], v[152:155]
ds_read_b64_tr_b16 v[100:101], v8 offset:49152
v_mfma_f32_16x16x32_bf16 v[132:135], v[20:23], v[48:51], v[132:135]
v_mfma_f32_16x16x32_bf16 v[140:143], v[20:23], v[52:55], v[140:143]
ds_read_b64_tr_b16 v[102:103], v8 offset:50176
v_mfma_f32_16x16x32_bf16 v[148:151], v[20:23], v[56:59], v[148:151]
s_add_u32 m0, s38, 131072
s_add_u32 s43, s36, 1048576
buffer_load_dwordx4 v13, s[16:19], s43 offen lds
v_mfma_f32_16x16x32_bf16 v[156:159], v[20:23], v[60:63], v[156:159]
ds_read_b64_tr_b16 v[104:105], v9 offset:49152
v_mfma_f32_16x16x32_bf16 v[160:163], v[24:27], v[48:51], v[160:163]
ds_read_b64_tr_b16 v[106:107], v9 offset:50176
v_mfma_f32_16x16x32_bf16 v[168:171], v[24:27], v[52:55], v[168:171]
v_mfma_f32_16x16x32_bf16 v[176:179], v[24:27], v[56:59], v[176:179]
ds_read_b64_tr_b16 v[108:109], v10 offset:49152
v_mfma_f32_16x16x32_bf16 v[184:187], v[24:27], v[60:63], v[184:187]
v_mfma_f32_16x16x32_bf16 v[164:167], v[28:31], v[48:51], v[164:167]
ds_read_b64_tr_b16 v[110:111], v10 offset:50176
v_mfma_f32_16x16x32_bf16 v[172:175], v[28:31], v[52:55], v[172:175]
s_add_u32 m0, s38, 132096
s_add_u32 s43, s36, 1081344
buffer_load_dwordx4 v13, s[16:19], s43 offen lds
v_mfma_f32_16x16x32_bf16 v[180:183], v[28:31], v[56:59], v[180:183]
ds_read_b128 v[64:67], v4 offset:32768
v_mfma_f32_16x16x32_bf16 v[188:191], v[28:31], v[60:63], v[188:191]
ds_read_b128 v[68:71], v4 offset:34816
v_mfma_f32_16x16x32_bf16 v[192:195], v[32:35], v[48:51], v[192:195]
v_mfma_f32_16x16x32_bf16 v[200:203], v[32:35], v[52:55], v[200:203]
ds_read_b128 v[72:75], v4 offset:36864
v_mfma_f32_16x16x32_bf16 v[208:211], v[32:35], v[56:59], v[208:211]
v_mfma_f32_16x16x32_bf16 v[216:219], v[32:35], v[60:63], v[216:219]
ds_read_b128 v[76:79], v4 offset:38912
v_mfma_f32_16x16x32_bf16 v[196:199], v[36:39], v[48:51], v[196:199]
s_add_u32 m0, s37, 2048
s_add_u32 s43, s34, 16512
buffer_load_dwordx4 v11, s[4:7], s43 offen lds
v_mfma_f32_16x16x32_bf16 v[204:207], v[36:39], v[52:55], v[204:207]
ds_read_b128 v[80:83], v4 offset:40960
v_mfma_f32_16x16x32_bf16 v[212:215], v[36:39], v[56:59], v[212:215]
ds_read_b128 v[84:87], v4 offset:43008
v_mfma_f32_16x16x32_bf16 v[220:223], v[36:39], v[60:63], v[220:223]
v_mfma_f32_16x16x32_bf16 v[224:227], v[40:43], v[48:51], v[224:227]
ds_read_b128 v[88:91], v4 offset:45056
v_mfma_f32_16x16x32_bf16 v[232:235], v[40:43], v[52:55], v[232:235]
v_mfma_f32_16x16x32_bf16 v[240:243], v[40:43], v[56:59], v[240:243]
ds_read_b128 v[92:95], v4 offset:47104
v_mfma_f32_16x16x32_bf16 v[248:251], v[40:43], v[60:63], v[248:251]
s_add_u32 m0, s37, 3072
s_add_u32 s43, s34, 24704
buffer_load_dwordx4 v12, s[4:7], s43 offen lds
v_mfma_f32_16x16x32_bf16 v[228:231], v[44:47], v[48:51], v[228:231]
v_mfma_f32_16x16x32_bf16 v[236:239], v[44:47], v[52:55], v[236:239]
v_mfma_f32_16x16x32_bf16 v[244:247], v[44:47], v[56:59], v[244:247]
v_mfma_f32_16x16x32_bf16 v[252:255], v[44:47], v[60:63], v[252:255]
s_cmp_ge_u32 s31, 2
s_cbranch_scc1 L_qlateB
s_waitcnt vmcnt(8) lgkmcnt(0)
s_barrier
v_mfma_f32_16x16x32_bf16 v[128:131], v[64:67], v[96:99], v[128:131]
ds_read_b128 v[48:51], v114 offset:0
v_mfma_f32_16x16x32_bf16 v[136:139], v[64:67], v[100:103], v[136:139]
ds_read_b128 v[52:55], v114 offset:2048
v_mfma_f32_16x16x32_bf16 v[144:147], v[64:67], v[104:107], v[144:147]
ds_read_b64_tr_b16 v[16:17], v116 offset:0
s_add_u32 m0, s37, 32768
s_add_u32 s43, s34, 256
buffer_load_dwordx4 v11, s[4:7], s43 offen lds
v_mfma_f32_16x16x32_bf16 v[152:155], v[64:67], v[108:111], v[152:155]
ds_read_b64_tr_b16 v[18:19], v116 offset:1024
v_mfma_f32_16x16x32_bf16 v[132:135], v[68:71], v[96:99], v[132:135]
ds_read_b64_tr_b16 v[20:21], v117 offset:0
v_mfma_f32_16x16x32_bf16 v[140:143], v[68:71], v[100:103], v[140:143]
ds_read_b64_tr_b16 v[22:23], v117 offset:1024
v_mfma_f32_16x16x32_bf16 v[148:151], v[68:71], v[104:107], v[148:151]
ds_read_b64_tr_b16 v[24:25], v118 offset:0
s_add_u32 m0, s37, 33792
s_add_u32 s43, s34, 8448
buffer_load_dwordx4 v12, s[4:7], s43 offen lds
v_mfma_f32_16x16x32_bf16 v[156:159], v[68:71], v[108:111], v[156:159]
ds_read_b64_tr_b16 v[26:27], v118 offset:1024
v_mfma_f32_16x16x32_bf16 v[160:163], v[72:75], v[96:99], v[160:163]
ds_read_b64_tr_b16 v[28:29], v119 offset:0
v_mfma_f32_16x16x32_bf16 v[168:171], v[72:75], v[100:103], v[168:171]
v_mfma_f32_16x16x32_bf16 v[176:179], v[72:75], v[104:107], v[176:179]
ds_read_b64_tr_b16 v[30:31], v119 offset:1024
v_cvt_pk_bf16_f32 v128, v128, v129
v_cvt_pk_bf16_f32 v129, v130, v131
v_cvt_pk_bf16_f32 v130, v132, v133
v_cvt_pk_bf16_f32 v131, v134, v135
v_mfma_f32_16x16x32_bf16 v[184:187], v[72:75], v[108:111], v[184:187]
ds_read_b64_tr_b16 v[32:33], v120 offset:0
s_add_u32 m0, s37, 34816
s_add_u32 s43, s34, 16640
buffer_load_dwordx4 v11, s[4:7], s43 offen lds
v_cvt_pk_bf16_f32 v132, v136, v137
v_cvt_pk_bf16_f32 v133, v138, v139
v_cvt_pk_bf16_f32 v134, v140, v141
v_cvt_pk_bf16_f32 v135, v142, v143
v_mfma_f32_16x16x32_bf16 v[164:167], v[76:79], v[96:99], v[164:167]
ds_read_b64_tr_b16 v[34:35], v120 offset:1024
v_cvt_pk_bf16_f32 v136, v144, v145
v_cvt_pk_bf16_f32 v137, v146, v147
v_cvt_pk_bf16_f32 v138, v148, v149
v_cvt_pk_bf16_f32 v139, v150, v151
v_mfma_f32_16x16x32_bf16 v[172:175], v[76:79], v[100:103], v[172:175]
ds_read_b64_tr_b16 v[36:37], v121 offset:0
v_cvt_pk_bf16_f32 v140, v152, v153
v_cvt_pk_bf16_f32 v141, v154, v155
v_cvt_pk_bf16_f32 v142, v156, v157
v_cvt_pk_bf16_f32 v143, v158, v159
v_mfma_f32_16x16x32_bf16 v[180:183], v[76:79], v[104:107], v[180:183]
ds_read_b64_tr_b16 v[38:39], v121 offset:1024
v_mfma_f32_16x16x32_bf16 v[188:191], v[76:79], v[108:111], v[188:191]
ds_read_b64_tr_b16 v[40:41], v122 offset:0
v_mfma_f32_16x16x32_bf16 v[192:195], v[80:83], v[96:99], v[192:195]
ds_read_b64_tr_b16 v[42:43], v122 offset:1024
s_add_u32 m0, s37, 35840
s_add_u32 s43, s34, 24832
buffer_load_dwordx4 v12, s[4:7], s43 offen lds
v_mfma_f32_16x16x32_bf16 v[200:203], v[80:83], v[100:103], v[200:203]
ds_read_b64_tr_b16 v[44:45], v123 offset:0
v_mfma_f32_16x16x32_bf16 v[208:211], v[80:83], v[104:107], v[208:211]
ds_read_b64_tr_b16 v[46:47], v123 offset:1024
v_cvt_pk_bf16_f32 v144, v160, v161
v_cvt_pk_bf16_f32 v145, v162, v163
v_cvt_pk_bf16_f32 v146, v164, v165
v_cvt_pk_bf16_f32 v147, v166, v167
v_mfma_f32_16x16x32_bf16 v[216:219], v[80:83], v[108:111], v[216:219]
v_cvt_pk_bf16_f32 v148, v168, v169
v_cvt_pk_bf16_f32 v149, v170, v171
v_cvt_pk_bf16_f32 v150, v172, v173
v_cvt_pk_bf16_f32 v151, v174, v175
v_mfma_f32_16x16x32_bf16 v[196:199], v[84:87], v[96:99], v[196:199]
s_add_u32 m0, s38, 147456
s_add_u32 s43, s36, 1572864
buffer_load_dwordx4 v13, s[16:19], s43 offen lds
v_cvt_pk_bf16_f32 v152, v176, v177
v_cvt_pk_bf16_f32 v153, v178, v179
v_cvt_pk_bf16_f32 v154, v180, v181
v_cvt_pk_bf16_f32 v155, v182, v183
v_mfma_f32_16x16x32_bf16 v[204:207], v[84:87], v[100:103], v[204:207]
v_cvt_pk_bf16_f32 v156, v184, v185
v_cvt_pk_bf16_f32 v157, v186, v187
v_cvt_pk_bf16_f32 v158, v188, v189
v_cvt_pk_bf16_f32 v159, v190, v191
v_mfma_f32_16x16x32_bf16 v[212:215], v[84:87], v[104:107], v[212:215]
v_mfma_f32_16x16x32_bf16 v[220:223], v[84:87], v[108:111], v[220:223]
v_mfma_f32_16x16x32_bf16 v[224:227], v[88:91], v[96:99], v[224:227]
v_mfma_f32_16x16x32_bf16 v[232:235], v[88:91], v[100:103], v[232:235]
s_add_u32 m0, s38, 148480
s_add_u32 s43, s36, 1605632
buffer_load_dwordx4 v13, s[16:19], s43 offen lds
v_mfma_f32_16x16x32_bf16 v[240:243], v[88:91], v[104:107], v[240:243]
v_cvt_pk_bf16_f32 v160, v192, v193
v_cvt_pk_bf16_f32 v161, v194, v195
v_cvt_pk_bf16_f32 v162, v196, v197
v_cvt_pk_bf16_f32 v163, v198, v199
v_mfma_f32_16x16x32_bf16 v[248:251], v[88:91], v[108:111], v[248:251]
v_cvt_pk_bf16_f32 v164, v200, v201
v_cvt_pk_bf16_f32 v165, v202, v203
v_cvt_pk_bf16_f32 v166, v204, v205
v_cvt_pk_bf16_f32 v167, v206, v207
v_mfma_f32_16x16x32_bf16 v[228:231], v[92:95], v[96:99], v[228:231]
v_cvt_pk_bf16_f32 v168, v208, v209
v_cvt_pk_bf16_f32 v169, v210, v211
v_cvt_pk_bf16_f32 v170, v212, v213
v_cvt_pk_bf16_f32 v171, v214, v215
v_mfma_f32_16x16x32_bf16 v[236:239], v[92:95], v[100:103], v[236:239]
v_cvt_pk_bf16_f32 v172, v216, v217
v_cvt_pk_bf16_f32 v173, v218, v219
v_cvt_pk_bf16_f32 v174, v220, v221
v_cvt_pk_bf16_f32 v175, v222, v223
v_mfma_f32_16x16x32_bf16 v[244:247], v[92:95], v[104:107], v[244:247]
v_mfma_f32_16x16x32_bf16 v[252:255], v[92:95], v[108:111], v[252:255]
s_nop 7
v_cvt_pk_bf16_f32 v176, v224, v225
v_cvt_pk_bf16_f32 v177, v226, v227
v_cvt_pk_bf16_f32 v178, v228, v229
v_cvt_pk_bf16_f32 v179, v230, v231
v_cvt_pk_bf16_f32 v180, v232, v233
v_cvt_pk_bf16_f32 v181, v234, v235
v_cvt_pk_bf16_f32 v182, v236, v237
v_cvt_pk_bf16_f32 v183, v238, v239
v_cvt_pk_bf16_f32 v184, v240, v241
v_cvt_pk_bf16_f32 v185, v242, v243
v_cvt_pk_bf16_f32 v186, v244, v245
v_cvt_pk_bf16_f32 v187, v246, v247
v_cvt_pk_bf16_f32 v188, v248, v249
v_cvt_pk_bf16_f32 v189, v250, v251
v_cvt_pk_bf16_f32 v190, v252, v253
v_cvt_pk_bf16_f32 v191, v254, v255
s_waitcnt lgkmcnt(14)
v_mfma_f32_16x16x32_bf16 v[192:195], v[16:19], v[48:51], 0
ds_read_b128 v[96:99], v115 offset:0
ds_read_b128 v[100:103], v115 offset:2048
v_mfma_f32_16x16x32_bf16 v[224:227], v[16:19], v[52:55], 0
ds_read_b64_tr_b16 v[64:65], v116 offset:8192
s_add_u32 s44, s40, 0
s_cmp_eq_u32 s3, 0
s_cbranch_scc1 L_sst32
buffer_store_dwordx4 v[128:131], v2, s[20:23], s44 offen offset:0
L_sstr32:
s_waitcnt lgkmcnt(15)
v_mfma_f32_16x16x32_bf16 v[196:199], v[20:23], v[48:51], 0
ds_read_b64_tr_b16 v[66:67], v116 offset:9216
v_mfma_f32_16x16x32_bf16 v[228:231], v[20:23], v[52:55], 0
ds_read_b64_tr_b16 v[68:69], v117 offset:8192
ds_read_b64_tr_b16 v[70:71], v117 offset:9216
s_add_u32 s44, s40, 0
s_cmp_eq_u32 s3, 0
s_cbranch_scc1 L_sst33
buffer_store_dwordx4 v[132:135], v2, s[20:23], s44 offen offset:1024
L_sstr33:
s_waitcnt lgkmcnt(15)
v_mfma_f32_16x16x32_bf16 v[200:203], v[24:27], v[48:51], 0
ds_read_b64_tr_b16 v[72:73], v118 offset:8192
v_mfma_f32_16x16x32_bf16 v[232:235], v[24:27], v[52:55], 0
ds_read_b64_tr_b16 v[74:75], v118 offset:9216
s_waitcnt lgkmcnt(15)
v_mfma_f32_16x16x32_bf16 v[204:207], v[28:31], v[48:51], 0
ds_read_b64_tr_b16 v[76:77], v119 offset:8192
s_add_u32 s44, s40, 0
s_cmp_eq_u32 s3, 0
s_cbranch_scc1 L_sst34
buffer_store_dwordx4 v[136:139], v2, s[20:23], s44 offen offset:2048
L_sstr34:
v_mfma_f32_16x16x32_bf16 v[236:239], v[28:31], v[52:55], 0
ds_read_b64_tr_b16 v[78:79], v119 offset:9216
ds_read_b64_tr_b16 v[80:81], v120 offset:8192
s_waitcnt lgkmcnt(15)
v_mfma_f32_16x16x32_bf16 v[208:211], v[32:35], v[48:51], 0
ds_read_b64_tr_b16 v[82:83], v120 offset:9216
s_add_u32 s44, s40, 0
s_cmp_eq_u32 s3, 0
s_cbranch_scc1 L_sst35
buffer_store_dwordx4 v[140:143], v2, s[20:23], s44 offen offset:3072
L_sstr35:
v_mfma_f32_16x16x32_bf16 v[240:243], v[32:35], v[52:55], 0
ds_read_b64_tr_b16 v[84:85], v121 offset:8192
v_mfma_f32_16x16x32_bf16 v[212:215], v[36:39], v[48:51], 0
ds_read_b64_tr_b16 v[86:87], v121 offset:9216
ds_read_b64_tr_b16 v[88:89], v122 offset:8192
v_mfma_f32_16x16x32_bf16 v[244:247], v[36:39], v[52:55], 0
ds_read_b64_tr_b16 v[90:91], v122 offset:9216
s_add_u32 s44, s40, 8192
s_cmp_eq_u32 s3, 0
s_cbranch_scc1 L_sst36
buffer_store_dwordx4 v[144:147], v2, s[20:23], s44 offen offset:0
L_sstr36:
s_waitcnt lgkmcnt(15)
v_mfma_f32_16x16x32_bf16 v[216:219], v[40:43], v[48:51], 0
ds_read_b64_tr_b16 v[92:93], v123 offset:8192
v_mfma_f32_16x16x32_bf16 v[248:251], v[40:43], v[52:55], 0
ds_read_b64_tr_b16 v[94:95], v123 offset:9216
s_add_u32 s44, s40, 8192
s_cmp_eq_u32 s3, 0
s_cbranch_scc1 L_sst37
buffer_store_dwordx4 v[148:151], v2, s[20:23], s44 offen offset:1024
L_sstr37:
v_mfma_f32_16x16x32_bf16 v[220:223], v[44:47], v[48:51], 0
v_mfma_f32_16x16x32_bf16 v[252:255], v[44:47], v[52:55], 0
s_waitcnt vmcnt(12) lgkmcnt(0)
s_barrier
v_mfma_f32_16x16x32_bf16 v[192:195], v[64:67], v[96:99], v[192:195]
ds_read_b128 v[48:51], v112 offset:0
ds_read_b128 v[52:55], v112 offset:2048
v_mov_b32 v128, 0
v_mov_b32 v129, 0
v_mov_b32 v130, 0
v_mov_b32 v131, 0
v_mfma_f32_16x16x32_bf16 v[224:227], v[64:67], v[100:103], v[224:227]
ds_read_b64_tr_b16 v[16:17], v116 offset:16384
s_add_u32 m0, s37, 65536
s_add_u32 s43, s34, 384
buffer_load_dwordx4 v11, s[4:7], s43 offen lds
v_mfma_f32_16x16x32_bf16 v[196:199], v[68:71], v[96:99], v[196:199]
ds_read_b64_tr_b16 v[18:19], v116 offset:17408
v_mov_b32 v132, 0
v_mov_b32 v133, 0
v_mov_b32 v134, 0
v_mov_b32 v135, 0
v_mfma_f32_16x16x32_bf16 v[228:231], v[68:71], v[100:103], v[228:231]
ds_read_b64_tr_b16 v[20:21], v117 offset:16384
ds_read_b64_tr_b16 v[22:23], v117 offset:17408
s_add_u32 m0, s37, 66560
s_add_u32 s43, s34, 8576
buffer_load_dwordx4 v12, s[4:7], s43 offen lds
v_mfma_f32_16x16x32_bf16 v[200:203], v[72:75], v[96:99], v[200:203]
ds_read_b64_tr_b16 v[24:25], v118 offset:16384
v_mfma_f32_16x16x32_bf16 v[232:235], v[72:75], v[100:103], v[232:235]
ds_read_b64_tr_b16 v[26:27], v118 offset:17408
v_mov_b32 v136, 0
v_mov_b32 v137, 0
v_mov_b32 v138, 0
v_mov_b32 v139, 0
v_mfma_f32_16x16x32_bf16 v[204:207], v[76:79], v[96:99], v[204:207]
ds_read_b64_tr_b16 v[28:29], v119 offset:16384
s_add_u32 m0, s37, 67584
s_add_u32 s43, s34, 16768
buffer_load_dwordx4 v11, s[4:7], s43 offen lds
v_mfma_f32_16x16x32_bf16 v[236:239], v[76:79], v[100:103], v[236:239]
ds_read_b64_tr_b16 v[30:31], v119 offset:17408
ds_read_b64_tr_b16 v[32:33], v120 offset:16384
v_mfma_f32_16x16x32_bf16 v[208:211], v[80:83], v[96:99], v[208:211]
ds_read_b64_tr_b16 v[34:35], v120 offset:17408
s_add_u32 m0, s37, 68608
s_add_u32 s43, s34, 24960
buffer_load_dwordx4 v12, s[4:7], s43 offen lds
v_mov_b32 v140, 0
v_mov_b32 v141, 0
v_mov_b32 v142, 0
v_mov_b32 v143, 0
v_mfma_f32_16x16x32_bf16 v[240:243], v[80:83], v[100:103], v[240:243]
ds_read_b64_tr_b16 v[36:37], v121 offset:16384
v_mfma_f32_16x16x32_bf16 v[212:215], v[84:87], v[96:99], v[212:215]
ds_read_b64_tr_b16 v[38:39], v121 offset:17408
ds_read_b64_tr_b16 v[40:41], v122 offset:16384
v_mov_b32 v144, 0
v_mov_b32 v145, 0
v_mov_b32 v146, 0
v_mov_b32 v147, 0
v_mfma_f32_16x16x32_bf16 v[244:247], v[84:87], v[100:103], v[244:247]
ds_read_b64_tr_b16 v[42:43], v122 offset:17408
s_add_u32 m0, s38, 98304
s_add_u32 s43, s36, 2097152
buffer_load_dwordx4 v13, s[16:19], s43 offen lds
v_mfma_f32_16x16x32_bf16 v[216:219], v[88:91], v[96:99], v[216:219]
ds_read_b64_tr_b16 v[44:45], v123 offset:16384
v_mfma_f32_16x16x32_bf16 v[248:251], v[88:91], v[100:103], v[248:251]
ds_read_b64_tr_b16 v[46:47], v123 offset:17408
s_add_u32 m0, s38, 99328
s_add_u32 s43, s36, 2129920
buffer_load_dwordx4 v13, s[16:19], s43 offen lds
v_mov_b32 v148, 0
v_mov_b32 v149, 0
v_mov_b32 v150, 0
v_mov_b32 v151, 0
v_mfma_f32_16x16x32_bf16 v[220:223], v[92:95], v[96:99], v[220:223]
v_mfma_f32_16x16x32_bf16 v[252:255], v[92:95], v[100:103], v[252:255]
s_waitcnt lgkmcnt(14)
v_mfma_f32_16x16x32_bf16 v[192:195], v[16:19], v[48:51], v[192:195]
ds_read_b128 v[96:99], v113 offset:0
ds_read_b128 v[100:103], v113 offset:2048
v_mfma_f32_16x16x32_bf16 v[224:227], v[16:19], v[52:55], v[224:227]
ds_read_b64_tr_b16 v[64:65], v116 offset:24576
s_add_u32 s44, s40, 8192
s_cmp_eq_u32 s3, 0
s_cbranch_scc1 L_sst38
buffer_store_dwordx4 v[152:155], v2, s[20:23], s44 offen offset:2048
L_sstr38:
s_waitcnt lgkmcnt(15)
v_mfma_f32_16x16x32_bf16 v[196:199], v[20:23], v[48:51], v[196:199]
ds_read_b64_tr_b16 v[66:67], v116 offset:25600
v_mfma_f32_16x16x32_bf16 v[228:231], v[20:23], v[52:55], v[228:231]
ds_read_b64_tr_b16 v[68:69], v117 offset:24576
ds_read_b64_tr_b16 v[70:71], v117 offset:25600
s_waitcnt lgkmcnt(15)
v_mfma_f32_16x16x32_bf16 v[200:203], v[24:27], v[48:51], v[200:203]
ds_read_b64_tr_b16 v[72:73], v118 offset:24576
s_add_u32 s44, s40, 8192
s_cmp_eq_u32 s3, 0
s_cbranch_scc1 L_sst39
buffer_store_dwordx4 v[156:159], v2, s[20:23], s44 offen offset:3072
L_sstr39:
v_mfma_f32_16x16x32_bf16 v[232:235], v[24:27], v[52:55], v[232:235]
ds_read_b64_tr_b16 v[74:75], v118 offset:25600
s_waitcnt lgkmcnt(15)
v_mfma_f32_16x16x32_bf16 v[204:207], v[28:31], v[48:51], v[204:207]
ds_read_b64_tr_b16 v[76:77], v119 offset:24576
v_mfma_f32_16x16x32_bf16 v[236:239], v[28:31], v[52:55], v[236:239]
ds_read_b64_tr_b16 v[78:79], v119 offset:25600
ds_read_b64_tr_b16 v[80:81], v120 offset:24576
s_add_u32 s44, s40, 16384
s_cmp_eq_u32 s3, 0
s_cbranch_scc1 L_sst40
buffer_store_dwordx4 v[160:163], v2, s[20:23], s44 offen offset:0
L_sstr40:
s_waitcnt lgkmcnt(15)
v_mfma_f32_16x16x32_bf16 v[208:211], v[32:35], v[48:51], v[208:211]
ds_read_b64_tr_b16 v[82:83], v120 offset:25600
v_mfma_f32_16x16x32_bf16 v[240:243], v[32:35], v[52:55], v[240:243]
ds_read_b64_tr_b16 v[84:85], v121 offset:24576
v_mfma_f32_16x16x32_bf16 v[212:215], v[36:39], v[48:51], v[212:215]
ds_read_b64_tr_b16 v[86:87], v121 offset:25600
ds_read_b64_tr_b16 v[88:89], v122 offset:24576
s_add_u32 s44, s40, 16384
s_cmp_eq_u32 s3, 0
s_cbranch_scc1 L_sst41
buffer_store_dwordx4 v[164:167], v2, s[20:23], s44 offen offset:1024
L_sstr41:
v_mfma_f32_16x16x32_bf16 v[244:247], v[36:39], v[52:55], v[244:247]
ds_read_b64_tr_b16 v[90:91], v122 offset:25600
s_waitcnt lgkmcnt(15)
v_mfma_f32_16x16x32_bf16 v[216:219], v[40:43], v[48:51], v[216:219]
ds_read_b64_tr_b16 v[92:93], v123 offset:24576
v_mfma_f32_16x16x32_bf16 v[248:251], v[40:43], v[52:55], v[248:251]
ds_read_b64_tr_b16 v[94:95], v123 offset:25600
s_add_u32 s44, s40, 16384
s_cmp_eq_u32 s3, 0
s_cbranch_scc1 L_sst42
buffer_store_dwordx4 v[168:171], v2, s[20:23], s44 offen offset:2048
L_sstr42:
v_mfma_f32_16x16x32_bf16 v[220:223], v[44:47], v[48:51], v[220:223]
v_mfma_f32_16x16x32_bf16 v[252:255], v[44:47], v[52:55], v[252:255]
s_waitcnt vmcnt(19) lgkmcnt(0)
s_barrier
v_mfma_f32_16x16x32_bf16 v[192:195], v[64:67], v[96:99], v[192:195]
ds_read_b128 v[48:51], v112 offset:32768
ds_read_b128 v[52:55], v112 offset:34816
v_mov_b32 v152, 0
v_mov_b32 v153, 0
v_mov_b32 v154, 0
v_mov_b32 v155, 0
v_mfma_f32_16x16x32_bf16 v[224:227], v[64:67], v[100:103], v[224:227]
ds_read_b64_tr_b16 v[16:17], v116 offset:32768
s_add_u32 m0, s37, 0
s_add_u32 s43, s34, 512
buffer_load_dwordx4 v11, s[4:7], s43 offen lds
v_mfma_f32_16x16x32_bf16 v[196:199], v[68:71], v[96:99], v[196:199]
ds_read_b64_tr_b16 v[18:19], v116 offset:33792
v_mfma_f32_16x16x32_bf16 v[228:231], v[68:71], v[100:103], v[228:231]
ds_read_b64_tr_b16 v[20:21], v117 offset:32768
ds_read_b64_tr_b16 v[22:23], v117 offset:33792
s_add_u32 m0, s37, 1024
s_add_u32 s43, s34, 8704
buffer_load_dwordx4 v12, s[4:7], s43 offen lds
v_mov_b32 v156, 0
v_mov_b32 v157, 0
v_mov_b32 v158, 0
v_mov_b32 v159, 0
v_mfma_f32_16x16x32_bf16 v[200:203], v[72:75], v[96:99], v[200:203]
ds_read_b64_tr_b16 v[24:25], v118 offset:32768
v_mfma_f32_16x16x32_bf16 v[232:235], v[72:75], v[100:103], v[232:235]
ds_read_b64_tr_b16 v[26:27], v118 offset:33792
v_mfma_f32_16x16x32_bf16 v[204:207], v[76:79], v[96:99], v[204:207]
ds_read_b64_tr_b16 v[28:29], v119 offset:32768
s_add_u32 m0, s37, 2048
s_add_u32 s43, s34, 16896
buffer_load_dwordx4 v11, s[4:7], s43 offen lds
v_mov_b32 v160, 0
v_mov_b32 v161, 0
v_mov_b32 v162, 0
v_mov_b32 v163, 0
v_mfma_f32_16x16x32_bf16 v[236:239], v[76:79], v[100:103], v[236:239]
ds_read_b64_tr_b16 v[30:31], v119 offset:33792
ds_read_b64_tr_b16 v[32:33], v120 offset:32768
v_mfma_f32_16x16x32_bf16 v[208:211], v[80:83], v[96:99], v[208:211]
ds_read_b64_tr_b16 v[34:35], v120 offset:33792
s_add_u32 m0, s37, 3072
s_add_u32 s43, s34, 25088
buffer_load_dwordx4 v12, s[4:7], s43 offen lds
v_mfma_f32_16x16x32_bf16 v[240:243], v[80:83], v[100:103], v[240:243]
ds_read_b64_tr_b16 v[36:37], v121 offset:32768
v_mov_b32 v164, 0
v_mov_b32 v165, 0
v_mov_b32 v166, 0
v_mov_b32 v167, 0
v_mfma_f32_16x16x32_bf16 v[212:215], v[84:87], v[96:99], v[212:215]
ds_read_b64_tr_b16 v[38:39], v121 offset:33792
ds_read_b64_tr_b16 v[40:41], v122 offset:32768
v_mfma_f32_16x16x32_bf16 v[244:247], v[84:87], v[100:103], v[244:247]
ds_read_b64_tr_b16 v[42:43], v122 offset:33792
s_add_u32 m0, s38, 114688
s_add_u32 s43, s36, 2621440
buffer_load_dwordx4 v13, s[16:19], s43 offen lds
v_mfma_f32_16x16x32_bf16 v[216:219], v[88:91], v[96:99], v[216:219]
ds_read_b64_tr_b16 v[44:45], v123 offset:32768
v_mov_b32 v168, 0
v_mov_b32 v169, 0
v_mov_b32 v170, 0
v_mov_b32 v171, 0
v_mfma_f32_16x16x32_bf16 v[248:251], v[88:91], v[100:103], v[248:251]
ds_read_b64_tr_b16 v[46:47], v123 offset:33792
s_add_u32 m0, s38, 115712
s_add_u32 s43, s36, 2654208
buffer_load_dwordx4 v13, s[16:19], s43 offen lds
v_mfma_f32_16x16x32_bf16 v[220:223], v[92:95], v[96:99], v[220:223]
v_mfma_f32_16x16x32_bf16 v[252:255], v[92:95], v[100:103], v[252:255]
s_waitcnt lgkmcnt(14)
v_mfma_f32_16x16x32_bf16 v[192:195], v[16:19], v[48:51], v[192:195]
ds_read_b128 v[96:99], v113 offset:32768
ds_read_b128 v[100:103], v113 offset:34816
v_mfma_f32_16x16x32_bf16 v[224:227], v[16:19], v[52:55], v[224:227]
ds_read_b64_tr_b16 v[64:65], v116 offset:40960
s_add_u32 s44, s40, 16384
s_cmp_eq_u32 s3, 0
s_cbranch_scc1 L_sst43
buffer_store_dwordx4 v[172:175], v2, s[20:23], s44 offen offset:3072
L_sstr43:
s_waitcnt lgkmcnt(15)
v_mfma_f32_16x16x32_bf16 v[196:199], v[20:23], v[48:51], v[196:199]
ds_read_b64_tr_b16 v[66:67], v116 offset:41984
v_mfma_f32_16x16x32_bf16 v[228:231], v[20:23], v[52:55], v[228:231]
ds_read_b64_tr_b16 v[68:69], v117 offset:40960
ds_read_b64_tr_b16 v[70:71], v117 offset:41984
s_waitcnt lgkmcnt(15)
v_mfma_f32_16x16x32_bf16 v[200:203], v[24:27], v[48:51], v[200:203]
ds_read_b64_tr_b16 v[72:73], v118 offset:40960
s_add_u32 s44, s40, 24576
s_cmp_eq_u32 s3, 0
s_cbranch_scc1 L_sst44
buffer_store_dwordx4 v[176:179], v2, s[20:23], s44 offen offset:0
L_sstr44:
v_mfma_f32_16x16x32_bf16 v[232:235], v[24:27], v[52:55], v[232:235]
ds_read_b64_tr_b16 v[74:75], v118 offset:41984
s_waitcnt lgkmcnt(15)
v_mfma_f32_16x16x32_bf16 v[204:207], v[28:31], v[48:51], v[204:207]
ds_read_b64_tr_b16 v[76:77], v119 offset:40960
v_mfma_f32_16x16x32_bf16 v[236:239], v[28:31], v[52:55], v[236:239]
ds_read_b64_tr_b16 v[78:79], v119 offset:41984
ds_read_b64_tr_b16 v[80:81], v120 offset:40960
s_add_u32 s44, s40, 24576
s_cmp_eq_u32 s3, 0
s_cbranch_scc1 L_sst45
buffer_store_dwordx4 v[180:183], v2, s[20:23], s44 offen offset:1024
L_sstr45:
s_waitcnt lgkmcnt(15)
v_mfma_f32_16x16x32_bf16 v[208:211], v[32:35], v[48:51], v[208:211]
ds_read_b64_tr_b16 v[82:83], v120 offset:41984
v_mfma_f32_16x16x32_bf16 v[240:243], v[32:35], v[52:55], v[240:243]
ds_read_b64_tr_b16 v[84:85], v121 offset:40960
v_mfma_f32_16x16x32_bf16 v[212:215], v[36:39], v[48:51], v[212:215]
ds_read_b64_tr_b16 v[86:87], v121 offset:41984
ds_read_b64_tr_b16 v[88:89], v122 offset:40960
s_add_u32 s44, s40, 24576
s_cmp_eq_u32 s3, 0
s_cbranch_scc1 L_sst46
buffer_store_dwordx4 v[184:187], v2, s[20:23], s44 offen offset:2048
L_sstr46:
v_mfma_f32_16x16x32_bf16 v[244:247], v[36:39], v[52:55], v[244:247]
ds_read_b64_tr_b16 v[90:91], v122 offset:41984
s_waitcnt lgkmcnt(15)
v_mfma_f32_16x16x32_bf16 v[216:219], v[40:43], v[48:51], v[216:219]
ds_read_b64_tr_b16 v[92:93], v123 offset:40960
v_mfma_f32_16x16x32_bf16 v[248:251], v[40:43], v[52:55], v[248:251]
ds_read_b64_tr_b16 v[94:95], v123 offset:41984
s_add_u32 s44, s40, 24576
s_cmp_eq_u32 s3, 0
s_cbranch_scc1 L_sst47
buffer_store_dwordx4 v[188:191], v2, s[20:23], s44 offen offset:3072
L_sstr47:
v_mfma_f32_16x16x32_bf16 v[220:223], v[44:47], v[48:51], v[220:223]
v_mfma_f32_16x16x32_bf16 v[252:255], v[44:47], v[52:55], v[252:255]
s_waitcnt vmcnt(18) lgkmcnt(0)
s_barrier
v_mfma_f32_16x16x32_bf16 v[192:195], v[64:67], v[96:99], v[192:195]
ds_read_b128 v[48:51], v114 offset:0
ds_read_b128 v[52:55], v114 offset:2048
v_mov_b32 v172, 0
v_mov_b32 v173, 0
v_mov_b32 v174, 0
v_mov_b32 v175, 0
v_mfma_f32_16x16x32_bf16 v[224:227], v[64:67], v[100:103], v[224:227]
ds_read_b64_tr_b16 v[16:17], v116 offset:49152
s_add_u32 m0, s37, 32768
s_add_u32 s43, s34, 640
buffer_load_dwordx4 v11, s[4:7], s43 offen lds
v_mfma_f32_16x16x32_bf16 v[196:199], v[68:71], v[96:99], v[196:199]
ds_read_b64_tr_b16 v[18:19], v116 offset:50176
v_mfma_f32_16x16x32_bf16 v[228:231], v[68:71], v[100:103], v[228:231]
ds_read_b64_tr_b16 v[20:21], v117 offset:49152
ds_read_b64_tr_b16 v[22:23], v117 offset:50176
v_mov_b32 v176, 0
v_mov_b32 v177, 0
v_mov_b32 v178, 0
v_mov_b32 v179, 0
v_mfma_f32_16x16x32_bf16 v[200:203], v[72:75], v[96:99], v[200:203]
ds_read_b64_tr_b16 v[24:25], v118 offset:49152
v_mfma_f32_16x16x32_bf16 v[232:235], v[72:75], v[100:103], v[232:235]
ds_read_b64_tr_b16 v[26:27], v118 offset:50176
v_mfma_f32_16x16x32_bf16 v[204:207], v[76:79], v[96:99], v[204:207]
ds_read_b64_tr_b16 v[28:29], v119 offset:49152
s_add_u32 m0, s37, 33792
s_add_u32 s43, s34, 8832
buffer_load_dwordx4 v12, s[4:7], s43 offen lds
v_mov_b32 v180, 0
v_mov_b32 v181, 0
v_mov_b32 v182, 0
v_mov_b32 v183, 0
v_mfma_f32_16x16x32_bf16 v[236:239], v[76:79], v[100:103], v[236:239]
ds_read_b64_tr_b16 v[30:31], v119 offset:50176
ds_read_b64_tr_b16 v[32:33], v120 offset:49152
v_mfma_f32_16x16x32_bf16 v[208:211], v[80:83], v[96:99], v[208:211]
ds_read_b64_tr_b16 v[34:35], v120 offset:50176
v_mfma_f32_16x16x32_bf16 v[240:243], v[80:83], v[100:103], v[240:243]
ds_read_b64_tr_b16 v[36:37], v121 offset:49152
v_mov_b32 v184, 0
v_mov_b32 v185, 0
v_mov_b32 v186, 0
v_mov_b32 v187, 0
v_mfma_f32_16x16x32_bf16 v[212:215], v[84:87], v[96:99], v[212:215]
ds_read_b64_tr_b16 v[38:39], v121 offset:50176
ds_read_b64_tr_b16 v[40:41], v122 offset:49152
v_mfma_f32_16x16x32_bf16 v[244:247], v[84:87], v[100:103], v[244:247]
ds_read_b64_tr_b16 v[42:43], v122 offset:50176
s_add_u32 m0, s37, 34816
s_add_u32 s43, s34, 17024
buffer_load_dwordx4 v11, s[4:7], s43 offen lds
v_mfma_f32_16x16x32_bf16 v[216:219], v[88:91], v[96:99], v[216:219]
ds_read_b64_tr_b16 v[44:45], v123 offset:49152
v_mov_b32 v188, 0
v_mov_b32 v189, 0
v_mov_b32 v190, 0
v_mov_b32 v191, 0
v_mfma_f32_16x16x32_bf16 v[248:251], v[88:91], v[100:103], v[248:251]
ds_read_b64_tr_b16 v[46:47], v123 offset:50176
v_mfma_f32_16x16x32_bf16 v[220:223], v[92:95], v[96:99], v[220:223]
v_mfma_f32_16x16x32_bf16 v[252:255], v[92:95], v[100:103], v[252:255]
s_waitcnt lgkmcnt(14)
v_mfma_f32_16x16x32_bf16 v[192:195], v[16:19], v[48:51], v[192:195]
ds_read_b128 v[96:99], v115 offset:0
ds_read_b128 v[100:103], v115 offset:2048
v_mfma_f32_16x16x32_bf16 v[224:227], v[16:19], v[52:55], v[224:227]
ds_read_b64_tr_b16 v[64:65], v116 offset:57344
s_add_u32 m0, s37, 35840
s_add_u32 s43, s34, 25216
buffer_load_dwordx4 v12, s[4:7], s43 offen lds
s_waitcnt lgkmcnt(15)
v_mfma_f32_16x16x32_bf16 v[196:199], v[20:23], v[48:51], v[196:199]
ds_read_b64_tr_b16 v[66:67], v116 offset:58368
v_mfma_f32_16x16x32_bf16 v[228:231], v[20:23], v[52:55], v[228:231]
ds_read_b64_tr_b16 v[68:69], v117 offset:57344
ds_read_b64_tr_b16 v[70:71], v117 offset:58368
s_waitcnt lgkmcnt(15)
v_mfma_f32_16x16x32_bf16 v[200:203], v[24:27], v[48:51], v[200:203]
ds_read_b64_tr_b16 v[72:73], v118 offset:57344
v_mfma_f32_16x16x32_bf16 v[232:235], v[24:27], v[52:55], v[232:235]
ds_read_b64_tr_b16 v[74:75], v118 offset:58368
s_waitcnt lgkmcnt(15)
v_mfma_f32_16x16x32_bf16 v[204:207], v[28:31], v[48:51], v[204:207]
ds_read_b64_tr_b16 v[76:77], v119 offset:57344
s_add_u32 m0, s38, 131072
s_add_u32 s43, s36, 3145728
buffer_load_dwordx4 v13, s[16:19], s43 offen lds
v_mfma_f32_16x16x32_bf16 v[236:239], v[28:31], v[52:55], v[236:239]
ds_read_b64_tr_b16 v[78:79], v119 offset:58368
ds_read_b64_tr_b16 v[80:81], v120 offset:57344
s_waitcnt lgkmcnt(15)
v_mfma_f32_16x16x32_bf16 v[208:211], v[32:35], v[48:51], v[208:211]
ds_read_b64_tr_b16 v[82:83], v120 offset:58368
v_mfma_f32_16x16x32_bf16 v[240:243], v[32:35], v[52:55], v[240:243]
ds_read_b64_tr_b16 v[84:85], v121 offset:57344
v_mfma_f32_16x16x32_bf16 v[212:215], v[36:39], v[48:51], v[212:215]
ds_read_b64_tr_b16 v[86:87], v121 offset:58368
ds_read_b64_tr_b16 v[88:89], v122 offset:57344
v_mfma_f32_16x16x32_bf16 v[244:247], v[36:39], v[52:55], v[244:247]
ds_read_b64_tr_b16 v[90:91], v122 offset:58368
s_add_u32 m0, s38, 132096
s_add_u32 s43, s36, 3178496
buffer_load_dwordx4 v13, s[16:19], s43 offen lds
s_waitcnt lgkmcnt(15)
v_mfma_f32_16x16x32_bf16 v[216:219], v[40:43], v[48:51], v[216:219]
ds_read_b64_tr_b16 v[92:93], v123 offset:57344
v_mfma_f32_16x16x32_bf16 v[248:251], v[40:43], v[52:55], v[248:251]
ds_read_b64_tr_b16 v[94:95], v123 offset:58368
v_mfma_f32_16x16x32_bf16 v[220:223], v[44:47], v[48:51], v[220:223]
v_mfma_f32_16x16x32_bf16 v[252:255], v[44:47], v[52:55], v[252:255]
s_waitcnt vmcnt(6) lgkmcnt(0)
s_barrier
v_mfma_f32_16x16x32_bf16 v[192:195], v[64:67], v[96:99], v[192:195]
ds_read_b128 v[48:51], v112 offset:0
ds_read_b128 v[52:55], v112 offset:2048
v_mfma_f32_16x16x32_bf16 v[224:227], v[64:67], v[100:103], v[224:227]
ds_read_b64_tr_b16 v[16:17], v116 offset:0
s_add_u32 m0, s37, 65536
s_add_u32 s43, s34, 768
buffer_load_dwordx4 v11, s[4:7], s43 offen lds
v_mfma_f32_16x16x32_bf16 v[196:199], v[68:71], v[96:99], v[196:199]
ds_read_b64_tr_b16 v[18:19], v116 offset:1024
v_mfma_f32_16x16x32_bf16 v[228:231], v[68:71], v[100:103], v[228:231]
ds_read_b64_tr_b16 v[20:21], v117 offset:0
ds_read_b64_tr_b16 v[22:23], v117 offset:1024
v_mfma_f32_16x16x32_bf16 v[200:203], v[72:75], v[96:99], v[200:203]
ds_read_b64_tr_b16 v[24:25], v118 offset:0
v_mfma_f32_16x16x32_bf16 v[232:235], v[72:75], v[100:103], v[232:235]
ds_read_b64_tr_b16 v[26:27], v118 offset:1024
v_mfma_f32_16x16x32_bf16 v[204:207], v[76:79], v[96:99], v[204:207]
ds_read_b64_tr_b16 v[28:29], v119 offset:0
s_add_u32 m0, s37, 66560
s_add_u32 s43, s34, 8960
buffer_load_dwordx4 v12, s[4:7], s43 offen lds
v_mfma_f32_16x16x32_bf16 v[236:239], v[76:79], v[100:103], v[236:239]
ds_read_b64_tr_b16 v[30:31], v119 offset:1024
ds_read_b64_tr_b16 v[32:33], v120 offset:0
v_mfma_f32_16x16x32_bf16 v[208:211], v[80:83], v[96:99], v[208:211]
ds_read_b64_tr_b16 v[34:35], v120 offset:1024
v_mfma_f32_16x16x32_bf16 v[240:243], v[80:83], v[100:103], v[240:243]
ds_read_b64_tr_b16 v[36:37], v121 offset:0
v_mfma_f32_16x16x32_bf16 v[212:215], v[84:87], v[96:99], v[212:215]
ds_read_b64_tr_b16 v[38:39], v121 offset:1024
ds_read_b64_tr_b16 v[40:41], v122 offset:0
v_mfma_f32_16x16x32_bf16 v[244:247], v[84:87], v[100:103], v[244:247]
ds_read_b64_tr_b16 v[42:43], v122 offset:1024
s_add_u32 m0, s37, 67584
s_add_u32 s43, s34, 17152
buffer_load_dwordx4 v11, s[4:7], s43 offen lds
v_mfma_f32_16x16x32_bf16 v[216:219], v[88:91], v[96:99], v[216:219]
ds_read_b64_tr_b16 v[44:45], v123 offset:0
v_mfma_f32_16x16x32_bf16 v[248:251], v[88:91], v[100:103], v[248:251]
ds_read_b64_tr_b16 v[46:47], v123 offset:1024
v_mfma_f32_16x16x32_bf16 v[220:223], v[92:95], v[96:99], v[220:223]
v_mfma_f32_16x16x32_bf16 v[252:255], v[92:95], v[100:103], v[252:255]
s_waitcnt lgkmcnt(14)
v_mfma_f32_16x16x32_bf16 v[192:195], v[16:19], v[48:51], v[192:195]
ds_read_b128 v[96:99], v113 offset:0
ds_read_b128 v[100:103], v113 offset:2048
v_mfma_f32_16x16x32_bf16 v[224:227], v[16:19], v[52:55], v[224:227]
ds_read_b64_tr_b16 v[64:65], v116 offset:8192
s_add_u32 m0, s37, 68608
s_add_u32 s43, s34, 25344
buffer_load_dwordx4 v12, s[4:7], s43 offen lds
s_waitcnt lgkmcnt(15)
v_mfma_f32_16x16x32_bf16 v[196:199], v[20:23], v[48:51], v[196:199]
ds_read_b64_tr_b16 v[66:67], v116 offset:9216
v_mfma_f32_16x16x32_bf16 v[228:231], v[20:23], v[52:55], v[228:231]
ds_read_b64_tr_b16 v[68:69], v117 offset:8192
ds_read_b64_tr_b16 v[70:71], v117 offset:9216
s_waitcnt lgkmcnt(15)
v_mfma_f32_16x16x32_bf16 v[200:203], v[24:27], v[48:51], v[200:203]
ds_read_b64_tr_b16 v[72:73], v118 offset:8192
v_mfma_f32_16x16x32_bf16 v[232:235], v[24:27], v[52:55], v[232:235]
ds_read_b64_tr_b16 v[74:75], v118 offset:9216
s_waitcnt lgkmcnt(15)
v_mfma_f32_16x16x32_bf16 v[204:207], v[28:31], v[48:51], v[204:207]
ds_read_b64_tr_b16 v[76:77], v119 offset:8192
s_add_u32 m0, s38, 147456
s_add_u32 s43, s36, 3670016
buffer_load_dwordx4 v13, s[16:19], s43 offen lds
v_mfma_f32_16x16x32_bf16 v[236:239], v[28:31], v[52:55], v[236:239]
ds_read_b64_tr_b16 v[78:79], v119 offset:9216
ds_read_b64_tr_b16 v[80:81], v120 offset:8192
s_waitcnt lgkmcnt(15)
v_mfma_f32_16x16x32_bf16 v[208:211], v[32:35], v[48:51], v[208:211]
ds_read_b64_tr_b16 v[82:83], v120 offset:9216
v_mfma_f32_16x16x32_bf16 v[240:243], v[32:35], v[52:55], v[240:243]
ds_read_b64_tr_b16 v[84:85], v121 offset:8192
v_mfma_f32_16x16x32_bf16 v[212:215], v[36:39], v[48:51], v[212:215]
ds_read_b64_tr_b16 v[86:87], v121 offset:9216
ds_read_b64_tr_b16 v[88:89], v122 offset:8192
v_mfma_f32_16x16x32_bf16 v[244:247], v[36:39], v[52:55], v[244:247]
ds_read_b64_tr_b16 v[90:91], v122 offset:9216
s_add_u32 m0, s38, 148480
s_add_u32 s43, s36, 3702784
buffer_load_dwordx4 v13, s[16:19], s43 offen lds
s_waitcnt lgkmcnt(15)
v_mfma_f32_16x16x32_bf16 v[216:219], v[40:43], v[48:51], v[216:219]
ds_read_b64_tr_b16 v[92:93], v123 offset:8192
v_mfma_f32_16x16x32_bf16 v[248:251], v[40:43], v[52:55], v[248:251]
ds_read_b64_tr_b16 v[94:95], v123 offset:9216
v_mfma_f32_16x16x32_bf16 v[220:223], v[44:47], v[48:51], v[220:223]
v_mfma_f32_16x16x32_bf16 v[252:255], v[44:47], v[52:55], v[252:255]
s_waitcnt vmcnt(8) lgkmcnt(0)
s_barrier
v_mfma_f32_16x16x32_bf16 v[192:195], v[64:67], v[96:99], v[192:195]
ds_read_b128 v[48:51], v112 offset:32768
ds_read_b128 v[52:55], v112 offset:34816
v_mfma_f32_16x16x32_bf16 v[224:227], v[64:67], v[100:103], v[224:227]
ds_read_b64_tr_b16 v[16:17], v116 offset:16384
s_add_u32 m0, s37, 0
s_add_u32 s43, s34, 896
buffer_load_dwordx4 v11, s[4:7], s43 offen lds
v_mfma_f32_16x16x32_bf16 v[196:199], v[68:71], v[96:99], v[196:199]
ds_read_b64_tr_b16 v[18:19], v116 offset:17408
v_mfma_f32_16x16x32_bf16 v[228:231], v[68:71], v[100:103], v[228:231]
ds_read_b64_tr_b16 v[20:21], v117 offset:16384
ds_read_b64_tr_b16 v[22:23], v117 offset:17408
v_mfma_f32_16x16x32_bf16 v[200:203], v[72:75], v[96:99], v[200:203]
ds_read_b64_tr_b16 v[24:25], v118 offset:16384
v_mfma_f32_16x16x32_bf16 v[232:235], v[72:75], v[100:103], v[232:235]
ds_read_b64_tr_b16 v[26:27], v118 offset:17408
v_mfma_f32_16x16x32_bf16 v[204:207], v[76:79], v[96:99], v[204:207]
ds_read_b64_tr_b16 v[28:29], v119 offset:16384
v_mfma_f32_16x16x32_bf16 v[236:239], v[76:79], v[100:103], v[236:239]
ds_read_b64_tr_b16 v[30:31], v119 offset:17408
ds_read_b64_tr_b16 v[32:33], v120 offset:16384
v_mfma_f32_16x16x32_bf16 v[208:211], v[80:83], v[96:99], v[208:211]
ds_read_b64_tr_b16 v[34:35], v120 offset:17408
s_add_u32 m0, s37, 1024
s_add_u32 s43, s34, 9088
buffer_load_dwordx4 v12, s[4:7], s43 offen lds
v_mfma_f32_16x16x32_bf16 v[240:243], v[80:83], v[100:103], v[240:243]
ds_read_b64_tr_b16 v[36:37], v121 offset:16384
v_mfma_f32_16x16x32_bf16 v[212:215], v[84:87], v[96:99], v[212:215]
ds_read_b64_tr_b16 v[38:39], v121 offset:17408
ds_read_b64_tr_b16 v[40:41], v122 offset:16384
v_mfma_f32_16x16x32_bf16 v[244:247], v[84:87], v[100:103], v[244:247]
ds_read_b64_tr_b16 v[42:43], v122 offset:17408
v_mfma_f32_16x16x32_bf16 v[216:219], v[88:91], v[96:99], v[216:219]
ds_read_b64_tr_b16 v[44:45], v123 offset:16384
v_mfma_f32_16x16x32_bf16 v[248:251], v[88:91], v[100:103], v[248:251]
ds_read_b64_tr_b16 v[46:47], v123 offset:17408
v_mfma_f32_16x16x32_bf16 v[220:223], v[92:95], v[96:99], v[220:223]
v_mfma_f32_16x16x32_bf16 v[252:255], v[92:95], v[100:103], v[252:255]
s_waitcnt lgkmcnt(14)
v_mfma_f32_16x16x32_bf16 v[192:195], v[16:19], v[48:51], v[192:195]
ds_read_b128 v[96:99], v113 offset:32768
ds_read_b128 v[100:103], v113 offset:34816
v_mfma_f32_16x16x32_bf16 v[224:227], v[16:19], v[52:55], v[224:227]
ds_read_b64_tr_b16 v[64:65], v116 offset:24576
s_add_u32 m0, s37, 2048
s_add_u32 s43, s34, 17280
buffer_load_dwordx4 v11, s[4:7], s43 offen lds
s_waitcnt lgkmcnt(15)
v_mfma_f32_16x16x32_bf16 v[196:199], v[20:23], v[48:51], v[196:199]
ds_read_b64_tr_b16 v[66:67], v116 offset:25600
v_mfma_f32_16x16x32_bf16 v[228:231], v[20:23], v[52:55], v[228:231]
ds_read_b64_tr_b16 v[68:69], v117 offset:24576
ds_read_b64_tr_b16 v[70:71], v117 offset:25600
s_waitcnt lgkmcnt(15)
v_mfma_f32_16x16x32_bf16 v[200:203], v[24:27], v[48:51], v[200:203]
ds_read_b64_tr_b16 v[72:73], v118 offset:24576
v_mfma_f32_16x16x32_bf16 v[232:235], v[24:27], v[52:55], v[232:235]
ds_read_b64_tr_b16 v[74:75], v118 offset:25600
s_waitcnt lgkmcnt(15)
v_mfma_f32_16x16x32_bf16 v[204:207], v[28:31], v[48:51], v[204:207]
ds_read_b64_tr_b16 v[76:77], v119 offset:24576
v_mfma_f32_16x16x32_bf16 v[236:239], v[28:31], v[52:55], v[236:239]
ds_read_b64_tr_b16 v[78:79], v119 offset:25600
ds_read_b64_tr_b16 v[80:81], v120 offset:24576
s_waitcnt lgkmcnt(15)
v_mfma_f32_16x16x32_bf16 v[208:211], v[32:35], v[48:51], v[208:211]
ds_read_b64_tr_b16 v[82:83], v120 offset:25600
s_add_u32 m0, s37, 3072
s_add_u32 s43, s34, 25472
buffer_load_dwordx4 v12, s[4:7], s43 offen lds
v_mfma_f32_16x16x32_bf16 v[240:243], v[32:35], v[52:55], v[240:243]
ds_read_b64_tr_b16 v[84:85], v121 offset:24576
v_mfma_f32_16x16x32_bf16 v[212:215], v[36:39], v[48:51], v[212:215]
ds_read_b64_tr_b16 v[86:87], v121 offset:25600
ds_read_b64_tr_b16 v[88:89], v122 offset:24576
v_mfma_f32_16x16x32_bf16 v[244:247], v[36:39], v[52:55], v[244:247]
ds_read_b64_tr_b16 v[90:91], v122 offset:25600
s_waitcnt lgkmcnt(15)
v_mfma_f32_16x16x32_bf16 v[216:219], v[40:43], v[48:51], v[216:219]
ds_read_b64_tr_b16 v[92:93], v123 offset:24576
v_mfma_f32_16x16x32_bf16 v[248:251], v[40:43], v[52:55], v[248:251]
ds_read_b64_tr_b16 v[94:95], v123 offset:25600
v_mfma_f32_16x16x32_bf16 v[220:223], v[44:47], v[48:51], v[220:223]
v_mfma_f32_16x16x32_bf16 v[252:255], v[44:47], v[52:55], v[252:255]
s_cmp_lg_u32 s32, 4
s_cbranch_scc1 L_poll_done0
s_mov_b32 s45, 0
v_lshrrev_b32 v14, 2, v2
v_and_b32 v14, 0x7c, v14
L_pk0:
global_load_dword v15, v14, s[28:29] offset:128 sc1
L_pk0w:
s_waitcnt vmcnt(0)
v_readlane_b32 s41, v15, s30
v_lshrrev_b32 v15, 28, v15
v_cmp_ne_u32 vcc, 8, v15
s_nop 2
s_and_b32 s41, s41, 0xff
s_cmp_lg_u32 s41, 0x11
s_cbranch_scc1 L_pk0q
s_cbranch_vccz L_poll_done0
L_pk0q:
s_sleep 6
s_add_u32 s45, s45, 1
s_cmp_lt_u32 s45, 0x40000
s_cbranch_scc1 L_pk0
L_poll_done0:
s_waitcnt vmcnt(6) lgkmcnt(0)
s_barrier
s_and_b32 s41, s32, 3
s_lshl_b32 s38, s41, 13
s_movk_i32 s50, 0x1000
s_add_u32 s42, s41, 1
s_sub_u32 s43, s41, 2
s_cmp_lt_u32 s41, 2
s_cselect_b32 s42, s42, s43
s_lshl_b32 s55, s42, 13
s_lshl_b32 s41, s41, 11
s_lshl_b32 s42, s30, 20
s_add_u32 s42, s42, s41
s_add_u32 m0, s41, 40960
s_nop 0
buffer_load_dwordx4 v2, s[20:23], s42 offen lds
buffer_load_dwordx4 v2, s[20:23], s42 offen offset:1024 lds
v_mfma_f32_16x16x32_bf16 v[192:195], v[64:67], v[96:99], v[192:195]
ds_read_b128 v[48:51], v114 offset:0
ds_read_b128 v[52:55], v114 offset:2048
v_mfma_f32_16x16x32_bf16 v[224:227], v[64:67], v[100:103], v[224:227]
ds_read_b64_tr_b16 v[16:17], v116 offset:32768
s_add_u32 s41, s55, 16384
v_add_u32 v4, s41, v2
s_mov_b32 s49, 98304
v_mfma_f32_16x16x32_bf16 v[196:199], v[68:71], v[96:99], v[196:199]
ds_read_b64_tr_b16 v[18:19], v116 offset:33792
v_mfma_f32_16x16x32_bf16 v[228:231], v[68:71], v[100:103], v[228:231]
ds_read_b64_tr_b16 v[20:21], v117 offset:32768
ds_read_b64_tr_b16 v[22:23], v117 offset:33792
v_mfma_f32_16x16x32_bf16 v[200:203], v[72:75], v[96:99], v[200:203]
ds_read_b64_tr_b16 v[24:25], v118 offset:32768
s_add_u32 m0, s49, s38
s_nop 0
buffer_load_dwordx4 v4, s[24:27], 0 offen offset:0 lds
v_mfma_f32_16x16x32_bf16 v[232:235], v[72:75], v[100:103], v[232:235]
ds_read_b64_tr_b16 v[26:27], v118 offset:33792
v_mfma_f32_16x16x32_bf16 v[204:207], v[76:79], v[96:99], v[204:207]
ds_read_b64_tr_b16 v[28:29], v119 offset:32768
v_mfma_f32_16x16x32_bf16 v[236:239], v[76:79], v[100:103], v[236:239]
ds_read_b64_tr_b16 v[30:31], v119 offset:33792
ds_read_b64_tr_b16 v[32:33], v120 offset:32768
buffer_load_dwordx4 v4, s[24:27], 0 offen offset:1024 lds
v_mfma_f32_16x16x32_bf16 v[208:211], v[80:83], v[96:99], v[208:211]
ds_read_b64_tr_b16 v[34:35], v120 offset:33792
v_mfma_f32_16x16x32_bf16 v[240:243], v[80:83], v[100:103], v[240:243]
ds_read_b64_tr_b16 v[36:37], v121 offset:32768
v_mfma_f32_16x16x32_bf16 v[212:215], v[84:87], v[96:99], v[212:215]
ds_read_b64_tr_b16 v[38:39], v121 offset:33792
ds_read_b64_tr_b16 v[40:41], v122 offset:32768
buffer_load_dwordx4 v4, s[24:27], 0 offen offset:2048 lds
v_mfma_f32_16x16x32_bf16 v[244:247], v[84:87], v[100:103], v[244:247]
ds_read_b64_tr_b16 v[42:43], v122 offset:33792
v_mfma_f32_16x16x32_bf16 v[216:219], v[88:91], v[96:99], v[216:219]
ds_read_b64_tr_b16 v[44:45], v123 offset:32768
v_mfma_f32_16x16x32_bf16 v[248:251], v[88:91], v[100:103], v[248:251]
ds_read_b64_tr_b16 v[46:47], v123 offset:33792
buffer_load_dwordx4 v4, s[24:27], 0 offen offset:3072 lds
v_mfma_f32_16x16x32_bf16 v[220:223], v[92:95], v[96:99], v[220:223]
v_mfma_f32_16x16x32_bf16 v[252:255], v[92:95], v[100:103], v[252:255]
s_waitcnt lgkmcnt(14)
v_mfma_f32_16x16x32_bf16 v[192:195], v[16:19], v[48:51], v[192:195]
ds_read_b128 v[96:99], v115 offset:0
ds_read_b128 v[100:103], v115 offset:2048
v_mfma_f32_16x16x32_bf16 v[224:227], v[16:19], v[52:55], v[224:227]
ds_read_b64_tr_b16 v[64:65], v116 offset:40960
s_add_u32 m0, m0, 4096
s_nop 0
buffer_load_dwordx4 v4, s[24:27], s50 offen offset:0 lds
s_waitcnt lgkmcnt(15)
v_mfma_f32_16x16x32_bf16 v[196:199], v[20:23], v[48:51], v[196:199]
ds_read_b64_tr_b16 v[66:67], v116 offset:41984
v_mfma_f32_16x16x32_bf16 v[228:231], v[20:23], v[52:55], v[228:231]
ds_read_b64_tr_b16 v[68:69], v117 offset:40960
ds_read_b64_tr_b16 v[70:71], v117 offset:41984
s_waitcnt lgkmcnt(15)
v_mfma_f32_16x16x32_bf16 v[200:203], v[24:27], v[48:51], v[200:203]
ds_read_b64_tr_b16 v[72:73], v118 offset:40960
buffer_load_dwordx4 v4, s[24:27], s50 offen offset:1024 lds
v_mfma_f32_16x16x32_bf16 v[232:235], v[24:27], v[52:55], v[232:235]
ds_read_b64_tr_b16 v[74:75], v118 offset:41984
s_waitcnt lgkmcnt(15)
v_mfma_f32_16x16x32_bf16 v[204:207], v[28:31], v[48:51], v[204:207]
ds_read_b64_tr_b16 v[76:77], v119 offset:40960
v_mfma_f32_16x16x32_bf16 v[236:239], v[28:31], v[52:55], v[236:239]
ds_read_b64_tr_b16 v[78:79], v119 offset:41984
ds_read_b64_tr_b16 v[80:81], v120 offset:40960
s_waitcnt lgkmcnt(15)
v_mfma_f32_16x16x32_bf16 v[208:211], v[32:35], v[48:51], v[208:211]
ds_read_b64_tr_b16 v[82:83], v120 offset:41984
buffer_load_dwordx4 v4, s[24:27], s50 offen offset:2048 lds
v_mfma_f32_16x16x32_bf16 v[240:243], v[32:35], v[52:55], v[240:243]
ds_read_b64_tr_b16 v[84:85], v121 offset:40960
v_mfma_f32_16x16x32_bf16 v[212:215], v[36:39], v[48:51], v[212:215]
ds_read_b64_tr_b16 v[86:87], v121 offset:41984
ds_read_b64_tr_b16 v[88:89], v122 offset:40960
v_mfma_f32_16x16x32_bf16 v[244:247], v[36:39], v[52:55], v[244:247]
ds_read_b64_tr_b16 v[90:91], v122 offset:41984
s_waitcnt lgkmcnt(15)
v_mfma_f32_16x16x32_bf16 v[216:219], v[40:43], v[48:51], v[216:219]
ds_read_b64_tr_b16 v[92:93], v123 offset:40960
buffer_load_dwordx4 v4, s[24:27], s50 offen offset:3072 lds
v_mfma_f32_16x16x32_bf16 v[248:251], v[40:43], v[52:55], v[248:251]
ds_read_b64_tr_b16 v[94:95], v123 offset:41984
v_mfma_f32_16x16x32_bf16 v[220:223], v[44:47], v[48:51], v[220:223]
v_mfma_f32_16x16x32_bf16 v[252:255], v[44:47], v[52:55], v[252:255]
s_waitcnt vmcnt(10) lgkmcnt(0)
s_barrier
v_mfma_f32_16x16x32_bf16 v[192:195], v[64:67], v[96:99], v[192:195]
ds_read_b128 v[48:51], v112 offset:0
ds_read_b128 v[52:55], v112 offset:2048
v_mfma_f32_16x16x32_bf16 v[224:227], v[64:67], v[100:103], v[224:227]
ds_read_b64_tr_b16 v[16:17], v116 offset:49152
s_add_u32 s41, s55, 0
v_add_u32 v4, s41, v2
s_mov_b32 s49, 65536
v_mfma_f32_16x16x32_bf16 v[196:199], v[68:71], v[96:99], v[196:199]
ds_read_b64_tr_b16 v[18:19], v116 offset:50176
v_mfma_f32_16x16x32_bf16 v[228:231], v[68:71], v[100:103], v[228:231]
ds_read_b64_tr_b16 v[20:21], v117 offset:49152
ds_read_b64_tr_b16 v[22:23], v117 offset:50176
v_mfma_f32_16x16x32_bf16 v[200:203], v[72:75], v[96:99], v[200:203]
ds_read_b64_tr_b16 v[24:25], v118 offset:49152
s_add_u32 m0, s49, s38
s_nop 0
buffer_load_dwordx4 v4, s[24:27], 0 offen offset:0 lds
v_mfma_f32_16x16x32_bf16 v[232:235], v[72:75], v[100:103], v[232:235]
ds_read_b64_tr_b16 v[26:27], v118 offset:50176
v_mfma_f32_16x16x32_bf16 v[204:207], v[76:79], v[96:99], v[204:207]
ds_read_b64_tr_b16 v[28:29], v119 offset:49152
v_mfma_f32_16x16x32_bf16 v[236:239], v[76:79], v[100:103], v[236:239]
ds_read_b64_tr_b16 v[30:31], v119 offset:50176
ds_read_b64_tr_b16 v[32:33], v120 offset:49152
buffer_load_dwordx4 v4, s[24:27], 0 offen offset:1024 lds
v_mfma_f32_16x16x32_bf16 v[208:211], v[80:83], v[96:99], v[208:211]
ds_read_b64_tr_b16 v[34:35], v120 offset:50176
v_mfma_f32_16x16x32_bf16 v[240:243], v[80:83], v[100:103], v[240:243]
ds_read_b64_tr_b16 v[36:37], v121 offset:49152
v_mfma_f32_16x16x32_bf16 v[212:215], v[84:87], v[96:99], v[212:215]
ds_read_b64_tr_b16 v[38:39], v121 offset:50176
ds_read_b64_tr_b16 v[40:41], v122 offset:49152
buffer_load_dwordx4 v4, s[24:27], 0 offen offset:2048 lds
v_mfma_f32_16x16x32_bf16 v[244:247], v[84:87], v[100:103], v[244:247]
ds_read_b64_tr_b16 v[42:43], v122 offset:50176
v_mfma_f32_16x16x32_bf16 v[216:219], v[88:91], v[96:99], v[216:219]
ds_read_b64_tr_b16 v[44:45], v123 offset:49152
v_mfma_f32_16x16x32_bf16 v[248:251], v[88:91], v[100:103], v[248:251]
ds_read_b64_tr_b16 v[46:47], v123 offset:50176
buffer_load_dwordx4 v4, s[24:27], 0 offen offset:3072 lds
v_mfma_f32_16x16x32_bf16 v[220:223], v[92:95], v[96:99], v[220:223]
v_mfma_f32_16x16x32_bf16 v[252:255], v[92:95], v[100:103], v[252:255]
s_waitcnt lgkmcnt(14)
v_mfma_f32_16x16x32_bf16 v[192:195], v[16:19], v[48:51], v[192:195]
ds_read_b128 v[96:99], v113 offset:0
ds_read_b128 v[100:103], v113 offset:2048
v_mfma_f32_16x16x32_bf16 v[224:227], v[16:19], v[52:55], v[224:227]
ds_read_b64_tr_b16 v[64:65], v116 offset:57344
s_add_u32 m0, m0, 4096
s_nop 0
buffer_load_dwordx4 v4, s[24:27], s50 offen offset:0 lds
s_waitcnt lgkmcnt(15)
v_mfma_f32_16x16x32_bf16 v[196:199], v[20:23], v[48:51], v[196:199]
ds_read_b64_tr_b16 v[66:67], v116 offset:58368
v_mfma_f32_16x16x32_bf16 v[228:231], v[20:23], v[52:55], v[228:231]
ds_read_b64_tr_b16 v[68:69], v117 offset:57344
ds_read_b64_tr_b16 v[70:71], v117 offset:58368
s_waitcnt lgkmcnt(15)
v_mfma_f32_16x16x32_bf16 v[200:203], v[24:27], v[48:51], v[200:203]
ds_read_b64_tr_b16 v[72:73], v118 offset:57344
buffer_load_dwordx4 v4, s[24:27], s50 offen offset:1024 lds
v_mfma_f32_16x16x32_bf16 v[232:235], v[24:27], v[52:55], v[232:235]
ds_read_b64_tr_b16 v[74:75], v118 offset:58368
s_waitcnt lgkmcnt(15)
v_mfma_f32_16x16x32_bf16 v[204:207], v[28:31], v[48:51], v[204:207]
ds_read_b64_tr_b16 v[76:77], v119 offset:57344
v_mfma_f32_16x16x32_bf16 v[236:239], v[28:31], v[52:55], v[236:239]
ds_read_b64_tr_b16 v[78:79], v119 offset:58368
ds_read_b64_tr_b16 v[80:81], v120 offset:57344
s_waitcnt lgkmcnt(15)
v_mfma_f32_16x16x32_bf16 v[208:211], v[32:35], v[48:51], v[208:211]
ds_read_b64_tr_b16 v[82:83], v120 offset:58368
buffer_load_dwordx4 v4, s[24:27], s50 offen offset:2048 lds
v_mfma_f32_16x16x32_bf16 v[240:243], v[32:35], v[52:55], v[240:243]
ds_read_b64_tr_b16 v[84:85], v121 offset:57344
v_mfma_f32_16x16x32_bf16 v[212:215], v[36:39], v[48:51], v[212:215]
ds_read_b64_tr_b16 v[86:87], v121 offset:58368
ds_read_b64_tr_b16 v[88:89], v122 offset:57344
v_mfma_f32_16x16x32_bf16 v[244:247], v[36:39], v[52:55], v[244:247]
ds_read_b64_tr_b16 v[90:91], v122 offset:58368
s_waitcnt lgkmcnt(15)
v_mfma_f32_16x16x32_bf16 v[216:219], v[40:43], v[48:51], v[216:219]
ds_read_b64_tr_b16 v[92:93], v123 offset:57344
buffer_load_dwordx4 v4, s[24:27], s50 offen offset:3072 lds
v_mfma_f32_16x16x32_bf16 v[248:251], v[40:43], v[52:55], v[248:251]
ds_read_b64_tr_b16 v[94:95], v123 offset:58368
v_mfma_f32_16x16x32_bf16 v[220:223], v[44:47], v[48:51], v[220:223]
v_mfma_f32_16x16x32_bf16 v[252:255], v[44:47], v[52:55], v[252:255]
s_branch L_qjoinB
L_qlateB:
s_waitcnt vmcnt(8) lgkmcnt(0)
s_barrier
v_mfma_f32_16x16x32_bf16 v[128:131], v[64:67], v[96:99], v[128:131]
ds_read_b128 v[48:51], v114 offset:0
v_mfma_f32_16x16x32_bf16 v[136:139], v[64:67], v[100:103], v[136:139]
ds_read_b128 v[52:55], v114 offset:2048
v_mfma_f32_16x16x32_bf16 v[144:147], v[64:67], v[104:107], v[144:147]
ds_read_b64_tr_b16 v[16:17], v116 offset:0
s_add_u32 m0, s37, 32768
s_add_u32 s43, s34, 256
buffer_load_dwordx4 v11, s[4:7], s43 offen lds
v_mfma_f32_16x16x32_bf16 v[152:155], v[64:67], v[108:111], v[152:155]
ds_read_b64_tr_b16 v[18:19], v116 offset:1024
v_mfma_f32_16x16x32_bf16 v[132:135], v[68:71], v[96:99], v[132:135]
ds_read_b64_tr_b16 v[20:21], v117 offset:0
v_mfma_f32_16x16x32_bf16 v[140:143], v[68:71], v[100:103], v[140:143]
ds_read_b64_tr_b16 v[22:23], v117 offset:1024
v_mfma_f32_16x16x32_bf16 v[148:151], v[68:71], v[104:107], v[148:151]
ds_read_b64_tr_b16 v[24:25], v118 offset:0
s_add_u32 m0, s37, 33792
s_add_u32 s43, s34, 8448
buffer_load_dwordx4 v12, s[4:7], s43 offen lds
v_mfma_f32_16x16x32_bf16 v[156:159], v[68:71], v[108:111], v[156:159]
ds_read_b64_tr_b16 v[26:27], v118 offset:1024
v_mfma_f32_16x16x32_bf16 v[160:163], v[72:75], v[96:99], v[160:163]
ds_read_b64_tr_b16 v[28:29], v119 offset:0
v_mfma_f32_16x16x32_bf16 v[168:171], v[72:75], v[100:103], v[168:171]
v_mfma_f32_16x16x32_bf16 v[176:179], v[72:75], v[104:107], v[176:179]
ds_read_b64_tr_b16 v[30:31], v119 offset:1024
v_cvt_pk_bf16_f32 v128, v128, v129
v_cvt_pk_bf16_f32 v129, v130, v131
v_cvt_pk_bf16_f32 v130, v132, v133
v_cvt_pk_bf16_f32 v131, v134, v135
v_mfma_f32_16x16x32_bf16 v[184:187], v[72:75], v[108:111], v[184:187]
ds_read_b64_tr_b16 v[32:33], v120 offset:0
s_add_u32 m0, s37, 34816
s_add_u32 s43, s34, 16640
buffer_load_dwordx4 v11, s[4:7], s43 offen lds
v_cvt_pk_bf16_f32 v132, v136, v137
v_cvt_pk_bf16_f32 v133, v138, v139
v_cvt_pk_bf16_f32 v134, v140, v141
v_cvt_pk_bf16_f32 v135, v142, v143
v_mfma_f32_16x16x32_bf16 v[164:167], v[76:79], v[96:99], v[164:167]
ds_read_b64_tr_b16 v[34:35], v120 offset:1024
v_cvt_pk_bf16_f32 v136, v144, v145
v_cvt_pk_bf16_f32 v137, v146, v147
v_cvt_pk_bf16_f32 v138, v148, v149
v_cvt_pk_bf16_f32 v139, v150, v151
v_mfma_f32_16x16x32_bf16 v[172:175], v[76:79], v[100:103], v[172:175]
ds_read_b64_tr_b16 v[36:37], v121 offset:0
v_cvt_pk_bf16_f32 v140, v152, v153
v_cvt_pk_bf16_f32 v141, v154, v155
v_cvt_pk_bf16_f32 v142, v156, v157
v_cvt_pk_bf16_f32 v143, v158, v159
v_mfma_f32_16x16x32_bf16 v[180:183], v[76:79], v[104:107], v[180:183]
ds_read_b64_tr_b16 v[38:39], v121 offset:1024
v_mfma_f32_16x16x32_bf16 v[188:191], v[76:79], v[108:111], v[188:191]
ds_read_b64_tr_b16 v[40:41], v122 offset:0
v_mfma_f32_16x16x32_bf16 v[192:195], v[80:83], v[96:99], v[192:195]
ds_read_b64_tr_b16 v[42:43], v122 offset:1024
s_add_u32 m0, s37, 35840
s_add_u32 s43, s34, 24832
buffer_load_dwordx4 v12, s[4:7], s43 offen lds
v_mfma_f32_16x16x32_bf16 v[200:203], v[80:83], v[100:103], v[200:203]
ds_read_b64_tr_b16 v[44:45], v123 offset:0
v_mfma_f32_16x16x32_bf16 v[208:211], v[80:83], v[104:107], v[208:211]
ds_read_b64_tr_b16 v[46:47], v123 offset:1024
v_cvt_pk_bf16_f32 v144, v160, v161
v_cvt_pk_bf16_f32 v145, v162, v163
v_cvt_pk_bf16_f32 v146, v164, v165
v_cvt_pk_bf16_f32 v147, v166, v167
v_mfma_f32_16x16x32_bf16 v[216:219], v[80:83], v[108:111], v[216:219]
v_cvt_pk_bf16_f32 v148, v168, v169
v_cvt_pk_bf16_f32 v149, v170, v171
v_cvt_pk_bf16_f32 v150, v172, v173
v_cvt_pk_bf16_f32 v151, v174, v175
v_mfma_f32_16x16x32_bf16 v[196:199], v[84:87], v[96:99], v[196:199]
s_add_u32 m0, s38, 147456
s_add_u32 s43, s36, 1572864
buffer_load_dwordx4 v13, s[16:19], s43 offen lds
v_cvt_pk_bf16_f32 v152, v176, v177
v_cvt_pk_bf16_f32 v153, v178, v179
v_cvt_pk_bf16_f32 v154, v180, v181
v_cvt_pk_bf16_f32 v155, v182, v183
v_mfma_f32_16x16x32_bf16 v[204:207], v[84:87], v[100:103], v[204:207]
v_cvt_pk_bf16_f32 v156, v184, v185
v_cvt_pk_bf16_f32 v157, v186, v187
v_cvt_pk_bf16_f32 v158, v188, v189
v_cvt_pk_bf16_f32 v159, v190, v191
v_mfma_f32_16x16x32_bf16 v[212:215], v[84:87], v[104:107], v[212:215]
v_mfma_f32_16x16x32_bf16 v[220:223], v[84:87], v[108:111], v[220:223]
v_mfma_f32_16x16x32_bf16 v[224:227], v[88:91], v[96:99], v[224:227]
v_mfma_f32_16x16x32_bf16 v[232:235], v[88:91], v[100:103], v[232:235]
s_add_u32 m0, s38, 148480
s_add_u32 s43, s36, 1605632
buffer_load_dwordx4 v13, s[16:19], s43 offen lds
v_mfma_f32_16x16x32_bf16 v[240:243], v[88:91], v[104:107], v[240:243]
v_cvt_pk_bf16_f32 v160, v192, v193
v_cvt_pk_bf16_f32 v161, v194, v195
v_cvt_pk_bf16_f32 v162, v196, v197
v_cvt_pk_bf16_f32 v163, v198, v199
v_mfma_f32_16x16x32_bf16 v[248:251], v[88:91], v[108:111], v[248:251]
v_cvt_pk_bf16_f32 v164, v200, v201
v_cvt_pk_bf16_f32 v165, v202, v203
v_cvt_pk_bf16_f32 v166, v204, v205
v_cvt_pk_bf16_f32 v167, v206, v207
v_mfma_f32_16x16x32_bf16 v[228:231], v[92:95], v[96:99], v[228:231]
v_cvt_pk_bf16_f32 v168, v208, v209
v_cvt_pk_bf16_f32 v169, v210, v211
v_cvt_pk_bf16_f32 v170, v212, v213
v_cvt_pk_bf16_f32 v171, v214, v215
v_mfma_f32_16x16x32_bf16 v[236:239], v[92:95], v[100:103], v[236:239]
v_cvt_pk_bf16_f32 v172, v216, v217
v_cvt_pk_bf16_f32 v173, v218, v219
v_cvt_pk_bf16_f32 v174, v220, v221
v_cvt_pk_bf16_f32 v175, v222, v223
v_mfma_f32_16x16x32_bf16 v[244:247], v[92:95], v[104:107], v[244:247]
v_mfma_f32_16x16x32_bf16 v[252:255], v[92:95], v[108:111], v[252:255]
s_nop 7
v_cvt_pk_bf16_f32 v176, v224, v225
v_cvt_pk_bf16_f32 v177, v226, v227
v_cvt_pk_bf16_f32 v178, v228, v229
v_cvt_pk_bf16_f32 v179, v230, v231
v_cvt_pk_bf16_f32 v180, v232, v233
v_cvt_pk_bf16_f32 v181, v234, v235
v_cvt_pk_bf16_f32 v182, v236, v237
v_cvt_pk_bf16_f32 v183, v238, v239
v_cvt_pk_bf16_f32 v184, v240, v241
v_cvt_pk_bf16_f32 v185, v242, v243
v_cvt_pk_bf16_f32 v186, v244, v245
v_cvt_pk_bf16_f32 v187, v246, v247
v_cvt_pk_bf16_f32 v188, v248, v249
v_cvt_pk_bf16_f32 v189, v250, v251
v_cvt_pk_bf16_f32 v190, v252, v253
v_cvt_pk_bf16_f32 v191, v254, v255
s_waitcnt lgkmcnt(14)
v_mfma_f32_16x16x32_bf16 v[192:195], v[16:19], v[48:51], 0
ds_read_b128 v[96:99], v115 offset:0
ds_read_b128 v[100:103], v115 offset:2048
v_mfma_f32_16x16x32_bf16 v[224:227], v[16:19], v[52:55], 0
ds_read_b64_tr_b16 v[64:65], v116 offset:8192
s_waitcnt lgkmcnt(15)
v_mfma_f32_16x16x32_bf16 v[196:199], v[20:23], v[48:51], 0
ds_read_b64_tr_b16 v[66:67], v116 offset:9216
v_mfma_f32_16x16x32_bf16 v[228:231], v[20:23], v[52:55], 0
ds_read_b64_tr_b16 v[68:69], v117 offset:8192
ds_read_b64_tr_b16 v[70:71], v117 offset:9216
s_waitcnt lgkmcnt(15)
v_mfma_f32_16x16x32_bf16 v[200:203], v[24:27], v[48:51], 0
ds_read_b64_tr_b16 v[72:73], v118 offset:8192
v_mfma_f32_16x16x32_bf16 v[232:235], v[24:27], v[52:55], 0
ds_read_b64_tr_b16 v[74:75], v118 offset:9216
s_waitcnt lgkmcnt(15)
v_mfma_f32_16x16x32_bf16 v[204:207], v[28:31], v[48:51], 0
ds_read_b64_tr_b16 v[76:77], v119 offset:8192
v_mfma_f32_16x16x32_bf16 v[236:239], v[28:31], v[52:55], 0
ds_read_b64_tr_b16 v[78:79], v119 offset:9216
ds_read_b64_tr_b16 v[80:81], v120 offset:8192
s_waitcnt lgkmcnt(15)
v_mfma_f32_16x16x32_bf16 v[208:211], v[32:35], v[48:51], 0
ds_read_b64_tr_b16 v[82:83], v120 offset:9216
v_mfma_f32_16x16x32_bf16 v[240:243], v[32:35], v[52:55], 0
ds_read_b64_tr_b16 v[84:85], v121 offset:8192
v_mfma_f32_16x16x32_bf16 v[212:215], v[36:39], v[48:51], 0
ds_read_b64_tr_b16 v[86:87], v121 offset:9216
ds_read_b64_tr_b16 v[88:89], v122 offset:8192
v_mfma_f32_16x16x32_bf16 v[244:247], v[36:39], v[52:55], 0
ds_read_b64_tr_b16 v[90:91], v122 offset:9216
s_waitcnt lgkmcnt(15)
v_mfma_f32_16x16x32_bf16 v[216:219], v[40:43], v[48:51], 0
ds_read_b64_tr_b16 v[92:93], v123 offset:8192
v_mfma_f32_16x16x32_bf16 v[248:251], v[40:43], v[52:55], 0
ds_read_b64_tr_b16 v[94:95], v123 offset:9216
v_mfma_f32_16x16x32_bf16 v[220:223], v[44:47], v[48:51], 0
v_mfma_f32_16x16x32_bf16 v[252:255], v[44:47], v[52:55], 0
s_waitcnt vmcnt(6) lgkmcnt(0)
s_barrier
v_mfma_f32_16x16x32_bf16 v[192:195], v[64:67], v[96:99], v[192:195]
ds_read_b128 v[48:51], v112 offset:0
ds_read_b128 v[52:55], v112 offset:2048
v_mfma_f32_16x16x32_bf16 v[224:227], v[64:67], v[100:103], v[224:227]
ds_read_b64_tr_b16 v[16:17], v116 offset:16384
s_add_u32 m0, s37, 65536
s_add_u32 s43, s34, 384
buffer_load_dwordx4 v11, s[4:7], s43 offen lds
v_mfma_f32_16x16x32_bf16 v[196:199], v[68:71], v[96:99], v[196:199]
ds_read_b64_tr_b16 v[18:19], v116 offset:17408
v_mfma_f32_16x16x32_bf16 v[228:231], v[68:71], v[100:103], v[228:231]
ds_read_b64_tr_b16 v[20:21], v117 offset:16384
ds_read_b64_tr_b16 v[22:23], v117 offset:17408
v_mfma_f32_16x16x32_bf16 v[200:203], v[72:75], v[96:99], v[200:203]
ds_read_b64_tr_b16 v[24:25], v118 offset:16384
s_add_u32 m0, s37, 66560
s_add_u32 s43, s34, 8576
buffer_load_dwordx4 v12, s[4:7], s43 offen lds
v_mfma_f32_16x16x32_bf16 v[232:235], v[72:75], v[100:103], v[232:235]
ds_read_b64_tr_b16 v[26:27], v118 offset:17408
v_mfma_f32_16x16x32_bf16 v[204:207], v[76:79], v[96:99], v[204:207]
ds_read_b64_tr_b16 v[28:29], v119 offset:16384
v_mfma_f32_16x16x32_bf16 v[236:239], v[76:79], v[100:103], v[236:239]
ds_read_b64_tr_b16 v[30:31], v119 offset:17408
ds_read_b64_tr_b16 v[32:33], v120 offset:16384
v_mfma_f32_16x16x32_bf16 v[208:211], v[80:83], v[96:99], v[208:211]
ds_read_b64_tr_b16 v[34:35], v120 offset:17408
s_add_u32 m0, s37, 67584
s_add_u32 s43, s34, 16768
buffer_load_dwordx4 v11, s[4:7], s43 offen lds
v_mfma_f32_16x16x32_bf16 v[240:243], v[80:83], v[100:103], v[240:243]
ds_read_b64_tr_b16 v[36:37], v121 offset:16384
v_mfma_f32_16x16x32_bf16 v[212:215], v[84:87], v[96:99], v[212:215]
ds_read_b64_tr_b16 v[38:39], v121 offset:17408
ds_read_b64_tr_b16 v[40:41], v122 offset:16384
v_mfma_f32_16x16x32_bf16 v[244:247], v[84:87], v[100:103], v[244:247]
ds_read_b64_tr_b16 v[42:43], v122 offset:17408
v_mfma_f32_16x16x32_bf16 v[216:219], v[88:91], v[96:99], v[216:219]
ds_read_b64_tr_b16 v[44:45], v123 offset:16384
s_add_u32 m0, s37, 68608
s_add_u32 s43, s34, 24960
buffer_load_dwordx4 v12, s[4:7], s43 offen lds
v_mfma_f32_16x16x32_bf16 v[248:251], v[88:91], v[100:103], v[248:251]
ds_read_b64_tr_b16 v[46:47], v123 offset:17408
v_mfma_f32_16x16x32_bf16 v[220:223], v[92:95], v[96:99], v[220:223]
v_mfma_f32_16x16x32_bf16 v[252:255], v[92:95], v[100:103], v[252:255]
s_waitcnt lgkmcnt(14)
v_mfma_f32_16x16x32_bf16 v[192:195], v[16:19], v[48:51], v[192:195]
ds_read_b128 v[96:99], v113 offset:0
ds_read_b128 v[100:103], v113 offset:2048
v_mfma_f32_16x16x32_bf16 v[224:227], v[16:19], v[52:55], v[224:227]
ds_read_b64_tr_b16 v[64:65], v116 offset:24576
s_add_u32 m0, s38, 98304
s_add_u32 s43, s36, 2097152
buffer_load_dwordx4 v13, s[16:19], s43 offen lds
s_waitcnt lgkmcnt(15)
v_mfma_f32_16x16x32_bf16 v[196:199], v[20:23], v[48:51], v[196:199]
ds_read_b64_tr_b16 v[66:67], v116 offset:25600
v_mfma_f32_16x16x32_bf16 v[228:231], v[20:23], v[52:55], v[228:231]
ds_read_b64_tr_b16 v[68:69], v117 offset:24576
ds_read_b64_tr_b16 v[70:71], v117 offset:25600
s_waitcnt lgkmcnt(15)
v_mfma_f32_16x16x32_bf16 v[200:203], v[24:27], v[48:51], v[200:203]
ds_read_b64_tr_b16 v[72:73], v118 offset:24576
s_add_u32 m0, s38, 99328
s_add_u32 s43, s36, 2129920
buffer_load_dwordx4 v13, s[16:19], s43 offen lds
v_mfma_f32_16x16x32_bf16 v[232:235], v[24:27], v[52:55], v[232:235]
ds_read_b64_tr_b16 v[74:75], v118 offset:25600
s_waitcnt lgkmcnt(15)
v_mfma_f32_16x16x32_bf16 v[204:207], v[28:31], v[48:51], v[204:207]
ds_read_b64_tr_b16 v[76:77], v119 offset:24576
v_mfma_f32_16x16x32_bf16 v[236:239], v[28:31], v[52:55], v[236:239]
ds_read_b64_tr_b16 v[78:79], v119 offset:25600
ds_read_b64_tr_b16 v[80:81], v120 offset:24576
s_waitcnt lgkmcnt(15)
v_mfma_f32_16x16x32_bf16 v[208:211], v[32:35], v[48:51], v[208:211]
ds_read_b64_tr_b16 v[82:83], v120 offset:25600
s_add_u32 s44, s40, 0
s_cmp_eq_u32 s3, 0
s_cbranch_scc1 L_sst48
buffer_store_dwordx4 v[128:131], v2, s[20:23], s44 offen offset:0
L_sstr48:
v_mfma_f32_16x16x32_bf16 v[240:243], v[32:35], v[52:55], v[240:243]
ds_read_b64_tr_b16 v[84:85], v121 offset:24576
v_mfma_f32_16x16x32_bf16 v[212:215], v[36:39], v[48:51], v[212:215]
ds_read_b64_tr_b16 v[86:87], v121 offset:25600
ds_read_b64_tr_b16 v[88:89], v122 offset:24576
v_mfma_f32_16x16x32_bf16 v[244:247], v[36:39], v[52:55], v[244:247]
ds_read_b64_tr_b16 v[90:91], v122 offset:25600
s_waitcnt lgkmcnt(15)
v_mfma_f32_16x16x32_bf16 v[216:219], v[40:43], v[48:51], v[216:219]
ds_read_b64_tr_b16 v[92:93], v123 offset:24576
s_add_u32 s44, s40, 0
s_cmp_eq_u32 s3, 0
s_cbranch_scc1 L_sst49
buffer_store_dwordx4 v[132:135], v2, s[20:23], s44 offen offset:1024
L_sstr49:
v_mfma_f32_16x16x32_bf16 v[248:251], v[40:43], v[52:55], v[248:251]
ds_read_b64_tr_b16 v[94:95], v123 offset:25600
v_mfma_f32_16x16x32_bf16 v[220:223], v[44:47], v[48:51], v[220:223]
v_mfma_f32_16x16x32_bf16 v[252:255], v[44:47], v[52:55], v[252:255]
s_waitcnt vmcnt(10) lgkmcnt(0)
s_barrier
v_mfma_f32_16x16x32_bf16 v[192:195], v[64:67], v[96:99], v[192:195]
ds_read_b128 v[48:51], v112 offset:32768
ds_read_b128 v[52:55], v112 offset:34816
v_mov_b32 v128, 0
v_mov_b32 v129, 0
v_mov_b32 v130, 0
v_mov_b32 v131, 0
v_mfma_f32_16x16x32_bf16 v[224:227], v[64:67], v[100:103], v[224:227]
ds_read_b64_tr_b16 v[16:17], v116 offset:32768
s_add_u32 m0, s37, 0
s_add_u32 s43, s34, 512
buffer_load_dwordx4 v11, s[4:7], s43 offen lds
v_mfma_f32_16x16x32_bf16 v[196:199], v[68:71], v[96:99], v[196:199]
ds_read_b64_tr_b16 v[18:19], v116 offset:33792
v_mfma_f32_16x16x32_bf16 v[228:231], v[68:71], v[100:103], v[228:231]
ds_read_b64_tr_b16 v[20:21], v117 offset:32768
ds_read_b64_tr_b16 v[22:23], v117 offset:33792
v_mfma_f32_16x16x32_bf16 v[200:203], v[72:75], v[96:99], v[200:203]
ds_read_b64_tr_b16 v[24:25], v118 offset:32768
s_add_u32 m0, s37, 1024
s_add_u32 s43, s34, 8704
buffer_load_dwordx4 v12, s[4:7], s43 offen lds
v_mfma_f32_16x16x32_bf16 v[232:235], v[72:75], v[100:103], v[232:235]
ds_read_b64_tr_b16 v[26:27], v118 offset:33792
v_mfma_f32_16x16x32_bf16 v[204:207], v[76:79], v[96:99], v[204:207]
ds_read_b64_tr_b16 v[28:29], v119 offset:32768
v_mfma_f32_16x16x32_bf16 v[236:239], v[76:79], v[100:103], v[236:239]
ds_read_b64_tr_b16 v[30:31], v119 offset:33792
ds_read_b64_tr_b16 v[32:33], v120 offset:32768
s_add_u32 m0, s37, 2048
s_add_u32 s43, s34, 16896
buffer_load_dwordx4 v11, s[4:7], s43 offen lds
v_mfma_f32_16x16x32_bf16 v[208:211], v[80:83], v[96:99], v[208:211]
ds_read_b64_tr_b16 v[34:35], v120 offset:33792
v_mov_b32 v132, 0
v_mov_b32 v133, 0
v_mov_b32 v134, 0
v_mov_b32 v135, 0
v_mfma_f32_16x16x32_bf16 v[240:243], v[80:83], v[100:103], v[240:243]
ds_read_b64_tr_b16 v[36:37], v121 offset:32768
v_mfma_f32_16x16x32_bf16 v[212:215], v[84:87], v[96:99], v[212:215]
ds_read_b64_tr_b16 v[38:39], v121 offset:33792
ds_read_b64_tr_b16 v[40:41], v122 offset:32768
s_add_u32 m0, s37, 3072
s_add_u32 s43, s34, 25088
buffer_load_dwordx4 v12, s[4:7], s43 offen lds
v_mfma_f32_16x16x32_bf16 v[244:247], v[84:87], v[100:103], v[244:247]
ds_read_b64_tr_b16 v[42:43], v122 offset:33792
v_mfma_f32_16x16x32_bf16 v[216:219], v[88:91], v[96:99], v[216:219]
ds_read_b64_tr_b16 v[44:45], v123 offset:32768
v_mfma_f32_16x16x32_bf16 v[248:251], v[88:91], v[100:103], v[248:251]
ds_read_b64_tr_b16 v[46:47], v123 offset:33792
s_add_u32 m0, s38, 114688
s_add_u32 s43, s36, 2621440
buffer_load_dwordx4 v13, s[16:19], s43 offen lds
v_mfma_f32_16x16x32_bf16 v[220:223], v[92:95], v[96:99], v[220:223]
v_mfma_f32_16x16x32_bf16 v[252:255], v[92:95], v[100:103], v[252:255]
s_waitcnt lgkmcnt(14)
v_mfma_f32_16x16x32_bf16 v[192:195], v[16:19], v[48:51], v[192:195]
ds_read_b128 v[96:99], v113 offset:32768
ds_read_b128 v[100:103], v113 offset:34816
v_mfma_f32_16x16x32_bf16 v[224:227], v[16:19], v[52:55], v[224:227]
ds_read_b64_tr_b16 v[64:65], v116 offset:40960
s_add_u32 m0, s38, 115712
s_add_u32 s43, s36, 2654208
buffer_load_dwordx4 v13, s[16:19], s43 offen lds
s_waitcnt lgkmcnt(15)
v_mfma_f32_16x16x32_bf16 v[196:199], v[20:23], v[48:51], v[196:199]
ds_read_b64_tr_b16 v[66:67], v116 offset:41984
v_mfma_f32_16x16x32_bf16 v[228:231], v[20:23], v[52:55], v[228:231]
ds_read_b64_tr_b16 v[68:69], v117 offset:40960
ds_read_b64_tr_b16 v[70:71], v117 offset:41984
s_waitcnt lgkmcnt(15)
v_mfma_f32_16x16x32_bf16 v[200:203], v[24:27], v[48:51], v[200:203]
ds_read_b64_tr_b16 v[72:73], v118 offset:40960
s_add_u32 s44, s40, 0
s_cmp_eq_u32 s3, 0
s_cbranch_scc1 L_sst50
buffer_store_dwordx4 v[136:139], v2, s[20:23], s44 offen offset:2048
L_sstr50:
v_mfma_f32_16x16x32_bf16 v[232:235], v[24:27], v[52:55], v[232:235]
ds_read_b64_tr_b16 v[74:75], v118 offset:41984
s_waitcnt lgkmcnt(15)
v_mfma_f32_16x16x32_bf16 v[204:207], v[28:31], v[48:51], v[204:207]
ds_read_b64_tr_b16 v[76:77], v119 offset:40960
v_mfma_f32_16x16x32_bf16 v[236:239], v[28:31], v[52:55], v[236:239]
ds_read_b64_tr_b16 v[78:79], v119 offset:41984
ds_read_b64_tr_b16 v[80:81], v120 offset:40960
s_waitcnt lgkmcnt(15)
v_mfma_f32_16x16x32_bf16 v[208:211], v[32:35], v[48:51], v[208:211]
ds_read_b64_tr_b16 v[82:83], v120 offset:41984
s_add_u32 s44, s40, 0
s_cmp_eq_u32 s3, 0
s_cbranch_scc1 L_sst51
buffer_store_dwordx4 v[140:143], v2, s[20:23], s44 offen offset:3072
L_sstr51:
v_mfma_f32_16x16x32_bf16 v[240:243], v[32:35], v[52:55], v[240:243]
ds_read_b64_tr_b16 v[84:85], v121 offset:40960
v_mfma_f32_16x16x32_bf16 v[212:215], v[36:39], v[48:51], v[212:215]
ds_read_b64_tr_b16 v[86:87], v121 offset:41984
ds_read_b64_tr_b16 v[88:89], v122 offset:40960
v_mfma_f32_16x16x32_bf16 v[244:247], v[36:39], v[52:55], v[244:247]
ds_read_b64_tr_b16 v[90:91], v122 offset:41984
s_waitcnt lgkmcnt(15)
v_mfma_f32_16x16x32_bf16 v[216:219], v[40:43], v[48:51], v[216:219]
ds_read_b64_tr_b16 v[92:93], v123 offset:40960
s_add_u32 s44, s40, 8192
s_cmp_eq_u32 s3, 0
s_cbranch_scc1 L_sst52
buffer_store_dwordx4 v[144:147], v2, s[20:23], s44 offen offset:0
L_sstr52:
v_mfma_f32_16x16x32_bf16 v[248:251], v[40:43], v[52:55], v[248:251]
ds_read_b64_tr_b16 v[94:95], v123 offset:41984
v_mfma_f32_16x16x32_bf16 v[220:223], v[44:47], v[48:51], v[220:223]
v_mfma_f32_16x16x32_bf16 v[252:255], v[44:47], v[52:55], v[252:255]
s_waitcnt vmcnt(13) lgkmcnt(0)
s_barrier
v_mfma_f32_16x16x32_bf16 v[192:195], v[64:67], v[96:99], v[192:195]
ds_read_b128 v[48:51], v114 offset:0
ds_read_b128 v[52:55], v114 offset:2048
v_mov_b32 v136, 0
v_mov_b32 v137, 0
v_mov_b32 v138, 0
v_mov_b32 v139, 0
v_mfma_f32_16x16x32_bf16 v[224:227], v[64:67], v[100:103], v[224:227]
ds_read_b64_tr_b16 v[16:17], v116 offset:49152
s_add_u32 m0, s37, 32768
s_add_u32 s43, s34, 640
buffer_load_dwordx4 v11, s[4:7], s43 offen lds
v_mfma_f32_16x16x32_bf16 v[196:199], v[68:71], v[96:99], v[196:199]
ds_read_b64_tr_b16 v[18:19], v116 offset:50176
v_mfma_f32_16x16x32_bf16 v[228:231], v[68:71], v[100:103], v[228:231]
ds_read_b64_tr_b16 v[20:21], v117 offset:49152
ds_read_b64_tr_b16 v[22:23], v117 offset:50176
v_mfma_f32_16x16x32_bf16 v[200:203], v[72:75], v[96:99], v[200:203]
ds_read_b64_tr_b16 v[24:25], v118 offset:49152
s_add_u32 m0, s37, 33792
s_add_u32 s43, s34, 8832
buffer_load_dwordx4 v12, s[4:7], s43 offen lds
v_mfma_f32_16x16x32_bf16 v[232:235], v[72:75], v[100:103], v[232:235]
ds_read_b64_tr_b16 v[26:27], v118 offset:50176
v_mov_b32 v140, 0
v_mov_b32 v141, 0
v_mov_b32 v142, 0
v_mov_b32 v143, 0
v_mfma_f32_16x16x32_bf16 v[204:207], v[76:79], v[96:99], v[204:207]
ds_read_b64_tr_b16 v[28:29], v119 offset:49152
v_mfma_f32_16x16x32_bf16 v[236:239], v[76:79], v[100:103], v[236:239]
ds_read_b64_tr_b16 v[30:31], v119 offset:50176
ds_read_b64_tr_b16 v[32:33], v120 offset:49152
s_add_u32 m0, s37, 34816
s_add_u32 s43, s34, 17024
buffer_load_dwordx4 v11, s[4:7], s43 offen lds
v_mfma_f32_16x16x32_bf16 v[208:211], v[80:83], v[96:99], v[208:211]
ds_read_b64_tr_b16 v[34:35], v120 offset:50176
v_mfma_f32_16x16x32_bf16 v[240:243], v[80:83], v[100:103], v[240:243]
ds_read_b64_tr_b16 v[36:37], v121 offset:49152
v_mfma_f32_16x16x32_bf16 v[212:215], v[84:87], v[96:99], v[212:215]
ds_read_b64_tr_b16 v[38:39], v121 offset:50176
ds_read_b64_tr_b16 v[40:41], v122 offset:49152
s_add_u32 m0, s37, 35840
s_add_u32 s43, s34, 25216
buffer_load_dwordx4 v12, s[4:7], s43 offen lds
v_mov_b32 v144, 0
v_mov_b32 v145, 0
v_mov_b32 v146, 0
v_mov_b32 v147, 0
v_mfma_f32_16x16x32_bf16 v[244:247], v[84:87], v[100:103], v[244:247]
ds_read_b64_tr_b16 v[42:43], v122 offset:50176
v_mfma_f32_16x16x32_bf16 v[216:219], v[88:91], v[96:99], v[216:219]
ds_read_b64_tr_b16 v[44:45], v123 offset:49152
v_mfma_f32_16x16x32_bf16 v[248:251], v[88:91], v[100:103], v[248:251]
ds_read_b64_tr_b16 v[46:47], v123 offset:50176
s_add_u32 m0, s38, 131072
s_add_u32 s43, s36, 3145728
buffer_load_dwordx4 v13, s[16:19], s43 offen lds
v_mfma_f32_16x16x32_bf16 v[220:223], v[92:95], v[96:99], v[220:223]
v_mfma_f32_16x16x32_bf16 v[252:255], v[92:95], v[100:103], v[252:255]
s_waitcnt lgkmcnt(14)
v_mfma_f32_16x16x32_bf16 v[192:195], v[16:19], v[48:51], v[192:195]
ds_read_b128 v[96:99], v115 offset:0
ds_read_b128 v[100:103], v115 offset:2048
v_mfma_f32_16x16x32_bf16 v[224:227], v[16:19], v[52:55], v[224:227]
ds_read_b64_tr_b16 v[64:65], v116 offset:57344
s_add_u32 m0, s38, 132096
s_add_u32 s43, s36, 3178496
buffer_load_dwordx4 v13, s[16:19], s43 offen lds
s_waitcnt lgkmcnt(15)
v_mfma_f32_16x16x32_bf16 v[196:199], v[20:23], v[48:51], v[196:199]
ds_read_b64_tr_b16 v[66:67], v116 offset:58368
v_mfma_f32_16x16x32_bf16 v[228:231], v[20:23], v[52:55], v[228:231]
ds_read_b64_tr_b16 v[68:69], v117 offset:57344
ds_read_b64_tr_b16 v[70:71], v117 offset:58368
s_waitcnt lgkmcnt(15)
v_mfma_f32_16x16x32_bf16 v[200:203], v[24:27], v[48:51], v[200:203]
ds_read_b64_tr_b16 v[72:73], v118 offset:57344
s_add_u32 s44, s40, 8192
s_cmp_eq_u32 s3, 0
s_cbranch_scc1 L_sst53
buffer_store_dwordx4 v[148:151], v2, s[20:23], s44 offen offset:1024
L_sstr53:
v_mfma_f32_16x16x32_bf16 v[232:235], v[24:27], v[52:55], v[232:235]
ds_read_b64_tr_b16 v[74:75], v118 offset:58368
s_waitcnt lgkmcnt(15)
v_mfma_f32_16x16x32_bf16 v[204:207], v[28:31], v[48:51], v[204:207]
ds_read_b64_tr_b16 v[76:77], v119 offset:57344
v_mfma_f32_16x16x32_bf16 v[236:239], v[28:31], v[52:55], v[236:239]
ds_read_b64_tr_b16 v[78:79], v119 offset:58368
ds_read_b64_tr_b16 v[80:81], v120 offset:57344
s_waitcnt lgkmcnt(15)
v_mfma_f32_16x16x32_bf16 v[208:211], v[32:35], v[48:51], v[208:211]
ds_read_b64_tr_b16 v[82:83], v120 offset:58368
s_add_u32 s44, s40, 8192
s_cmp_eq_u32 s3, 0
s_cbranch_scc1 L_sst54
buffer_store_dwordx4 v[152:155], v2, s[20:23], s44 offen offset:2048
L_sstr54:
v_mfma_f32_16x16x32_bf16 v[240:243], v[32:35], v[52:55], v[240:243]
ds_read_b64_tr_b16 v[84:85], v121 offset:57344
v_mfma_f32_16x16x32_bf16 v[212:215], v[36:39], v[48:51], v[212:215]
ds_read_b64_tr_b16 v[86:87], v121 offset:58368
ds_read_b64_tr_b16 v[88:89], v122 offset:57344
v_mfma_f32_16x16x32_bf16 v[244:247], v[36:39], v[52:55], v[244:247]
ds_read_b64_tr_b16 v[90:91], v122 offset:58368
s_waitcnt lgkmcnt(15)
v_mfma_f32_16x16x32_bf16 v[216:219], v[40:43], v[48:51], v[216:219]
ds_read_b64_tr_b16 v[92:93], v123 offset:57344
s_add_u32 s44, s40, 8192
s_cmp_eq_u32 s3, 0
s_cbranch_scc1 L_sst55
buffer_store_dwordx4 v[156:159], v2, s[20:23], s44 offen offset:3072
L_sstr55:
v_mfma_f32_16x16x32_bf16 v[248:251], v[40:43], v[52:55], v[248:251]
ds_read_b64_tr_b16 v[94:95], v123 offset:58368
v_mfma_f32_16x16x32_bf16 v[220:223], v[44:47], v[48:51], v[220:223]
v_mfma_f32_16x16x32_bf16 v[252:255], v[44:47], v[52:55], v[252:255]
s_waitcnt vmcnt(14) lgkmcnt(0)
s_barrier
v_mfma_f32_16x16x32_bf16 v[192:195], v[64:67], v[96:99], v[192:195]
ds_read_b128 v[48:51], v112 offset:0
ds_read_b128 v[52:55], v112 offset:2048
v_mov_b32 v148, 0
v_mov_b32 v149, 0
v_mov_b32 v150, 0
v_mov_b32 v151, 0
v_mfma_f32_16x16x32_bf16 v[224:227], v[64:67], v[100:103], v[224:227]
ds_read_b64_tr_b16 v[16:17], v116 offset:0
s_add_u32 m0, s37, 65536
s_add_u32 s43, s34, 768
buffer_load_dwordx4 v11, s[4:7], s43 offen lds
v_mfma_f32_16x16x32_bf16 v[196:199], v[68:71], v[96:99], v[196:199]
ds_read_b64_tr_b16 v[18:19], v116 offset:1024
v_mfma_f32_16x16x32_bf16 v[228:231], v[68:71], v[100:103], v[228:231]
ds_read_b64_tr_b16 v[20:21], v117 offset:0
ds_read_b64_tr_b16 v[22:23], v117 offset:1024
v_mfma_f32_16x16x32_bf16 v[200:203], v[72:75], v[96:99], v[200:203]
ds_read_b64_tr_b16 v[24:25], v118 offset:0
s_add_u32 m0, s37, 66560
s_add_u32 s43, s34, 8960
buffer_load_dwordx4 v12, s[4:7], s43 offen lds
v_mfma_f32_16x16x32_bf16 v[232:235], v[72:75], v[100:103], v[232:235]
ds_read_b64_tr_b16 v[26:27], v118 offset:1024
v_mov_b32 v152, 0
v_mov_b32 v153, 0
v_mov_b32 v154, 0
v_mov_b32 v155, 0
v_mfma_f32_16x16x32_bf16 v[204:207], v[76:79], v[96:99], v[204:207]
ds_read_b64_tr_b16 v[28:29], v119 offset:0
v_mfma_f32_16x16x32_bf16 v[236:239], v[76:79], v[100:103], v[236:239]
ds_read_b64_tr_b16 v[30:31], v119 offset:1024
ds_read_b64_tr_b16 v[32:33], v120 offset:0
s_add_u32 m0, s37, 67584
s_add_u32 s43, s34, 17152
buffer_load_dwordx4 v11, s[4:7], s43 offen lds
v_mfma_f32_16x16x32_bf16 v[208:211], v[80:83], v[96:99], v[208:211]
ds_read_b64_tr_b16 v[34:35], v120 offset:1024
v_mfma_f32_16x16x32_bf16 v[240:243], v[80:83], v[100:103], v[240:243]
ds_read_b64_tr_b16 v[36:37], v121 offset:0
v_mfma_f32_16x16x32_bf16 v[212:215], v[84:87], v[96:99], v[212:215]
ds_read_b64_tr_b16 v[38:39], v121 offset:1024
ds_read_b64_tr_b16 v[40:41], v122 offset:0
s_add_u32 m0, s37, 68608
s_add_u32 s43, s34, 25344
buffer_load_dwordx4 v12, s[4:7], s43 offen lds
v_mov_b32 v156, 0
v_mov_b32 v157, 0
v_mov_b32 v158, 0
v_mov_b32 v159, 0
v_mfma_f32_16x16x32_bf16 v[244:247], v[84:87], v[100:103], v[244:247]
ds_read_b64_tr_b16 v[42:43], v122 offset:1024
v_mfma_f32_16x16x32_bf16 v[216:219], v[88:91], v[96:99], v[216:219]
ds_read_b64_tr_b16 v[44:45], v123 offset:0
v_mfma_f32_16x16x32_bf16 v[248:251], v[88:91], v[100:103], v[248:251]
ds_read_b64_tr_b16 v[46:47], v123 offset:1024
s_add_u32 m0, s38, 147456
s_add_u32 s43, s36, 3670016
buffer_load_dwordx4 v13, s[16:19], s43 offen lds
v_mfma_f32_16x16x32_bf16 v[220:223], v[92:95], v[96:99], v[220:223]
v_mfma_f32_16x16x32_bf16 v[252:255], v[92:95], v[100:103], v[252:255]
s_waitcnt lgkmcnt(14)
v_mfma_f32_16x16x32_bf16 v[192:195], v[16:19], v[48:51], v[192:195]
ds_read_b128 v[96:99], v113 offset:0
ds_read_b128 v[100:103], v113 offset:2048
v_mfma_f32_16x16x32_bf16 v[224:227], v[16:19], v[52:55], v[224:227]
ds_read_b64_tr_b16 v[64:65], v116 offset:8192
s_add_u32 m0, s38, 148480
s_add_u32 s43, s36, 3702784
buffer_load_dwordx4 v13, s[16:19], s43 offen lds
s_waitcnt lgkmcnt(15)
v_mfma_f32_16x16x32_bf16 v[196:199], v[20:23], v[48:51], v[196:199]
ds_read_b64_tr_b16 v[66:67], v116 offset:9216
v_mfma_f32_16x16x32_bf16 v[228:231], v[20:23], v[52:55], v[228:231]
ds_read_b64_tr_b16 v[68:69], v117 offset:8192
ds_read_b64_tr_b16 v[70:71], v117 offset:9216
s_waitcnt lgkmcnt(15)
v_mfma_f32_16x16x32_bf16 v[200:203], v[24:27], v[48:51], v[200:203]
ds_read_b64_tr_b16 v[72:73], v118 offset:8192
s_add_u32 s44, s40, 16384
s_cmp_eq_u32 s3, 0
s_cbranch_scc1 L_sst56
buffer_store_dwordx4 v[160:163], v2, s[20:23], s44 offen offset:0
L_sstr56:
v_mfma_f32_16x16x32_bf16 v[232:235], v[24:27], v[52:55], v[232:235]
ds_read_b64_tr_b16 v[74:75], v118 offset:9216
s_waitcnt lgkmcnt(15)
v_mfma_f32_16x16x32_bf16 v[204:207], v[28:31], v[48:51], v[204:207]
ds_read_b64_tr_b16 v[76:77], v119 offset:8192
v_mfma_f32_16x16x32_bf16 v[236:239], v[28:31], v[52:55], v[236:239]
ds_read_b64_tr_b16 v[78:79], v119 offset:9216
ds_read_b64_tr_b16 v[80:81], v120 offset:8192
s_waitcnt lgkmcnt(15)
v_mfma_f32_16x16x32_bf16 v[208:211], v[32:35], v[48:51], v[208:211]
ds_read_b64_tr_b16 v[82:83], v120 offset:9216
s_add_u32 s44, s40, 16384
s_cmp_eq_u32 s3, 0
s_cbranch_scc1 L_sst57
buffer_store_dwordx4 v[164:167], v2, s[20:23], s44 offen offset:1024
L_sstr57:
v_mfma_f32_16x16x32_bf16 v[240:243], v[32:35], v[52:55], v[240:243]
ds_read_b64_tr_b16 v[84:85], v121 offset:8192
v_mfma_f32_16x16x32_bf16 v[212:215], v[36:39], v[48:51], v[212:215]
ds_read_b64_tr_b16 v[86:87], v121 offset:9216
ds_read_b64_tr_b16 v[88:89], v122 offset:8192
v_mfma_f32_16x16x32_bf16 v[244:247], v[36:39], v[52:55], v[244:247]
ds_read_b64_tr_b16 v[90:91], v122 offset:9216
s_waitcnt lgkmcnt(15)
v_mfma_f32_16x16x32_bf16 v[216:219], v[40:43], v[48:51], v[216:219]
ds_read_b64_tr_b16 v[92:93], v123 offset:8192
s_add_u32 s44, s40, 16384
s_cmp_eq_u32 s3, 0
s_cbranch_scc1 L_sst58
buffer_store_dwordx4 v[168:171], v2, s[20:23], s44 offen offset:2048
L_sstr58:
v_mfma_f32_16x16x32_bf16 v[248:251], v[40:43], v[52:55], v[248:251]
ds_read_b64_tr_b16 v[94:95], v123 offset:9216
v_mfma_f32_16x16x32_bf16 v[220:223], v[44:47], v[48:51], v[220:223]
v_mfma_f32_16x16x32_bf16 v[252:255], v[44:47], v[52:55], v[252:255]
s_waitcnt vmcnt(14) lgkmcnt(0)
s_barrier
v_mfma_f32_16x16x32_bf16 v[192:195], v[64:67], v[96:99], v[192:195]
ds_read_b128 v[48:51], v112 offset:32768
ds_read_b128 v[52:55], v112 offset:34816
v_mov_b32 v160, 0
v_mov_b32 v161, 0
v_mov_b32 v162, 0
v_mov_b32 v163, 0
v_mfma_f32_16x16x32_bf16 v[224:227], v[64:67], v[100:103], v[224:227]
ds_read_b64_tr_b16 v[16:17], v116 offset:16384
s_add_u32 m0, s37, 0
s_add_u32 s43, s34, 896
buffer_load_dwordx4 v11, s[4:7], s43 offen lds
v_mfma_f32_16x16x32_bf16 v[196:199], v[68:71], v[96:99], v[196:199]
ds_read_b64_tr_b16 v[18:19], v116 offset:17408
v_mfma_f32_16x16x32_bf16 v[228:231], v[68:71], v[100:103], v[228:231]
ds_read_b64_tr_b16 v[20:21], v117 offset:16384
ds_read_b64_tr_b16 v[22:23], v117 offset:17408
v_mfma_f32_16x16x32_bf16 v[200:203], v[72:75], v[96:99], v[200:203]
ds_read_b64_tr_b16 v[24:25], v118 offset:16384
s_add_u32 m0, s37, 1024
s_add_u32 s43, s34, 9088
buffer_load_dwordx4 v12, s[4:7], s43 offen lds
v_mfma_f32_16x16x32_bf16 v[232:235], v[72:75], v[100:103], v[232:235]
ds_read_b64_tr_b16 v[26:27], v118 offset:17408
v_mov_b32 v164, 0
v_mov_b32 v165, 0
v_mov_b32 v166, 0
v_mov_b32 v167, 0
v_mfma_f32_16x16x32_bf16 v[204:207], v[76:79], v[96:99], v[204:207]
ds_read_b64_tr_b16 v[28:29], v119 offset:16384
v_mfma_f32_16x16x32_bf16 v[236:239], v[76:79], v[100:103], v[236:239]
ds_read_b64_tr_b16 v[30:31], v119 offset:17408
ds_read_b64_tr_b16 v[32:33], v120 offset:16384
v_mfma_f32_16x16x32_bf16 v[208:211], v[80:83], v[96:99], v[208:211]
ds_read_b64_tr_b16 v[34:35], v120 offset:17408
s_add_u32 m0, s37, 2048
s_add_u32 s43, s34, 17280
buffer_load_dwordx4 v11, s[4:7], s43 offen lds
v_mfma_f32_16x16x32_bf16 v[240:243], v[80:83], v[100:103], v[240:243]
ds_read_b64_tr_b16 v[36:37], v121 offset:16384
v_mfma_f32_16x16x32_bf16 v[212:215], v[84:87], v[96:99], v[212:215]
ds_read_b64_tr_b16 v[38:39], v121 offset:17408
ds_read_b64_tr_b16 v[40:41], v122 offset:16384
v_mov_b32 v168, 0
v_mov_b32 v169, 0
v_mov_b32 v170, 0
v_mov_b32 v171, 0
v_mfma_f32_16x16x32_bf16 v[244:247], v[84:87], v[100:103], v[244:247]
ds_read_b64_tr_b16 v[42:43], v122 offset:17408
v_mfma_f32_16x16x32_bf16 v[216:219], v[88:91], v[96:99], v[216:219]
ds_read_b64_tr_b16 v[44:45], v123 offset:16384
s_add_u32 m0, s37, 3072
s_add_u32 s43, s34, 25472
buffer_load_dwordx4 v12, s[4:7], s43 offen lds
v_mfma_f32_16x16x32_bf16 v[248:251], v[88:91], v[100:103], v[248:251]
ds_read_b64_tr_b16 v[46:47], v123 offset:17408
v_mfma_f32_16x16x32_bf16 v[220:223], v[92:95], v[96:99], v[220:223]
v_mfma_f32_16x16x32_bf16 v[252:255], v[92:95], v[100:103], v[252:255]
s_waitcnt lgkmcnt(14)
v_mfma_f32_16x16x32_bf16 v[192:195], v[16:19], v[48:51], v[192:195]
ds_read_b128 v[96:99], v113 offset:32768
ds_read_b128 v[100:103], v113 offset:34816
v_mfma_f32_16x16x32_bf16 v[224:227], v[16:19], v[52:55], v[224:227]
ds_read_b64_tr_b16 v[64:65], v116 offset:24576
s_add_u32 s44, s40, 16384
s_cmp_eq_u32 s3, 0
s_cbranch_scc1 L_sst59
buffer_store_dwordx4 v[172:175], v2, s[20:23], s44 offen offset:3072
L_sstr59:
s_waitcnt lgkmcnt(15)
v_mfma_f32_16x16x32_bf16 v[196:199], v[20:23], v[48:51], v[196:199]
ds_read_b64_tr_b16 v[66:67], v116 offset:25600
v_mfma_f32_16x16x32_bf16 v[228:231], v[20:23], v[52:55], v[228:231]
ds_read_b64_tr_b16 v[68:69], v117 offset:24576
ds_read_b64_tr_b16 v[70:71], v117 offset:25600
s_waitcnt lgkmcnt(15)
v_mfma_f32_16x16x32_bf16 v[200:203], v[24:27], v[48:51], v[200:203]
ds_read_b64_tr_b16 v[72:73], v118 offset:24576
v_mfma_f32_16x16x32_bf16 v[232:235], v[24:27], v[52:55], v[232:235]
ds_read_b64_tr_b16 v[74:75], v118 offset:25600
s_waitcnt lgkmcnt(15)
v_mfma_f32_16x16x32_bf16 v[204:207], v[28:31], v[48:51], v[204:207]
ds_read_b64_tr_b16 v[76:77], v119 offset:24576
s_add_u32 s44, s40, 24576
s_cmp_eq_u32 s3, 0
s_cbranch_scc1 L_sst60
buffer_store_dwordx4 v[176:179], v2, s[20:23], s44 offen offset:0
L_sstr60:
v_mfma_f32_16x16x32_bf16 v[236:239], v[28:31], v[52:55], v[236:239]
ds_read_b64_tr_b16 v[78:79], v119 offset:25600
ds_read_b64_tr_b16 v[80:81], v120 offset:24576
s_waitcnt lgkmcnt(15)
v_mfma_f32_16x16x32_bf16 v[208:211], v[32:35], v[48:51], v[208:211]
ds_read_b64_tr_b16 v[82:83], v120 offset:25600
v_mfma_f32_16x16x32_bf16 v[240:243], v[32:35], v[52:55], v[240:243]
ds_read_b64_tr_b16 v[84:85], v121 offset:24576
v_mfma_f32_16x16x32_bf16 v[212:215], v[36:39], v[48:51], v[212:215]
ds_read_b64_tr_b16 v[86:87], v121 offset:25600
ds_read_b64_tr_b16 v[88:89], v122 offset:24576
v_mfma_f32_16x16x32_bf16 v[244:247], v[36:39], v[52:55], v[244:247]
ds_read_b64_tr_b16 v[90:91], v122 offset:25600
s_add_u32 s44, s40, 24576
s_cmp_eq_u32 s3, 0
s_cbranch_scc1 L_sst61
buffer_store_dwordx4 v[180:183], v2, s[20:23], s44 offen offset:1024
L_sstr61:
s_waitcnt lgkmcnt(15)
v_mfma_f32_16x16x32_bf16 v[216:219], v[40:43], v[48:51], v[216:219]
ds_read_b64_tr_b16 v[92:93], v123 offset:24576
v_mfma_f32_16x16x32_bf16 v[248:251], v[40:43], v[52:55], v[248:251]
ds_read_b64_tr_b16 v[94:95], v123 offset:25600
v_mfma_f32_16x16x32_bf16 v[220:223], v[44:47], v[48:51], v[220:223]
v_mfma_f32_16x16x32_bf16 v[252:255], v[44:47], v[52:55], v[252:255]
s_cmp_lg_u32 s32, 4
s_cbranch_scc1 L_poll_done1
s_mov_b32 s45, 0
v_lshrrev_b32 v14, 2, v2
v_and_b32 v14, 0x7c, v14
L_pk1:
global_load_dword v15, v14, s[28:29] offset:128 sc1
L_pk1w:
s_waitcnt vmcnt(0)
v_readlane_b32 s41, v15, s30
v_lshrrev_b32 v15, 28, v15
v_cmp_ne_u32 vcc, 8, v15
s_nop 2
s_and_b32 s41, s41, 0xff
s_cmp_lg_u32 s41, 0x11
s_cbranch_scc1 L_pk1q
s_cbranch_vccz L_poll_done1
L_pk1q:
s_sleep 6
s_add_u32 s45, s45, 1
s_cmp_lt_u32 s45, 0x40000
s_cbranch_scc1 L_pk1
L_poll_done1:
s_waitcnt vmcnt(12) lgkmcnt(0)
s_barrier
s_and_b32 s41, s32, 3
s_lshl_b32 s38, s41, 13
s_movk_i32 s50, 0x1000
s_add_u32 s42, s41, 1
s_sub_u32 s43, s41, 2
s_cmp_lt_u32 s41, 2
s_cselect_b32 s42, s42, s43
s_lshl_b32 s55, s42, 13
s_lshl_b32 s41, s41, 11
s_lshl_b32 s42, s30, 20
s_add_u32 s42, s42, s41
s_add_u32 m0, s41, 40960
s_nop 0
buffer_load_dwordx4 v2, s[20:23], s42 offen lds
buffer_load_dwordx4 v2, s[20:23], s42 offen offset:1024 lds
v_mfma_f32_16x16x32_bf16 v[192:195], v[64:67], v[96:99], v[192:195]
ds_read_b128 v[48:51], v114 offset:0
ds_read_b128 v[52:55], v114 offset:2048
v_mov_b32 v172, 0
v_mov_b32 v173, 0
v_mov_b32 v174, 0
v_mov_b32 v175, 0
v_mfma_f32_16x16x32_bf16 v[224:227], v[64:67], v[100:103], v[224:227]
ds_read_b64_tr_b16 v[16:17], v116 offset:32768
s_add_u32 s41, s55, 16384
v_add_u32 v4, s41, v2
s_mov_b32 s49, 98304
v_mfma_f32_16x16x32_bf16 v[196:199], v[68:71], v[96:99], v[196:199]
ds_read_b64_tr_b16 v[18:19], v116 offset:33792
v_mfma_f32_16x16x32_bf16 v[228:231], v[68:71], v[100:103], v[228:231]
ds_read_b64_tr_b16 v[20:21], v117 offset:32768
ds_read_b64_tr_b16 v[22:23], v117 offset:33792
s_add_u32 m0, s49, s38
s_nop 0
buffer_load_dwordx4 v4, s[24:27], 0 offen offset:0 lds
v_mfma_f32_16x16x32_bf16 v[200:203], v[72:75], v[96:99], v[200:203]
ds_read_b64_tr_b16 v[24:25], v118 offset:32768
v_mfma_f32_16x16x32_bf16 v[232:235], v[72:75], v[100:103], v[232:235]
ds_read_b64_tr_b16 v[26:27], v118 offset:33792
v_mov_b32 v176, 0
v_mov_b32 v177, 0
v_mov_b32 v178, 0
v_mov_b32 v179, 0
v_mfma_f32_16x16x32_bf16 v[204:207], v[76:79], v[96:99], v[204:207]
ds_read_b64_tr_b16 v[28:29], v119 offset:32768
buffer_load_dwordx4 v4, s[24:27], 0 offen offset:1024 lds
v_mfma_f32_16x16x32_bf16 v[236:239], v[76:79], v[100:103], v[236:239]
ds_read_b64_tr_b16 v[30:31], v119 offset:33792
ds_read_b64_tr_b16 v[32:33], v120 offset:32768
v_mfma_f32_16x16x32_bf16 v[208:211], v[80:83], v[96:99], v[208:211]
ds_read_b64_tr_b16 v[34:35], v120 offset:33792
buffer_load_dwordx4 v4, s[24:27], 0 offen offset:2048 lds
v_mfma_f32_16x16x32_bf16 v[240:243], v[80:83], v[100:103], v[240:243]
ds_read_b64_tr_b16 v[36:37], v121 offset:32768
v_mfma_f32_16x16x32_bf16 v[212:215], v[84:87], v[96:99], v[212:215]
ds_read_b64_tr_b16 v[38:39], v121 offset:33792
ds_read_b64_tr_b16 v[40:41], v122 offset:32768
v_mov_b32 v180, 0
v_mov_b32 v181, 0
v_mov_b32 v182, 0
v_mov_b32 v183, 0
v_mfma_f32_16x16x32_bf16 v[244:247], v[84:87], v[100:103], v[244:247]
ds_read_b64_tr_b16 v[42:43], v122 offset:33792
buffer_load_dwordx4 v4, s[24:27], 0 offen offset:3072 lds
v_mfma_f32_16x16x32_bf16 v[216:219], v[88:91], v[96:99], v[216:219]
ds_read_b64_tr_b16 v[44:45], v123 offset:32768
v_mfma_f32_16x16x32_bf16 v[248:251], v[88:91], v[100:103], v[248:251]
ds_read_b64_tr_b16 v[46:47], v123 offset:33792
s_add_u32 m0, m0, 4096
s_nop 0
buffer_load_dwordx4 v4, s[24:27], s50 offen offset:0 lds
v_mfma_f32_16x16x32_bf16 v[220:223], v[92:95], v[96:99], v[220:223]
v_mfma_f32_16x16x32_bf16 v[252:255], v[92:95], v[100:103], v[252:255]
s_waitcnt lgkmcnt(14)
v_mfma_f32_16x16x32_bf16 v[192:195], v[16:19], v[48:51], v[192:195]
ds_read_b128 v[96:99], v115 offset:0
ds_read_b128 v[100:103], v115 offset:2048
v_mfma_f32_16x16x32_bf16 v[224:227], v[16:19], v[52:55], v[224:227]
ds_read_b64_tr_b16 v[64:65], v116 offset:40960
buffer_load_dwordx4 v4, s[24:27], s50 offen offset:1024 lds
s_waitcnt lgkmcnt(15)
v_mfma_f32_16x16x32_bf16 v[196:199], v[20:23], v[48:51], v[196:199]
ds_read_b64_tr_b16 v[66:67], v116 offset:41984
v_mfma_f32_16x16x32_bf16 v[228:231], v[20:23], v[52:55], v[228:231]
ds_read_b64_tr_b16 v[68:69], v117 offset:40960
ds_read_b64_tr_b16 v[70:71], v117 offset:41984
s_waitcnt lgkmcnt(15)
v_mfma_f32_16x16x32_bf16 v[200:203], v[24:27], v[48:51], v[200:203]
ds_read_b64_tr_b16 v[72:73], v118 offset:40960
buffer_load_dwordx4 v4, s[24:27], s50 offen offset:2048 lds
v_mfma_f32_16x16x32_bf16 v[232:235], v[24:27], v[52:55], v[232:235]
ds_read_b64_tr_b16 v[74:75], v118 offset:41984
s_waitcnt lgkmcnt(15)
v_mfma_f32_16x16x32_bf16 v[204:207], v[28:31], v[48:51], v[204:207]
ds_read_b64_tr_b16 v[76:77], v119 offset:40960
v_mfma_f32_16x16x32_bf16 v[236:239], v[28:31], v[52:55], v[236:239]
ds_read_b64_tr_b16 v[78:79], v119 offset:41984
ds_read_b64_tr_b16 v[80:81], v120 offset:40960
buffer_load_dwordx4 v4, s[24:27], s50 offen offset:3072 lds
s_waitcnt lgkmcnt(15)
v_mfma_f32_16x16x32_bf16 v[208:211], v[32:35], v[48:51], v[208:211]
ds_read_b64_tr_b16 v[82:83], v120 offset:41984
v_mfma_f32_16x16x32_bf16 v[240:243], v[32:35], v[52:55], v[240:243]
ds_read_b64_tr_b16 v[84:85], v121 offset:40960
v_mfma_f32_16x16x32_bf16 v[212:215], v[36:39], v[48:51], v[212:215]
ds_read_b64_tr_b16 v[86:87], v121 offset:41984
ds_read_b64_tr_b16 v[88:89], v122 offset:40960
s_add_u32 s44, s40, 24576
s_cmp_eq_u32 s3, 0
s_cbranch_scc1 L_sst62
buffer_store_dwordx4 v[184:187], v2, s[20:23], s44 offen offset:2048
L_sstr62:
v_mfma_f32_16x16x32_bf16 v[244:247], v[36:39], v[52:55], v[244:247]
ds_read_b64_tr_b16 v[90:91], v122 offset:41984
s_waitcnt lgkmcnt(15)
v_mfma_f32_16x16x32_bf16 v[216:219], v[40:43], v[48:51], v[216:219]
ds_read_b64_tr_b16 v[92:93], v123 offset:40960
v_mfma_f32_16x16x32_bf16 v[248:251], v[40:43], v[52:55], v[248:251]
ds_read_b64_tr_b16 v[94:95], v123 offset:41984
s_add_u32 s44, s40, 24576
s_cmp_eq_u32 s3, 0
s_cbranch_scc1 L_sst63
buffer_store_dwordx4 v[188:191], v2, s[20:23], s44 offen offset:3072
L_sstr63:
v_mfma_f32_16x16x32_bf16 v[220:223], v[44:47], v[48:51], v[220:223]
v_mfma_f32_16x16x32_bf16 v[252:255], v[44:47], v[52:55], v[252:255]
s_waitcnt vmcnt(15) lgkmcnt(0)
s_barrier
v_mfma_f32_16x16x32_bf16 v[192:195], v[64:67], v[96:99], v[192:195]
ds_read_b128 v[48:51], v112 offset:0
ds_read_b128 v[52:55], v112 offset:2048
v_mov_b32 v184, 0
v_mov_b32 v185, 0
v_mov_b32 v186, 0
v_mov_b32 v187, 0
v_mfma_f32_16x16x32_bf16 v[224:227], v[64:67], v[100:103], v[224:227]
ds_read_b64_tr_b16 v[16:17], v116 offset:49152
s_add_u32 s41, s55, 0
v_add_u32 v4, s41, v2
s_mov_b32 s49, 65536
v_mfma_f32_16x16x32_bf16 v[196:199], v[68:71], v[96:99], v[196:199]
ds_read_b64_tr_b16 v[18:19], v116 offset:50176
v_mfma_f32_16x16x32_bf16 v[228:231], v[68:71], v[100:103], v[228:231]
ds_read_b64_tr_b16 v[20:21], v117 offset:49152
ds_read_b64_tr_b16 v[22:23], v117 offset:50176
v_mfma_f32_16x16x32_bf16 v[200:203], v[72:75], v[96:99], v[200:203]
ds_read_b64_tr_b16 v[24:25], v118 offset:49152
s_add_u32 m0, s49, s38
s_nop 0
buffer_load_dwordx4 v4, s[24:27], 0 offen offset:0 lds
v_mfma_f32_16x16x32_bf16 v[232:235], v[72:75], v[100:103], v[232:235]
ds_read_b64_tr_b16 v[26:27], v118 offset:50176
v_mfma_f32_16x16x32_bf16 v[204:207], v[76:79], v[96:99], v[204:207]
ds_read_b64_tr_b16 v[28:29], v119 offset:49152
v_mfma_f32_16x16x32_bf16 v[236:239], v[76:79], v[100:103], v[236:239]
ds_read_b64_tr_b16 v[30:31], v119 offset:50176
ds_read_b64_tr_b16 v[32:33], v120 offset:49152
buffer_load_dwordx4 v4, s[24:27], 0 offen offset:1024 lds
v_mfma_f32_16x16x32_bf16 v[208:211], v[80:83], v[96:99], v[208:211]
ds_read_b64_tr_b16 v[34:35], v120 offset:50176
v_mov_b32 v188, 0
v_mov_b32 v189, 0
v_mov_b32 v190, 0
v_mov_b32 v191, 0
v_mfma_f32_16x16x32_bf16 v[240:243], v[80:83], v[100:103], v[240:243]
ds_read_b64_tr_b16 v[36:37], v121 offset:49152
v_mfma_f32_16x16x32_bf16 v[212:215], v[84:87], v[96:99], v[212:215]
ds_read_b64_tr_b16 v[38:39], v121 offset:50176
ds_read_b64_tr_b16 v[40:41], v122 offset:49152
buffer_load_dwordx4 v4, s[24:27], 0 offen offset:2048 lds
v_mfma_f32_16x16x32_bf16 v[244:247], v[84:87], v[100:103], v[244:247]
ds_read_b64_tr_b16 v[42:43], v122 offset:50176
v_mfma_f32_16x16x32_bf16 v[216:219], v[88:91], v[96:99], v[216:219]
ds_read_b64_tr_b16 v[44:45], v123 offset:49152
v_mfma_f32_16x16x32_bf16 v[248:251], v[88:91], v[100:103], v[248:251]
ds_read_b64_tr_b16 v[46:47], v123 offset:50176
buffer_load_dwordx4 v4, s[24:27], 0 offen offset:3072 lds
v_mfma_f32_16x16x32_bf16 v[220:223], v[92:95], v[96:99], v[220:223]
v_mfma_f32_16x16x32_bf16 v[252:255], v[92:95], v[100:103], v[252:255]
s_waitcnt lgkmcnt(14)
v_mfma_f32_16x16x32_bf16 v[192:195], v[16:19], v[48:51], v[192:195]
ds_read_b128 v[96:99], v113 offset:0
ds_read_b128 v[100:103], v113 offset:2048
v_mfma_f32_16x16x32_bf16 v[224:227], v[16:19], v[52:55], v[224:227]
ds_read_b64_tr_b16 v[64:65], v116 offset:57344
s_add_u32 m0, m0, 4096
s_nop 0
buffer_load_dwordx4 v4, s[24:27], s50 offen offset:0 lds
s_waitcnt lgkmcnt(15)
v_mfma_f32_16x16x32_bf16 v[196:199], v[20:23], v[48:51], v[196:199]
ds_read_b64_tr_b16 v[66:67], v116 offset:58368
v_mfma_f32_16x16x32_bf16 v[228:231], v[20:23], v[52:55], v[228:231]
ds_read_b64_tr_b16 v[68:69], v117 offset:57344
ds_read_b64_tr_b16 v[70:71], v117 offset:58368
s_waitcnt lgkmcnt(15)
v_mfma_f32_16x16x32_bf16 v[200:203], v[24:27], v[48:51], v[200:203]
ds_read_b64_tr_b16 v[72:73], v118 offset:57344
buffer_load_dwordx4 v4, s[24:27], s50 offen offset:1024 lds
v_mfma_f32_16x16x32_bf16 v[232:235], v[24:27], v[52:55], v[232:235]
ds_read_b64_tr_b16 v[74:75], v118 offset:58368
s_waitcnt lgkmcnt(15)
v_mfma_f32_16x16x32_bf16 v[204:207], v[28:31], v[48:51], v[204:207]
ds_read_b64_tr_b16 v[76:77], v119 offset:57344
v_mfma_f32_16x16x32_bf16 v[236:239], v[28:31], v[52:55], v[236:239]
ds_read_b64_tr_b16 v[78:79], v119 offset:58368
ds_read_b64_tr_b16 v[80:81], v120 offset:57344
s_waitcnt lgkmcnt(15)
v_mfma_f32_16x16x32_bf16 v[208:211], v[32:35], v[48:51], v[208:211]
ds_read_b64_tr_b16 v[82:83], v120 offset:58368
buffer_load_dwordx4 v4, s[24:27], s50 offen offset:2048 lds
v_mfma_f32_16x16x32_bf16 v[240:243], v[32:35], v[52:55], v[240:243]
ds_read_b64_tr_b16 v[84:85], v121 offset:57344
v_mfma_f32_16x16x32_bf16 v[212:215], v[36:39], v[48:51], v[212:215]
ds_read_b64_tr_b16 v[86:87], v121 offset:58368
ds_read_b64_tr_b16 v[88:89], v122 offset:57344
v_mfma_f32_16x16x32_bf16 v[244:247], v[36:39], v[52:55], v[244:247]
ds_read_b64_tr_b16 v[90:91], v122 offset:58368
s_waitcnt lgkmcnt(15)
v_mfma_f32_16x16x32_bf16 v[216:219], v[40:43], v[48:51], v[216:219]
ds_read_b64_tr_b16 v[92:93], v123 offset:57344
buffer_load_dwordx4 v4, s[24:27], s50 offen offset:3072 lds
v_mfma_f32_16x16x32_bf16 v[248:251], v[40:43], v[52:55], v[248:251]
ds_read_b64_tr_b16 v[94:95], v123 offset:58368
v_mfma_f32_16x16x32_bf16 v[220:223], v[44:47], v[48:51], v[220:223]
v_mfma_f32_16x16x32_bf16 v[252:255], v[44:47], v[52:55], v[252:255]
L_qjoinB:
s_waitcnt vmcnt(16) lgkmcnt(0)
s_barrier
v_add_u32 v3, 40960, v2
v_mfma_f32_16x16x32_bf16 v[192:195], v[64:67], v[96:99], v[192:195]
ds_read_b128 v[16:19], v3 offset:0
v_mov_b32 v112, 0
v_mov_b32 v113, 0
v_mfma_f32_16x16x32_bf16 v[224:227], v[64:67], v[100:103], v[224:227]
ds_read_b128 v[20:23], v3 offset:1024
v_mov_b32 v114, 0
v_mfma_f32_16x16x32_bf16 v[196:199], v[68:71], v[96:99], v[196:199]
ds_read_b128 v[24:27], v3 offset:2048
s_add_u32 s41, s55, 32768
v_add_u32 v4, s41, v2
s_mov_b32 s49, 0
v_mov_b32 v115, 0
v_mfma_f32_16x16x32_bf16 v[228:231], v[68:71], v[100:103], v[228:231]
ds_read_b128 v[28:31], v3 offset:3072
s_add_u32 m0, s49, s38
s_nop 0
buffer_load_dwordx4 v4, s[24:27], 0 offen offset:0 lds
v_mov_b32 v116, 0
v_mfma_f32_16x16x32_bf16 v[200:203], v[72:75], v[96:99], v[200:203]
ds_read_b128 v[32:35], v3 offset:4096
v_mov_b32 v117, 0
v_mov_b32 v118, 0
v_mfma_f32_16x16x32_bf16 v[232:235], v[72:75], v[100:103], v[232:235]
ds_read_b128 v[36:39], v3 offset:5120
buffer_load_dwordx4 v4, s[24:27], 0 offen offset:1024 lds
v_mov_b32 v119, 0
v_mfma_f32_16x16x32_bf16 v[204:207], v[76:79], v[96:99], v[204:207]
ds_read_b128 v[40:43], v3 offset:6144
buffer_load_dwordx4 v4, s[24:27], 0 offen offset:2048 lds
v_mov_b32 v120, 0
v_mfma_f32_16x16x32_bf16 v[236:239], v[76:79], v[100:103], v[236:239]
ds_read_b128 v[44:47], v3 offset:7168
v_mov_b32 v121, 0
v_mfma_f32_16x16x32_bf16 v[208:211], v[80:83], v[96:99], v[208:211]
buffer_load_dwordx4 v4, s[24:27], 0 offen offset:3072 lds
v_mov_b32 v122, 0
v_mov_b32 v123, 0
v_mfma_f32_16x16x32_bf16 v[240:243], v[80:83], v[100:103], v[240:243]
s_add_u32 m0, m0, 4096
s_nop 0
buffer_load_dwordx4 v4, s[24:27], s50 offen offset:0 lds
v_mov_b32 v124, 0
v_mfma_f32_16x16x32_bf16 v[212:215], v[84:87], v[96:99], v[212:215]
v_mov_b32 v125, 0
v_mfma_f32_16x16x32_bf16 v[244:247], v[84:87], v[100:103], v[244:247]
buffer_load_dwordx4 v4, s[24:27], s50 offen offset:1024 lds
v_mov_b32 v126, 0
v_mfma_f32_16x16x32_bf16 v[216:219], v[88:91], v[96:99], v[216:219]
buffer_load_dwordx4 v4, s[24:27], s50 offen offset:2048 lds
v_mov_b32 v127, 0
v_mov_b32 v8, 0x3f803f80
v_mfma_f32_16x16x32_bf16 v[248:251], v[88:91], v[100:103], v[248:251]
v_mov_b32 v9, 0x3f803f80
v_mfma_f32_16x16x32_bf16 v[220:223], v[92:95], v[96:99], v[220:223]
buffer_load_dwordx4 v4, s[24:27], s50 offen offset:3072 lds
v_mov_b32 v10, 0x3f803f80
v_mfma_f32_16x16x32_bf16 v[252:255], v[92:95], v[100:103], v[252:255]
v_mov_b32 v11, 0x3f803f80
v_add_u32 v4, 0x4000, v4
s_add_u32 s49, s49, 32768
s_and_b32 s49, s49, 0x1ffff
s_mov_b32 s64, 0x4e800000
s_lshr_b32 s55, s34, 15
s_lshl_b32 s41, s31, 1
s_sub_u32 s67, 31, s41
s_mov_b32 s65, 3
s_mov_b32 s66, 1
s_mov_b32 s72, 1
s_lshl_b32 s41, s32, 8
s_add_u32 s41, s41, 131072
v_lshlrev_b32 v0, 2, v1
v_add_u32 v0, s41, v0
v_and_b32 v1, 3, v1
v_lshlrev_b32 v1, 8, v1
v_add_u32 v1, 131072, v1
s_mov_b32 s48, 65536
v_mov_b32 v88, 0
v_mov_b32 v89, 0
v_mov_b32 v90, 0
v_mov_b32 v91, 0
v_mov_b32 v92, 0
v_mov_b32 v93, 0
v_mov_b32 v94, 0
v_mov_b32 v95, 0
v_cvt_pk_bf16_f32 v192, v192, v193
v_cvt_pk_bf16_f32 v193, v194, v195
v_cvt_pk_bf16_f32 v194, v196, v197
v_cvt_pk_bf16_f32 v195, v198, v199
v_cvt_pk_bf16_f32 v196, v200, v201
v_cvt_pk_bf16_f32 v197, v202, v203
v_cvt_pk_bf16_f32 v198, v204, v205
v_cvt_pk_bf16_f32 v199, v206, v207
v_cvt_pk_bf16_f32 v200, v208, v209
v_cvt_pk_bf16_f32 v201, v210, v211
v_cvt_pk_bf16_f32 v202, v212, v213
v_cvt_pk_bf16_f32 v203, v214, v215
v_cvt_pk_bf16_f32 v204, v216, v217
v_cvt_pk_bf16_f32 v205, v218, v219
v_cvt_pk_bf16_f32 v206, v220, v221
v_cvt_pk_bf16_f32 v207, v222, v223
v_cvt_pk_bf16_f32 v208, v224, v225
v_cvt_pk_bf16_f32 v209, v226, v227
v_cvt_pk_bf16_f32 v210, v228, v229
v_cvt_pk_bf16_f32 v211, v230, v231
v_cvt_pk_bf16_f32 v212, v232, v233
v_cvt_pk_bf16_f32 v213, v234, v235
v_cvt_pk_bf16_f32 v214, v236, v237
v_cvt_pk_bf16_f32 v215, v238, v239
v_cvt_pk_bf16_f32 v216, v240, v241
v_cvt_pk_bf16_f32 v217, v242, v243
v_cvt_pk_bf16_f32 v218, v244, v245
v_cvt_pk_bf16_f32 v219, v246, v247
v_cvt_pk_bf16_f32 v220, v248, v249
v_cvt_pk_bf16_f32 v221, v250, v251
v_cvt_pk_bf16_f32 v222, v252, v253
v_cvt_pk_bf16_f32 v223, v254, v255
s_sub_u32 s45, s55, 1
s_mov_b32 s46, 0
s_cmp_lg_u32 s55, 0
s_cbranch_scc1 L_nmB
v_mov_b32 v7, 0xf149f2ca
v_cndmask_b32 v112, v112, v7, s[56:57]
v_cndmask_b32 v124, v124, v7, s[56:57]
v_mov_b32 v116, v7
v_cndmask_b32 v113, v113, v7, s[58:59]
v_cndmask_b32 v125, v125, v7, s[58:59]
v_mov_b32 v117, v7
v_cndmask_b32 v114, v114, v7, s[60:61]
v_cndmask_b32 v126, v126, v7, s[60:61]
v_mov_b32 v118, v7
v_cndmask_b32 v115, v115, v7, s[62:63]
v_cndmask_b32 v127, v127, v7, s[62:63]
v_mov_b32 v119, v7
s_nop 1
s_mov_b32 s45, 0
s_mov_b32 s46, 1
L_nmB:
s_nop 1
s_waitcnt lgkmcnt(7)
v_mfma_f32_16x16x32_bf16 v[224:227], v[16:19], v[192:195], v[112:115]
v_mfma_f32_16x16x32_bf16 v[232:235], v[16:19], v[208:211], v[120:123]
s_waitcnt lgkmcnt(6)
v_mfma_f32_16x16x32_bf16 v[224:227], v[20:23], v[196:199], v[224:227]
v_mfma_f32_16x16x32_bf16 v[232:235], v[20:23], v[212:215], v[232:235]
s_waitcnt lgkmcnt(5)
v_mfma_f32_16x16x32_bf16 v[224:227], v[24:27], v[200:203], v[224:227]
v_mfma_f32_16x16x32_bf16 v[232:235], v[24:27], v[216:219], v[232:235]
s_waitcnt lgkmcnt(4)
v_mfma_f32_16x16x32_bf16 v[224:227], v[28:31], v[204:207], v[224:227]
v_mfma_f32_16x16x32_bf16 v[232:235], v[28:31], v[220:223], v[232:235]
s_waitcnt lgkmcnt(3)
v_mfma_f32_16x16x32_bf16 v[228:231], v[32:35], v[192:195], v[116:119]
v_mfma_f32_16x16x32_bf16 v[236:239], v[32:35], v[208:211], v[124:127]
s_waitcnt lgkmcnt(2)
v_mfma_f32_16x16x32_bf16 v[228:231], v[36:39], v[196:199], v[228:231]
v_mfma_f32_16x16x32_bf16 v[236:239], v[36:39], v[212:215], v[236:239]
s_waitcnt lgkmcnt(1)
v_mfma_f32_16x16x32_bf16 v[228:231], v[40:43], v[200:203], v[228:231]
v_mfma_f32_16x16x32_bf16 v[236:239], v[40:43], v[216:219], v[236:239]
s_waitcnt lgkmcnt(0)
v_mfma_f32_16x16x32_bf16 v[228:231], v[44:47], v[204:207], v[228:231]
v_mfma_f32_16x16x32_bf16 v[236:239], v[44:47], v[220:223], v[236:239]
s_nop 5
v_max3_f32 v5, v224, v225, v226
v_max3_f32 v6, v232, v233, v234
v_max3_f32 v5, v5, v227, v228
v_max3_f32 v6, v6, v235, v236
v_max3_f32 v5, v5, v229, v230
v_max3_f32 v6, v6, v237, v238
v_max_f32 v5, v5, v231
v_max_f32 v6, v6, v239
v_mov_b32 v7, v5
v_mov_b32 v15, v6
s_nop 0
v_permlane16_swap_b32 v5, v7
v_permlane16_swap_b32 v6, v15
s_nop 0
v_max_f32 v5, v5, v7
v_max_f32 v6, v6, v15
v_mov_b32 v7, v5
v_mov_b32 v15, v6
s_nop 0
v_permlane32_swap_b32 v5, v7
v_permlane32_swap_b32 v6, v15
s_nop 0
v_max_f32 v5, v5, v7
v_max_f32 v6, v6, v15
v_ceil_f32 v5, v5
v_ceil_f32 v6, v6
v_sub_f32 v224, v224, v5
v_sub_f32 v225, v225, v5
v_sub_f32 v226, v226, v5
v_sub_f32 v227, v227, v5
v_sub_f32 v228, v228, v5
v_sub_f32 v229, v229, v5
v_sub_f32 v230, v230, v5
v_sub_f32 v231, v231, v5
v_sub_f32 v232, v232, v6
v_sub_f32 v233, v233, v6
v_sub_f32 v234, v234, v6
v_sub_f32 v235, v235, v6
v_sub_f32 v236, v236, v6
v_sub_f32 v237, v237, v6
v_sub_f32 v238, v238, v6
v_sub_f32 v239, v239, v6
v_exp_f32 v12, v224
v_exp_f32 v13, v225
v_sub_f32 v112, v112, v5
v_sub_f32 v113, v113, v5
v_cvt_pk_bf16_f32 v96, v12, v13
v_exp_f32 v14, v226
v_exp_f32 v15, v227
v_sub_f32 v114, v114, v5
v_sub_f32 v115, v115, v5
v_cvt_pk_bf16_f32 v97, v14, v15
v_exp_f32 v12, v228
v_exp_f32 v13, v229
v_sub_f32 v116, v116, v5
v_sub_f32 v117, v117, v5
v_cvt_pk_bf16_f32 v98, v12, v13
v_exp_f32 v14, v230
v_exp_f32 v15, v231
v_sub_f32 v118, v118, v5
v_sub_f32 v119, v119, v5
v_cvt_pk_bf16_f32 v99, v14, v15
v_exp_f32 v12, v232
v_exp_f32 v13, v233
v_sub_f32 v120, v120, v6
v_sub_f32 v121, v121, v6
v_cvt_pk_bf16_f32 v100, v12, v13
v_exp_f32 v14, v234
v_sub_f32 v122, v122, v6
v_sub_f32 v123, v123, v6
v_sub_f32 v124, v124, v6
v_sub_f32 v125, v125, v6
v_sub_f32 v126, v126, v6
v_sub_f32 v127, v127, v6
v_mov_b32 v5, 1
ds_write_b32 v0, v5
s_waitcnt vmcnt(8)
s_waitcnt vmcnt(8)
v_mov_b32 v6, 3
ds_write_b32 v0, v6 offset:1024
v_mov_b32 v6, 134144
v_mov_b32 v7, 0
ds_write_b32 v6, v7
ds_write_b32 v6, v7 offset:4
ds_write_b32 v6, v7 offset:512
s_waitcnt lgkmcnt(0)
s_barrier
v_add_u32 v3, s48, v2
ds_read_b128 v[16:19], v3 offset:0
ds_read_b128 v[20:23], v3 offset:1024
ds_read_b128 v[24:27], v3 offset:2048
ds_read_b128 v[28:31], v3 offset:3072
ds_read_b128 v[32:35], v3 offset:4096
ds_read_b128 v[36:39], v3 offset:5120
ds_read_b128 v[40:43], v3 offset:6144
ds_read_b128 v[44:47], v3 offset:7168
s_setprio 1
L_loopB:
s_sub_u32 s45, s45, 1
s_cbranch_scc1 L_X0B
L_it0B:
s_waitcnt lgkmcnt(4)
v_mfma_f32_16x16x32_bf16 v[240:243], v[16:19], v[192:195], v[112:115]
ds_read_b128 v[48:51], v3 offset:16384
v_exp_f32 v15, v235
v_mfma_f32_16x16x32_bf16 v[248:251], v[16:19], v[208:211], v[120:123]
v_cvt_pk_bf16_f32 v101, v14, v15
v_mfma_f32_16x16x32_bf16 v[80:83], v[8:11], v[96:99], v[88:91]
v_exp_f32 v12, v236
v_mfma_f32_16x16x32_bf16 v[240:243], v[20:23], v[196:199], v[240:243]
ds_read_b128 v[52:55], v3 offset:17408
v_mfma_f32_16x16x32_bf16 v[248:251], v[20:23], v[212:215], v[248:251]
v_exp_f32 v13, v237
v_mfma_f32_16x16x32_bf16 v[240:243], v[24:27], v[200:203], v[240:243]
ds_read_b128 v[56:59], v3 offset:18432
v_cvt_pk_bf16_f32 v102, v12, v13
v_mfma_f32_16x16x32_bf16 v[248:251], v[24:27], v[216:219], v[248:251]
v_exp_f32 v14, v238
v_mfma_f32_16x16x32_bf16 v[240:243], v[28:31], v[204:207], v[240:243]
ds_read_b128 v[60:63], v3 offset:19456
v_mfma_f32_16x16x32_bf16 v[248:251], v[28:31], v[220:223], v[248:251]
v_exp_f32 v15, v239
s_waitcnt lgkmcnt(4)
v_mfma_f32_16x16x32_bf16 v[244:247], v[32:35], v[192:195], v[116:119]
ds_read_b128 v[64:67], v3 offset:20480
v_cvt_pk_bf16_f32 v103, v14, v15
v_mfma_f32_16x16x32_bf16 v[252:255], v[32:35], v[208:211], v[124:127]
v_mfma_f32_16x16x32_bf16 v[244:247], v[36:39], v[196:199], v[244:247]
ds_read_b128 v[68:71], v3 offset:21504
v_exp_f32 v12, v240
v_mfma_f32_16x16x32_bf16 v[84:87], v[8:11], v[100:103], v[92:95]
v_mfma_f32_16x16x32_bf16 v[252:255], v[36:39], v[212:215], v[252:255]
v_exp_f32 v13, v241
v_mfma_f32_16x16x32_bf16 v[244:247], v[40:43], v[200:203], v[244:247]
ds_read_b128 v[72:75], v3 offset:22528
v_cvt_pk_bf16_f32 v104, v12, v13
v_mfma_f32_16x16x32_bf16 v[252:255], v[40:43], v[216:219], v[252:255]
v_exp_f32 v14, v242
v_mfma_f32_16x16x32_bf16 v[244:247], v[44:47], v[204:207], v[244:247]
ds_read_b128 v[76:79], v3 offset:23552
v_max_f32 v5, v80, v84
v_cmp_lt_f32 vcc, s64, v5
v_mfma_f32_16x16x32_bf16 v[252:255], v[44:47], v[220:223], v[252:255]
v_exp_f32 v15, v243
s_cbranch_vccnz L_slow0B
L_ret0B:
s_waitcnt lgkmcnt(4)
v_mfma_f32_16x16x32_bf16 v[128:131], v[48:51], v[96:99], v[128:131]
ds_read_b128 v[16:19], v3 offset:8192
v_cvt_pk_bf16_f32 v105, v14, v15
v_mfma_f32_16x16x32_bf16 v[160:163], v[48:51], v[100:103], v[160:163]
v_exp_f32 v12, v244
v_mfma_f32_16x16x32_bf16 v[132:135], v[52:55], v[96:99], v[132:135]
ds_read_b128 v[20:23], v3 offset:9216
v_mfma_f32_16x16x32_bf16 v[164:167], v[52:55], v[100:103], v[164:167]
v_exp_f32 v13, v245
v_mfma_f32_16x16x32_bf16 v[136:139], v[56:59], v[96:99], v[136:139]
ds_read_b128 v[24:27], v3 offset:10240
v_cvt_pk_bf16_f32 v106, v12, v13
v_mfma_f32_16x16x32_bf16 v[168:171], v[56:59], v[100:103], v[168:171]
v_exp_f32 v14, v246
v_mfma_f32_16x16x32_bf16 v[140:143], v[60:63], v[96:99], v[140:143]
ds_read_b128 v[28:31], v3 offset:11264
v_mfma_f32_16x16x32_bf16 v[172:175], v[60:63], v[100:103], v[172:175]
v_exp_f32 v15, v247
s_waitcnt lgkmcnt(4)
v_mfma_f32_16x16x32_bf16 v[144:147], v[64:67], v[96:99], v[144:147]
ds_read_b128 v[32:35], v3 offset:12288
v_cvt_pk_bf16_f32 v107, v14, v15
v_mfma_f32_16x16x32_bf16 v[176:179], v[64:67], v[100:103], v[176:179]
v_exp_f32 v12, v248
v_mfma_f32_16x16x32_bf16 v[148:151], v[68:71], v[96:99], v[148:151]
ds_read_b128 v[36:39], v3 offset:13312
v_mfma_f32_16x16x32_bf16 v[180:183], v[68:71], v[100:103], v[180:183]
v_exp_f32 v13, v249
v_mfma_f32_16x16x32_bf16 v[152:155], v[72:75], v[96:99], v[152:155]
ds_read_b128 v[40:43], v3 offset:14336
v_cvt_pk_bf16_f32 v108, v12, v13
v_mfma_f32_16x16x32_bf16 v[184:187], v[72:75], v[100:103], v[184:187]
v_exp_f32 v14, v250
v_mfma_f32_16x16x32_bf16 v[156:159], v[76:79], v[96:99], v[156:159]
ds_read_b128 v[44:47], v3 offset:15360
v_mfma_f32_16x16x32_bf16 v[188:191], v[76:79], v[100:103], v[188:191]
s_sub_u32 s45, s45, 1
s_cbranch_scc1 L_X1B
L_it1B:
s_waitcnt lgkmcnt(4)
v_mfma_f32_16x16x32_bf16 v[224:227], v[16:19], v[192:195], v[112:115]
ds_read_b128 v[48:51], v3 offset:24576
v_exp_f32 v15, v251
v_mfma_f32_16x16x32_bf16 v[232:235], v[16:19], v[208:211], v[120:123]
v_cvt_pk_bf16_f32 v109, v14, v15
v_mfma_f32_16x16x32_bf16 v[88:91], v[8:11], v[104:107], v[80:83]
v_exp_f32 v12, v252
v_mfma_f32_16x16x32_bf16 v[224:227], v[20:23], v[196:199], v[224:227]
ds_read_b128 v[52:55], v3 offset:25600
v_mfma_f32_16x16x32_bf16 v[232:235], v[20:23], v[212:215], v[232:235]
v_exp_f32 v13, v253
ds_read_b32 v5, v1 offset:2048
v_mfma_f32_16x16x32_bf16 v[224:227], v[24:27], v[200:203], v[224:227]
ds_read_b128 v[56:59], v3 offset:26624
v_cvt_pk_bf16_f32 v110, v12, v13
ds_read2st64_b32 v[6:7], v1 offset0:0 offset1:4
v_mfma_f32_16x16x32_bf16 v[232:235], v[24:27], v[216:219], v[232:235]
v_exp_f32 v14, v254
v_mfma_f32_16x16x32_bf16 v[224:227], v[28:31], v[204:207], v[224:227]
ds_read_b128 v[60:63], v3 offset:27648
v_mfma_f32_16x16x32_bf16 v[232:235], v[28:31], v[220:223], v[232:235]
v_exp_f32 v15, v255
s_waitcnt lgkmcnt(6)
v_mfma_f32_16x16x32_bf16 v[228:231], v[32:35], v[192:195], v[116:119]
ds_read_b128 v[64:67], v3 offset:28672
v_cvt_pk_bf16_f32 v111, v14, v15
v_mfma_f32_16x16x32_bf16 v[236:239], v[32:35], v[208:211], v[124:127]
v_mfma_f32_16x16x32_bf16 v[228:231], v[36:39], v[196:199], v[228:231]
ds_read_b128 v[68:71], v3 offset:29696
v_exp_f32 v12, v224
v_mfma_f32_16x16x32_bf16 v[92:95], v[8:11], v[108:111], v[84:87]
v_mfma_f32_16x16x32_bf16 v[236:239], v[36:39], v[212:215], v[236:239]
v_exp_f32 v13, v225
s_waitcnt lgkmcnt(5)
v_cmp_gt_u32 s[68:69], s65, v5
s_waitcnt lgkmcnt(3)
v_min_u32 v6, v6, v7
v_mfma_f32_16x16x32_bf16 v[228:231], v[40:43], v[200:203], v[228:231]
ds_read_b128 v[72:75], v3 offset:30720
v_cvt_pk_bf16_f32 v96, v12, v13
v_cmp_gt_u32 s[70:71], s66, v6
v_mfma_f32_16x16x32_bf16 v[236:239], v[40:43], v[216:219], v[236:239]
v_exp_f32 v14, v226
v_mfma_f32_16x16x32_bf16 v[228:231], v[44:47], v[204:207], v[228:231]
ds_read_b128 v[76:79], v3 offset:31744
v_max_f32 v5, v88, v92
v_cmp_lt_f32 vcc, s64, v5
s_or_b64 s[68:69], s[68:69], s[70:71]
v_mfma_f32_16x16x32_bf16 v[236:239], v[44:47], v[220:223], v[236:239]
v_exp_f32 v15, v227
s_or_b64 vcc, vcc, s[68:69]
s_cbranch_scc1 L_slow1B
L_ret1B:
s_add_u32 s48, s48, 32768
s_and_b32 s48, s48, 0x1ffff
v_add_u32 v3, s48, v2
s_waitcnt lgkmcnt(4)
v_mfma_f32_16x16x32_bf16 v[128:131], v[48:51], v[104:107], v[128:131]
ds_read_b128 v[16:19], v3 offset:0
v_cvt_pk_bf16_f32 v97, v14, v15
s_add_u32 m0, s49, s38
s_nop 0
buffer_load_dwordx4 v4, s[24:27], 0 offen offset:0 lds
v_mfma_f32_16x16x32_bf16 v[160:163], v[48:51], v[108:111], v[160:163]
v_exp_f32 v12, v228
v_mfma_f32_16x16x32_bf16 v[132:135], v[52:55], v[104:107], v[132:135]
ds_read_b128 v[20:23], v3 offset:1024
buffer_load_dwordx4 v4, s[24:27], 0 offen offset:1024 lds
v_mfma_f32_16x16x32_bf16 v[164:167], v[52:55], v[108:111], v[164:167]
v_exp_f32 v13, v229
v_mfma_f32_16x16x32_bf16 v[136:139], v[56:59], v[104:107], v[136:139]
ds_read_b128 v[24:27], v3 offset:2048
v_cvt_pk_bf16_f32 v98, v12, v13
buffer_load_dwordx4 v4, s[24:27], 0 offen offset:2048 lds
v_mfma_f32_16x16x32_bf16 v[168:171], v[56:59], v[108:111], v[168:171]
v_exp_f32 v14, v230
v_mfma_f32_16x16x32_bf16 v[140:143], v[60:63], v[104:107], v[140:143]
ds_read_b128 v[28:31], v3 offset:3072
buffer_load_dwordx4 v4, s[24:27], 0 offen offset:3072 lds
v_mfma_f32_16x16x32_bf16 v[172:175], v[60:63], v[108:111], v[172:175]
v_exp_f32 v15, v231
s_waitcnt lgkmcnt(4)
v_mfma_f32_16x16x32_bf16 v[144:147], v[64:67], v[104:107], v[144:147]
ds_read_b128 v[32:35], v3 offset:4096
s_sub_u32 s41, s65, 1
v_mov_b32 v6, s41
ds_write_b32 v0, v6
s_add_u32 s65, s65, 1
v_cvt_pk_bf16_f32 v99, v14, v15
s_add_u32 m0, m0, 4096
s_nop 0
buffer_load_dwordx4 v4, s[24:27], s50 offen offset:0 lds
v_mfma_f32_16x16x32_bf16 v[176:179], v[64:67], v[108:111], v[176:179]
v_exp_f32 v12, v232
v_mfma_f32_16x16x32_bf16 v[148:151], v[68:71], v[104:107], v[148:151]
ds_read_b128 v[36:39], v3 offset:5120
buffer_load_dwordx4 v4, s[24:27], s50 offen offset:1024 lds
v_mfma_f32_16x16x32_bf16 v[180:183], v[68:71], v[108:111], v[180:183]
v_exp_f32 v13, v233
v_mfma_f32_16x16x32_bf16 v[152:155], v[72:75], v[104:107], v[152:155]
ds_read_b128 v[40:43], v3 offset:6144
v_cvt_pk_bf16_f32 v100, v12, v13
buffer_load_dwordx4 v4, s[24:27], s50 offen offset:2048 lds
v_mfma_f32_16x16x32_bf16 v[184:187], v[72:75], v[108:111], v[184:187]
v_exp_f32 v14, v234
v_mfma_f32_16x16x32_bf16 v[156:159], v[76:79], v[104:107], v[156:159]
ds_read_b128 v[44:47], v3 offset:7168
buffer_load_dwordx4 v4, s[24:27], s50 offen offset:3072 lds
v_mfma_f32_16x16x32_bf16 v[188:191], v[76:79], v[108:111], v[188:191]
v_add_u32 v4, 0x4000, v4
s_add_u32 s49, s49, 32768
s_and_b32 s49, s49, 0x1ffff
s_waitcnt vmcnt(8)
v_mov_b32 v6, s65
ds_write_b32 v0, v6 offset:1024
s_add_u32 s66, s66, 1
s_cmp_eq_u32 s65, 7
s_cselect_b32 s66, 0x7fffffff, s66
s_sub_u32 s45, s45, 1
s_cbranch_scc1 L_X2B
L_it2B:
s_waitcnt lgkmcnt(6)
v_mfma_f32_16x16x32_bf16 v[240:243], v[16:19], v[192:195], v[112:115]
ds_read_b128 v[48:51], v3 offset:16384
v_exp_f32 v15, v235
v_mfma_f32_16x16x32_bf16 v[248:251], v[16:19], v[208:211], v[120:123]
v_cvt_pk_bf16_f32 v101, v14, v15
v_mfma_f32_16x16x32_bf16 v[80:83], v[8:11], v[96:99], v[88:91]
v_exp_f32 v12, v236
v_mfma_f32_16x16x32_bf16 v[240:243], v[20:23], v[196:199], v[240:243]
ds_read_b128 v[52:55], v3 offset:17408
v_mfma_f32_16x16x32_bf16 v[248:251], v[20:23], v[212:215], v[248:251]
v_exp_f32 v13, v237
v_mfma_f32_16x16x32_bf16 v[240:243], v[24:27], v[200:203], v[240:243]
ds_read_b128 v[56:59], v3 offset:18432
v_cvt_pk_bf16_f32 v102, v12, v13
v_mfma_f32_16x16x32_bf16 v[248:251], v[24:27], v[216:219], v[248:251]
v_exp_f32 v14, v238
v_mfma_f32_16x16x32_bf16 v[240:243], v[28:31], v[204:207], v[240:243]
ds_read_b128 v[60:63], v3 offset:19456
v_mfma_f32_16x16x32_bf16 v[248:251], v[28:31], v[220:223], v[248:251]
v_exp_f32 v15, v239
s_waitcnt lgkmcnt(5)
v_mfma_f32_16x16x32_bf16 v[244:247], v[32:35], v[192:195], v[116:119]
ds_read_b128 v[64:67], v3 offset:20480
v_cvt_pk_bf16_f32 v103, v14, v15
v_mfma_f32_16x16x32_bf16 v[252:255], v[32:35], v[208:211], v[124:127]
v_mfma_f32_16x16x32_bf16 v[244:247], v[36:39], v[196:199], v[244:247]
ds_read_b128 v[68:71], v3 offset:21504
v_exp_f32 v12, v240
v_mfma_f32_16x16x32_bf16 v[84:87], v[8:11], v[100:103], v[92:95]
v_mfma_f32_16x16x32_bf16 v[252:255], v[36:39], v[212:215], v[252:255]
v_exp_f32 v13, v241
v_mfma_f32_16x16x32_bf16 v[244:247], v[40:43], v[200:203], v[244:247]
ds_read_b128 v[72:75], v3 offset:22528
v_cvt_pk_bf16_f32 v104, v12, v13
v_mfma_f32_16x16x32_bf16 v[252:255], v[40:43], v[216:219], v[252:255]
v_exp_f32 v14, v242
v_mfma_f32_16x16x32_bf16 v[244:247], v[44:47], v[204:207], v[244:247]
ds_read_b128 v[76:79], v3 offset:23552
v_max_f32 v5, v80, v84
v_cmp_lt_f32 vcc, s64, v5
v_mfma_f32_16x16x32_bf16 v[252:255], v[44:47], v[220:223], v[252:255]
v_exp_f32 v15, v243
s_cbranch_vccnz L_slow2B
L_ret2B:
s_waitcnt lgkmcnt(4)
v_mfma_f32_16x16x32_bf16 v[128:131], v[48:51], v[96:99], v[128:131]
ds_read_b128 v[16:19], v3 offset:8192
v_cvt_pk_bf16_f32 v105, v14, v15
v_mfma_f32_16x16x32_bf16 v[160:163], v[48:51], v[100:103], v[160:163]
v_exp_f32 v12, v244
v_mfma_f32_16x16x32_bf16 v[132:135], v[52:55], v[96:99], v[132:135]
ds_read_b128 v[20:23], v3 offset:9216
v_mfma_f32_16x16x32_bf16 v[164:167], v[52:55], v[100:103], v[164:167]
v_exp_f32 v13, v245
v_mfma_f32_16x16x32_bf16 v[136:139], v[56:59], v[96:99], v[136:139]
ds_read_b128 v[24:27], v3 offset:10240
v_cvt_pk_bf16_f32 v106, v12, v13
v_mfma_f32_16x16x32_bf16 v[168:171], v[56:59], v[100:103], v[168:171]
v_exp_f32 v14, v246
v_mfma_f32_16x16x32_bf16 v[140:143], v[60:63], v[96:99], v[140:143]
ds_read_b128 v[28:31], v3 offset:11264
v_mfma_f32_16x16x32_bf16 v[172:175], v[60:63], v[100:103], v[172:175]
v_exp_f32 v15, v247
s_waitcnt lgkmcnt(4)
v_mfma_f32_16x16x32_bf16 v[144:147], v[64:67], v[96:99], v[144:147]
ds_read_b128 v[32:35], v3 offset:12288
v_cvt_pk_bf16_f32 v107, v14, v15
v_mfma_f32_16x16x32_bf16 v[176:179], v[64:67], v[100:103], v[176:179]
v_exp_f32 v12, v248
v_mfma_f32_16x16x32_bf16 v[148:151], v[68:71], v[96:99], v[148:151]
ds_read_b128 v[36:39], v3 offset:13312
v_mfma_f32_16x16x32_bf16 v[180:183], v[68:71], v[100:103], v[180:183]
v_exp_f32 v13, v249
v_mfma_f32_16x16x32_bf16 v[152:155], v[72:75], v[96:99], v[152:155]
ds_read_b128 v[40:43], v3 offset:14336
v_cvt_pk_bf16_f32 v108, v12, v13
v_mfma_f32_16x16x32_bf16 v[184:187], v[72:75], v[100:103], v[184:187]
v_exp_f32 v14, v250
v_mfma_f32_16x16x32_bf16 v[156:159], v[76:79], v[96:99], v[156:159]
ds_read_b128 v[44:47], v3 offset:15360
v_mfma_f32_16x16x32_bf16 v[188:191], v[76:79], v[100:103], v[188:191]
s_sub_u32 s45, s45, 1
s_cbranch_scc1 L_X3B
L_it3B:
s_waitcnt lgkmcnt(4)
v_mfma_f32_16x16x32_bf16 v[224:227], v[16:19], v[192:195], v[112:115]
ds_read_b128 v[48:51], v3 offset:24576
v_exp_f32 v15, v251
v_mfma_f32_16x16x32_bf16 v[232:235], v[16:19], v[208:211], v[120:123]
v_cvt_pk_bf16_f32 v109, v14, v15
v_mfma_f32_16x16x32_bf16 v[88:91], v[8:11], v[104:107], v[80:83]
v_exp_f32 v12, v252
v_mfma_f32_16x16x32_bf16 v[224:227], v[20:23], v[196:199], v[224:227]
ds_read_b128 v[52:55], v3 offset:25600
v_mfma_f32_16x16x32_bf16 v[232:235], v[20:23], v[212:215], v[232:235]
v_exp_f32 v13, v253
ds_read_b32 v5, v1 offset:2048
v_mfma_f32_16x16x32_bf16 v[224:227], v[24:27], v[200:203], v[224:227]
ds_read_b128 v[56:59], v3 offset:26624
v_cvt_pk_bf16_f32 v110, v12, v13
ds_read2st64_b32 v[6:7], v1 offset0:0 offset1:4
v_mfma_f32_16x16x32_bf16 v[232:235], v[24:27], v[216:219], v[232:235]
v_exp_f32 v14, v254
v_mfma_f32_16x16x32_bf16 v[224:227], v[28:31], v[204:207], v[224:227]
ds_read_b128 v[60:63], v3 offset:27648
v_mfma_f32_16x16x32_bf16 v[232:235], v[28:31], v[220:223], v[232:235]
v_exp_f32 v15, v255
s_waitcnt lgkmcnt(6)
v_mfma_f32_16x16x32_bf16 v[228:231], v[32:35], v[192:195], v[116:119]
ds_read_b128 v[64:67], v3 offset:28672
v_cvt_pk_bf16_f32 v111, v14, v15
v_mfma_f32_16x16x32_bf16 v[236:239], v[32:35], v[208:211], v[124:127]
v_mfma_f32_16x16x32_bf16 v[228:231], v[36:39], v[196:199], v[228:231]
ds_read_b128 v[68:71], v3 offset:29696
v_exp_f32 v12, v224
v_mfma_f32_16x16x32_bf16 v[92:95], v[8:11], v[108:111], v[84:87]
v_mfma_f32_16x16x32_bf16 v[236:239], v[36:39], v[212:215], v[236:239]
v_exp_f32 v13, v225
s_waitcnt lgkmcnt(5)
v_cmp_gt_u32 s[68:69], s65, v5
s_waitcnt lgkmcnt(3)
v_min_u32 v6, v6, v7
v_mfma_f32_16x16x32_bf16 v[228:231], v[40:43], v[200:203], v[228:231]
ds_read_b128 v[72:75], v3 offset:30720
v_cvt_pk_bf16_f32 v96, v12, v13
v_cmp_gt_u32 s[70:71], s66, v6
v_mfma_f32_16x16x32_bf16 v[236:239], v[40:43], v[216:219], v[236:239]
v_exp_f32 v14, v226
v_mfma_f32_16x16x32_bf16 v[228:231], v[44:47], v[204:207], v[228:231]
ds_read_b128 v[76:79], v3 offset:31744
v_max_f32 v5, v88, v92
v_cmp_lt_f32 vcc, s64, v5
s_or_b64 s[68:69], s[68:69], s[70:71]
v_mfma_f32_16x16x32_bf16 v[236:239], v[44:47], v[220:223], v[236:239]
v_exp_f32 v15, v227
s_or_b64 vcc, vcc, s[68:69]
s_cbranch_scc1 L_slow3B
L_ret3B:
s_add_u32 s48, s48, 32768
s_and_b32 s48, s48, 0x1ffff
v_add_u32 v3, s48, v2
s_waitcnt lgkmcnt(4)
v_mfma_f32_16x16x32_bf16 v[128:131], v[48:51], v[104:107], v[128:131]
ds_read_b128 v[16:19], v3 offset:0
v_cvt_pk_bf16_f32 v97, v14, v15
s_add_u32 m0, s49, s38
s_nop 0
buffer_load_dwordx4 v4, s[24:27], 0 offen offset:0 lds
v_mfma_f32_16x16x32_bf16 v[160:163], v[48:51], v[108:111], v[160:163]
v_exp_f32 v12, v228
v_mfma_f32_16x16x32_bf16 v[132:135], v[52:55], v[104:107], v[132:135]
ds_read_b128 v[20:23], v3 offset:1024
buffer_load_dwordx4 v4, s[24:27], 0 offen offset:1024 lds
v_mfma_f32_16x16x32_bf16 v[164:167], v[52:55], v[108:111], v[164:167]
v_exp_f32 v13, v229
v_mfma_f32_16x16x32_bf16 v[136:139], v[56:59], v[104:107], v[136:139]
ds_read_b128 v[24:27], v3 offset:2048
v_cvt_pk_bf16_f32 v98, v12, v13
buffer_load_dwordx4 v4, s[24:27], 0 offen offset:2048 lds
v_mfma_f32_16x16x32_bf16 v[168:171], v[56:59], v[108:111], v[168:171]
v_exp_f32 v14, v230
v_mfma_f32_16x16x32_bf16 v[140:143], v[60:63], v[104:107], v[140:143]
ds_read_b128 v[28:31], v3 offset:3072
buffer_load_dwordx4 v4, s[24:27], 0 offen offset:3072 lds
v_mfma_f32_16x16x32_bf16 v[172:175], v[60:63], v[108:111], v[172:175]
v_exp_f32 v15, v231
s_waitcnt lgkmcnt(4)
v_mfma_f32_16x16x32_bf16 v[144:147], v[64:67], v[104:107], v[144:147]
ds_read_b128 v[32:35], v3 offset:4096
s_sub_u32 s41, s65, 1
v_mov_b32 v6, s41
ds_write_b32 v0, v6
s_add_u32 s65, s65, 1
v_cvt_pk_bf16_f32 v99, v14, v15
s_add_u32 m0, m0, 4096
s_nop 0
buffer_load_dwordx4 v4, s[24:27], s50 offen offset:0 lds
v_mfma_f32_16x16x32_bf16 v[176:179], v[64:67], v[108:111], v[176:179]
v_exp_f32 v12, v232
v_mfma_f32_16x16x32_bf16 v[148:151], v[68:71], v[104:107], v[148:151]
ds_read_b128 v[36:39], v3 offset:5120
buffer_load_dwordx4 v4, s[24:27], s50 offen offset:1024 lds
v_mfma_f32_16x16x32_bf16 v[180:183], v[68:71], v[108:111], v[180:183]
v_exp_f32 v13, v233
v_mfma_f32_16x16x32_bf16 v[152:155], v[72:75], v[104:107], v[152:155]
ds_read_b128 v[40:43], v3 offset:6144
v_cvt_pk_bf16_f32 v100, v12, v13
buffer_load_dwordx4 v4, s[24:27], s50 offen offset:2048 lds
v_mfma_f32_16x16x32_bf16 v[184:187], v[72:75], v[108:111], v[184:187]
v_exp_f32 v14, v234
v_mfma_f32_16x16x32_bf16 v[156:159], v[76:79], v[104:107], v[156:159]
ds_read_b128 v[44:47], v3 offset:7168
buffer_load_dwordx4 v4, s[24:27], s50 offen offset:3072 lds
v_mfma_f32_16x16x32_bf16 v[188:191], v[76:79], v[108:111], v[188:191]
v_add_u32 v4, 0x4000, v4
s_add_u32 s49, s49, 32768
s_and_b32 s49, s49, 0x1ffff
s_waitcnt vmcnt(8)
v_mov_b32 v6, s65
ds_write_b32 v0, v6 offset:1024
s_add_u32 s66, s66, 1
s_cmp_eq_u32 s65, 7
s_cselect_b32 s66, 0x7fffffff, s66
s_branch L_loopB
L_slow0B:
s_call_b64 s[52:53], L_rh0
s_branch L_ret0B
L_X0B:
s_cmp_lg_u32 s46, 0
s_cbranch_scc1 L_tail0
v_mov_b32 v7, 0xf149f2ca
v_cndmask_b32 v112, v112, v7, s[56:57]
v_cndmask_b32 v124, v124, v7, s[56:57]
v_mov_b32 v116, v7
v_cndmask_b32 v113, v113, v7, s[58:59]
v_cndmask_b32 v125, v125, v7, s[58:59]
v_mov_b32 v117, v7
v_cndmask_b32 v114, v114, v7, s[60:61]
v_cndmask_b32 v126, v126, v7, s[60:61]
v_mov_b32 v118, v7
v_cndmask_b32 v115, v115, v7, s[62:63]
v_cndmask_b32 v127, v127, v7, s[62:63]
v_mov_b32 v119, v7
s_nop 1
s_mov_b32 s46, 1
s_mov_b32 s45, 0
s_branch L_it0B
L_slow1B:
v_max_f32 v5, v88, v92
v_cmp_lt_f32 vcc, s64, v5
s_nop 1
s_cbranch_vccz L_sl1Ba
s_call_b64 s[52:53], L_rh1
L_sl1Ba:
s_cmp_eq_u32 s72, 0
s_cbranch_scc1 L_sl1Bf
s_cmp_lt_u32 s65, 7
s_cbranch_scc1 L_sl1Bf
s_cmp_lg_u32 s32, 4
s_cbranch_scc1 L_sl1Bfw
v_lshrrev_b32 v6, 2, v2
v_and_b32 v6, 0x7c, v6
s_mov_b32 s44, 0
L_sl1Bfp:
global_load_dword v7, v6, s[28:29] offset:128 sc1
s_waitcnt vmcnt(0)
v_readlane_b32 s41, v7, s30
v_lshrrev_b32 v7, 28, v7
v_cmp_ne_u32 vcc, 8, v7
s_nop 2
s_and_b32 s41, s41, 0xf00
s_cmp_lg_u32 s41, 0x600
s_cbranch_scc1 L_sl1Bfq
s_cbranch_vccz L_sl1Bfr
L_sl1Bfq:
s_sleep 6
s_add_u32 s44, s44, 1
s_cmp_lt_u32 s44, 0x40000
s_cbranch_scc1 L_sl1Bfp
L_sl1Bfr:
v_mov_b32 v6, 134144
v_mov_b32 v7, 1
ds_write_b32 v6, v7
s_branch L_sl1Bfd
L_sl1Bfw:
s_mov_b32 s44, 0
L_sl1Bfl:
v_mov_b32 v6, 134144
ds_read_b32 v6, v6
s_waitcnt lgkmcnt(0)
v_readfirstlane_b32 s41, v6
s_nop 3
s_cmp_lg_u32 s41, 0
s_cbranch_scc1 L_sl1Bfd
s_sleep 2
s_add_u32 s44, s44, 1
s_cmp_lt_u32 s44, 0x200000
s_cbranch_scc1 L_sl1Bfl
L_sl1Bfd:
s_mov_b32 s72, 0
s_sub_u32 s66, s65, 2
L_sl1Bf:
s_mov_b32 s44, 0
L_sl1Bb:
ds_read_b32 v6, v1 offset:2048
s_waitcnt lgkmcnt(0)
v_cmp_gt_u32 vcc, s65, v6
s_nop 1
s_cbranch_vccz L_sl1Bbx
s_sleep 1
s_add_u32 s44, s44, 1
s_cmp_lt_u32 s44, 0x200000
s_cbranch_scc1 L_sl1Bb
L_sl1Bbx:
s_mov_b32 s44, 0
L_sl1Bc:
ds_read2st64_b32 v[6:7], v1 offset0:0 offset1:4
s_waitcnt lgkmcnt(0)
v_min_u32 v6, v6, v7
v_cmp_gt_u32 vcc, s66, v6
s_nop 1
s_cbranch_vccz L_sl1Bcx
s_sleep 2
s_add_u32 s44, s44, 1
s_cmp_lt_u32 s44, 0x200000
s_cbranch_scc1 L_sl1Bc
L_sl1Bcx:
s_branch L_ret1B
L_X1B:
s_cmp_lg_u32 s46, 0
s_cbranch_scc1 L_tail1
v_mov_b32 v7, 0xf149f2ca
v_cndmask_b32 v112, v112, v7, s[56:57]
v_cndmask_b32 v124, v124, v7, s[56:57]
v_mov_b32 v116, v7
v_cndmask_b32 v113, v113, v7, s[58:59]
v_cndmask_b32 v125, v125, v7, s[58:59]
v_mov_b32 v117, v7
v_cndmask_b32 v114, v114, v7, s[60:61]
v_cndmask_b32 v126, v126, v7, s[60:61]
v_mov_b32 v118, v7
v_cndmask_b32 v115, v115, v7, s[62:63]
v_cndmask_b32 v127, v127, v7, s[62:63]
v_mov_b32 v119, v7
s_nop 1
s_mov_b32 s46, 1
s_mov_b32 s45, 0
s_branch L_it1B
L_slow2B:
s_call_b64 s[52:53], L_rh0
s_branch L_ret2B
L_X2B:
s_cmp_lg_u32 s46, 0
s_cbranch_scc1 L_tail0
v_mov_b32 v7, 0xf149f2ca
v_cndmask_b32 v112, v112, v7, s[56:57]
v_cndmask_b32 v124, v124, v7, s[56:57]
v_mov_b32 v116, v7
v_cndmask_b32 v113, v113, v7, s[58:59]
v_cndmask_b32 v125, v125, v7, s[58:59]
v_mov_b32 v117, v7
v_cndmask_b32 v114, v114, v7, s[60:61]
v_cndmask_b32 v126, v126, v7, s[60:61]
v_mov_b32 v118, v7
v_cndmask_b32 v115, v115, v7, s[62:63]
v_cndmask_b32 v127, v127, v7, s[62:63]
v_mov_b32 v119, v7
s_nop 1
s_mov_b32 s46, 1
s_mov_b32 s45, 0
s_branch L_it2B
L_slow3B:
v_max_f32 v5, v88, v92
v_cmp_lt_f32 vcc, s64, v5
s_nop 1
s_cbranch_vccz L_sl3Ba
s_call_b64 s[52:53], L_rh1
L_sl3Ba:
s_cmp_eq_u32 s72, 0
s_cbranch_scc1 L_sl3Bf
s_cmp_lt_u32 s65, 7
s_cbranch_scc1 L_sl3Bf
s_cmp_lg_u32 s32, 4
s_cbranch_scc1 L_sl3Bfw
v_lshrrev_b32 v6, 2, v2
v_and_b32 v6, 0x7c, v6
s_mov_b32 s44, 0
L_sl3Bfp:
global_load_dword v7, v6, s[28:29] offset:128 sc1
s_waitcnt vmcnt(0)
v_readlane_b32 s41, v7, s30
v_lshrrev_b32 v7, 28, v7
v_cmp_ne_u32 vcc, 8, v7
s_nop 2
s_and_b32 s41, s41, 0xf00
s_cmp_lg_u32 s41, 0x600
s_cbranch_scc1 L_sl3Bfq
s_cbranch_vccz L_sl3Bfr
L_sl3Bfq:
s_sleep 6
s_add_u32 s44, s44, 1
s_cmp_lt_u32 s44, 0x40000
s_cbranch_scc1 L_sl3Bfp
L_sl3Bfr:
v_mov_b32 v6, 134144
v_mov_b32 v7, 1
ds_write_b32 v6, v7
s_branch L_sl3Bfd
L_sl3Bfw:
s_mov_b32 s44, 0
L_sl3Bfl:
v_mov_b32 v6, 134144
ds_read_b32 v6, v6
s_waitcnt lgkmcnt(0)
v_readfirstlane_b32 s41, v6
s_nop 3
s_cmp_lg_u32 s41, 0
s_cbranch_scc1 L_sl3Bfd
s_sleep 2
s_add_u32 s44, s44, 1
s_cmp_lt_u32 s44, 0x200000
s_cbranch_scc1 L_sl3Bfl
L_sl3Bfd:
s_mov_b32 s72, 0
s_sub_u32 s66, s65, 2
L_sl3Bf:
s_mov_b32 s44, 0
L_sl3Bb:
ds_read_b32 v6, v1 offset:2048
s_waitcnt lgkmcnt(0)
v_cmp_gt_u32 vcc, s65, v6
s_nop 1
s_cbranch_vccz L_sl3Bbx
s_sleep 1
s_add_u32 s44, s44, 1
s_cmp_lt_u32 s44, 0x200000
s_cbranch_scc1 L_sl3Bb
L_sl3Bbx:
s_mov_b32 s44, 0
L_sl3Bc:
ds_read2st64_b32 v[6:7], v1 offset0:0 offset1:4
s_waitcnt lgkmcnt(0)
v_min_u32 v6, v6, v7
v_cmp_gt_u32 vcc, s66, v6
s_nop 1
s_cbranch_vccz L_sl3Bcx
s_sleep 2
s_add_u32 s44, s44, 1
s_cmp_lt_u32 s44, 0x200000
s_cbranch_scc1 L_sl3Bc
L_sl3Bcx:
s_branch L_ret3B
L_X3B:
s_cmp_lg_u32 s46, 0
s_cbranch_scc1 L_tail1
v_mov_b32 v7, 0xf149f2ca
v_cndmask_b32 v112, v112, v7, s[56:57]
v_cndmask_b32 v124, v124, v7, s[56:57]
v_mov_b32 v116, v7
v_cndmask_b32 v113, v113, v7, s[58:59]
v_cndmask_b32 v125, v125, v7, s[58:59]
v_mov_b32 v117, v7
v_cndmask_b32 v114, v114, v7, s[60:61]
v_cndmask_b32 v126, v126, v7, s[60:61]
v_mov_b32 v118, v7
v_cndmask_b32 v115, v115, v7, s[62:63]
v_cndmask_b32 v127, v127, v7, s[62:63]
v_mov_b32 v119, v7
s_nop 1
s_mov_b32 s46, 1
s_mov_b32 s45, 0
s_branch L_it3B
L_tail0:
s_waitcnt lgkmcnt(0)
ds_read_b128 v[48:51], v3 offset:16384
ds_read_b128 v[52:55], v3 offset:17408
ds_read_b128 v[56:59], v3 offset:18432
ds_read_b128 v[60:63], v3 offset:19456
ds_read_b128 v[64:67], v3 offset:20480
ds_read_b128 v[68:71], v3 offset:21504
ds_read_b128 v[72:75], v3 offset:22528
ds_read_b128 v[76:79], v3 offset:23552
v_mfma_f32_16x16x32_bf16 v[80:83], v[8:11], v[96:99], v[88:91]
v_exp_f32 v15, v235
s_nop 0
v_cvt_pk_bf16_f32 v101, v14, v15
v_exp_f32 v12, v236
v_exp_f32 v13, v237
s_nop 0
v_cvt_pk_bf16_f32 v102, v12, v13
v_exp_f32 v14, v238
v_exp_f32 v15, v239
s_nop 0
v_cvt_pk_bf16_f32 v103, v14, v15
s_nop 1
v_mfma_f32_16x16x32_bf16 v[84:87], v[8:11], v[100:103], v[92:95]
s_nop 7
v_max_f32 v5, v80, v84
v_cmp_lt_f32 vcc, s64, v5
s_nop 1
s_cbranch_vccz L_tl0ok
s_call_b64 s[52:53], L_rh0
L_tl0ok:
s_waitcnt lgkmcnt(7)
v_mfma_f32_16x16x32_bf16 v[128:131], v[48:51], v[96:99], v[128:131]
v_mfma_f32_16x16x32_bf16 v[160:163], v[48:51], v[100:103], v[160:163]
s_waitcnt lgkmcnt(6)
v_mfma_f32_16x16x32_bf16 v[132:135], v[52:55], v[96:99], v[132:135]
v_mfma_f32_16x16x32_bf16 v[164:167], v[52:55], v[100:103], v[164:167]
s_waitcnt lgkmcnt(5)
v_mfma_f32_16x16x32_bf16 v[136:139], v[56:59], v[96:99], v[136:139]
v_mfma_f32_16x16x32_bf16 v[168:171], v[56:59], v[100:103], v[168:171]
s_waitcnt lgkmcnt(4)
v_mfma_f32_16x16x32_bf16 v[140:143], v[60:63], v[96:99], v[140:143]
v_mfma_f32_16x16x32_bf16 v[172:175], v[60:63], v[100:103], v[172:175]
s_waitcnt lgkmcnt(3)
v_mfma_f32_16x16x32_bf16 v[144:147], v[64:67], v[96:99], v[144:147]
v_mfma_f32_16x16x32_bf16 v[176:179], v[64:67], v[100:103], v[176:179]
s_waitcnt lgkmcnt(2)
v_mfma_f32_16x16x32_bf16 v[148:151], v[68:71], v[96:99], v[148:151]
v_mfma_f32_16x16x32_bf16 v[180:183], v[68:71], v[100:103], v[180:183]
s_waitcnt lgkmcnt(1)
v_mfma_f32_16x16x32_bf16 v[152:155], v[72:75], v[96:99], v[152:155]
v_mfma_f32_16x16x32_bf16 v[184:187], v[72:75], v[100:103], v[184:187]
s_waitcnt lgkmcnt(0)
v_mfma_f32_16x16x32_bf16 v[156:159], v[76:79], v[96:99], v[156:159]
v_mfma_f32_16x16x32_bf16 v[188:191], v[76:79], v[100:103], v[188:191]
v_mov_b32 v6, 0x7fffffff
ds_write_b32 v0, v6
v_rcp_f32 v12, v80
v_rcp_f32 v13, v84
s_branch L_epi
L_tail1:
s_waitcnt lgkmcnt(0)
ds_read_b128 v[48:51], v3 offset:24576
ds_read_b128 v[52:55], v3 offset:25600
ds_read_b128 v[56:59], v3 offset:26624
ds_read_b128 v[60:63], v3 offset:27648
ds_read_b128 v[64:67], v3 offset:28672
ds_read_b128 v[68:71], v3 offset:29696
ds_read_b128 v[72:75], v3 offset:30720
ds_read_b128 v[76:79], v3 offset:31744
v_mfma_f32_16x16x32_bf16 v[88:91], v[8:11], v[104:107], v[80:83]
v_exp_f32 v15, v251
s_nop 0
v_cvt_pk_bf16_f32 v109, v14, v15
v_exp_f32 v12, v252
v_exp_f32 v13, v253
s_nop 0
v_cvt_pk_bf16_f32 v110, v12, v13
v_exp_f32 v14, v254
v_exp_f32 v15, v255
s_nop 0
v_cvt_pk_bf16_f32 v111, v14, v15
s_nop 1
v_mfma_f32_16x16x32_bf16 v[92:95], v[8:11], v[108:111], v[84:87]
s_nop 7
v_max_f32 v5, v88, v92
v_cmp_lt_f32 vcc, s64, v5
s_nop 1
s_cbranch_vccz L_tl1ok
s_call_b64 s[52:53], L_rh1
L_tl1ok:
s_waitcnt lgkmcnt(7)
v_mfma_f32_16x16x32_bf16 v[128:131], v[48:51], v[104:107], v[128:131]
v_mfma_f32_16x16x32_bf16 v[160:163], v[48:51], v[108:111], v[160:163]
s_waitcnt lgkmcnt(6)
v_mfma_f32_16x16x32_bf16 v[132:135], v[52:55], v[104:107], v[132:135]
v_mfma_f32_16x16x32_bf16 v[164:167], v[52:55], v[108:111], v[164:167]
s_waitcnt lgkmcnt(5)
v_mfma_f32_16x16x32_bf16 v[136:139], v[56:59], v[104:107], v[136:139]
v_mfma_f32_16x16x32_bf16 v[168:171], v[56:59], v[108:111], v[168:171]
s_waitcnt lgkmcnt(4)
v_mfma_f32_16x16x32_bf16 v[140:143], v[60:63], v[104:107], v[140:143]
v_mfma_f32_16x16x32_bf16 v[172:175], v[60:63], v[108:111], v[172:175]
s_waitcnt lgkmcnt(3)
v_mfma_f32_16x16x32_bf16 v[144:147], v[64:67], v[104:107], v[144:147]
v_mfma_f32_16x16x32_bf16 v[176:179], v[64:67], v[108:111], v[176:179]
s_waitcnt lgkmcnt(2)
v_mfma_f32_16x16x32_bf16 v[148:151], v[68:71], v[104:107], v[148:151]
v_mfma_f32_16x16x32_bf16 v[180:183], v[68:71], v[108:111], v[180:183]
s_waitcnt lgkmcnt(1)
v_mfma_f32_16x16x32_bf16 v[152:155], v[72:75], v[104:107], v[152:155]
v_mfma_f32_16x16x32_bf16 v[184:187], v[72:75], v[108:111], v[184:187]
s_waitcnt lgkmcnt(0)
v_mfma_f32_16x16x32_bf16 v[156:159], v[76:79], v[104:107], v[156:159]
v_mfma_f32_16x16x32_bf16 v[188:191], v[76:79], v[108:111], v[188:191]
v_mov_b32 v6, 0x7fffffff
ds_write_b32 v0, v6
v_rcp_f32 v12, v88
v_rcp_f32 v13, v92
L_epi:
s_lshr_b32 s41, s34, 14
s_lshl_b32 s41, s41, 17
s_lshl_b32 s42, s30, 12
s_add_u32 s41, s41, s42
s_add_u32 s41, s41, 33554432
s_nop 5
v_mul_f32 v128, v12, v128
v_mul_f32 v129, v12, v129
v_mul_f32 v130, v12, v130
v_mul_f32 v131, v12, v131
v_mul_f32 v132, v12, v132
v_mul_f32 v133, v12, v133
v_mul_f32 v134, v12, v134
v_mul_f32 v135, v12, v135
v_cvt_pk_bf16_f32 v128, v128, v129
v_cvt_pk_bf16_f32 v129, v130, v131
v_cvt_pk_bf16_f32 v130, v132, v133
v_cvt_pk_bf16_f32 v131, v134, v135
buffer_store_dwordx4 v[128:131], v2, s[20:23], s41 offen offset:0 sc1
v_mul_f32 v136, v12, v136
v_mul_f32 v137, v12, v137
v_mul_f32 v138, v12, v138
v_mul_f32 v139, v12, v139
v_mul_f32 v140, v12, v140
v_mul_f32 v141, v12, v141
v_mul_f32 v142, v12, v142
v_mul_f32 v143, v12, v143
v_cvt_pk_bf16_f32 v136, v136, v137
v_cvt_pk_bf16_f32 v137, v138, v139
v_cvt_pk_bf16_f32 v138, v140, v141
v_cvt_pk_bf16_f32 v139, v142, v143
buffer_store_dwordx4 v[136:139], v2, s[20:23], s41 offen offset:1024 sc1
v_mul_f32 v144, v12, v144
v_mul_f32 v145, v12, v145
v_mul_f32 v146, v12, v146
v_mul_f32 v147, v12, v147
v_mul_f32 v148, v12, v148
v_mul_f32 v149, v12, v149
v_mul_f32 v150, v12, v150
v_mul_f32 v151, v12, v151
v_cvt_pk_bf16_f32 v144, v144, v145
v_cvt_pk_bf16_f32 v145, v146, v147
v_cvt_pk_bf16_f32 v146, v148, v149
v_cvt_pk_bf16_f32 v147, v150, v151
buffer_store_dwordx4 v[144:147], v2, s[20:23], s41 offen offset:2048 sc1
v_mul_f32 v152, v12, v152
v_mul_f32 v153, v12, v153
v_mul_f32 v154, v12, v154
v_mul_f32 v155, v12, v155
v_mul_f32 v156, v12, v156
v_mul_f32 v157, v12, v157
v_mul_f32 v158, v12, v158
v_mul_f32 v159, v12, v159
v_cvt_pk_bf16_f32 v152, v152, v153
v_cvt_pk_bf16_f32 v153, v154, v155
v_cvt_pk_bf16_f32 v154, v156, v157
v_cvt_pk_bf16_f32 v155, v158, v159
buffer_store_dwordx4 v[152:155], v2, s[20:23], s41 offen offset:3072 sc1
s_add_u32 s41, s41, 131072
v_mul_f32 v160, v13, v160
v_mul_f32 v161, v13, v161
v_mul_f32 v162, v13, v162
v_mul_f32 v163, v13, v163
v_mul_f32 v164, v13, v164
v_mul_f32 v165, v13, v165
v_mul_f32 v166, v13, v166
v_mul_f32 v167, v13, v167
v_cvt_pk_bf16_f32 v160, v160, v161
v_cvt_pk_bf16_f32 v161, v162, v163
v_cvt_pk_bf16_f32 v162, v164, v165
v_cvt_pk_bf16_f32 v163, v166, v167
buffer_store_dwordx4 v[160:163], v2, s[20:23], s41 offen offset:0 sc1
v_mul_f32 v168, v13, v168
v_mul_f32 v169, v13, v169
v_mul_f32 v170, v13, v170
v_mul_f32 v171, v13, v171
v_mul_f32 v172, v13, v172
v_mul_f32 v173, v13, v173
v_mul_f32 v174, v13, v174
v_mul_f32 v175, v13, v175
v_cvt_pk_bf16_f32 v168, v168, v169
v_cvt_pk_bf16_f32 v169, v170, v171
v_cvt_pk_bf16_f32 v170, v172, v173
v_cvt_pk_bf16_f32 v171, v174, v175
buffer_store_dwordx4 v[168:171], v2, s[20:23], s41 offen offset:1024 sc1
v_mul_f32 v176, v13, v176
v_mul_f32 v177, v13, v177
v_mul_f32 v178, v13, v178
v_mul_f32 v179, v13, v179
v_mul_f32 v180, v13, v180
v_mul_f32 v181, v13, v181
v_mul_f32 v182, v13, v182
v_mul_f32 v183, v13, v183
v_cvt_pk_bf16_f32 v176, v176, v177
v_cvt_pk_bf16_f32 v177, v178, v179
v_cvt_pk_bf16_f32 v178, v180, v181
v_cvt_pk_bf16_f32 v179, v182, v183
buffer_store_dwordx4 v[176:179], v2, s[20:23], s41 offen offset:2048 sc1
v_mul_f32 v184, v13, v184
v_mul_f32 v185, v13, v185
v_mul_f32 v186, v13, v186
v_mul_f32 v187, v13, v187
v_mul_f32 v188, v13, v188
v_mul_f32 v189, v13, v189
v_mul_f32 v190, v13, v190
v_mul_f32 v191, v13, v191
v_cvt_pk_bf16_f32 v184, v184, v185
v_cvt_pk_bf16_f32 v185, v186, v187
v_cvt_pk_bf16_f32 v186, v188, v189
v_cvt_pk_bf16_f32 v187, v190, v191
buffer_store_dwordx4 v[184:187], v2, s[20:23], s41 offen offset:3072 sc1
s_cmp_lt_u32 s32, 4
s_cbranch_scc1 L_done
s_setprio 0
s_sub_u32 s41, s31, 0
s_cmp_lt_u32 s41, 2
s_cbranch_scc1 L_special
s_cmp_eq_u32 s72, 0
s_cbranch_scc1 L_ldf
s_cmp_lt_u32 s65, 7
s_cbranch_scc1 L_ldf
s_cmp_lg_u32 s32, 4
s_cbranch_scc1 L_ldfw
v_lshrrev_b32 v6, 2, v2
v_and_b32 v6, 0x7c, v6
s_mov_b32 s44, 0
L_ldfp:
global_load_dword v7, v6, s[28:29] offset:128 sc1
s_waitcnt vmcnt(0)
v_readlane_b32 s41, v7, s30
v_lshrrev_b32 v7, 28, v7
v_cmp_ne_u32 vcc, 8, v7
s_nop 2
s_and_b32 s41, s41, 0xf00
s_cmp_lg_u32 s41, 0x600
s_cbranch_scc1 L_ldfq
s_cbranch_vccz L_ldfr
L_ldfq:
s_sleep 6
s_add_u32 s44, s44, 1
s_cmp_lt_u32 s44, 0x40000
s_cbranch_scc1 L_ldfp
L_ldfr:
v_mov_b32 v6, 134144
v_mov_b32 v7, 1
ds_write_b32 v6, v7
s_branch L_ldfd
L_ldfw:
s_mov_b32 s44, 0
L_ldfl:
v_mov_b32 v6, 134144
ds_read_b32 v6, v6
s_waitcnt lgkmcnt(0)
v_readfirstlane_b32 s41, v6
s_nop 3
s_cmp_lg_u32 s41, 0
s_cbranch_scc1 L_ldfd
s_sleep 2
s_add_u32 s44, s44, 1
s_cmp_lt_u32 s44, 0x200000
s_cbranch_scc1 L_ldfl
L_ldfd:
s_mov_b32 s72, 0
s_sub_u32 s66, s65, 2
L_ldf:
L_ld:
s_cmp_gt_u32 s65, s67
s_cbranch_scc1 L_ldend
s_cmp_eq_u32 s72, 0
s_cbranch_scc1 L_ldf2
s_cmp_lt_u32 s65, 7
s_cbranch_scc1 L_ldf2
s_cmp_lg_u32 s32, 4
s_cbranch_scc1 L_ldf2w
v_lshrrev_b32 v6, 2, v2
v_and_b32 v6, 0x7c, v6
s_mov_b32 s44, 0
L_ldf2p:
global_load_dword v7, v6, s[28:29] offset:128 sc1
s_waitcnt vmcnt(0)
v_readlane_b32 s41, v7, s30
v_lshrrev_b32 v7, 28, v7
v_cmp_ne_u32 vcc, 8, v7
s_nop 2
s_and_b32 s41, s41, 0xf00
s_cmp_lg_u32 s41, 0x600
s_cbranch_scc1 L_ldf2q
s_cbranch_vccz L_ldf2r
L_ldf2q:
s_sleep 6
s_add_u32 s44, s44, 1
s_cmp_lt_u32 s44, 0x40000
s_cbranch_scc1 L_ldf2p
L_ldf2r:
v_mov_b32 v6, 134144
v_mov_b32 v7, 1
ds_write_b32 v6, v7
s_branch L_ldf2d
L_ldf2w:
s_mov_b32 s44, 0
L_ldf2l:
v_mov_b32 v6, 134144
ds_read_b32 v6, v6
s_waitcnt lgkmcnt(0)
v_readfirstlane_b32 s41, v6
s_nop 3
s_cmp_lg_u32 s41, 0
s_cbranch_scc1 L_ldf2d
s_sleep 2
s_add_u32 s44, s44, 1
s_cmp_lt_u32 s44, 0x200000
s_cbranch_scc1 L_ldf2l
L_ldf2d:
s_mov_b32 s72, 0
s_sub_u32 s66, s65, 2
L_ldf2:
s_mov_b32 s44, 0
L_ldw:
ds_read2st64_b32 v[6:7], v1 offset0:0 offset1:4
s_waitcnt lgkmcnt(0)
v_min_u32 v6, v6, v7
v_cmp_gt_u32 vcc, s66, v6
s_nop 1
s_cbranch_vccz L_ldwx
s_sleep 2
s_add_u32 s44, s44, 1
s_cmp_lt_u32 s44, 0x200000
s_cbranch_scc1 L_ldw
L_ldwx:
s_setprio 3
s_add_u32 m0, s49, s38
s_nop 0
buffer_load_dwordx4 v4, s[24:27], 0 offen offset:0 lds
buffer_load_dwordx4 v4, s[24:27], 0 offen offset:1024 lds
buffer_load_dwordx4 v4, s[24:27], 0 offen offset:2048 lds
buffer_load_dwordx4 v4, s[24:27], 0 offen offset:3072 lds
s_add_u32 m0, m0, 4096
s_nop 0
buffer_load_dwordx4 v4, s[24:27], s50 offen offset:0 lds
buffer_load_dwordx4 v4, s[24:27], s50 offen offset:1024 lds
buffer_load_dwordx4 v4, s[24:27], s50 offen offset:2048 lds
buffer_load_dwordx4 v4, s[24:27], s50 offen offset:3072 lds
v_add_u32 v4, 0x4000, v4
s_add_u32 s49, s49, 32768
s_and_b32 s49, s49, 0x1ffff
s_add_u32 s65, s65, 1
s_add_u32 s66, s66, 1
s_waitcnt vmcnt(8)
v_mov_b32 v5, s65
ds_write_b32 v0, v5 offset:1024
s_setprio 0
s_branch L_ld
L_ldend:
s_waitcnt vmcnt(0)
v_mov_b32 v5, 0x7fffffff
ds_write_b32 v0, v5 offset:1024
s_branch L_done
L_special:
s_and_b32 s41, s32, 1
s_cmp_eq_u32 s41, 0
s_cbranch_scc1 L_dbl
s_waitcnt vmcnt(0)
s_add_u32 s41, s65, 1
v_mov_b32 v5, s41
ds_write_b32 v0, v5 offset:1024
s_waitcnt lgkmcnt(0)
s_sub_u32 s62, s31, 0
s_lshl_b32 s62, s62, 5
s_add_u32 s62, s62, s30
s_lshl_b32 s62, s62, 1
s_lshr_b32 s41, s32, 1
s_and_b32 s41, s41, 1
s_add_u32 s62, s62, s41
s_mov_b32 s69, s65
s_cmp_ge_u32 s62, 112
s_cbranch_scc1 L_done
s_load_dwordx2 s[56:57], s[0:1], 64
s_load_dwordx2 s[58:59], s[0:1], 72
s_load_dwordx2 s[60:61], s[0:1], 80
v_lshrrev_b32 v8, 4, v2
s_waitcnt lgkmcnt(0)
s_mov_b32 s8, s56
s_and_b32 s9, s57, 0xffff
s_mov_b32 s10, 1835008
s_mov_b32 s11, 0x20000
s_mov_b32 s12, s58
s_and_b32 s13, s59, 0xffff
s_mov_b32 s14, 1835008
s_mov_b32 s15, 0x20000
s_mov_b32 s24, s60
s_and_b32 s25, s61, 0xffff
s_mov_b32 s26, 1835008
s_mov_b32 s27, 0x20000
s_mul_hi_u32 s68, s62, 0x0924924a
s_mul_i32 s67, s68, 28
s_sub_u32 s67, s62, s67
v_lshrrev_b32 v9, 3, v8
s_movk_i32 s64, 3584
v_mul_lo_u32 v10, v9, s64
v_and_b32 v11, 7, v8
v_lshlrev_b32 v11, 4, v11
v_add_u32 v10, v10, v11
s_mul_i32 s64, s68, 458752
s_lshl_b32 s65, s67, 7
s_add_u32 s64, s64, s65
v_lshlrev_b32 v12, 4, v8
s_mov_b32 s65, 50331648
buffer_load_dwordx4 v[16:19], v12, s[20:23], s65 offen offset:0 sc1
buffer_load_dwordx4 v[20:23], v12, s[20:23], s65 offen offset:1024 sc1
buffer_load_dwordx4 v[24:27], v12, s[20:23], s65 offen offset:2048 sc1
buffer_load_dwordx4 v[28:31], v12, s[20:23], s65 offen offset:3072 sc1
s_add_u32 s65, s65, 4096
buffer_load_dwordx4 v[32:35], v12, s[20:23], s65 offen offset:0 sc1
buffer_load_dwordx4 v[36:39], v12, s[20:23], s65 offen offset:1024 sc1
buffer_load_dwordx4 v[40:43], v12, s[20:23], s65 offen offset:2048 sc1
buffer_load_dwordx4 v[44:47], v12, s[20:23], s65 offen offset:3072 sc1
s_add_u32 s65, s64, 0
buffer_load_dwordx4 v[128:131], v10, s[8:11], s65 offen
buffer_load_dwordx4 v[192:195], v10, s[12:15], s65 offen
s_add_u32 s65, s64, 28672
buffer_load_dwordx4 v[132:135], v10, s[8:11], s65 offen
buffer_load_dwordx4 v[196:199], v10, s[12:15], s65 offen
s_add_u32 s65, s64, 57344
buffer_load_dwordx4 v[136:139], v10, s[8:11], s65 offen
buffer_load_dwordx4 v[200:203], v10, s[12:15], s65 offen
s_add_u32 s65, s64, 86016
buffer_load_dwordx4 v[140:143], v10, s[8:11], s65 offen
buffer_load_dwordx4 v[204:207], v10, s[12:15], s65 offen
s_add_u32 s65, s64, 114688
buffer_load_dwordx4 v[144:147], v10, s[8:11], s65 offen
buffer_load_dwordx4 v[208:211], v10, s[12:15], s65 offen
s_add_u32 s65, s64, 143360
buffer_load_dwordx4 v[148:151], v10, s[8:11], s65 offen
buffer_load_dwordx4 v[212:215], v10, s[12:15], s65 offen
s_add_u32 s65, s64, 172032
buffer_load_dwordx4 v[152:155], v10, s[8:11], s65 offen
buffer_load_dwordx4 v[216:219], v10, s[12:15], s65 offen
s_add_u32 s65, s64, 200704
buffer_load_dwordx4 v[156:159], v10, s[8:11], s65 offen
buffer_load_dwordx4 v[220:223], v10, s[12:15], s65 offen
s_add_u32 s65, s64, 229376
buffer_load_dwordx4 v[160:163], v10, s[8:11], s65 offen
buffer_load_dwordx4 v[224:227], v10, s[12:15], s65 offen
s_add_u32 s65, s64, 258048
buffer_load_dwordx4 v[164:167], v10, s[8:11], s65 offen
buffer_load_dwordx4 v[228:231], v10, s[12:15], s65 offen
s_add_u32 s65, s64, 286720
buffer_load_dwordx4 v[168:171], v10, s[8:11], s65 offen
buffer_load_dwordx4 v[232:235], v10, s[12:15], s65 offen
s_add_u32 s65, s64, 315392
buffer_load_dwordx4 v[172:175], v10, s[8:11], s65 offen
buffer_load_dwordx4 v[236:239], v10, s[12:15], s65 offen
s_add_u32 s65, s64, 344064
buffer_load_dwordx4 v[176:179], v10, s[8:11], s65 offen
buffer_load_dwordx4 v[240:243], v10, s[12:15], s65 offen
s_add_u32 s65, s64, 372736
buffer_load_dwordx4 v[180:183], v10, s[8:11], s65 offen
buffer_load_dwordx4 v[244:247], v10, s[12:15], s65 offen
s_add_u32 s65, s64, 401408
buffer_load_dwordx4 v[184:187], v10, s[8:11], s65 offen
buffer_load_dwordx4 v[248:251], v10, s[12:15], s65 offen
s_add_u32 s65, s64, 430080
buffer_load_dwordx4 v[188:191], v10, s[8:11], s65 offen
buffer_load_dwordx4 v[252:255], v10, s[12:15], s65 offen
s_lshl_b32 s64, s62, 14
buffer_load_dwordx4 v[64:67], v2, s[24:27], s64 offen offset:0
buffer_load_dwordx4 v[68:71], v2, s[24:27], s64 offen offset:1024
buffer_load_dwordx4 v[72:75], v2, s[24:27], s64 offen offset:2048
buffer_load_dwordx4 v[76:79], v2, s[24:27], s64 offen offset:3072
s_add_u32 s64, s64, 4096
buffer_load_dwordx4 v[80:83], v2, s[24:27], s64 offen offset:0
buffer_load_dwordx4 v[84:87], v2, s[24:27], s64 offen offset:1024
buffer_load_dwordx4 v[88:91], v2, s[24:27], s64 offen offset:2048
buffer_load_dwordx4 v[92:95], v2, s[24:27], s64 offen offset:3072
s_add_u32 s64, s64, 4096
buffer_load_dwordx4 v[96:99], v2, s[24:27], s64 offen offset:0
buffer_load_dwordx4 v[100:103], v2, s[24:27], s64 offen offset:1024
buffer_load_dwordx4 v[104:107], v2, s[24:27], s64 offen offset:2048
buffer_load_dwordx4 v[108:111], v2, s[24:27], s64 offen offset:3072
s_add_u32 s64, s64, 4096
buffer_load_dwordx4 v[112:115], v2, s[24:27], s64 offen offset:0
buffer_load_dwordx4 v[116:119], v2, s[24:27], s64 offen offset:1024
buffer_load_dwordx4 v[120:123], v2, s[24:27], s64 offen offset:2048
buffer_load_dwordx4 v[124:127], v2, s[24:27], s64 offen offset:3072
s_waitcnt vmcnt(55)
v_max3_f32 v48, v16, v17, v18
s_waitcnt vmcnt(54)
v_max3_f32 v48, v48, v19, v20
v_max3_f32 v48, v48, v21, v22
s_waitcnt vmcnt(53)
v_max3_f32 v48, v48, v23, v24
v_max3_f32 v48, v48, v25, v26
s_waitcnt vmcnt(52)
v_max3_f32 v48, v48, v27, v28
v_max3_f32 v48, v48, v29, v30
s_waitcnt vmcnt(51)
v_max3_f32 v48, v48, v31, v32
v_max3_f32 v48, v48, v33, v34
s_waitcnt vmcnt(50)
v_max3_f32 v48, v48, v35, v36
v_max3_f32 v48, v48, v37, v38
s_waitcnt vmcnt(49)
v_max3_f32 v48, v48, v39, v40
v_max3_f32 v48, v48, v41, v42
s_waitcnt vmcnt(48)
v_max3_f32 v48, v48, v43, v44
v_max3_f32 v48, v48, v45, v46
v_max_f32 v48, v48, v47
s_nop 1
v_max_f32 v48, v48, v48 row_ror:8 row_mask:0xf bank_mask:0xf
s_nop 1
v_max_f32 v48, v48, v48 row_ror:4 row_mask:0xf bank_mask:0xf
s_nop 1
v_max_f32 v48, v48, v48 row_ror:2 row_mask:0xf bank_mask:0xf
s_nop 1
v_max_f32 v48, v48, v48 row_ror:1 row_mask:0xf bank_mask:0xf
v_mov_b32 v49, v48
s_nop 1
v_permlane16_swap_b32 v48, v49
s_nop 1
v_max_f32 v48, v48, v49
v_mov_b32 v49, v48
s_nop 1
v_permlane32_swap_b32 v48, v49
s_nop 1
v_max_f32 v48, v48, v49
s_movk_i32 s63, 0x7ff
v_cmp_eq_f32 vcc, v16, v48
s_nop 3
s_ff1_i32_b64 s64, vcc
s_lshl_b32 s65, s64, 2
s_add_u32 s65, s65, 0
s_cmp_lt_i32 s64, 0
s_cselect_b32 s65, 0x7ff, s65
s_min_u32 s63, s63, s65
v_cmp_eq_f32 vcc, v17, v48
s_nop 3
s_ff1_i32_b64 s64, vcc
s_lshl_b32 s65, s64, 2
s_add_u32 s65, s65, 1
s_cmp_lt_i32 s64, 0
s_cselect_b32 s65, 0x7ff, s65
s_min_u32 s63, s63, s65
v_cmp_eq_f32 vcc, v18, v48
s_nop 3
s_ff1_i32_b64 s64, vcc
s_lshl_b32 s65, s64, 2
s_add_u32 s65, s65, 2
s_cmp_lt_i32 s64, 0
s_cselect_b32 s65, 0x7ff, s65
s_min_u32 s63, s63, s65
v_cmp_eq_f32 vcc, v19, v48
s_nop 3
s_ff1_i32_b64 s64, vcc
s_lshl_b32 s65, s64, 2
s_add_u32 s65, s65, 3
s_cmp_lt_i32 s64, 0
s_cselect_b32 s65, 0x7ff, s65
s_min_u32 s63, s63, s65
v_cmp_eq_f32 vcc, v20, v48
s_nop 3
s_ff1_i32_b64 s64, vcc
s_lshl_b32 s65, s64, 2
s_add_u32 s65, s65, 256
s_cmp_lt_i32 s64, 0
s_cselect_b32 s65, 0x7ff, s65
s_min_u32 s63, s63, s65
v_cmp_eq_f32 vcc, v21, v48
s_nop 3
s_ff1_i32_b64 s64, vcc
s_lshl_b32 s65, s64, 2
s_add_u32 s65, s65, 257
s_cmp_lt_i32 s64, 0
s_cselect_b32 s65, 0x7ff, s65
s_min_u32 s63, s63, s65
v_cmp_eq_f32 vcc, v22, v48
s_nop 3
s_ff1_i32_b64 s64, vcc
s_lshl_b32 s65, s64, 2
s_add_u32 s65, s65, 258
s_cmp_lt_i32 s64, 0
s_cselect_b32 s65, 0x7ff, s65
s_min_u32 s63, s63, s65
v_cmp_eq_f32 vcc, v23, v48
s_nop 3
s_ff1_i32_b64 s64, vcc
s_lshl_b32 s65, s64, 2
s_add_u32 s65, s65, 259
s_cmp_lt_i32 s64, 0
s_cselect_b32 s65, 0x7ff, s65
s_min_u32 s63, s63, s65
v_cmp_eq_f32 vcc, v24, v48
s_nop 3
s_ff1_i32_b64 s64, vcc
s_lshl_b32 s65, s64, 2
s_add_u32 s65, s65, 512
s_cmp_lt_i32 s64, 0
s_cselect_b32 s65, 0x7ff, s65
s_min_u32 s63, s63, s65
v_cmp_eq_f32 vcc, v25, v48
s_nop 3
s_ff1_i32_b64 s64, vcc
s_lshl_b32 s65, s64, 2
s_add_u32 s65, s65, 513
s_cmp_lt_i32 s64, 0
s_cselect_b32 s65, 0x7ff, s65
s_min_u32 s63, s63, s65
v_cmp_eq_f32 vcc, v26, v48
s_nop 3
s_ff1_i32_b64 s64, vcc
s_lshl_b32 s65, s64, 2
s_add_u32 s65, s65, 514
s_cmp_lt_i32 s64, 0
s_cselect_b32 s65, 0x7ff, s65
s_min_u32 s63, s63, s65
v_cmp_eq_f32 vcc, v27, v48
s_nop 3
s_ff1_i32_b64 s64, vcc
s_lshl_b32 s65, s64, 2
s_add_u32 s65, s65, 515
s_cmp_lt_i32 s64, 0
s_cselect_b32 s65, 0x7ff, s65
s_min_u32 s63, s63, s65
v_cmp_eq_f32 vcc, v28, v48
s_nop 3
s_ff1_i32_b64 s64, vcc
s_lshl_b32 s65, s64, 2
s_add_u32 s65, s65, 768
s_cmp_lt_i32 s64, 0
s_cselect_b32 s65, 0x7ff, s65
s_min_u32 s63, s63, s65
v_cmp_eq_f32 vcc, v29, v48
s_nop 3
s_ff1_i32_b64 s64, vcc
s_lshl_b32 s65, s64, 2
s_add_u32 s65, s65, 769
s_cmp_lt_i32 s64, 0
s_cselect_b32 s65, 0x7ff, s65
s_min_u32 s63, s63, s65
v_cmp_eq_f32 vcc, v30, v48
s_nop 3
s_ff1_i32_b64 s64, vcc
s_lshl_b32 s65, s64, 2
s_add_u32 s65, s65, 770
s_cmp_lt_i32 s64, 0
s_cselect_b32 s65, 0x7ff, s65
s_min_u32 s63, s63, s65
v_cmp_eq_f32 vcc, v31, v48
s_nop 3
s_ff1_i32_b64 s64, vcc
s_lshl_b32 s65, s64, 2
s_add_u32 s65, s65, 771
s_cmp_lt_i32 s64, 0
s_cselect_b32 s65, 0x7ff, s65
s_min_u32 s63, s63, s65
v_cmp_eq_f32 vcc, v32, v48
s_nop 3
s_ff1_i32_b64 s64, vcc
s_lshl_b32 s65, s64, 2
s_add_u32 s65, s65, 1024
s_cmp_lt_i32 s64, 0
s_cselect_b32 s65, 0x7ff, s65
s_min_u32 s63, s63, s65
v_cmp_eq_f32 vcc, v33, v48
s_nop 3
s_ff1_i32_b64 s64, vcc
s_lshl_b32 s65, s64, 2
s_add_u32 s65, s65, 1025
s_cmp_lt_i32 s64, 0
s_cselect_b32 s65, 0x7ff, s65
s_min_u32 s63, s63, s65
v_cmp_eq_f32 vcc, v34, v48
s_nop 3
s_ff1_i32_b64 s64, vcc
s_lshl_b32 s65, s64, 2
s_add_u32 s65, s65, 1026
s_cmp_lt_i32 s64, 0
s_cselect_b32 s65, 0x7ff, s65
s_min_u32 s63, s63, s65
v_cmp_eq_f32 vcc, v35, v48
s_nop 3
s_ff1_i32_b64 s64, vcc
s_lshl_b32 s65, s64, 2
s_add_u32 s65, s65, 1027
s_cmp_lt_i32 s64, 0
s_cselect_b32 s65, 0x7ff, s65
s_min_u32 s63, s63, s65
v_cmp_eq_f32 vcc, v36, v48
s_nop 3
s_ff1_i32_b64 s64, vcc
s_lshl_b32 s65, s64, 2
s_add_u32 s65, s65, 1280
s_cmp_lt_i32 s64, 0
s_cselect_b32 s65, 0x7ff, s65
s_min_u32 s63, s63, s65
v_cmp_eq_f32 vcc, v37, v48
s_nop 3
s_ff1_i32_b64 s64, vcc
s_lshl_b32 s65, s64, 2
s_add_u32 s65, s65, 1281
s_cmp_lt_i32 s64, 0
s_cselect_b32 s65, 0x7ff, s65
s_min_u32 s63, s63, s65
v_cmp_eq_f32 vcc, v38, v48
s_nop 3
s_ff1_i32_b64 s64, vcc
s_lshl_b32 s65, s64, 2
s_add_u32 s65, s65, 1282
s_cmp_lt_i32 s64, 0
s_cselect_b32 s65, 0x7ff, s65
s_min_u32 s63, s63, s65
v_cmp_eq_f32 vcc, v39, v48
s_nop 3
s_ff1_i32_b64 s64, vcc
s_lshl_b32 s65, s64, 2
s_add_u32 s65, s65, 1283
s_cmp_lt_i32 s64, 0
s_cselect_b32 s65, 0x7ff, s65
s_min_u32 s63, s63, s65
v_cmp_eq_f32 vcc, v40, v48
s_nop 3
s_ff1_i32_b64 s64, vcc
s_lshl_b32 s65, s64, 2
s_add_u32 s65, s65, 1536
s_cmp_lt_i32 s64, 0
s_cselect_b32 s65, 0x7ff, s65
s_min_u32 s63, s63, s65
v_cmp_eq_f32 vcc, v41, v48
s_nop 3
s_ff1_i32_b64 s64, vcc
s_lshl_b32 s65, s64, 2
s_add_u32 s65, s65, 1537
s_cmp_lt_i32 s64, 0
s_cselect_b32 s65, 0x7ff, s65
s_min_u32 s63, s63, s65
v_cmp_eq_f32 vcc, v42, v48
s_nop 3
s_ff1_i32_b64 s64, vcc
s_lshl_b32 s65, s64, 2
s_add_u32 s65, s65, 1538
s_cmp_lt_i32 s64, 0
s_cselect_b32 s65, 0x7ff, s65
s_min_u32 s63, s63, s65
v_cmp_eq_f32 vcc, v43, v48
s_nop 3
s_ff1_i32_b64 s64, vcc
s_lshl_b32 s65, s64, 2
s_add_u32 s65, s65, 1539
s_cmp_lt_i32 s64, 0
s_cselect_b32 s65, 0x7ff, s65
s_min_u32 s63, s63, s65
v_cmp_eq_f32 vcc, v44, v48
s_nop 3
s_ff1_i32_b64 s64, vcc
s_lshl_b32 s65, s64, 2
s_add_u32 s65, s65, 1792
s_cmp_lt_i32 s64, 0
s_cselect_b32 s65, 0x7ff, s65
s_min_u32 s63, s63, s65
v_cmp_eq_f32 vcc, v45, v48
s_nop 3
s_ff1_i32_b64 s64, vcc
s_lshl_b32 s65, s64, 2
s_add_u32 s65, s65, 1793
s_cmp_lt_i32 s64, 0
s_cselect_b32 s65, 0x7ff, s65
s_min_u32 s63, s63, s65
v_cmp_eq_f32 vcc, v46, v48
s_nop 3
s_ff1_i32_b64 s64, vcc
s_lshl_b32 s65, s64, 2
s_add_u32 s65, s65, 1794
s_cmp_lt_i32 s64, 0
s_cselect_b32 s65, 0x7ff, s65
s_min_u32 s63, s63, s65
v_cmp_eq_f32 vcc, v47, v48
s_nop 3
s_ff1_i32_b64 s64, vcc
s_lshl_b32 s65, s64, 2
s_add_u32 s65, s65, 1795
s_cmp_lt_i32 s64, 0
s_cselect_b32 s65, 0x7ff, s65
s_min_u32 s63, s63, s65
s_cmp_lg_u32 s62, 0
s_cbranch_scc1 L_mo_a
v_mov_b32 v55, v48
v_mul_f32 v56, 0x3fb8aa3b, v55
v_sub_f32 v56, 0, v56
v_exp_f32 v56, v56
s_nop 0
v_add_f32 v56, 1.0, v56
v_rcp_f32 v55, v56
s_nop 0
v_mov_b32 v54, s63
v_mov_b32 v56, 0
s_mov_b32 s64, 50348032
buffer_store_dwordx2 v[54:55], v56, s[20:23], s64 offen sc1
s_waitcnt vmcnt(0)
v_mov_b32 v56, 196
v_mov_b32 v57, 0x10000
s_mov_b64 exec, 1
global_atomic_add v56, v57, s[28:29]
s_mov_b64 exec, -1
L_mo_a:
s_lshl_b32 s64, s63, 10
s_lshl_b32 s65, s68, 8
s_add_u32 s64, s64, s65
v_lshlrev_b32 v11, 1, v9
buffer_load_ushort v16, v11, s[4:7], s64 offen offset:0
buffer_load_ushort v17, v11, s[4:7], s64 offen offset:16
buffer_load_ushort v18, v11, s[4:7], s64 offen offset:32
buffer_load_ushort v19, v11, s[4:7], s64 offen offset:48
buffer_load_ushort v20, v11, s[4:7], s64 offen offset:64
buffer_load_ushort v21, v11, s[4:7], s64 offen offset:80
buffer_load_ushort v22, v11, s[4:7], s64 offen offset:96
buffer_load_ushort v23, v11, s[4:7], s64 offen offset:112
buffer_load_ushort v24, v11, s[4:7], s64 offen offset:128
buffer_load_ushort v25, v11, s[4:7], s64 offen offset:144
buffer_load_ushort v26, v11, s[4:7], s64 offen offset:160
buffer_load_ushort v27, v11, s[4:7], s64 offen offset:176
buffer_load_ushort v28, v11, s[4:7], s64 offen offset:192
buffer_load_ushort v29, v11, s[4:7], s64 offen offset:208
buffer_load_ushort v30, v11, s[4:7], s64 offen offset:224
buffer_load_ushort v31, v11, s[4:7], s64 offen offset:240
v_mov_b32 v32, 0
v_mov_b32 v33, 0
v_mov_b32 v34, 0
v_mov_b32 v35, 0
v_mov_b32 v36, 0
v_mov_b32 v37, 0
v_mov_b32 v38, 0
v_mov_b32 v39, 0
v_mov_b32 v40, 0
v_mov_b32 v41, 0
v_mov_b32 v42, 0
v_mov_b32 v43, 0
v_mov_b32 v44, 0
v_mov_b32 v45, 0
v_mov_b32 v46, 0
v_mov_b32 v47, 0
s_waitcnt vmcnt(15)
v_lshlrev_b32 v48, 16, v16
v_lshlrev_b32 v49, 16, v128
v_and_b32 v50, 0xffff0000, v128
v_fmac_f32 v32, v49, v48
v_fmac_f32 v33, v50, v48
v_lshlrev_b32 v49, 16, v129
v_and_b32 v50, 0xffff0000, v129
v_fmac_f32 v34, v49, v48
v_fmac_f32 v35, v50, v48
v_lshlrev_b32 v49, 16, v130
v_and_b32 v50, 0xffff0000, v130
v_fmac_f32 v36, v49, v48
v_fmac_f32 v37, v50, v48
v_lshlrev_b32 v49, 16, v131
v_and_b32 v50, 0xffff0000, v131
v_fmac_f32 v38, v49, v48
v_fmac_f32 v39, v50, v48
v_lshlrev_b32 v49, 16, v192
v_and_b32 v50, 0xffff0000, v192
v_fmac_f32 v40, v49, v48
v_fmac_f32 v41, v50, v48
v_lshlrev_b32 v49, 16, v193
v_and_b32 v50, 0xffff0000, v193
v_fmac_f32 v42, v49, v48
v_fmac_f32 v43, v50, v48
v_lshlrev_b32 v49, 16, v194
v_and_b32 v50, 0xffff0000, v194
v_fmac_f32 v44, v49, v48
v_fmac_f32 v45, v50, v48
v_lshlrev_b32 v49, 16, v195
v_and_b32 v50, 0xffff0000, v195
v_fmac_f32 v46, v49, v48
v_fmac_f32 v47, v50, v48
s_waitcnt vmcnt(14)
v_lshlrev_b32 v48, 16, v17
v_lshlrev_b32 v49, 16, v132
v_and_b32 v50, 0xffff0000, v132
v_fmac_f32 v32, v49, v48
v_fmac_f32 v33, v50, v48
v_lshlrev_b32 v49, 16, v133
v_and_b32 v50, 0xffff0000, v133
v_fmac_f32 v34, v49, v48
v_fmac_f32 v35, v50, v48
v_lshlrev_b32 v49, 16, v134
v_and_b32 v50, 0xffff0000, v134
v_fmac_f32 v36, v49, v48
v_fmac_f32 v37, v50, v48
v_lshlrev_b32 v49, 16, v135
v_and_b32 v50, 0xffff0000, v135
v_fmac_f32 v38, v49, v48
v_fmac_f32 v39, v50, v48
v_lshlrev_b32 v49, 16, v196
v_and_b32 v50, 0xffff0000, v196
v_fmac_f32 v40, v49, v48
v_fmac_f32 v41, v50, v48
v_lshlrev_b32 v49, 16, v197
v_and_b32 v50, 0xffff0000, v197
v_fmac_f32 v42, v49, v48
v_fmac_f32 v43, v50, v48
v_lshlrev_b32 v49, 16, v198
v_and_b32 v50, 0xffff0000, v198
v_fmac_f32 v44, v49, v48
v_fmac_f32 v45, v50, v48
v_lshlrev_b32 v49, 16, v199
v_and_b32 v50, 0xffff0000, v199
v_fmac_f32 v46, v49, v48
v_fmac_f32 v47, v50, v48
s_waitcnt vmcnt(13)
v_lshlrev_b32 v48, 16, v18
v_lshlrev_b32 v49, 16, v136
v_and_b32 v50, 0xffff0000, v136
v_fmac_f32 v32, v49, v48
v_fmac_f32 v33, v50, v48
v_lshlrev_b32 v49, 16, v137
v_and_b32 v50, 0xffff0000, v137
v_fmac_f32 v34, v49, v48
v_fmac_f32 v35, v50, v48
v_lshlrev_b32 v49, 16, v138
v_and_b32 v50, 0xffff0000, v138
v_fmac_f32 v36, v49, v48
v_fmac_f32 v37, v50, v48
v_lshlrev_b32 v49, 16, v139
v_and_b32 v50, 0xffff0000, v139
v_fmac_f32 v38, v49, v48
v_fmac_f32 v39, v50, v48
v_lshlrev_b32 v49, 16, v200
v_and_b32 v50, 0xffff0000, v200
v_fmac_f32 v40, v49, v48
v_fmac_f32 v41, v50, v48
v_lshlrev_b32 v49, 16, v201
v_and_b32 v50, 0xffff0000, v201
v_fmac_f32 v42, v49, v48
v_fmac_f32 v43, v50, v48
v_lshlrev_b32 v49, 16, v202
v_and_b32 v50, 0xffff0000, v202
v_fmac_f32 v44, v49, v48
v_fmac_f32 v45, v50, v48
v_lshlrev_b32 v49, 16, v203
v_and_b32 v50, 0xffff0000, v203
v_fmac_f32 v46, v49, v48
v_fmac_f32 v47, v50, v48
s_waitcnt vmcnt(12)
v_lshlrev_b32 v48, 16, v19
v_lshlrev_b32 v49, 16, v140
v_and_b32 v50, 0xffff0000, v140
v_fmac_f32 v32, v49, v48
v_fmac_f32 v33, v50, v48
v_lshlrev_b32 v49, 16, v141
v_and_b32 v50, 0xffff0000, v141
v_fmac_f32 v34, v49, v48
v_fmac_f32 v35, v50, v48
v_lshlrev_b32 v49, 16, v142
v_and_b32 v50, 0xffff0000, v142
v_fmac_f32 v36, v49, v48
v_fmac_f32 v37, v50, v48
v_lshlrev_b32 v49, 16, v143
v_and_b32 v50, 0xffff0000, v143
v_fmac_f32 v38, v49, v48
v_fmac_f32 v39, v50, v48
v_lshlrev_b32 v49, 16, v204
v_and_b32 v50, 0xffff0000, v204
v_fmac_f32 v40, v49, v48
v_fmac_f32 v41, v50, v48
v_lshlrev_b32 v49, 16, v205
v_and_b32 v50, 0xffff0000, v205
v_fmac_f32 v42, v49, v48
v_fmac_f32 v43, v50, v48
v_lshlrev_b32 v49, 16, v206
v_and_b32 v50, 0xffff0000, v206
v_fmac_f32 v44, v49, v48
v_fmac_f32 v45, v50, v48
v_lshlrev_b32 v49, 16, v207
v_and_b32 v50, 0xffff0000, v207
v_fmac_f32 v46, v49, v48
v_fmac_f32 v47, v50, v48
s_waitcnt vmcnt(11)
v_lshlrev_b32 v48, 16, v20
v_lshlrev_b32 v49, 16, v144
v_and_b32 v50, 0xffff0000, v144
v_fmac_f32 v32, v49, v48
v_fmac_f32 v33, v50, v48
v_lshlrev_b32 v49, 16, v145
v_and_b32 v50, 0xffff0000, v145
v_fmac_f32 v34, v49, v48
v_fmac_f32 v35, v50, v48
v_lshlrev_b32 v49, 16, v146
v_and_b32 v50, 0xffff0000, v146
v_fmac_f32 v36, v49, v48
v_fmac_f32 v37, v50, v48
v_lshlrev_b32 v49, 16, v147
v_and_b32 v50, 0xffff0000, v147
v_fmac_f32 v38, v49, v48
v_fmac_f32 v39, v50, v48
v_lshlrev_b32 v49, 16, v208
v_and_b32 v50, 0xffff0000, v208
v_fmac_f32 v40, v49, v48
v_fmac_f32 v41, v50, v48
v_lshlrev_b32 v49, 16, v209
v_and_b32 v50, 0xffff0000, v209
v_fmac_f32 v42, v49, v48
v_fmac_f32 v43, v50, v48
v_lshlrev_b32 v49, 16, v210
v_and_b32 v50, 0xffff0000, v210
v_fmac_f32 v44, v49, v48
v_fmac_f32 v45, v50, v48
v_lshlrev_b32 v49, 16, v211
v_and_b32 v50, 0xffff0000, v211
v_fmac_f32 v46, v49, v48
v_fmac_f32 v47, v50, v48
s_waitcnt vmcnt(10)
v_lshlrev_b32 v48, 16, v21
v_lshlrev_b32 v49, 16, v148
v_and_b32 v50, 0xffff0000, v148
v_fmac_f32 v32, v49, v48
v_fmac_f32 v33, v50, v48
v_lshlrev_b32 v49, 16, v149
v_and_b32 v50, 0xffff0000, v149
v_fmac_f32 v34, v49, v48
v_fmac_f32 v35, v50, v48
v_lshlrev_b32 v49, 16, v150
v_and_b32 v50, 0xffff0000, v150
v_fmac_f32 v36, v49, v48
v_fmac_f32 v37, v50, v48
v_lshlrev_b32 v49, 16, v151
v_and_b32 v50, 0xffff0000, v151
v_fmac_f32 v38, v49, v48
v_fmac_f32 v39, v50, v48
v_lshlrev_b32 v49, 16, v212
v_and_b32 v50, 0xffff0000, v212
v_fmac_f32 v40, v49, v48
v_fmac_f32 v41, v50, v48
v_lshlrev_b32 v49, 16, v213
v_and_b32 v50, 0xffff0000, v213
v_fmac_f32 v42, v49, v48
v_fmac_f32 v43, v50, v48
v_lshlrev_b32 v49, 16, v214
v_and_b32 v50, 0xffff0000, v214
v_fmac_f32 v44, v49, v48
v_fmac_f32 v45, v50, v48
v_lshlrev_b32 v49, 16, v215
v_and_b32 v50, 0xffff0000, v215
v_fmac_f32 v46, v49, v48
v_fmac_f32 v47, v50, v48
s_waitcnt vmcnt(9)
v_lshlrev_b32 v48, 16, v22
v_lshlrev_b32 v49, 16, v152
v_and_b32 v50, 0xffff0000, v152
v_fmac_f32 v32, v49, v48
v_fmac_f32 v33, v50, v48
v_lshlrev_b32 v49, 16, v153
v_and_b32 v50, 0xffff0000, v153
v_fmac_f32 v34, v49, v48
v_fmac_f32 v35, v50, v48
v_lshlrev_b32 v49, 16, v154
v_and_b32 v50, 0xffff0000, v154
v_fmac_f32 v36, v49, v48
v_fmac_f32 v37, v50, v48
v_lshlrev_b32 v49, 16, v155
v_and_b32 v50, 0xffff0000, v155
v_fmac_f32 v38, v49, v48
v_fmac_f32 v39, v50, v48
v_lshlrev_b32 v49, 16, v216
v_and_b32 v50, 0xffff0000, v216
v_fmac_f32 v40, v49, v48
v_fmac_f32 v41, v50, v48
v_lshlrev_b32 v49, 16, v217
v_and_b32 v50, 0xffff0000, v217
v_fmac_f32 v42, v49, v48
v_fmac_f32 v43, v50, v48
v_lshlrev_b32 v49, 16, v218
v_and_b32 v50, 0xffff0000, v218
v_fmac_f32 v44, v49, v48
v_fmac_f32 v45, v50, v48
v_lshlrev_b32 v49, 16, v219
v_and_b32 v50, 0xffff0000, v219
v_fmac_f32 v46, v49, v48
v_fmac_f32 v47, v50, v48
s_waitcnt vmcnt(8)
v_lshlrev_b32 v48, 16, v23
v_lshlrev_b32 v49, 16, v156
v_and_b32 v50, 0xffff0000, v156
v_fmac_f32 v32, v49, v48
v_fmac_f32 v33, v50, v48
v_lshlrev_b32 v49, 16, v157
v_and_b32 v50, 0xffff0000, v157
v_fmac_f32 v34, v49, v48
v_fmac_f32 v35, v50, v48
v_lshlrev_b32 v49, 16, v158
v_and_b32 v50, 0xffff0000, v158
v_fmac_f32 v36, v49, v48
v_fmac_f32 v37, v50, v48
v_lshlrev_b32 v49, 16, v159
v_and_b32 v50, 0xffff0000, v159
v_fmac_f32 v38, v49, v48
v_fmac_f32 v39, v50, v48
v_lshlrev_b32 v49, 16, v220
v_and_b32 v50, 0xffff0000, v220
v_fmac_f32 v40, v49, v48
v_fmac_f32 v41, v50, v48
v_lshlrev_b32 v49, 16, v221
v_and_b32 v50, 0xffff0000, v221
v_fmac_f32 v42, v49, v48
v_fmac_f32 v43, v50, v48
v_lshlrev_b32 v49, 16, v222
v_and_b32 v50, 0xffff0000, v222
v_fmac_f32 v44, v49, v48
v_fmac_f32 v45, v50, v48
v_lshlrev_b32 v49, 16, v223
v_and_b32 v50, 0xffff0000, v223
v_fmac_f32 v46, v49, v48
v_fmac_f32 v47, v50, v48
s_waitcnt vmcnt(7)
v_lshlrev_b32 v48, 16, v24
v_lshlrev_b32 v49, 16, v160
v_and_b32 v50, 0xffff0000, v160
v_fmac_f32 v32, v49, v48
v_fmac_f32 v33, v50, v48
v_lshlrev_b32 v49, 16, v161
v_and_b32 v50, 0xffff0000, v161
v_fmac_f32 v34, v49, v48
v_fmac_f32 v35, v50, v48
v_lshlrev_b32 v49, 16, v162
v_and_b32 v50, 0xffff0000, v162
v_fmac_f32 v36, v49, v48
v_fmac_f32 v37, v50, v48
v_lshlrev_b32 v49, 16, v163
v_and_b32 v50, 0xffff0000, v163
v_fmac_f32 v38, v49, v48
v_fmac_f32 v39, v50, v48
v_lshlrev_b32 v49, 16, v224
v_and_b32 v50, 0xffff0000, v224
v_fmac_f32 v40, v49, v48
v_fmac_f32 v41, v50, v48
v_lshlrev_b32 v49, 16, v225
v_and_b32 v50, 0xffff0000, v225
v_fmac_f32 v42, v49, v48
v_fmac_f32 v43, v50, v48
v_lshlrev_b32 v49, 16, v226
v_and_b32 v50, 0xffff0000, v226
v_fmac_f32 v44, v49, v48
v_fmac_f32 v45, v50, v48
v_lshlrev_b32 v49, 16, v227
v_and_b32 v50, 0xffff0000, v227
v_fmac_f32 v46, v49, v48
v_fmac_f32 v47, v50, v48
s_waitcnt vmcnt(6)
v_lshlrev_b32 v48, 16, v25
v_lshlrev_b32 v49, 16, v164
v_and_b32 v50, 0xffff0000, v164
v_fmac_f32 v32, v49, v48
v_fmac_f32 v33, v50, v48
v_lshlrev_b32 v49, 16, v165
v_and_b32 v50, 0xffff0000, v165
v_fmac_f32 v34, v49, v48
v_fmac_f32 v35, v50, v48
v_lshlrev_b32 v49, 16, v166
v_and_b32 v50, 0xffff0000, v166
v_fmac_f32 v36, v49, v48
v_fmac_f32 v37, v50, v48
v_lshlrev_b32 v49, 16, v167
v_and_b32 v50, 0xffff0000, v167
v_fmac_f32 v38, v49, v48
v_fmac_f32 v39, v50, v48
v_lshlrev_b32 v49, 16, v228
v_and_b32 v50, 0xffff0000, v228
v_fmac_f32 v40, v49, v48
v_fmac_f32 v41, v50, v48
v_lshlrev_b32 v49, 16, v229
v_and_b32 v50, 0xffff0000, v229
v_fmac_f32 v42, v49, v48
v_fmac_f32 v43, v50, v48
v_lshlrev_b32 v49, 16, v230
v_and_b32 v50, 0xffff0000, v230
v_fmac_f32 v44, v49, v48
v_fmac_f32 v45, v50, v48
v_lshlrev_b32 v49, 16, v231
v_and_b32 v50, 0xffff0000, v231
v_fmac_f32 v46, v49, v48
v_fmac_f32 v47, v50, v48
s_waitcnt vmcnt(5)
v_lshlrev_b32 v48, 16, v26
v_lshlrev_b32 v49, 16, v168
v_and_b32 v50, 0xffff0000, v168
v_fmac_f32 v32, v49, v48
v_fmac_f32 v33, v50, v48
v_lshlrev_b32 v49, 16, v169
v_and_b32 v50, 0xffff0000, v169
v_fmac_f32 v34, v49, v48
v_fmac_f32 v35, v50, v48
v_lshlrev_b32 v49, 16, v170
v_and_b32 v50, 0xffff0000, v170
v_fmac_f32 v36, v49, v48
v_fmac_f32 v37, v50, v48
v_lshlrev_b32 v49, 16, v171
v_and_b32 v50, 0xffff0000, v171
v_fmac_f32 v38, v49, v48
v_fmac_f32 v39, v50, v48
v_lshlrev_b32 v49, 16, v232
v_and_b32 v50, 0xffff0000, v232
v_fmac_f32 v40, v49, v48
v_fmac_f32 v41, v50, v48
v_lshlrev_b32 v49, 16, v233
v_and_b32 v50, 0xffff0000, v233
v_fmac_f32 v42, v49, v48
v_fmac_f32 v43, v50, v48
v_lshlrev_b32 v49, 16, v234
v_and_b32 v50, 0xffff0000, v234
v_fmac_f32 v44, v49, v48
v_fmac_f32 v45, v50, v48
v_lshlrev_b32 v49, 16, v235
v_and_b32 v50, 0xffff0000, v235
v_fmac_f32 v46, v49, v48
v_fmac_f32 v47, v50, v48
s_waitcnt vmcnt(4)
v_lshlrev_b32 v48, 16, v27
v_lshlrev_b32 v49, 16, v172
v_and_b32 v50, 0xffff0000, v172
v_fmac_f32 v32, v49, v48
v_fmac_f32 v33, v50, v48
v_lshlrev_b32 v49, 16, v173
v_and_b32 v50, 0xffff0000, v173
v_fmac_f32 v34, v49, v48
v_fmac_f32 v35, v50, v48
v_lshlrev_b32 v49, 16, v174
v_and_b32 v50, 0xffff0000, v174
v_fmac_f32 v36, v49, v48
v_fmac_f32 v37, v50, v48
v_lshlrev_b32 v49, 16, v175
v_and_b32 v50, 0xffff0000, v175
v_fmac_f32 v38, v49, v48
v_fmac_f32 v39, v50, v48
v_lshlrev_b32 v49, 16, v236
v_and_b32 v50, 0xffff0000, v236
v_fmac_f32 v40, v49, v48
v_fmac_f32 v41, v50, v48
v_lshlrev_b32 v49, 16, v237
v_and_b32 v50, 0xffff0000, v237
v_fmac_f32 v42, v49, v48
v_fmac_f32 v43, v50, v48
v_lshlrev_b32 v49, 16, v238
v_and_b32 v50, 0xffff0000, v238
v_fmac_f32 v44, v49, v48
v_fmac_f32 v45, v50, v48
v_lshlrev_b32 v49, 16, v239
v_and_b32 v50, 0xffff0000, v239
v_fmac_f32 v46, v49, v48
v_fmac_f32 v47, v50, v48
s_waitcnt vmcnt(3)
v_lshlrev_b32 v48, 16, v28
v_lshlrev_b32 v49, 16, v176
v_and_b32 v50, 0xffff0000, v176
v_fmac_f32 v32, v49, v48
v_fmac_f32 v33, v50, v48
v_lshlrev_b32 v49, 16, v177
v_and_b32 v50, 0xffff0000, v177
v_fmac_f32 v34, v49, v48
v_fmac_f32 v35, v50, v48
v_lshlrev_b32 v49, 16, v178
v_and_b32 v50, 0xffff0000, v178
v_fmac_f32 v36, v49, v48
v_fmac_f32 v37, v50, v48
v_lshlrev_b32 v49, 16, v179
v_and_b32 v50, 0xffff0000, v179
v_fmac_f32 v38, v49, v48
v_fmac_f32 v39, v50, v48
v_lshlrev_b32 v49, 16, v240
v_and_b32 v50, 0xffff0000, v240
v_fmac_f32 v40, v49, v48
v_fmac_f32 v41, v50, v48
v_lshlrev_b32 v49, 16, v241
v_and_b32 v50, 0xffff0000, v241
v_fmac_f32 v42, v49, v48
v_fmac_f32 v43, v50, v48
v_lshlrev_b32 v49, 16, v242
v_and_b32 v50, 0xffff0000, v242
v_fmac_f32 v44, v49, v48
v_fmac_f32 v45, v50, v48
v_lshlrev_b32 v49, 16, v243
v_and_b32 v50, 0xffff0000, v243
v_fmac_f32 v46, v49, v48
v_fmac_f32 v47, v50, v48
s_waitcnt vmcnt(2)
v_lshlrev_b32 v48, 16, v29
v_lshlrev_b32 v49, 16, v180
v_and_b32 v50, 0xffff0000, v180
v_fmac_f32 v32, v49, v48
v_fmac_f32 v33, v50, v48
v_lshlrev_b32 v49, 16, v181
v_and_b32 v50, 0xffff0000, v181
v_fmac_f32 v34, v49, v48
v_fmac_f32 v35, v50, v48
v_lshlrev_b32 v49, 16, v182
v_and_b32 v50, 0xffff0000, v182
v_fmac_f32 v36, v49, v48
v_fmac_f32 v37, v50, v48
v_lshlrev_b32 v49, 16, v183
v_and_b32 v50, 0xffff0000, v183
v_fmac_f32 v38, v49, v48
v_fmac_f32 v39, v50, v48
v_lshlrev_b32 v49, 16, v244
v_and_b32 v50, 0xffff0000, v244
v_fmac_f32 v40, v49, v48
v_fmac_f32 v41, v50, v48
v_lshlrev_b32 v49, 16, v245
v_and_b32 v50, 0xffff0000, v245
v_fmac_f32 v42, v49, v48
v_fmac_f32 v43, v50, v48
v_lshlrev_b32 v49, 16, v246
v_and_b32 v50, 0xffff0000, v246
v_fmac_f32 v44, v49, v48
v_fmac_f32 v45, v50, v48
v_lshlrev_b32 v49, 16, v247
v_and_b32 v50, 0xffff0000, v247
v_fmac_f32 v46, v49, v48
v_fmac_f32 v47, v50, v48
s_waitcnt vmcnt(1)
v_lshlrev_b32 v48, 16, v30
v_lshlrev_b32 v49, 16, v184
v_and_b32 v50, 0xffff0000, v184
v_fmac_f32 v32, v49, v48
v_fmac_f32 v33, v50, v48
v_lshlrev_b32 v49, 16, v185
v_and_b32 v50, 0xffff0000, v185
v_fmac_f32 v34, v49, v48
v_fmac_f32 v35, v50, v48
v_lshlrev_b32 v49, 16, v186
v_and_b32 v50, 0xffff0000, v186
v_fmac_f32 v36, v49, v48
v_fmac_f32 v37, v50, v48
v_lshlrev_b32 v49, 16, v187
v_and_b32 v50, 0xffff0000, v187
v_fmac_f32 v38, v49, v48
v_fmac_f32 v39, v50, v48
v_lshlrev_b32 v49, 16, v248
v_and_b32 v50, 0xffff0000, v248
v_fmac_f32 v40, v49, v48
v_fmac_f32 v41, v50, v48
v_lshlrev_b32 v49, 16, v249
v_and_b32 v50, 0xffff0000, v249
v_fmac_f32 v42, v49, v48
v_fmac_f32 v43, v50, v48
v_lshlrev_b32 v49, 16, v250
v_and_b32 v50, 0xffff0000, v250
v_fmac_f32 v44, v49, v48
v_fmac_f32 v45, v50, v48
v_lshlrev_b32 v49, 16, v251
v_and_b32 v50, 0xffff0000, v251
v_fmac_f32 v46, v49, v48
v_fmac_f32 v47, v50, v48
s_waitcnt vmcnt(0)
v_lshlrev_b32 v48, 16, v31
v_lshlrev_b32 v49, 16, v188
v_and_b32 v50, 0xffff0000, v188
v_fmac_f32 v32, v49, v48
v_fmac_f32 v33, v50, v48
v_lshlrev_b32 v49, 16, v189
v_and_b32 v50, 0xffff0000, v189
v_fmac_f32 v34, v49, v48
v_fmac_f32 v35, v50, v48
v_lshlrev_b32 v49, 16, v190
v_and_b32 v50, 0xffff0000, v190
v_fmac_f32 v36, v49, v48
v_fmac_f32 v37, v50, v48
v_lshlrev_b32 v49, 16, v191
v_and_b32 v50, 0xffff0000, v191
v_fmac_f32 v38, v49, v48
v_fmac_f32 v39, v50, v48
v_lshlrev_b32 v49, 16, v252
v_and_b32 v50, 0xffff0000, v252
v_fmac_f32 v40, v49, v48
v_fmac_f32 v41, v50, v48
v_lshlrev_b32 v49, 16, v253
v_and_b32 v50, 0xffff0000, v253
v_fmac_f32 v42, v49, v48
v_fmac_f32 v43, v50, v48
v_lshlrev_b32 v49, 16, v254
v_and_b32 v50, 0xffff0000, v254
v_fmac_f32 v44, v49, v48
v_fmac_f32 v45, v50, v48
v_lshlrev_b32 v49, 16, v255
v_and_b32 v50, 0xffff0000, v255
v_fmac_f32 v46, v49, v48
v_fmac_f32 v47, v50, v48
s_nop 2
v_xor_b32 v48, 8, v8
v_lshlrev_b32 v48, 2, v48
ds_bpermute_b32 v16, v48, v32
ds_bpermute_b32 v17, v48, v33
ds_bpermute_b32 v18, v48, v34
ds_bpermute_b32 v19, v48, v35
ds_bpermute_b32 v20, v48, v36
ds_bpermute_b32 v21, v48, v37
ds_bpermute_b32 v22, v48, v38
ds_bpermute_b32 v23, v48, v39
ds_bpermute_b32 v24, v48, v40
ds_bpermute_b32 v25, v48, v41
ds_bpermute_b32 v26, v48, v42
ds_bpermute_b32 v27, v48, v43
ds_bpermute_b32 v28, v48, v44
ds_bpermute_b32 v29, v48, v45
ds_bpermute_b32 v30, v48, v46
ds_bpermute_b32 v31, v48, v47
s_waitcnt lgkmcnt(15)
v_add_f32 v32, v32, v16
s_waitcnt lgkmcnt(14)
v_add_f32 v33, v33, v17
s_waitcnt lgkmcnt(13)
v_add_f32 v34, v34, v18
s_waitcnt lgkmcnt(12)
v_add_f32 v35, v35, v19
s_waitcnt lgkmcnt(11)
v_add_f32 v36, v36, v20
s_waitcnt lgkmcnt(10)
v_add_f32 v37, v37, v21
s_waitcnt lgkmcnt(9)
v_add_f32 v38, v38, v22
s_waitcnt lgkmcnt(8)
v_add_f32 v39, v39, v23
s_waitcnt lgkmcnt(7)
v_add_f32 v40, v40, v24
s_waitcnt lgkmcnt(6)
v_add_f32 v41, v41, v25
s_waitcnt lgkmcnt(5)
v_add_f32 v42, v42, v26
s_waitcnt lgkmcnt(4)
v_add_f32 v43, v43, v27
s_waitcnt lgkmcnt(3)
v_add_f32 v44, v44, v28
s_waitcnt lgkmcnt(2)
v_add_f32 v45, v45, v29
s_waitcnt lgkmcnt(1)
v_add_f32 v46, v46, v30
s_waitcnt lgkmcnt(0)
v_add_f32 v47, v47, v31
v_xor_b32 v48, 16, v8
v_lshlrev_b32 v48, 2, v48
ds_bpermute_b32 v16, v48, v32
ds_bpermute_b32 v17, v48, v33
ds_bpermute_b32 v18, v48, v34
ds_bpermute_b32 v19, v48, v35
ds_bpermute_b32 v20, v48, v36
ds_bpermute_b32 v21, v48, v37
ds_bpermute_b32 v22, v48, v38
ds_bpermute_b32 v23, v48, v39
ds_bpermute_b32 v24, v48, v40
ds_bpermute_b32 v25, v48, v41
ds_bpermute_b32 v26, v48, v42
ds_bpermute_b32 v27, v48, v43
ds_bpermute_b32 v28, v48, v44
ds_bpermute_b32 v29, v48, v45
ds_bpermute_b32 v30, v48, v46
ds_bpermute_b32 v31, v48, v47
s_waitcnt lgkmcnt(15)
v_add_f32 v32, v32, v16
s_waitcnt lgkmcnt(14)
v_add_f32 v33, v33, v17
s_waitcnt lgkmcnt(13)
v_add_f32 v34, v34, v18
s_waitcnt lgkmcnt(12)
v_add_f32 v35, v35, v19
s_waitcnt lgkmcnt(11)
v_add_f32 v36, v36, v20
s_waitcnt lgkmcnt(10)
v_add_f32 v37, v37, v21
s_waitcnt lgkmcnt(9)
v_add_f32 v38, v38, v22
s_waitcnt lgkmcnt(8)
v_add_f32 v39, v39, v23
s_waitcnt lgkmcnt(7)
v_add_f32 v40, v40, v24
s_waitcnt lgkmcnt(6)
v_add_f32 v41, v41, v25
s_waitcnt lgkmcnt(5)
v_add_f32 v42, v42, v26
s_waitcnt lgkmcnt(4)
v_add_f32 v43, v43, v27
s_waitcnt lgkmcnt(3)
v_add_f32 v44, v44, v28
s_waitcnt lgkmcnt(2)
v_add_f32 v45, v45, v29
s_waitcnt lgkmcnt(1)
v_add_f32 v46, v46, v30
s_waitcnt lgkmcnt(0)
v_add_f32 v47, v47, v31
v_xor_b32 v48, 32, v8
v_lshlrev_b32 v48, 2, v48
ds_bpermute_b32 v16, v48, v32
ds_bpermute_b32 v17, v48, v33
ds_bpermute_b32 v18, v48, v34
ds_bpermute_b32 v19, v48, v35
ds_bpermute_b32 v20, v48, v36
ds_bpermute_b32 v21, v48, v37
ds_bpermute_b32 v22, v48, v38
ds_bpermute_b32 v23, v48, v39
ds_bpermute_b32 v24, v48, v40
ds_bpermute_b32 v25, v48, v41
ds_bpermute_b32 v26, v48, v42
ds_bpermute_b32 v27, v48, v43
ds_bpermute_b32 v28, v48, v44
ds_bpermute_b32 v29, v48, v45
ds_bpermute_b32 v30, v48, v46
ds_bpermute_b32 v31, v48, v47
s_waitcnt lgkmcnt(15)
v_add_f32 v32, v32, v16
s_waitcnt lgkmcnt(14)
v_add_f32 v33, v33, v17
s_waitcnt lgkmcnt(13)
v_add_f32 v34, v34, v18
s_waitcnt lgkmcnt(12)
v_add_f32 v35, v35, v19
s_waitcnt lgkmcnt(11)
v_add_f32 v36, v36, v20
s_waitcnt lgkmcnt(10)
v_add_f32 v37, v37, v21
s_waitcnt lgkmcnt(9)
v_add_f32 v38, v38, v22
s_waitcnt lgkmcnt(8)
v_add_f32 v39, v39, v23
s_waitcnt lgkmcnt(7)
v_add_f32 v40, v40, v24
s_waitcnt lgkmcnt(6)
v_add_f32 v41, v41, v25
s_waitcnt lgkmcnt(5)
v_add_f32 v42, v42, v26
s_waitcnt lgkmcnt(4)
v_add_f32 v43, v43, v27
s_waitcnt lgkmcnt(3)
v_add_f32 v44, v44, v28
s_waitcnt lgkmcnt(2)
v_add_f32 v45, v45, v29
s_waitcnt lgkmcnt(1)
v_add_f32 v46, v46, v30
s_waitcnt lgkmcnt(0)
v_add_f32 v47, v47, v31
v_and_b32 v11, 7, v8
v_lshlrev_b32 v11, 5, v11
s_mul_i32 s64, s68, 14336
s_lshl_b32 s65, s67, 8
s_add_u32 s64, s64, s65
s_add_u32 s64, s64, 50397184
s_add_u32 s65, s64, 7168
s_mov_b64 exec, 0xff
buffer_store_dwordx4 v[32:35], v11, s[20:23], s64 offen sc1
buffer_store_dwordx4 v[36:39], v11, s[20:23], s64 offen offset:16 sc1
buffer_store_dwordx4 v[40:43], v11, s[20:23], s65 offen sc1
buffer_store_dwordx4 v[44:47], v11, s[20:23], s65 offen offset:16 sc1
s_mov_b64 exec, -1
s_waitcnt vmcnt(0)
v_mov_b32 v12, s73
v_mov_b32 v13, 0x1000000
s_mov_b64 exec, 1
global_atomic_add v12, v13, s[28:29]
s_mov_b64 exec, -1
s_add_u32 s64, s69, 12
s_mov_b32 s66, 0
L_mo_d:
ds_read2st64_b32 v[14:15], v1 offset0:0 offset1:4
s_waitcnt lgkmcnt(0)
v_min_u32 v14, v14, v15
v_cmp_gt_u32 vcc, s64, v14
s_nop 1
s_cbranch_vccz L_mo_dx
s_sleep 8
s_add_u32 s66, s66, 1
s_cmp_lt_u32 s66, 0x100000
s_cbranch_scc1 L_mo_d
L_mo_dx:
v_lshlrev_b32 v12, 2, v8
v_and_b32 v12, 0x7c, v12
v_and_b32 v14, 31, v8
v_cmp_gt_u32 vcc, 24, v14
v_mov_b32 v15, 2
v_mov_b32 v14, 4
v_cndmask_b32 v14, v15, v14, vcc
s_mov_b32 s66, 0
L_mo_g:
global_load_dword v13, v12, s[28:29] offset:128 sc1
s_waitcnt vmcnt(0)
v_bfe_u32 v13, v13, 24, 4
v_cmp_ne_u32 vcc, v13, v14
s_nop 1
s_cbranch_vccz L_mo_gx
s_sleep 8
s_add_u32 s66, s66, 1
s_cmp_lt_u32 s66, 0x40000
s_cbranch_scc1 L_mo_g
L_mo_gx:
v_and_b32 v11, 15, v8
v_lshlrev_b32 v11, 2, v11
s_lshl_b32 s64, s62, 6
s_add_u32 s64, s64, 50397184
s_add_u32 s65, s64, 0
buffer_load_dword v16, v11, s[20:23], s65 offen sc1
s_add_u32 s65, s64, 7168
buffer_load_dword v17, v11, s[20:23], s65 offen sc1
s_add_u32 s65, s64, 14336
buffer_load_dword v18, v11, s[20:23], s65 offen sc1
s_add_u32 s65, s64, 21504
buffer_load_dword v19, v11, s[20:23], s65 offen sc1
s_add_u32 s65, s64, 28672
buffer_load_dword v20, v11, s[20:23], s65 offen sc1
s_add_u32 s65, s64, 35840
buffer_load_dword v21, v11, s[20:23], s65 offen sc1
s_add_u32 s65, s64, 43008
buffer_load_dword v22, v11, s[20:23], s65 offen sc1
s_add_u32 s65, s64, 50176
buffer_load_dword v23, v11, s[20:23], s65 offen sc1
s_waitcnt vmcnt(5)
v_add_f32 v16, v16, v18
s_waitcnt vmcnt(1)
v_add_f32 v20, v20, v22
v_add_f32 v16, v16, v20
v_add_f32 v17, v17, v19
s_waitcnt vmcnt(0)
v_add_f32 v21, v21, v23
v_add_f32 v17, v17, v21
v_mov_b32 v24, v16
v_mul_f32 v25, 0x3fb8aa3b, v24
v_sub_f32 v25, 0, v25
v_exp_f32 v25, v25
s_nop 0
v_add_f32 v25, 1.0, v25
v_rcp_f32 v24, v25
s_nop 0
v_mul_f32 v16, v16, v24
v_mul_f32 v16, v16, v17
v_cvt_pk_bf16_f32 v16, v16, v16
v_mov_b32 v32, 0
v_mov_b32 v33, 0
v_mov_b32 v34, 0
v_mov_b32 v35, 0
v_mov_b32 v36, 0
v_mov_b32 v37, 0
v_mov_b32 v38, 0
v_mov_b32 v39, 0
v_readlane_b32 s66, v16, 0
s_nop 3
s_and_b32 s64, s66, 0xffff
s_and_b32 s65, s66, 0xffff0000
v_lshlrev_b32 v49, 16, v64
v_and_b32 v50, 0xffff0000, v64
v_fmac_f32 v32, s65, v49
v_fmac_f32 v33, s65, v50
v_lshlrev_b32 v49, 16, v65
v_and_b32 v50, 0xffff0000, v65
v_fmac_f32 v34, s65, v49
v_fmac_f32 v35, s65, v50
v_lshlrev_b32 v49, 16, v66
v_and_b32 v50, 0xffff0000, v66
v_fmac_f32 v36, s65, v49
v_fmac_f32 v37, s65, v50
v_lshlrev_b32 v49, 16, v67
v_and_b32 v50, 0xffff0000, v67
v_fmac_f32 v38, s65, v49
v_fmac_f32 v39, s65, v50
v_readlane_b32 s66, v16, 1
s_nop 3
s_and_b32 s64, s66, 0xffff
s_and_b32 s65, s66, 0xffff0000
v_lshlrev_b32 v49, 16, v68
v_and_b32 v50, 0xffff0000, v68
v_fmac_f32 v32, s65, v49
v_fmac_f32 v33, s65, v50
v_lshlrev_b32 v49, 16, v69
v_and_b32 v50, 0xffff0000, v69
v_fmac_f32 v34, s65, v49
v_fmac_f32 v35, s65, v50
v_lshlrev_b32 v49, 16, v70
v_and_b32 v50, 0xffff0000, v70
v_fmac_f32 v36, s65, v49
v_fmac_f32 v37, s65, v50
v_lshlrev_b32 v49, 16, v71
v_and_b32 v50, 0xffff0000, v71
v_fmac_f32 v38, s65, v49
v_fmac_f32 v39, s65, v50
v_readlane_b32 s66, v16, 2
s_nop 3
s_and_b32 s64, s66, 0xffff
s_and_b32 s65, s66, 0xffff0000
v_lshlrev_b32 v49, 16, v72
v_and_b32 v50, 0xffff0000, v72
v_fmac_f32 v32, s65, v49
v_fmac_f32 v33, s65, v50
v_lshlrev_b32 v49, 16, v73
v_and_b32 v50, 0xffff0000, v73
v_fmac_f32 v34, s65, v49
v_fmac_f32 v35, s65, v50
v_lshlrev_b32 v49, 16, v74
v_and_b32 v50, 0xffff0000, v74
v_fmac_f32 v36, s65, v49
v_fmac_f32 v37, s65, v50
v_lshlrev_b32 v49, 16, v75
v_and_b32 v50, 0xffff0000, v75
v_fmac_f32 v38, s65, v49
v_fmac_f32 v39, s65, v50
v_readlane_b32 s66, v16, 3
s_nop 3
s_and_b32 s64, s66, 0xffff
s_and_b32 s65, s66, 0xffff0000
v_lshlrev_b32 v49, 16, v76
v_and_b32 v50, 0xffff0000, v76
v_fmac_f32 v32, s65, v49
v_fmac_f32 v33, s65, v50
v_lshlrev_b32 v49, 16, v77
v_and_b32 v50, 0xffff0000, v77
v_fmac_f32 v34, s65, v49
v_fmac_f32 v35, s65, v50
v_lshlrev_b32 v49, 16, v78
v_and_b32 v50, 0xffff0000, v78
v_fmac_f32 v36, s65, v49
v_fmac_f32 v37, s65, v50
v_lshlrev_b32 v49, 16, v79
v_and_b32 v50, 0xffff0000, v79
v_fmac_f32 v38, s65, v49
v_fmac_f32 v39, s65, v50
v_readlane_b32 s66, v16, 4
s_nop 3
s_and_b32 s64, s66, 0xffff
s_and_b32 s65, s66, 0xffff0000
v_lshlrev_b32 v49, 16, v80
v_and_b32 v50, 0xffff0000, v80
v_fmac_f32 v32, s65, v49
v_fmac_f32 v33, s65, v50
v_lshlrev_b32 v49, 16, v81
v_and_b32 v50, 0xffff0000, v81
v_fmac_f32 v34, s65, v49
v_fmac_f32 v35, s65, v50
v_lshlrev_b32 v49, 16, v82
v_and_b32 v50, 0xffff0000, v82
v_fmac_f32 v36, s65, v49
v_fmac_f32 v37, s65, v50
v_lshlrev_b32 v49, 16, v83
v_and_b32 v50, 0xffff0000, v83
v_fmac_f32 v38, s65, v49
v_fmac_f32 v39, s65, v50
v_readlane_b32 s66, v16, 5
s_nop 3
s_and_b32 s64, s66, 0xffff
s_and_b32 s65, s66, 0xffff0000
v_lshlrev_b32 v49, 16, v84
v_and_b32 v50, 0xffff0000, v84
v_fmac_f32 v32, s65, v49
v_fmac_f32 v33, s65, v50
v_lshlrev_b32 v49, 16, v85
v_and_b32 v50, 0xffff0000, v85
v_fmac_f32 v34, s65, v49
v_fmac_f32 v35, s65, v50
v_lshlrev_b32 v49, 16, v86
v_and_b32 v50, 0xffff0000, v86
v_fmac_f32 v36, s65, v49
v_fmac_f32 v37, s65, v50
v_lshlrev_b32 v49, 16, v87
v_and_b32 v50, 0xffff0000, v87
v_fmac_f32 v38, s65, v49
v_fmac_f32 v39, s65, v50
v_readlane_b32 s66, v16, 6
s_nop 3
s_and_b32 s64, s66, 0xffff
s_and_b32 s65, s66, 0xffff0000
v_lshlrev_b32 v49, 16, v88
v_and_b32 v50, 0xffff0000, v88
v_fmac_f32 v32, s65, v49
v_fmac_f32 v33, s65, v50
v_lshlrev_b32 v49, 16, v89
v_and_b32 v50, 0xffff0000, v89
v_fmac_f32 v34, s65, v49
v_fmac_f32 v35, s65, v50
v_lshlrev_b32 v49, 16, v90
v_and_b32 v50, 0xffff0000, v90
v_fmac_f32 v36, s65, v49
v_fmac_f32 v37, s65, v50
v_lshlrev_b32 v49, 16, v91
v_and_b32 v50, 0xffff0000, v91
v_fmac_f32 v38, s65, v49
v_fmac_f32 v39, s65, v50
v_readlane_b32 s66, v16, 7
s_nop 3
s_and_b32 s64, s66, 0xffff
s_and_b32 s65, s66, 0xffff0000
v_lshlrev_b32 v49, 16, v92
v_and_b32 v50, 0xffff0000, v92
v_fmac_f32 v32, s65, v49
v_fmac_f32 v33, s65, v50
v_lshlrev_b32 v49, 16, v93
v_and_b32 v50, 0xffff0000, v93
v_fmac_f32 v34, s65, v49
v_fmac_f32 v35, s65, v50
v_lshlrev_b32 v49, 16, v94
v_and_b32 v50, 0xffff0000, v94
v_fmac_f32 v36, s65, v49
v_fmac_f32 v37, s65, v50
v_lshlrev_b32 v49, 16, v95
v_and_b32 v50, 0xffff0000, v95
v_fmac_f32 v38, s65, v49
v_fmac_f32 v39, s65, v50
v_readlane_b32 s66, v16, 8
s_nop 3
s_and_b32 s64, s66, 0xffff
s_and_b32 s65, s66, 0xffff0000
v_lshlrev_b32 v49, 16, v96
v_and_b32 v50, 0xffff0000, v96
v_fmac_f32 v32, s65, v49
v_fmac_f32 v33, s65, v50
v_lshlrev_b32 v49, 16, v97
v_and_b32 v50, 0xffff0000, v97
v_fmac_f32 v34, s65, v49
v_fmac_f32 v35, s65, v50
v_lshlrev_b32 v49, 16, v98
v_and_b32 v50, 0xffff0000, v98
v_fmac_f32 v36, s65, v49
v_fmac_f32 v37, s65, v50
v_lshlrev_b32 v49, 16, v99
v_and_b32 v50, 0xffff0000, v99
v_fmac_f32 v38, s65, v49
v_fmac_f32 v39, s65, v50
v_readlane_b32 s66, v16, 9
s_nop 3
s_and_b32 s64, s66, 0xffff
s_and_b32 s65, s66, 0xffff0000
v_lshlrev_b32 v49, 16, v100
v_and_b32 v50, 0xffff0000, v100
v_fmac_f32 v32, s65, v49
v_fmac_f32 v33, s65, v50
v_lshlrev_b32 v49, 16, v101
v_and_b32 v50, 0xffff0000, v101
v_fmac_f32 v34, s65, v49
v_fmac_f32 v35, s65, v50
v_lshlrev_b32 v49, 16, v102
v_and_b32 v50, 0xffff0000, v102
v_fmac_f32 v36, s65, v49
v_fmac_f32 v37, s65, v50
v_lshlrev_b32 v49, 16, v103
v_and_b32 v50, 0xffff0000, v103
v_fmac_f32 v38, s65, v49
v_fmac_f32 v39, s65, v50
v_readlane_b32 s66, v16, 10
s_nop 3
s_and_b32 s64, s66, 0xffff
s_and_b32 s65, s66, 0xffff0000
v_lshlrev_b32 v49, 16, v104
v_and_b32 v50, 0xffff0000, v104
v_fmac_f32 v32, s65, v49
v_fmac_f32 v33, s65, v50
v_lshlrev_b32 v49, 16, v105
v_and_b32 v50, 0xffff0000, v105
v_fmac_f32 v34, s65, v49
v_fmac_f32 v35, s65, v50
v_lshlrev_b32 v49, 16, v106
v_and_b32 v50, 0xffff0000, v106
v_fmac_f32 v36, s65, v49
v_fmac_f32 v37, s65, v50
v_lshlrev_b32 v49, 16, v107
v_and_b32 v50, 0xffff0000, v107
v_fmac_f32 v38, s65, v49
v_fmac_f32 v39, s65, v50
v_readlane_b32 s66, v16, 11
s_nop 3
s_and_b32 s64, s66, 0xffff
s_and_b32 s65, s66, 0xffff0000
v_lshlrev_b32 v49, 16, v108
v_and_b32 v50, 0xffff0000, v108
v_fmac_f32 v32, s65, v49
v_fmac_f32 v33, s65, v50
v_lshlrev_b32 v49, 16, v109
v_and_b32 v50, 0xffff0000, v109
v_fmac_f32 v34, s65, v49
v_fmac_f32 v35, s65, v50
v_lshlrev_b32 v49, 16, v110
v_and_b32 v50, 0xffff0000, v110
v_fmac_f32 v36, s65, v49
v_fmac_f32 v37, s65, v50
v_lshlrev_b32 v49, 16, v111
v_and_b32 v50, 0xffff0000, v111
v_fmac_f32 v38, s65, v49
v_fmac_f32 v39, s65, v50
v_readlane_b32 s66, v16, 12
s_nop 3
s_and_b32 s64, s66, 0xffff
s_and_b32 s65, s66, 0xffff0000
v_lshlrev_b32 v49, 16, v112
v_and_b32 v50, 0xffff0000, v112
v_fmac_f32 v32, s65, v49
v_fmac_f32 v33, s65, v50
v_lshlrev_b32 v49, 16, v113
v_and_b32 v50, 0xffff0000, v113
v_fmac_f32 v34, s65, v49
v_fmac_f32 v35, s65, v50
v_lshlrev_b32 v49, 16, v114
v_and_b32 v50, 0xffff0000, v114
v_fmac_f32 v36, s65, v49
v_fmac_f32 v37, s65, v50
v_lshlrev_b32 v49, 16, v115
v_and_b32 v50, 0xffff0000, v115
v_fmac_f32 v38, s65, v49
v_fmac_f32 v39, s65, v50
v_readlane_b32 s66, v16, 13
s_nop 3
s_and_b32 s64, s66, 0xffff
s_and_b32 s65, s66, 0xffff0000
v_lshlrev_b32 v49, 16, v116
v_and_b32 v50, 0xffff0000, v116
v_fmac_f32 v32, s65, v49
v_fmac_f32 v33, s65, v50
v_lshlrev_b32 v49, 16, v117
v_and_b32 v50, 0xffff0000, v117
v_fmac_f32 v34, s65, v49
v_fmac_f32 v35, s65, v50
v_lshlrev_b32 v49, 16, v118
v_and_b32 v50, 0xffff0000, v118
v_fmac_f32 v36, s65, v49
v_fmac_f32 v37, s65, v50
v_lshlrev_b32 v49, 16, v119
v_and_b32 v50, 0xffff0000, v119
v_fmac_f32 v38, s65, v49
v_fmac_f32 v39, s65, v50
v_readlane_b32 s66, v16, 14
s_nop 3
s_and_b32 s64, s66, 0xffff
s_and_b32 s65, s66, 0xffff0000
v_lshlrev_b32 v49, 16, v120
v_and_b32 v50, 0xffff0000, v120
v_fmac_f32 v32, s65, v49
v_fmac_f32 v33, s65, v50
v_lshlrev_b32 v49, 16, v121
v_and_b32 v50, 0xffff0000, v121
v_fmac_f32 v34, s65, v49
v_fmac_f32 v35, s65, v50
v_lshlrev_b32 v49, 16, v122
v_and_b32 v50, 0xffff0000, v122
v_fmac_f32 v36, s65, v49
v_fmac_f32 v37, s65, v50
v_lshlrev_b32 v49, 16, v123
v_and_b32 v50, 0xffff0000, v123
v_fmac_f32 v38, s65, v49
v_fmac_f32 v39, s65, v50
v_readlane_b32 s66, v16, 15
s_nop 3
s_and_b32 s64, s66, 0xffff
s_and_b32 s65, s66, 0xffff0000
v_lshlrev_b32 v49, 16, v124
v_and_b32 v50, 0xffff0000, v124
v_fmac_f32 v32, s65, v49
v_fmac_f32 v33, s65, v50
v_lshlrev_b32 v49, 16, v125
v_and_b32 v50, 0xffff0000, v125
v_fmac_f32 v34, s65, v49
v_fmac_f32 v35, s65, v50
v_lshlrev_b32 v49, 16, v126
v_and_b32 v50, 0xffff0000, v126
v_fmac_f32 v36, s65, v49
v_fmac_f32 v37, s65, v50
v_lshlrev_b32 v49, 16, v127
v_and_b32 v50, 0xffff0000, v127
v_fmac_f32 v38, s65, v49
v_fmac_f32 v39, s65, v50
s_nop 2
v_lshlrev_b32 v11, 1, v2
s_lshl_b32 s64, s62, 11
s_add_u32 s64, s64, 51380224
buffer_store_dwordx4 v[32:35], v11, s[20:23], s64 offen sc1
buffer_store_dwordx4 v[36:39], v11, s[20:23], s64 offen offset:16 sc1
s_waitcnt vmcnt(0)
v_mov_b32 v12, 192
v_mov_b32 v13, 0x10000
s_mov_b64 exec, 1
global_atomic_add v12, v13, s[28:29]
s_mov_b64 exec, -1
s_branch L_done
L_dbl:
s_cmp_eq_u32 s72, 0
s_cbranch_scc1 L_dbf
s_cmp_lt_u32 s65, 7
s_cbranch_scc1 L_dbf
s_cmp_lg_u32 s32, 4
s_cbranch_scc1 L_dbfw
v_lshrrev_b32 v6, 2, v2
v_and_b32 v6, 0x7c, v6
s_mov_b32 s44, 0
L_dbfp:
global_load_dword v7, v6, s[28:29] offset:128 sc1
s_waitcnt vmcnt(0)
v_readlane_b32 s41, v7, s30
v_lshrrev_b32 v7, 28, v7
v_cmp_ne_u32 vcc, 8, v7
s_nop 2
s_and_b32 s41, s41, 0xf00
s_cmp_lg_u32 s41, 0x600
s_cbranch_scc1 L_dbfq
s_cbranch_vccz L_dbfr
L_dbfq:
s_sleep 6
s_add_u32 s44, s44, 1
s_cmp_lt_u32 s44, 0x40000
s_cbranch_scc1 L_dbfp
L_dbfr:
v_mov_b32 v6, 134144
v_mov_b32 v7, 1
ds_write_b32 v6, v7
s_branch L_dbfd
L_dbfw:
s_mov_b32 s44, 0
L_dbfl:
v_mov_b32 v6, 134144
ds_read_b32 v6, v6
s_waitcnt lgkmcnt(0)
v_readfirstlane_b32 s41, v6
s_nop 3
s_cmp_lg_u32 s41, 0
s_cbranch_scc1 L_dbfd
s_sleep 2
s_add_u32 s44, s44, 1
s_cmp_lt_u32 s44, 0x200000
s_cbranch_scc1 L_dbfl
L_dbfd:
s_mov_b32 s72, 0
s_sub_u32 s66, s65, 2
L_dbf:
s_add_u32 s46, s65, 2
L_dl:
s_cmp_gt_u32 s65, s67
s_cbranch_scc1 L_dlend
s_cmp_eq_u32 s72, 0
s_cbranch_scc1 L_dbf2
s_cmp_lt_u32 s65, 7
s_cbranch_scc1 L_dbf2
s_cmp_lg_u32 s32, 4
s_cbranch_scc1 L_dbf2w
v_lshrrev_b32 v6, 2, v2
v_and_b32 v6, 0x7c, v6
s_mov_b32 s44, 0
L_dbf2p:
global_load_dword v7, v6, s[28:29] offset:128 sc1
s_waitcnt vmcnt(0)
v_readlane_b32 s41, v7, s30
v_lshrrev_b32 v7, 28, v7
v_cmp_ne_u32 vcc, 8, v7
s_nop 2
s_and_b32 s41, s41, 0xf00
s_cmp_lg_u32 s41, 0x600
s_cbranch_scc1 L_dbf2q
s_cbranch_vccz L_dbf2r
L_dbf2q:
s_sleep 6
s_add_u32 s44, s44, 1
s_cmp_lt_u32 s44, 0x40000
s_cbranch_scc1 L_dbf2p
L_dbf2r:
v_mov_b32 v6, 134144
v_mov_b32 v7, 1
ds_write_b32 v6, v7
s_branch L_dbf2d
L_dbf2w:
s_mov_b32 s44, 0
L_dbf2l:
v_mov_b32 v6, 134144
ds_read_b32 v6, v6
s_waitcnt lgkmcnt(0)
v_readfirstlane_b32 s41, v6
s_nop 3
s_cmp_lg_u32 s41, 0
s_cbranch_scc1 L_dbf2d
s_sleep 2
s_add_u32 s44, s44, 1
s_cmp_lt_u32 s44, 0x200000
s_cbranch_scc1 L_dbf2l
L_dbf2d:
s_mov_b32 s72, 0
s_sub_u32 s66, s65, 2
L_dbf2:
s_mov_b32 s44, 0
L_dlw:
ds_read2st64_b32 v[6:7], v1 offset0:0 offset1:4
s_waitcnt lgkmcnt(0)
v_min_u32 v6, v6, v7
v_cmp_gt_u32 vcc, s66, v6
s_nop 1
s_cbranch_vccz L_dlwx
s_sleep 2
s_add_u32 s44, s44, 1
s_cmp_lt_u32 s44, 0x200000
s_cbranch_scc1 L_dlw
L_dlwx:
s_setprio 3
s_add_u32 m0, s49, s38
s_mov_b32 s42, 0
buffer_load_dwordx4 v4, s[24:27], s42 offen offset:0 lds
buffer_load_dwordx4 v4, s[24:27], s42 offen offset:1024 lds
buffer_load_dwordx4 v4, s[24:27], s42 offen offset:2048 lds
buffer_load_dwordx4 v4, s[24:27], s42 offen offset:3072 lds
s_add_u32 m0, m0, 4096
s_add_u32 s42, s42, 4096
buffer_load_dwordx4 v4, s[24:27], s42 offen offset:0 lds
buffer_load_dwordx4 v4, s[24:27], s42 offen offset:1024 lds
buffer_load_dwordx4 v4, s[24:27], s42 offen offset:2048 lds
buffer_load_dwordx4 v4, s[24:27], s42 offen offset:3072 lds
s_add_u32 m0, m0, 4096
s_add_u32 s42, s42, 4096
buffer_load_dwordx4 v4, s[24:27], s42 offen offset:0 lds
buffer_load_dwordx4 v4, s[24:27], s42 offen offset:1024 lds
buffer_load_dwordx4 v4, s[24:27], s42 offen offset:2048 lds
buffer_load_dwordx4 v4, s[24:27], s42 offen offset:3072 lds
s_add_u32 m0, m0, 4096
s_add_u32 s42, s42, 4096
buffer_load_dwordx4 v4, s[24:27], s42 offen offset:0 lds
buffer_load_dwordx4 v4, s[24:27], s42 offen offset:1024 lds
buffer_load_dwordx4 v4, s[24:27], s42 offen offset:2048 lds
buffer_load_dwordx4 v4, s[24:27], s42 offen offset:3072 lds
v_add_u32 v4, 0x4000, v4
s_add_u32 s49, s49, 32768
s_and_b32 s49, s49, 0x1ffff
s_add_u32 s65, s65, 1
s_add_u32 s66, s66, 1
s_waitcnt vmcnt(16)
v_mov_b32 v5, s65
ds_write_b32 v0, v5 offset:1024
s_cmp_lt_u32 s65, s46
s_cbranch_scc1 L_dl1
s_cmp_lg_u32 s65, s46
s_cbranch_scc1 L_dl2
s_sub_u32 s43, s46, 1
s_mov_b32 s44, 0
L_dpw:
ds_read_b32 v6, v0 offset:1280
s_waitcnt lgkmcnt(0)
v_cmp_gt_u32 vcc, s43, v6
s_nop 1
s_cbranch_vccz L_dpwx
s_sleep 1
s_add_u32 s44, s44, 1
s_cmp_lt_u32 s44, 0x200000
s_cbranch_scc1 L_dpw
L_dpwx:
L_dl2:
ds_write_b32 v0, v5 offset:1280
L_dl1:
s_setprio 0
s_branch L_dl
L_dlend:
s_waitcnt vmcnt(0)
s_sub_u32 s43, s46, 1
s_mov_b32 s44, 0
L_dpe:
ds_read_b32 v6, v0 offset:1280
s_waitcnt lgkmcnt(0)
v_cmp_gt_u32 vcc, s43, v6
s_nop 1
s_cbranch_vccz L_dpex
s_sleep 1
s_add_u32 s44, s44, 1
s_cmp_lt_u32 s44, 0x200000
s_cbranch_scc1 L_dpe
L_dpex:
v_mov_b32 v5, 0x7fffffff
ds_write_b32 v0, v5 offset:1024
ds_write_b32 v0, v5 offset:1280
s_branch L_done
L_rh0:
s_mov_b32 s54, 0
s_branch L_rh0c
L_rh0i:
s_mov_b32 s54, 0xff000000
L_rh0c:
s_nop 7
v_max3_f32 v5, v224, v225, v226
v_max3_f32 v5, v5, v227, v228
v_max3_f32 v5, v5, v229, v230
v_max_f32 v5, v5, v231
v_max3_f32 v6, v232, v233, v234
v_max3_f32 v6, v6, v235, v236
v_max3_f32 v6, v6, v237, v238
v_max_f32 v6, v6, v239
v_mov_b32 v7, v5
s_nop 1
v_permlane16_swap_b32 v5, v7
s_nop 1
v_max_f32 v5, v5, v7
v_mov_b32 v7, v5
s_nop 1
v_permlane32_swap_b32 v5, v7
s_nop 1
v_max_f32 v5, v5, v7
v_mov_b32 v7, v6
s_nop 1
v_permlane16_swap_b32 v6, v7
s_nop 1
v_max_f32 v6, v6, v7
v_mov_b32 v7, v6
s_nop 1
v_permlane32_swap_b32 v6, v7
s_nop 1
v_max_f32 v6, v6, v7
s_cmp_lg_u32 s54, 0
s_cbranch_scc1 L_rh0n
v_log_f32 v7, v88
s_nop 0
v_add_f32 v7, -4.0, v7
v_max_f32 v5, v5, v7
v_log_f32 v7, v92
s_nop 0
v_add_f32 v7, -4.0, v7
v_max_f32 v6, v6, v7
L_rh0n:
v_ceil_f32 v5, v5
v_max_f32 v5, s54, v5
v_ceil_f32 v6, v6
v_max_f32 v6, s54, v6
s_cmp_lg_u32 s54, 0
s_cbranch_scc1 L_rh0s
v_sub_f32 v12, 0, v5
v_exp_f32 v12, v12
v_sub_f32 v13, 0, v6
v_exp_f32 v13, v13
s_nop 0
v_mul_f32 v128, v12, v128
v_mul_f32 v129, v12, v129
v_mul_f32 v130, v12, v130
v_mul_f32 v131, v12, v131
v_mul_f32 v132, v12, v132
v_mul_f32 v133, v12, v133
v_mul_f32 v134, v12, v134
v_mul_f32 v135, v12, v135
v_mul_f32 v136, v12, v136
v_mul_f32 v137, v12, v137
v_mul_f32 v138, v12, v138
v_mul_f32 v139, v12, v139
v_mul_f32 v140, v12, v140
v_mul_f32 v141, v12, v141
v_mul_f32 v142, v12, v142
v_mul_f32 v143, v12, v143
v_mul_f32 v144, v12, v144
v_mul_f32 v145, v12, v145
v_mul_f32 v146, v12, v146
v_mul_f32 v147, v12, v147
v_mul_f32 v148, v12, v148
v_mul_f32 v149, v12, v149
v_mul_f32 v150, v12, v150
v_mul_f32 v151, v12, v151
v_mul_f32 v152, v12, v152
v_mul_f32 v153, v12, v153
v_mul_f32 v154, v12, v154
v_mul_f32 v155, v12, v155
v_mul_f32 v156, v12, v156
v_mul_f32 v157, v12, v157
v_mul_f32 v158, v12, v158
v_mul_f32 v159, v12, v159
v_mul_f32 v88, v12, v88
v_mul_f32 v89, v12, v89
v_mul_f32 v90, v12, v90
v_mul_f32 v91, v12, v91
v_sub_f32 v240, v240, v5
v_sub_f32 v241, v241, v5
v_sub_f32 v242, v242, v5
v_sub_f32 v243, v243, v5
v_sub_f32 v244, v244, v5
v_sub_f32 v245, v245, v5
v_sub_f32 v246, v246, v5
v_sub_f32 v247, v247, v5
v_mul_f32 v160, v13, v160
v_mul_f32 v161, v13, v161
v_mul_f32 v162, v13, v162
v_mul_f32 v163, v13, v163
v_mul_f32 v164, v13, v164
v_mul_f32 v165, v13, v165
v_mul_f32 v166, v13, v166
v_mul_f32 v167, v13, v167
v_mul_f32 v168, v13, v168
v_mul_f32 v169, v13, v169
v_mul_f32 v170, v13, v170
v_mul_f32 v171, v13, v171
v_mul_f32 v172, v13, v172
v_mul_f32 v173, v13, v173
v_mul_f32 v174, v13, v174
v_mul_f32 v175, v13, v175
v_mul_f32 v176, v13, v176
v_mul_f32 v177, v13, v177
v_mul_f32 v178, v13, v178
v_mul_f32 v179, v13, v179
v_mul_f32 v180, v13, v180
v_mul_f32 v181, v13, v181
v_mul_f32 v182, v13, v182
v_mul_f32 v183, v13, v183
v_mul_f32 v184, v13, v184
v_mul_f32 v185, v13, v185
v_mul_f32 v186, v13, v186
v_mul_f32 v187, v13, v187
v_mul_f32 v188, v13, v188
v_mul_f32 v189, v13, v189
v_mul_f32 v190, v13, v190
v_mul_f32 v191, v13, v191
v_mul_f32 v92, v13, v92
v_mul_f32 v93, v13, v93
v_mul_f32 v94, v13, v94
v_mul_f32 v95, v13, v95
v_sub_f32 v248, v248, v6
v_sub_f32 v249, v249, v6
v_sub_f32 v250, v250, v6
v_sub_f32 v251, v251, v6
v_sub_f32 v252, v252, v6
v_sub_f32 v253, v253, v6
v_sub_f32 v254, v254, v6
v_sub_f32 v255, v255, v6
L_rh0s:
v_sub_f32 v112, v112, v5
v_sub_f32 v224, v224, v5
v_sub_f32 v113, v113, v5
v_sub_f32 v225, v225, v5
v_sub_f32 v114, v114, v5
v_sub_f32 v226, v226, v5
v_sub_f32 v115, v115, v5
v_sub_f32 v227, v227, v5
v_sub_f32 v116, v116, v5
v_sub_f32 v228, v228, v5
v_sub_f32 v117, v117, v5
v_sub_f32 v229, v229, v5
v_sub_f32 v118, v118, v5
v_sub_f32 v230, v230, v5
v_sub_f32 v119, v119, v5
v_sub_f32 v231, v231, v5
v_sub_f32 v120, v120, v6
v_sub_f32 v232, v232, v6
v_sub_f32 v121, v121, v6
v_sub_f32 v233, v233, v6
v_sub_f32 v122, v122, v6
v_sub_f32 v234, v234, v6
v_sub_f32 v123, v123, v6
v_sub_f32 v235, v235, v6
v_sub_f32 v124, v124, v6
v_sub_f32 v236, v236, v6
v_sub_f32 v125, v125, v6
v_sub_f32 v237, v237, v6
v_sub_f32 v126, v126, v6
v_sub_f32 v238, v238, v6
v_sub_f32 v127, v127, v6
v_sub_f32 v239, v239, v6
v_exp_f32 v12, v224
v_exp_f32 v13, v225
s_nop 0
v_cvt_pk_bf16_f32 v96, v12, v13
v_exp_f32 v14, v226
v_exp_f32 v15, v227
s_nop 0
v_cvt_pk_bf16_f32 v97, v14, v15
v_exp_f32 v12, v228
v_exp_f32 v13, v229
s_nop 0
v_cvt_pk_bf16_f32 v98, v12, v13
v_exp_f32 v14, v230
v_exp_f32 v15, v231
s_nop 0
v_cvt_pk_bf16_f32 v99, v14, v15
v_exp_f32 v12, v232
v_exp_f32 v13, v233
s_nop 0
v_cvt_pk_bf16_f32 v100, v12, v13
v_exp_f32 v14, v234
v_exp_f32 v15, v235
s_nop 0
v_cvt_pk_bf16_f32 v101, v14, v15
v_exp_f32 v12, v236
v_exp_f32 v13, v237
s_nop 0
v_cvt_pk_bf16_f32 v102, v12, v13
v_exp_f32 v14, v238
v_exp_f32 v15, v239
s_nop 0
v_cvt_pk_bf16_f32 v103, v14, v15
s_nop 1
v_mfma_f32_16x16x32_bf16 v[80:83], v[8:11], v[96:99], v[88:91]
v_mfma_f32_16x16x32_bf16 v[84:87], v[8:11], v[100:103], v[92:95]
v_exp_f32 v12, v240
v_exp_f32 v13, v241
s_nop 0
v_cvt_pk_bf16_f32 v104, v12, v13
v_exp_f32 v14, v242
v_exp_f32 v15, v243
s_nop 0
s_setpc_b64 s[52:53]
L_rh1:
s_mov_b32 s54, 0
s_branch L_rh1c
L_rh1i:
s_mov_b32 s54, 0xff000000
L_rh1c:
s_nop 7
v_max3_f32 v5, v240, v241, v242
v_max3_f32 v5, v5, v243, v244
v_max3_f32 v5, v5, v245, v246
v_max_f32 v5, v5, v247
v_max3_f32 v6, v248, v249, v250
v_max3_f32 v6, v6, v251, v252
v_max3_f32 v6, v6, v253, v254
v_max_f32 v6, v6, v255
v_mov_b32 v7, v5
s_nop 1
v_permlane16_swap_b32 v5, v7
s_nop 1
v_max_f32 v5, v5, v7
v_mov_b32 v7, v5
s_nop 1
v_permlane32_swap_b32 v5, v7
s_nop 1
v_max_f32 v5, v5, v7
v_mov_b32 v7, v6
s_nop 1
v_permlane16_swap_b32 v6, v7
s_nop 1
v_max_f32 v6, v6, v7
v_mov_b32 v7, v6
s_nop 1
v_permlane32_swap_b32 v6, v7
s_nop 1
v_max_f32 v6, v6, v7
s_cmp_lg_u32 s54, 0
s_cbranch_scc1 L_rh1n
v_log_f32 v7, v80
s_nop 0
v_add_f32 v7, -4.0, v7
v_max_f32 v5, v5, v7
v_log_f32 v7, v84
s_nop 0
v_add_f32 v7, -4.0, v7
v_max_f32 v6, v6, v7
L_rh1n:
v_ceil_f32 v5, v5
v_max_f32 v5, s54, v5
v_ceil_f32 v6, v6
v_max_f32 v6, s54, v6
s_cmp_lg_u32 s54, 0
s_cbranch_scc1 L_rh1s
v_sub_f32 v12, 0, v5
v_exp_f32 v12, v12
v_sub_f32 v13, 0, v6
v_exp_f32 v13, v13
s_nop 0
v_mul_f32 v128, v12, v128
v_mul_f32 v129, v12, v129
v_mul_f32 v130, v12, v130
v_mul_f32 v131, v12, v131
v_mul_f32 v132, v12, v132
v_mul_f32 v133, v12, v133
v_mul_f32 v134, v12, v134
v_mul_f32 v135, v12, v135
v_mul_f32 v136, v12, v136
v_mul_f32 v137, v12, v137
v_mul_f32 v138, v12, v138
v_mul_f32 v139, v12, v139
v_mul_f32 v140, v12, v140
v_mul_f32 v141, v12, v141
v_mul_f32 v142, v12, v142
v_mul_f32 v143, v12, v143
v_mul_f32 v144, v12, v144
v_mul_f32 v145, v12, v145
v_mul_f32 v146, v12, v146
v_mul_f32 v147, v12, v147
v_mul_f32 v148, v12, v148
v_mul_f32 v149, v12, v149
v_mul_f32 v150, v12, v150
v_mul_f32 v151, v12, v151
v_mul_f32 v152, v12, v152
v_mul_f32 v153, v12, v153
v_mul_f32 v154, v12, v154
v_mul_f32 v155, v12, v155
v_mul_f32 v156, v12, v156
v_mul_f32 v157, v12, v157
v_mul_f32 v158, v12, v158
v_mul_f32 v159, v12, v159
v_mul_f32 v80, v12, v80
v_mul_f32 v81, v12, v81
v_mul_f32 v82, v12, v82
v_mul_f32 v83, v12, v83
v_sub_f32 v224, v224, v5
v_sub_f32 v225, v225, v5
v_sub_f32 v226, v226, v5
v_sub_f32 v227, v227, v5
v_sub_f32 v228, v228, v5
v_sub_f32 v229, v229, v5
v_sub_f32 v230, v230, v5
v_sub_f32 v231, v231, v5
v_mul_f32 v160, v13, v160
v_mul_f32 v161, v13, v161
v_mul_f32 v162, v13, v162
v_mul_f32 v163, v13, v163
v_mul_f32 v164, v13, v164
v_mul_f32 v165, v13, v165
v_mul_f32 v166, v13, v166
v_mul_f32 v167, v13, v167
v_mul_f32 v168, v13, v168
v_mul_f32 v169, v13, v169
v_mul_f32 v170, v13, v170
v_mul_f32 v171, v13, v171
v_mul_f32 v172, v13, v172
v_mul_f32 v173, v13, v173
v_mul_f32 v174, v13, v174
v_mul_f32 v175, v13, v175
v_mul_f32 v176, v13, v176
v_mul_f32 v177, v13, v177
v_mul_f32 v178, v13, v178
v_mul_f32 v179, v13, v179
v_mul_f32 v180, v13, v180
v_mul_f32 v181, v13, v181
v_mul_f32 v182, v13, v182
v_mul_f32 v183, v13, v183
v_mul_f32 v184, v13, v184
v_mul_f32 v185, v13, v185
v_mul_f32 v186, v13, v186
v_mul_f32 v187, v13, v187
v_mul_f32 v188, v13, v188
v_mul_f32 v189, v13, v189
v_mul_f32 v190, v13, v190
v_mul_f32 v191, v13, v191
v_mul_f32 v84, v13, v84
v_mul_f32 v85, v13, v85
v_mul_f32 v86, v13, v86
v_mul_f32 v87, v13, v87
v_sub_f32 v232, v232, v6
v_sub_f32 v233, v233, v6
v_sub_f32 v234, v234, v6
v_sub_f32 v235, v235, v6
v_sub_f32 v236, v236, v6
v_sub_f32 v237, v237, v6
v_sub_f32 v238, v238, v6
v_sub_f32 v239, v239, v6
L_rh1s:
v_sub_f32 v112, v112, v5
v_sub_f32 v240, v240, v5
v_sub_f32 v113, v113, v5
v_sub_f32 v241, v241, v5
v_sub_f32 v114, v114, v5
v_sub_f32 v242, v242, v5
v_sub_f32 v115, v115, v5
v_sub_f32 v243, v243, v5
v_sub_f32 v116, v116, v5
v_sub_f32 v244, v244, v5
v_sub_f32 v117, v117, v5
v_sub_f32 v245, v245, v5
v_sub_f32 v118, v118, v5
v_sub_f32 v246, v246, v5
v_sub_f32 v119, v119, v5
v_sub_f32 v247, v247, v5
v_sub_f32 v120, v120, v6
v_sub_f32 v248, v248, v6
v_sub_f32 v121, v121, v6
v_sub_f32 v249, v249, v6
v_sub_f32 v122, v122, v6
v_sub_f32 v250, v250, v6
v_sub_f32 v123, v123, v6
v_sub_f32 v251, v251, v6
v_sub_f32 v124, v124, v6
v_sub_f32 v252, v252, v6
v_sub_f32 v125, v125, v6
v_sub_f32 v253, v253, v6
v_sub_f32 v126, v126, v6
v_sub_f32 v254, v254, v6
v_sub_f32 v127, v127, v6
v_sub_f32 v255, v255, v6
v_exp_f32 v12, v240
v_exp_f32 v13, v241
s_nop 0
v_cvt_pk_bf16_f32 v104, v12, v13
v_exp_f32 v14, v242
v_exp_f32 v15, v243
s_nop 0
v_cvt_pk_bf16_f32 v105, v14, v15
v_exp_f32 v12, v244
v_exp_f32 v13, v245
s_nop 0
v_cvt_pk_bf16_f32 v106, v12, v13
v_exp_f32 v14, v246
v_exp_f32 v15, v247
s_nop 0
v_cvt_pk_bf16_f32 v107, v14, v15
v_exp_f32 v12, v248
v_exp_f32 v13, v249
s_nop 0
v_cvt_pk_bf16_f32 v108, v12, v13
v_exp_f32 v14, v250
v_exp_f32 v15, v251
s_nop 0
v_cvt_pk_bf16_f32 v109, v14, v15
v_exp_f32 v12, v252
v_exp_f32 v13, v253
s_nop 0
v_cvt_pk_bf16_f32 v110, v12, v13
v_exp_f32 v14, v254
v_exp_f32 v15, v255
s_nop 0
v_cvt_pk_bf16_f32 v111, v14, v15
s_nop 1
v_mfma_f32_16x16x32_bf16 v[88:91], v[8:11], v[104:107], v[80:83]
v_mfma_f32_16x16x32_bf16 v[92:95], v[8:11], v[108:111], v[84:87]
v_exp_f32 v12, v224
v_exp_f32 v13, v225
s_nop 0
v_cvt_pk_bf16_f32 v96, v12, v13
v_exp_f32 v14, v226
v_exp_f32 v15, v227
s_nop 0
s_setpc_b64 s[52:53]
L_done:
s_setprio 0
s_cmp_lg_u32 s32, 4
s_cbranch_scc1 L_dsig
v_mov_b32 v6, 0xc4
s_mov_b32 s44, 0
L_dsp:
s_mov_b64 exec, 1
global_load_dword v7, v6, s[28:29] sc1
s_mov_b64 exec, -1
s_waitcnt vmcnt(0)
v_readfirstlane_b32 s41, v7
s_nop 3
s_bfe_u32 s41, s41, 0x80010
s_cmp_eq_u32 s41, 1
s_cbranch_scc1 L_dsig
s_sleep 16
s_add_u32 s44, s44, 1
s_cmp_lt_u32 s44, 0x20000
s_cbranch_scc1 L_dsp
L_dsig:
s_mov_b32 s22, s32
s_lshr_b32 s26, s30, 2
s_and_b32 s26, s26, 3
s_sub_u32 s27, 15, s31
s_cmp_lt_u32 s26, 2
s_cselect_b32 s27, s31, s27
s_lshl_b32 s51, s31, 10
s_add_u32 s51, s51, 50372608
s_lshl_b32 s20, s27, 1
s_and_b32 s26, s26, 1
s_add_u32 s20, s20, s26
s_lshr_b32 s21, s30, 4
s_lshl_b32 s21, s21, 2
s_and_b32 s26, s30, 3
s_or_b32 s21, s21, s26
v_lshrrev_b32 v1, 4, v2
s_lshl_b32 s26, s22, 6
v_add_u32 v0, s26, v1
s_load_dwordx2 s[32:33], s[0:1], 0
s_load_dwordx2 s[34:35], s[0:1], 40
s_load_dwordx2 s[36:37], s[0:1], 96
s_load_dwordx2 s[38:39], s[0:1], 112
s_load_dwordx2 s[52:53], s[0:1], 104
v_lshrrev_b32 v8, 4, v1
v_lshlrev_b32 v9, 1, v8
v_and_b32 v10, 7, v1
v_xor_b32 v10, v10, v9
v_lshlrev_b32 v10, 4, v10
v_lshrrev_b32 v11, 3, v1
v_lshlrev_b32 v11, 10, v11
v_add_u32 v3, v10, v11
v_and_b32 v10, 15, v1
v_lshrrev_b32 v10, 2, v10
v_lshlrev_b32 v11, 2, v8
v_add_u32 v11, v11, v10
v_lshrrev_b32 v12, 1, v11
v_and_b32 v12, 3, v12
v_lshlrev_b32 v12, 5, v12
v_lshlrev_b32 v11, 7, v11
v_add_u32 v11, v11, v12
v_and_b32 v12, 3, v1
v_lshlrev_b32 v12, 3, v12
v_add_u32 v11, v11, v12
s_lshl_b32 s25, s22, 14
v_add_u32 v11, s25, v11
v_xor_b32 v4, 0, v11
v_xor_b32 v5, 32, v11
v_xor_b32 v6, 64, v11
v_xor_b32 v7, 96, v11
s_lshl_b32 s23, s20, 19
s_lshl_b32 s26, s22, 14
s_add_u32 s23, s23, s26
s_add_u32 s23, s23, 33554432
s_lshl_b32 s24, s22, 19
s_lshl_b32 s26, s21, 7
s_add_u32 s24, s24, s26
s_waitcnt lgkmcnt(0)
s_mov_b32 s4, s32
s_and_b32 s5, s33, 0xffff
s_mov_b32 s6, 2097152
s_mov_b32 s7, 0x20000
s_mov_b32 s8, s34
s_and_b32 s9, s35, 0xffff
s_mov_b32 s10, 4194304
s_mov_b32 s11, 0x20000
s_mov_b32 s16, s36
s_and_b32 s17, s37, 0xffff
s_mov_b32 s18, 2097152
s_mov_b32 s19, 0x20000
s_mov_b32 s12, s38
s_and_b32 s13, s39, 0xffff
s_mov_b32 s14, 268435456
s_mov_b32 s15, 0x20000
s_waitcnt vmcnt(0) lgkmcnt(0)
s_barrier
s_cmp_lg_u32 s22, 0
s_cbranch_scc1 L_k3_sg
s_lshr_b32 s26, s30, 2
s_lshl_b32 s26, s26, 7
s_add_u32 s26, s26, s51
v_mov_b32 v8, s26
v_mov_b32 v9, 1
s_mov_b64 exec, 1
buffer_atomic_add v9, v8, s[12:15], 0 offen
s_mov_b64 exec, -1
L_k3_sg:
s_add_u32 m0, s25, 0
s_add_u32 s28, s24, 0
buffer_load_dwordx4 v3, s[8:11], s28 offen lds
s_add_u32 m0, s25, 1024
s_add_u32 s28, s24, 8192
buffer_load_dwordx4 v3, s[8:11], s28 offen lds
s_add_u32 m0, s25, 2048
s_add_u32 s28, s24, 16384
buffer_load_dwordx4 v3, s[8:11], s28 offen lds
s_add_u32 m0, s25, 3072
s_add_u32 s28, s24, 24576
buffer_load_dwordx4 v3, s[8:11], s28 offen lds
s_add_u32 m0, s25, 4096
s_add_u32 s28, s24, 32768
buffer_load_dwordx4 v3, s[8:11], s28 offen lds
s_add_u32 m0, s25, 5120
s_add_u32 s28, s24, 40960
buffer_load_dwordx4 v3, s[8:11], s28 offen lds
s_add_u32 m0, s25, 6144
s_add_u32 s28, s24, 49152
buffer_load_dwordx4 v3, s[8:11], s28 offen lds
s_add_u32 m0, s25, 7168
s_add_u32 s28, s24, 57344
buffer_load_dwordx4 v3, s[8:11], s28 offen lds
s_add_u32 m0, s25, 8192
s_add_u32 s28, s24, 65536
buffer_load_dwordx4 v3, s[8:11], s28 offen lds
s_add_u32 m0, s25, 9216
s_add_u32 s28, s24, 73728
buffer_load_dwordx4 v3, s[8:11], s28 offen lds
s_add_u32 m0, s25, 10240
s_add_u32 s28, s24, 81920
buffer_load_dwordx4 v3, s[8:11], s28 offen lds
s_add_u32 m0, s25, 11264
s_add_u32 s28, s24, 90112
buffer_load_dwordx4 v3, s[8:11], s28 offen lds
s_add_u32 m0, s25, 12288
s_add_u32 s28, s24, 98304
buffer_load_dwordx4 v3, s[8:11], s28 offen lds
s_add_u32 m0, s25, 13312
s_add_u32 s28, s24, 106496
buffer_load_dwordx4 v3, s[8:11], s28 offen lds
s_add_u32 m0, s25, 14336
s_add_u32 s28, s24, 114688
buffer_load_dwordx4 v3, s[8:11], s28 offen lds
s_add_u32 m0, s25, 15360
s_add_u32 s28, s24, 122880
buffer_load_dwordx4 v3, s[8:11], s28 offen lds
s_waitcnt vmcnt(12)
ds_read_b64_tr_b16 v[208:209], v4 offset:0
ds_read_b64_tr_b16 v[210:211], v4 offset:2048
ds_read_b64_tr_b16 v[212:213], v5 offset:0
ds_read_b64_tr_b16 v[214:215], v5 offset:2048
ds_read_b64_tr_b16 v[216:217], v6 offset:0
ds_read_b64_tr_b16 v[218:219], v6 offset:2048
ds_read_b64_tr_b16 v[220:221], v7 offset:0
ds_read_b64_tr_b16 v[222:223], v7 offset:2048
s_waitcnt vmcnt(8)
ds_read_b64_tr_b16 v[224:225], v4 offset:4096
ds_read_b64_tr_b16 v[226:227], v4 offset:6144
ds_read_b64_tr_b16 v[228:229], v5 offset:4096
ds_read_b64_tr_b16 v[230:231], v5 offset:6144
ds_read_b64_tr_b16 v[232:233], v6 offset:4096
ds_read_b64_tr_b16 v[234:235], v6 offset:6144
ds_read_b64_tr_b16 v[236:237], v7 offset:4096
ds_read_b64_tr_b16 v[238:239], v7 offset:6144
s_waitcnt vmcnt(4)
ds_read_b64_tr_b16 v[240:241], v4 offset:8192
ds_read_b64_tr_b16 v[242:243], v4 offset:10240
ds_read_b64_tr_b16 v[244:245], v5 offset:8192
ds_read_b64_tr_b16 v[246:247], v5 offset:10240
ds_read_b64_tr_b16 v[248:249], v6 offset:8192
ds_read_b64_tr_b16 v[250:251], v6 offset:10240
ds_read_b64_tr_b16 v[252:253], v7 offset:8192
ds_read_b64_tr_b16 v[254:255], v7 offset:10240
s_waitcnt lgkmcnt(0)
s_add_u32 m0, s25, 0
s_add_u32 s28, s24, 131072
buffer_load_dwordx4 v3, s[8:11], s28 offen lds
s_add_u32 m0, s25, 1024
s_add_u32 s28, s24, 139264
buffer_load_dwordx4 v3, s[8:11], s28 offen lds
s_add_u32 m0, s25, 2048
s_add_u32 s28, s24, 147456
buffer_load_dwordx4 v3, s[8:11], s28 offen lds
s_add_u32 m0, s25, 3072
s_add_u32 s28, s24, 155648
buffer_load_dwordx4 v3, s[8:11], s28 offen lds
s_add_u32 m0, s25, 4096
s_add_u32 s28, s24, 163840
buffer_load_dwordx4 v3, s[8:11], s28 offen lds
s_add_u32 m0, s25, 5120
s_add_u32 s28, s24, 172032
buffer_load_dwordx4 v3, s[8:11], s28 offen lds
s_add_u32 m0, s25, 6144
s_add_u32 s28, s24, 180224
buffer_load_dwordx4 v3, s[8:11], s28 offen lds
s_add_u32 m0, s25, 7168
s_add_u32 s28, s24, 188416
buffer_load_dwordx4 v3, s[8:11], s28 offen lds
s_add_u32 m0, s25, 8192
s_add_u32 s28, s24, 196608
buffer_load_dwordx4 v3, s[8:11], s28 offen lds
s_add_u32 m0, s25, 9216
s_add_u32 s28, s24, 204800
buffer_load_dwordx4 v3, s[8:11], s28 offen lds
s_add_u32 m0, s25, 10240
s_add_u32 s28, s24, 212992
buffer_load_dwordx4 v3, s[8:11], s28 offen lds
s_add_u32 m0, s25, 11264
s_add_u32 s28, s24, 221184
buffer_load_dwordx4 v3, s[8:11], s28 offen lds
s_cmp_lg_u32 s22, 7
s_cbranch_scc1 L_k3_qw
v_lshlrev_b32 v8, 7, v1
v_add_u32 v8, s51, v8
v_mov_b32 v10, 134656
s_mov_b32 s28, 0
L_k3_ql:
s_mov_b64 exec, 0xff
buffer_load_dword v9, v8, s[12:15], 0 offen sc1
s_waitcnt vmcnt(0)
v_cmp_eq_u32 vcc, 4, v9
s_mov_b64 exec, -1
s_nop 2
s_and_b32 s26, vcc_lo, 0xff
v_mov_b32 v11, s26
ds_write_b32 v10, v11
s_cmp_eq_u32 s26, 0xff
s_cbranch_scc1 L_k3_pd
s_sleep 3
s_add_u32 s28, s28, 1
s_cmp_lt_u32 s28, 0x40000
s_cbranch_scc1 L_k3_ql
s_branch L_k3_pd
L_k3_qw:
s_mov_b32 s28, 0
L_k3_qs:
v_mov_b32 v8, 134656
ds_read_b32 v8, v8
s_waitcnt lgkmcnt(0)
v_readfirstlane_b32 s26, v8
s_nop 3
s_lshr_b32 s26, s26, s22
s_and_b32 s26, s26, 1
s_cmp_lg_u32 s26, 0
s_cbranch_scc1 L_k3_pd
s_sleep 2
s_add_u32 s28, s28, 1
s_cmp_lt_u32 s28, 0x200000
s_cbranch_scc1 L_k3_qs
L_k3_pd:
s_add_u32 s29, s23, 0
buffer_load_dwordx4 v[48:51], v2, s[12:15], s29 offen
s_add_u32 s29, s23, 131072
buffer_load_dwordx4 v[52:55], v2, s[12:15], s29 offen
s_add_u32 s29, s23, 262144
buffer_load_dwordx4 v[56:59], v2, s[12:15], s29 offen
s_add_u32 s29, s23, 393216
buffer_load_dwordx4 v[60:63], v2, s[12:15], s29 offen
s_add_u32 s29, s23, 1024
buffer_load_dwordx4 v[64:67], v2, s[12:15], s29 offen
s_add_u32 s29, s23, 132096
buffer_load_dwordx4 v[68:71], v2, s[12:15], s29 offen
s_add_u32 s29, s23, 263168
buffer_load_dwordx4 v[72:75], v2, s[12:15], s29 offen
s_add_u32 s29, s23, 394240
buffer_load_dwordx4 v[76:79], v2, s[12:15], s29 offen
s_add_u32 s29, s23, 2048
buffer_load_dwordx4 v[80:83], v2, s[12:15], s29 offen
s_add_u32 s29, s23, 133120
buffer_load_dwordx4 v[84:87], v2, s[12:15], s29 offen
s_add_u32 s29, s23, 264192
buffer_load_dwordx4 v[88:91], v2, s[12:15], s29 offen
s_add_u32 s29, s23, 395264
buffer_load_dwordx4 v[92:95], v2, s[12:15], s29 offen
s_add_u32 s29, s23, 3072
buffer_load_dwordx4 v[96:99], v2, s[12:15], s29 offen
s_add_u32 s29, s23, 134144
buffer_load_dwordx4 v[100:103], v2, s[12:15], s29 offen
s_add_u32 s29, s23, 265216
buffer_load_dwordx4 v[104:107], v2, s[12:15], s29 offen
s_add_u32 s29, s23, 396288
buffer_load_dwordx4 v[108:111], v2, s[12:15], s29 offen
v_mov_b32 v189, 0
s_mov_b32 s26, 50348032
buffer_load_dwordx2 v[190:191], v189, s[12:15], s26 offen sc1
s_waitcnt vmcnt(0)
v_readfirstlane_b32 s30, v190
v_readfirstlane_b32 s31, v191
v_lshrrev_b32 v8, 3, v0
v_and_b32 v9, 7, v0
s_lshl_b32 s26, s20, 6
v_add_u32 v10, s26, v8
v_lshlrev_b32 v11, 10, v10
v_lshlrev_b32 v12, 4, v9
v_add_u32 v11, v11, v12
s_lshl_b32 s27, s21, 7
v_add_u32 v11, s27, v11
v_lshlrev_b32 v12, 2, v10
buffer_load_dwordx4 v[184:187], v11, s[4:7], 0 offen
s_mov_b32 s26, 50339840
buffer_load_dword v188, v12, s[12:15], s26 offen
s_waitcnt lgkmcnt(0)
s_lshr_b32 s26, s30, 6
s_cmp_lg_u32 s26, s20
s_cselect_b32 s50, 0, 1
s_cbranch_scc1 L_k3_noyl
v_mov_b32 v200, 0xc0
s_mov_b32 s28, 0
L_k3_p3:
global_load_dword v201, v200, s[52:53] sc1
s_waitcnt vmcnt(0)
v_readfirstlane_b32 s26, v201
s_nop 3
s_bfe_u32 s26, s26, 0x80010
s_cmp_eq_u32 s26, 112
s_cbranch_scc1 L_k3_p3x
s_sleep 16
s_add_u32 s28, s28, 1
s_cmp_lt_u32 s28, 0x20000
s_cbranch_scc1 L_k3_p3
L_k3_p3x:
v_lshlrev_b32 v15, 11, v8
v_lshlrev_b32 v14, 5, v9
v_add_u32 v15, v15, v14
s_lshl_b32 s27, s21, 8
s_add_u32 s27, s27, 51380224
v_mov_b32 v200, 0
v_mov_b32 v201, 0
v_mov_b32 v202, 0
v_mov_b32 v203, 0
v_mov_b32 v204, 0
v_mov_b32 v205, 0
v_mov_b32 v206, 0
v_mov_b32 v207, 0
buffer_load_dwordx4 v[192:195], v15, s[12:15], s27 offen
buffer_load_dwordx4 v[196:199], v15, s[12:15], s27 offen offset:16
s_add_u32 s27, s27, 131072
v_cmp_gt_u32 vcc, 48, v8
s_and_saveexec_b64 s[42:43], vcc
s_cbranch_execz L_k3_y2
buffer_load_dwordx4 v[200:203], v15, s[12:15], s27 offen
buffer_load_dwordx4 v[204:207], v15, s[12:15], s27 offen offset:16
L_k3_y2:
s_mov_b64 exec, s[42:43]
L_k3_noyl:
v_mfma_f32_16x16x32_bf16 v[112:115], v[208:211], v[48:51], 0
v_mfma_f32_16x16x32_bf16 v[116:119], v[212:215], v[48:51], 0
v_mfma_f32_16x16x32_bf16 v[120:123], v[216:219], v[48:51], 0
v_mfma_f32_16x16x32_bf16 v[124:127], v[220:223], v[48:51], 0
v_mfma_f32_16x16x32_bf16 v[128:131], v[208:211], v[52:55], 0
v_mfma_f32_16x16x32_bf16 v[132:135], v[212:215], v[52:55], 0
v_mfma_f32_16x16x32_bf16 v[136:139], v[216:219], v[52:55], 0
v_mfma_f32_16x16x32_bf16 v[140:143], v[220:223], v[52:55], 0
v_mfma_f32_16x16x32_bf16 v[144:147], v[208:211], v[56:59], 0
v_mfma_f32_16x16x32_bf16 v[148:151], v[212:215], v[56:59], 0
v_mfma_f32_16x16x32_bf16 v[152:155], v[216:219], v[56:59], 0
v_mfma_f32_16x16x32_bf16 v[156:159], v[220:223], v[56:59], 0
v_mfma_f32_16x16x32_bf16 v[160:163], v[208:211], v[60:63], 0
v_mfma_f32_16x16x32_bf16 v[164:167], v[212:215], v[60:63], 0
v_mfma_f32_16x16x32_bf16 v[168:171], v[216:219], v[60:63], 0
v_mfma_f32_16x16x32_bf16 v[172:175], v[220:223], v[60:63], 0
s_add_u32 s29, s23, 4096
buffer_load_dwordx4 v[48:51], v2, s[12:15], s29 offen
s_add_u32 s29, s23, 135168
buffer_load_dwordx4 v[52:55], v2, s[12:15], s29 offen
s_add_u32 s29, s23, 266240
buffer_load_dwordx4 v[56:59], v2, s[12:15], s29 offen
s_add_u32 s29, s23, 397312
buffer_load_dwordx4 v[60:63], v2, s[12:15], s29 offen
v_mfma_f32_16x16x32_bf16 v[112:115], v[224:227], v[64:67], v[112:115]
v_mfma_f32_16x16x32_bf16 v[116:119], v[228:231], v[64:67], v[116:119]
v_mfma_f32_16x16x32_bf16 v[120:123], v[232:235], v[64:67], v[120:123]
v_mfma_f32_16x16x32_bf16 v[124:127], v[236:239], v[64:67], v[124:127]
v_mfma_f32_16x16x32_bf16 v[128:131], v[224:227], v[68:71], v[128:131]
v_mfma_f32_16x16x32_bf16 v[132:135], v[228:231], v[68:71], v[132:135]
v_mfma_f32_16x16x32_bf16 v[136:139], v[232:235], v[68:71], v[136:139]
v_mfma_f32_16x16x32_bf16 v[140:143], v[236:239], v[68:71], v[140:143]
v_mfma_f32_16x16x32_bf16 v[144:147], v[224:227], v[72:75], v[144:147]
v_mfma_f32_16x16x32_bf16 v[148:151], v[228:231], v[72:75], v[148:151]
v_mfma_f32_16x16x32_bf16 v[152:155], v[232:235], v[72:75], v[152:155]
v_mfma_f32_16x16x32_bf16 v[156:159], v[236:239], v[72:75], v[156:159]
v_mfma_f32_16x16x32_bf16 v[160:163], v[224:227], v[76:79], v[160:163]
v_mfma_f32_16x16x32_bf16 v[164:167], v[228:231], v[76:79], v[164:167]
v_mfma_f32_16x16x32_bf16 v[168:171], v[232:235], v[76:79], v[168:171]
v_mfma_f32_16x16x32_bf16 v[172:175], v[236:239], v[76:79], v[172:175]
s_add_u32 s29, s23, 5120
buffer_load_dwordx4 v[64:67], v2, s[12:15], s29 offen
s_add_u32 s29, s23, 136192
buffer_load_dwordx4 v[68:71], v2, s[12:15], s29 offen
s_add_u32 s29, s23, 267264
buffer_load_dwordx4 v[72:75], v2, s[12:15], s29 offen
s_add_u32 s29, s23, 398336
buffer_load_dwordx4 v[76:79], v2, s[12:15], s29 offen
v_mfma_f32_16x16x32_bf16 v[112:115], v[240:243], v[80:83], v[112:115]
v_mfma_f32_16x16x32_bf16 v[116:119], v[244:247], v[80:83], v[116:119]
v_mfma_f32_16x16x32_bf16 v[120:123], v[248:251], v[80:83], v[120:123]
ds_read_b64_tr_b16 v[32:33], v4 offset:12288
v_mfma_f32_16x16x32_bf16 v[124:127], v[252:255], v[80:83], v[124:127]
ds_read_b64_tr_b16 v[34:35], v4 offset:14336
v_mfma_f32_16x16x32_bf16 v[128:131], v[240:243], v[84:87], v[128:131]
ds_read_b64_tr_b16 v[36:37], v5 offset:12288
v_mfma_f32_16x16x32_bf16 v[132:135], v[244:247], v[84:87], v[132:135]
ds_read_b64_tr_b16 v[38:39], v5 offset:14336
v_mfma_f32_16x16x32_bf16 v[136:139], v[248:251], v[84:87], v[136:139]
ds_read_b64_tr_b16 v[40:41], v6 offset:12288
v_mfma_f32_16x16x32_bf16 v[140:143], v[252:255], v[84:87], v[140:143]
ds_read_b64_tr_b16 v[42:43], v6 offset:14336
v_mfma_f32_16x16x32_bf16 v[144:147], v[240:243], v[88:91], v[144:147]
ds_read_b64_tr_b16 v[44:45], v7 offset:12288
v_mfma_f32_16x16x32_bf16 v[148:151], v[244:247], v[88:91], v[148:151]
ds_read_b64_tr_b16 v[46:47], v7 offset:14336
v_mfma_f32_16x16x32_bf16 v[152:155], v[248:251], v[88:91], v[152:155]
v_mfma_f32_16x16x32_bf16 v[156:159], v[252:255], v[88:91], v[156:159]
v_mfma_f32_16x16x32_bf16 v[160:163], v[240:243], v[92:95], v[160:163]
v_mfma_f32_16x16x32_bf16 v[164:167], v[244:247], v[92:95], v[164:167]
v_mfma_f32_16x16x32_bf16 v[168:171], v[248:251], v[92:95], v[168:171]
v_mfma_f32_16x16x32_bf16 v[172:175], v[252:255], v[92:95], v[172:175]
s_add_u32 s29, s23, 6144
buffer_load_dwordx4 v[80:83], v2, s[12:15], s29 offen
s_add_u32 s29, s23, 137216
buffer_load_dwordx4 v[84:87], v2, s[12:15], s29 offen
s_add_u32 s29, s23, 268288
buffer_load_dwordx4 v[88:91], v2, s[12:15], s29 offen
s_add_u32 s29, s23, 399360
buffer_load_dwordx4 v[92:95], v2, s[12:15], s29 offen
s_waitcnt lgkmcnt(6)
v_mfma_f32_16x16x32_bf16 v[112:115], v[32:35], v[96:99], v[112:115]
s_waitcnt lgkmcnt(4)
v_mfma_f32_16x16x32_bf16 v[116:119], v[36:39], v[96:99], v[116:119]
s_waitcnt lgkmcnt(2)
v_mfma_f32_16x16x32_bf16 v[120:123], v[40:43], v[96:99], v[120:123]
ds_read_b64_tr_b16 v[16:17], v4 offset:0
s_waitcnt lgkmcnt(1)
v_mfma_f32_16x16x32_bf16 v[124:127], v[44:47], v[96:99], v[124:127]
ds_read_b64_tr_b16 v[18:19], v4 offset:2048
v_mfma_f32_16x16x32_bf16 v[128:131], v[32:35], v[100:103], v[128:131]
ds_read_b64_tr_b16 v[20:21], v5 offset:0
s_add_u32 m0, s25, 12288
s_add_u32 s28, s24, 229376
buffer_load_dwordx4 v3, s[8:11], s28 offen lds
v_mfma_f32_16x16x32_bf16 v[132:135], v[36:39], v[100:103], v[132:135]
ds_read_b64_tr_b16 v[22:23], v5 offset:2048
v_mfma_f32_16x16x32_bf16 v[136:139], v[40:43], v[100:103], v[136:139]
ds_read_b64_tr_b16 v[24:25], v6 offset:0
s_add_u32 m0, s25, 13312
s_add_u32 s28, s24, 237568
buffer_load_dwordx4 v3, s[8:11], s28 offen lds
v_mfma_f32_16x16x32_bf16 v[140:143], v[44:47], v[100:103], v[140:143]
ds_read_b64_tr_b16 v[26:27], v6 offset:2048
v_mfma_f32_16x16x32_bf16 v[144:147], v[32:35], v[104:107], v[144:147]
ds_read_b64_tr_b16 v[28:29], v7 offset:0
s_add_u32 m0, s25, 14336
s_add_u32 s28, s24, 245760
buffer_load_dwordx4 v3, s[8:11], s28 offen lds
v_mfma_f32_16x16x32_bf16 v[148:151], v[36:39], v[104:107], v[148:151]
ds_read_b64_tr_b16 v[30:31], v7 offset:2048
v_mfma_f32_16x16x32_bf16 v[152:155], v[40:43], v[104:107], v[152:155]
s_add_u32 m0, s25, 15360
s_add_u32 s28, s24, 253952
buffer_load_dwordx4 v3, s[8:11], s28 offen lds
v_mfma_f32_16x16x32_bf16 v[156:159], v[44:47], v[104:107], v[156:159]
v_mfma_f32_16x16x32_bf16 v[160:163], v[32:35], v[108:111], v[160:163]
v_mfma_f32_16x16x32_bf16 v[164:167], v[36:39], v[108:111], v[164:167]
v_mfma_f32_16x16x32_bf16 v[168:171], v[40:43], v[108:111], v[168:171]
v_mfma_f32_16x16x32_bf16 v[172:175], v[44:47], v[108:111], v[172:175]
s_add_u32 s29, s23, 7168
buffer_load_dwordx4 v[96:99], v2, s[12:15], s29 offen
s_add_u32 s29, s23, 138240
buffer_load_dwordx4 v[100:103], v2, s[12:15], s29 offen
s_add_u32 s29, s23, 269312
buffer_load_dwordx4 v[104:107], v2, s[12:15], s29 offen
s_add_u32 s29, s23, 400384
buffer_load_dwordx4 v[108:111], v2, s[12:15], s29 offen
s_waitcnt lgkmcnt(6)
s_waitcnt vmcnt(19)
v_mfma_f32_16x16x32_bf16 v[112:115], v[16:19], v[48:51], v[112:115]
s_waitcnt lgkmcnt(4)
v_mfma_f32_16x16x32_bf16 v[116:119], v[20:23], v[48:51], v[116:119]
s_waitcnt lgkmcnt(2)
v_mfma_f32_16x16x32_bf16 v[120:123], v[24:27], v[48:51], v[120:123]
ds_read_b64_tr_b16 v[32:33], v4 offset:4096
s_waitcnt lgkmcnt(1)
v_mfma_f32_16x16x32_bf16 v[124:127], v[28:31], v[48:51], v[124:127]
ds_read_b64_tr_b16 v[34:35], v4 offset:6144
s_waitcnt vmcnt(18)
v_mfma_f32_16x16x32_bf16 v[128:131], v[16:19], v[52:55], v[128:131]
ds_read_b64_tr_b16 v[36:37], v5 offset:4096
s_add_u32 m0, s25, 0
s_add_u32 s28, s24, 262144
buffer_load_dwordx4 v3, s[8:11], s28 offen lds
v_mfma_f32_16x16x32_bf16 v[132:135], v[20:23], v[52:55], v[132:135]
ds_read_b64_tr_b16 v[38:39], v5 offset:6144
v_mfma_f32_16x16x32_bf16 v[136:139], v[24:27], v[52:55], v[136:139]
ds_read_b64_tr_b16 v[40:41], v6 offset:4096
s_add_u32 m0, s25, 1024
s_add_u32 s28, s24, 270336
buffer_load_dwordx4 v3, s[8:11], s28 offen lds
v_mfma_f32_16x16x32_bf16 v[140:143], v[28:31], v[52:55], v[140:143]
ds_read_b64_tr_b16 v[42:43], v6 offset:6144
s_waitcnt vmcnt(19)
v_mfma_f32_16x16x32_bf16 v[144:147], v[16:19], v[56:59], v[144:147]
ds_read_b64_tr_b16 v[44:45], v7 offset:4096
s_add_u32 m0, s25, 2048
s_add_u32 s28, s24, 278528
buffer_load_dwordx4 v3, s[8:11], s28 offen lds
v_mfma_f32_16x16x32_bf16 v[148:151], v[20:23], v[56:59], v[148:151]
ds_read_b64_tr_b16 v[46:47], v7 offset:6144
v_mfma_f32_16x16x32_bf16 v[152:155], v[24:27], v[56:59], v[152:155]
s_add_u32 m0, s25, 3072
s_add_u32 s28, s24, 286720
buffer_load_dwordx4 v3, s[8:11], s28 offen lds
v_mfma_f32_16x16x32_bf16 v[156:159], v[28:31], v[56:59], v[156:159]
s_waitcnt vmcnt(20)
v_mfma_f32_16x16x32_bf16 v[160:163], v[16:19], v[60:63], v[160:163]
v_mfma_f32_16x16x32_bf16 v[164:167], v[20:23], v[60:63], v[164:167]
v_mfma_f32_16x16x32_bf16 v[168:171], v[24:27], v[60:63], v[168:171]
v_mfma_f32_16x16x32_bf16 v[172:175], v[28:31], v[60:63], v[172:175]
s_add_u32 s29, s23, 8192
buffer_load_dwordx4 v[48:51], v2, s[12:15], s29 offen
s_add_u32 s29, s23, 139264
buffer_load_dwordx4 v[52:55], v2, s[12:15], s29 offen
s_add_u32 s29, s23, 270336
buffer_load_dwordx4 v[56:59], v2, s[12:15], s29 offen
s_add_u32 s29, s23, 401408
buffer_load_dwordx4 v[60:63], v2, s[12:15], s29 offen
s_waitcnt lgkmcnt(6)
s_waitcnt vmcnt(23)
v_mfma_f32_16x16x32_bf16 v[112:115], v[32:35], v[64:67], v[112:115]
s_waitcnt lgkmcnt(4)
v_mfma_f32_16x16x32_bf16 v[116:119], v[36:39], v[64:67], v[116:119]
s_waitcnt lgkmcnt(2)
v_mfma_f32_16x16x32_bf16 v[120:123], v[40:43], v[64:67], v[120:123]
ds_read_b64_tr_b16 v[16:17], v4 offset:8192
s_waitcnt lgkmcnt(1)
v_mfma_f32_16x16x32_bf16 v[124:127], v[44:47], v[64:67], v[124:127]
ds_read_b64_tr_b16 v[18:19], v4 offset:10240
s_waitcnt vmcnt(22)
v_mfma_f32_16x16x32_bf16 v[128:131], v[32:35], v[68:71], v[128:131]
ds_read_b64_tr_b16 v[20:21], v5 offset:8192
s_add_u32 m0, s25, 4096
s_add_u32 s28, s24, 294912
buffer_load_dwordx4 v3, s[8:11], s28 offen lds
v_mfma_f32_16x16x32_bf16 v[132:135], v[36:39], v[68:71], v[132:135]
ds_read_b64_tr_b16 v[22:23], v5 offset:10240
v_mfma_f32_16x16x32_bf16 v[136:139], v[40:43], v[68:71], v[136:139]
ds_read_b64_tr_b16 v[24:25], v6 offset:8192
s_add_u32 m0, s25, 5120
s_add_u32 s28, s24, 303104
buffer_load_dwordx4 v3, s[8:11], s28 offen lds
v_mfma_f32_16x16x32_bf16 v[140:143], v[44:47], v[68:71], v[140:143]
ds_read_b64_tr_b16 v[26:27], v6 offset:10240
s_waitcnt vmcnt(23)
v_mfma_f32_16x16x32_bf16 v[144:147], v[32:35], v[72:75], v[144:147]
ds_read_b64_tr_b16 v[28:29], v7 offset:8192
s_add_u32 m0, s25, 6144
s_add_u32 s28, s24, 311296
buffer_load_dwordx4 v3, s[8:11], s28 offen lds
v_mfma_f32_16x16x32_bf16 v[148:151], v[36:39], v[72:75], v[148:151]
ds_read_b64_tr_b16 v[30:31], v7 offset:10240
v_mfma_f32_16x16x32_bf16 v[152:155], v[40:43], v[72:75], v[152:155]
s_add_u32 m0, s25, 7168
s_add_u32 s28, s24, 319488
buffer_load_dwordx4 v3, s[8:11], s28 offen lds
v_mfma_f32_16x16x32_bf16 v[156:159], v[44:47], v[72:75], v[156:159]
s_waitcnt vmcnt(24)
v_mfma_f32_16x16x32_bf16 v[160:163], v[32:35], v[76:79], v[160:163]
v_mfma_f32_16x16x32_bf16 v[164:167], v[36:39], v[76:79], v[164:167]
v_mfma_f32_16x16x32_bf16 v[168:171], v[40:43], v[76:79], v[168:171]
v_mfma_f32_16x16x32_bf16 v[172:175], v[44:47], v[76:79], v[172:175]
s_add_u32 s29, s23, 9216
buffer_load_dwordx4 v[64:67], v2, s[12:15], s29 offen
s_add_u32 s29, s23, 140288
buffer_load_dwordx4 v[68:71], v2, s[12:15], s29 offen
s_add_u32 s29, s23, 271360
buffer_load_dwordx4 v[72:75], v2, s[12:15], s29 offen
s_add_u32 s29, s23, 402432
buffer_load_dwordx4 v[76:79], v2, s[12:15], s29 offen
s_waitcnt lgkmcnt(6)
s_waitcnt vmcnt(27)
v_mfma_f32_16x16x32_bf16 v[112:115], v[16:19], v[80:83], v[112:115]
s_waitcnt lgkmcnt(4)
v_mfma_f32_16x16x32_bf16 v[116:119], v[20:23], v[80:83], v[116:119]
s_waitcnt vmcnt(20)
s_waitcnt lgkmcnt(2)
v_mfma_f32_16x16x32_bf16 v[120:123], v[24:27], v[80:83], v[120:123]
ds_read_b64_tr_b16 v[32:33], v4 offset:12288
s_waitcnt lgkmcnt(1)
v_mfma_f32_16x16x32_bf16 v[124:127], v[28:31], v[80:83], v[124:127]
ds_read_b64_tr_b16 v[34:35], v4 offset:14336
v_mfma_f32_16x16x32_bf16 v[128:131], v[16:19], v[84:87], v[128:131]
ds_read_b64_tr_b16 v[36:37], v5 offset:12288
s_add_u32 m0, s25, 8192
s_add_u32 s28, s24, 327680
buffer_load_dwordx4 v3, s[8:11], s28 offen lds
v_mfma_f32_16x16x32_bf16 v[132:135], v[20:23], v[84:87], v[132:135]
ds_read_b64_tr_b16 v[38:39], v5 offset:14336
v_mfma_f32_16x16x32_bf16 v[136:139], v[24:27], v[84:87], v[136:139]
ds_read_b64_tr_b16 v[40:41], v6 offset:12288
s_add_u32 m0, s25, 9216
s_add_u32 s28, s24, 335872
buffer_load_dwordx4 v3, s[8:11], s28 offen lds
v_mfma_f32_16x16x32_bf16 v[140:143], v[28:31], v[84:87], v[140:143]
ds_read_b64_tr_b16 v[42:43], v6 offset:14336
v_mfma_f32_16x16x32_bf16 v[144:147], v[16:19], v[88:91], v[144:147]
ds_read_b64_tr_b16 v[44:45], v7 offset:12288
s_add_u32 m0, s25, 10240
s_add_u32 s28, s24, 344064
buffer_load_dwordx4 v3, s[8:11], s28 offen lds
v_mfma_f32_16x16x32_bf16 v[148:151], v[20:23], v[88:91], v[148:151]
ds_read_b64_tr_b16 v[46:47], v7 offset:14336
v_mfma_f32_16x16x32_bf16 v[152:155], v[24:27], v[88:91], v[152:155]
s_add_u32 m0, s25, 11264
s_add_u32 s28, s24, 352256
buffer_load_dwordx4 v3, s[8:11], s28 offen lds
v_mfma_f32_16x16x32_bf16 v[156:159], v[28:31], v[88:91], v[156:159]
v_mfma_f32_16x16x32_bf16 v[160:163], v[16:19], v[92:95], v[160:163]
v_mfma_f32_16x16x32_bf16 v[164:167], v[20:23], v[92:95], v[164:167]
v_mfma_f32_16x16x32_bf16 v[168:171], v[24:27], v[92:95], v[168:171]
v_mfma_f32_16x16x32_bf16 v[172:175], v[28:31], v[92:95], v[172:175]
s_add_u32 s29, s23, 10240
buffer_load_dwordx4 v[80:83], v2, s[12:15], s29 offen
s_add_u32 s29, s23, 141312
buffer_load_dwordx4 v[84:87], v2, s[12:15], s29 offen
s_add_u32 s29, s23, 272384
buffer_load_dwordx4 v[88:91], v2, s[12:15], s29 offen
s_add_u32 s29, s23, 403456
buffer_load_dwordx4 v[92:95], v2, s[12:15], s29 offen
s_waitcnt lgkmcnt(6)
s_waitcnt vmcnt(27)
v_mfma_f32_16x16x32_bf16 v[112:115], v[32:35], v[96:99], v[112:115]
s_waitcnt lgkmcnt(4)
v_mfma_f32_16x16x32_bf16 v[116:119], v[36:39], v[96:99], v[116:119]
s_waitcnt vmcnt(20)
s_waitcnt lgkmcnt(2)
v_mfma_f32_16x16x32_bf16 v[120:123], v[40:43], v[96:99], v[120:123]
ds_read_b64_tr_b16 v[16:17], v4 offset:0
s_waitcnt lgkmcnt(1)
v_mfma_f32_16x16x32_bf16 v[124:127], v[44:47], v[96:99], v[124:127]
ds_read_b64_tr_b16 v[18:19], v4 offset:2048
v_mfma_f32_16x16x32_bf16 v[128:131], v[32:35], v[100:103], v[128:131]
ds_read_b64_tr_b16 v[20:21], v5 offset:0
s_add_u32 m0, s25, 12288
s_add_u32 s28, s24, 360448
buffer_load_dwordx4 v3, s[8:11], s28 offen lds
v_mfma_f32_16x16x32_bf16 v[132:135], v[36:39], v[100:103], v[132:135]
ds_read_b64_tr_b16 v[22:23], v5 offset:2048
v_mfma_f32_16x16x32_bf16 v[136:139], v[40:43], v[100:103], v[136:139]
ds_read_b64_tr_b16 v[24:25], v6 offset:0
s_add_u32 m0, s25, 13312
s_add_u32 s28, s24, 368640
buffer_load_dwordx4 v3, s[8:11], s28 offen lds
v_mfma_f32_16x16x32_bf16 v[140:143], v[44:47], v[100:103], v[140:143]
ds_read_b64_tr_b16 v[26:27], v6 offset:2048
v_mfma_f32_16x16x32_bf16 v[144:147], v[32:35], v[104:107], v[144:147]
ds_read_b64_tr_b16 v[28:29], v7 offset:0
s_add_u32 m0, s25, 14336
s_add_u32 s28, s24, 376832
buffer_load_dwordx4 v3, s[8:11], s28 offen lds
v_mfma_f32_16x16x32_bf16 v[148:151], v[36:39], v[104:107], v[148:151]
ds_read_b64_tr_b16 v[30:31], v7 offset:2048
v_mfma_f32_16x16x32_bf16 v[152:155], v[40:43], v[104:107], v[152:155]
s_add_u32 m0, s25, 15360
s_add_u32 s28, s24, 385024
buffer_load_dwordx4 v3, s[8:11], s28 offen lds
v_mfma_f32_16x16x32_bf16 v[156:159], v[44:47], v[104:107], v[156:159]
v_mfma_f32_16x16x32_bf16 v[160:163], v[32:35], v[108:111], v[160:163]
v_mfma_f32_16x16x32_bf16 v[164:167], v[36:39], v[108:111], v[164:167]
v_mfma_f32_16x16x32_bf16 v[168:171], v[40:43], v[108:111], v[168:171]
v_mfma_f32_16x16x32_bf16 v[172:175], v[44:47], v[108:111], v[172:175]
s_add_u32 s29, s23, 11264
buffer_load_dwordx4 v[96:99], v2, s[12:15], s29 offen
s_add_u32 s29, s23, 142336
buffer_load_dwordx4 v[100:103], v2, s[12:15], s29 offen
s_add_u32 s29, s23, 273408
buffer_load_dwordx4 v[104:107], v2, s[12:15], s29 offen
s_add_u32 s29, s23, 404480
buffer_load_dwordx4 v[108:111], v2, s[12:15], s29 offen
s_waitcnt lgkmcnt(6)
s_waitcnt vmcnt(27)
v_mfma_f32_16x16x32_bf16 v[112:115], v[16:19], v[48:51], v[112:115]
s_waitcnt lgkmcnt(4)
v_mfma_f32_16x16x32_bf16 v[116:119], v[20:23], v[48:51], v[116:119]
s_waitcnt vmcnt(20)
s_waitcnt lgkmcnt(2)
v_mfma_f32_16x16x32_bf16 v[120:123], v[24:27], v[48:51], v[120:123]
ds_read_b64_tr_b16 v[32:33], v4 offset:4096
s_waitcnt lgkmcnt(1)
v_mfma_f32_16x16x32_bf16 v[124:127], v[28:31], v[48:51], v[124:127]
ds_read_b64_tr_b16 v[34:35], v4 offset:6144
v_mfma_f32_16x16x32_bf16 v[128:131], v[16:19], v[52:55], v[128:131]
ds_read_b64_tr_b16 v[36:37], v5 offset:4096
s_add_u32 m0, s25, 0
s_add_u32 s28, s24, 393216
buffer_load_dwordx4 v3, s[8:11], s28 offen lds
v_mfma_f32_16x16x32_bf16 v[132:135], v[20:23], v[52:55], v[132:135]
ds_read_b64_tr_b16 v[38:39], v5 offset:6144
v_mfma_f32_16x16x32_bf16 v[136:139], v[24:27], v[52:55], v[136:139]
ds_read_b64_tr_b16 v[40:41], v6 offset:4096
s_add_u32 m0, s25, 1024
s_add_u32 s28, s24, 401408
buffer_load_dwordx4 v3, s[8:11], s28 offen lds
v_mfma_f32_16x16x32_bf16 v[140:143], v[28:31], v[52:55], v[140:143]
ds_read_b64_tr_b16 v[42:43], v6 offset:6144
v_mfma_f32_16x16x32_bf16 v[144:147], v[16:19], v[56:59], v[144:147]
ds_read_b64_tr_b16 v[44:45], v7 offset:4096
s_add_u32 m0, s25, 2048
s_add_u32 s28, s24, 409600
buffer_load_dwordx4 v3, s[8:11], s28 offen lds
v_mfma_f32_16x16x32_bf16 v[148:151], v[20:23], v[56:59], v[148:151]
ds_read_b64_tr_b16 v[46:47], v7 offset:6144
v_mfma_f32_16x16x32_bf16 v[152:155], v[24:27], v[56:59], v[152:155]
s_add_u32 m0, s25, 3072
s_add_u32 s28, s24, 417792
buffer_load_dwordx4 v3, s[8:11], s28 offen lds
v_mfma_f32_16x16x32_bf16 v[156:159], v[28:31], v[56:59], v[156:159]
v_mfma_f32_16x16x32_bf16 v[160:163], v[16:19], v[60:63], v[160:163]
v_mfma_f32_16x16x32_bf16 v[164:167], v[20:23], v[60:63], v[164:167]
v_mfma_f32_16x16x32_bf16 v[168:171], v[24:27], v[60:63], v[168:171]
v_mfma_f32_16x16x32_bf16 v[172:175], v[28:31], v[60:63], v[172:175]
s_add_u32 s29, s23, 12288
buffer_load_dwordx4 v[48:51], v2, s[12:15], s29 offen
s_add_u32 s29, s23, 143360
buffer_load_dwordx4 v[52:55], v2, s[12:15], s29 offen
s_add_u32 s29, s23, 274432
buffer_load_dwordx4 v[56:59], v2, s[12:15], s29 offen
s_add_u32 s29, s23, 405504
buffer_load_dwordx4 v[60:63], v2, s[12:15], s29 offen
s_waitcnt lgkmcnt(6)
s_waitcnt vmcnt(27)
v_mfma_f32_16x16x32_bf16 v[112:115], v[32:35], v[64:67], v[112:115]
s_waitcnt lgkmcnt(4)
v_mfma_f32_16x16x32_bf16 v[116:119], v[36:39], v[64:67], v[116:119]
s_waitcnt vmcnt(20)
s_waitcnt lgkmcnt(2)
v_mfma_f32_16x16x32_bf16 v[120:123], v[40:43], v[64:67], v[120:123]
ds_read_b64_tr_b16 v[16:17], v4 offset:8192
s_waitcnt lgkmcnt(1)
v_mfma_f32_16x16x32_bf16 v[124:127], v[44:47], v[64:67], v[124:127]
ds_read_b64_tr_b16 v[18:19], v4 offset:10240
v_mfma_f32_16x16x32_bf16 v[128:131], v[32:35], v[68:71], v[128:131]
ds_read_b64_tr_b16 v[20:21], v5 offset:8192
s_add_u32 m0, s25, 4096
s_add_u32 s28, s24, 425984
buffer_load_dwordx4 v3, s[8:11], s28 offen lds
v_mfma_f32_16x16x32_bf16 v[132:135], v[36:39], v[68:71], v[132:135]
ds_read_b64_tr_b16 v[22:23], v5 offset:10240
v_mfma_f32_16x16x32_bf16 v[136:139], v[40:43], v[68:71], v[136:139]
ds_read_b64_tr_b16 v[24:25], v6 offset:8192
s_add_u32 m0, s25, 5120
s_add_u32 s28, s24, 434176
buffer_load_dwordx4 v3, s[8:11], s28 offen lds
v_mfma_f32_16x16x32_bf16 v[140:143], v[44:47], v[68:71], v[140:143]
ds_read_b64_tr_b16 v[26:27], v6 offset:10240
v_mfma_f32_16x16x32_bf16 v[144:147], v[32:35], v[72:75], v[144:147]
ds_read_b64_tr_b16 v[28:29], v7 offset:8192
s_add_u32 m0, s25, 6144
s_add_u32 s28, s24, 442368
buffer_load_dwordx4 v3, s[8:11], s28 offen lds
v_mfma_f32_16x16x32_bf16 v[148:151], v[36:39], v[72:75], v[148:151]
ds_read_b64_tr_b16 v[30:31], v7 offset:10240
v_mfma_f32_16x16x32_bf16 v[152:155], v[40:43], v[72:75], v[152:155]
s_add_u32 m0, s25, 7168
s_add_u32 s28, s24, 450560
buffer_load_dwordx4 v3, s[8:11], s28 offen lds
v_mfma_f32_16x16x32_bf16 v[156:159], v[44:47], v[72:75], v[156:159]
v_mfma_f32_16x16x32_bf16 v[160:163], v[32:35], v[76:79], v[160:163]
v_mfma_f32_16x16x32_bf16 v[164:167], v[36:39], v[76:79], v[164:167]
v_mfma_f32_16x16x32_bf16 v[168:171], v[40:43], v[76:79], v[168:171]
v_mfma_f32_16x16x32_bf16 v[172:175], v[44:47], v[76:79], v[172:175]
s_add_u32 s29, s23, 13312
buffer_load_dwordx4 v[64:67], v2, s[12:15], s29 offen
s_add_u32 s29, s23, 144384
buffer_load_dwordx4 v[68:71], v2, s[12:15], s29 offen
s_add_u32 s29, s23, 275456
buffer_load_dwordx4 v[72:75], v2, s[12:15], s29 offen
s_add_u32 s29, s23, 406528
buffer_load_dwordx4 v[76:79], v2, s[12:15], s29 offen
s_waitcnt lgkmcnt(6)
s_waitcnt vmcnt(27)
v_mfma_f32_16x16x32_bf16 v[112:115], v[16:19], v[80:83], v[112:115]
s_waitcnt lgkmcnt(4)
v_mfma_f32_16x16x32_bf16 v[116:119], v[20:23], v[80:83], v[116:119]
s_waitcnt vmcnt(20)
s_waitcnt lgkmcnt(2)
v_mfma_f32_16x16x32_bf16 v[120:123], v[24:27], v[80:83], v[120:123]
ds_read_b64_tr_b16 v[32:33], v4 offset:12288
s_waitcnt lgkmcnt(1)
v_mfma_f32_16x16x32_bf16 v[124:127], v[28:31], v[80:83], v[124:127]
ds_read_b64_tr_b16 v[34:35], v4 offset:14336
v_mfma_f32_16x16x32_bf16 v[128:131], v[16:19], v[84:87], v[128:131]
ds_read_b64_tr_b16 v[36:37], v5 offset:12288
s_add_u32 m0, s25, 8192
s_add_u32 s28, s24, 458752
buffer_load_dwordx4 v3, s[8:11], s28 offen lds
v_mfma_f32_16x16x32_bf16 v[132:135], v[20:23], v[84:87], v[132:135]
ds_read_b64_tr_b16 v[38:39], v5 offset:14336
v_mfma_f32_16x16x32_bf16 v[136:139], v[24:27], v[84:87], v[136:139]
ds_read_b64_tr_b16 v[40:41], v6 offset:12288
s_add_u32 m0, s25, 9216
s_add_u32 s28, s24, 466944
buffer_load_dwordx4 v3, s[8:11], s28 offen lds
v_mfma_f32_16x16x32_bf16 v[140:143], v[28:31], v[84:87], v[140:143]
ds_read_b64_tr_b16 v[42:43], v6 offset:14336
v_mfma_f32_16x16x32_bf16 v[144:147], v[16:19], v[88:91], v[144:147]
ds_read_b64_tr_b16 v[44:45], v7 offset:12288
s_add_u32 m0, s25, 10240
s_add_u32 s28, s24, 475136
buffer_load_dwordx4 v3, s[8:11], s28 offen lds
v_mfma_f32_16x16x32_bf16 v[148:151], v[20:23], v[88:91], v[148:151]
ds_read_b64_tr_b16 v[46:47], v7 offset:14336
v_mfma_f32_16x16x32_bf16 v[152:155], v[24:27], v[88:91], v[152:155]
s_add_u32 m0, s25, 11264
s_add_u32 s28, s24, 483328
buffer_load_dwordx4 v3, s[8:11], s28 offen lds
v_mfma_f32_16x16x32_bf16 v[156:159], v[28:31], v[88:91], v[156:159]
v_mfma_f32_16x16x32_bf16 v[160:163], v[16:19], v[92:95], v[160:163]
v_mfma_f32_16x16x32_bf16 v[164:167], v[20:23], v[92:95], v[164:167]
v_mfma_f32_16x16x32_bf16 v[168:171], v[24:27], v[92:95], v[168:171]
v_mfma_f32_16x16x32_bf16 v[172:175], v[28:31], v[92:95], v[172:175]
s_add_u32 s29, s23, 14336
buffer_load_dwordx4 v[80:83], v2, s[12:15], s29 offen
s_add_u32 s29, s23, 145408
buffer_load_dwordx4 v[84:87], v2, s[12:15], s29 offen
s_add_u32 s29, s23, 276480
buffer_load_dwordx4 v[88:91], v2, s[12:15], s29 offen
s_add_u32 s29, s23, 407552
buffer_load_dwordx4 v[92:95], v2, s[12:15], s29 offen
s_waitcnt lgkmcnt(6)
s_waitcnt vmcnt(27)
v_mfma_f32_16x16x32_bf16 v[112:115], v[32:35], v[96:99], v[112:115]
s_waitcnt lgkmcnt(4)
v_mfma_f32_16x16x32_bf16 v[116:119], v[36:39], v[96:99], v[116:119]
s_waitcnt vmcnt(20)
s_waitcnt lgkmcnt(2)
v_mfma_f32_16x16x32_bf16 v[120:123], v[40:43], v[96:99], v[120:123]
ds_read_b64_tr_b16 v[16:17], v4 offset:0
s_waitcnt lgkmcnt(1)
v_mfma_f32_16x16x32_bf16 v[124:127], v[44:47], v[96:99], v[124:127]
ds_read_b64_tr_b16 v[18:19], v4 offset:2048
v_mfma_f32_16x16x32_bf16 v[128:131], v[32:35], v[100:103], v[128:131]
ds_read_b64_tr_b16 v[20:21], v5 offset:0
s_add_u32 m0, s25, 12288
s_add_u32 s28, s24, 491520
buffer_load_dwordx4 v3, s[8:11], s28 offen lds
v_mfma_f32_16x16x32_bf16 v[132:135], v[36:39], v[100:103], v[132:135]
ds_read_b64_tr_b16 v[22:23], v5 offset:2048
v_mfma_f32_16x16x32_bf16 v[136:139], v[40:43], v[100:103], v[136:139]
ds_read_b64_tr_b16 v[24:25], v6 offset:0
s_add_u32 m0, s25, 13312
s_add_u32 s28, s24, 499712
buffer_load_dwordx4 v3, s[8:11], s28 offen lds
v_mfma_f32_16x16x32_bf16 v[140:143], v[44:47], v[100:103], v[140:143]
ds_read_b64_tr_b16 v[26:27], v6 offset:2048
v_mfma_f32_16x16x32_bf16 v[144:147], v[32:35], v[104:107], v[144:147]
ds_read_b64_tr_b16 v[28:29], v7 offset:0
s_add_u32 m0, s25, 14336
s_add_u32 s28, s24, 507904
buffer_load_dwordx4 v3, s[8:11], s28 offen lds
v_mfma_f32_16x16x32_bf16 v[148:151], v[36:39], v[104:107], v[148:151]
ds_read_b64_tr_b16 v[30:31], v7 offset:2048
v_mfma_f32_16x16x32_bf16 v[152:155], v[40:43], v[104:107], v[152:155]
s_add_u32 m0, s25, 15360
s_add_u32 s28, s24, 516096
buffer_load_dwordx4 v3, s[8:11], s28 offen lds
v_mfma_f32_16x16x32_bf16 v[156:159], v[44:47], v[104:107], v[156:159]
v_mfma_f32_16x16x32_bf16 v[160:163], v[32:35], v[108:111], v[160:163]
v_mfma_f32_16x16x32_bf16 v[164:167], v[36:39], v[108:111], v[164:167]
v_mfma_f32_16x16x32_bf16 v[168:171], v[40:43], v[108:111], v[168:171]
v_mfma_f32_16x16x32_bf16 v[172:175], v[44:47], v[108:111], v[172:175]
s_add_u32 s29, s23, 15360
buffer_load_dwordx4 v[96:99], v2, s[12:15], s29 offen
s_add_u32 s29, s23, 146432
buffer_load_dwordx4 v[100:103], v2, s[12:15], s29 offen
s_add_u32 s29, s23, 277504
buffer_load_dwordx4 v[104:107], v2, s[12:15], s29 offen
s_add_u32 s29, s23, 408576
buffer_load_dwordx4 v[108:111], v2, s[12:15], s29 offen
s_waitcnt lgkmcnt(6)
s_waitcnt vmcnt(27)
v_mfma_f32_16x16x32_bf16 v[112:115], v[16:19], v[48:51], v[112:115]
s_waitcnt lgkmcnt(4)
v_mfma_f32_16x16x32_bf16 v[116:119], v[20:23], v[48:51], v[116:119]
s_waitcnt vmcnt(20)
s_waitcnt lgkmcnt(2)
v_mfma_f32_16x16x32_bf16 v[120:123], v[24:27], v[48:51], v[120:123]
ds_read_b64_tr_b16 v[32:33], v4 offset:4096
s_waitcnt lgkmcnt(1)
v_mfma_f32_16x16x32_bf16 v[124:127], v[28:31], v[48:51], v[124:127]
ds_read_b64_tr_b16 v[34:35], v4 offset:6144
v_mfma_f32_16x16x32_bf16 v[128:131], v[16:19], v[52:55], v[128:131]
ds_read_b64_tr_b16 v[36:37], v5 offset:4096
v_mfma_f32_16x16x32_bf16 v[132:135], v[20:23], v[52:55], v[132:135]
ds_read_b64_tr_b16 v[38:39], v5 offset:6144
v_mfma_f32_16x16x32_bf16 v[136:139], v[24:27], v[52:55], v[136:139]
ds_read_b64_tr_b16 v[40:41], v6 offset:4096
v_mfma_f32_16x16x32_bf16 v[140:143], v[28:31], v[52:55], v[140:143]
ds_read_b64_tr_b16 v[42:43], v6 offset:6144
v_mfma_f32_16x16x32_bf16 v[144:147], v[16:19], v[56:59], v[144:147]
ds_read_b64_tr_b16 v[44:45], v7 offset:4096
v_mfma_f32_16x16x32_bf16 v[148:151], v[20:23], v[56:59], v[148:151]
ds_read_b64_tr_b16 v[46:47], v7 offset:6144
v_mfma_f32_16x16x32_bf16 v[152:155], v[24:27], v[56:59], v[152:155]
v_mfma_f32_16x16x32_bf16 v[156:159], v[28:31], v[56:59], v[156:159]
v_mfma_f32_16x16x32_bf16 v[160:163], v[16:19], v[60:63], v[160:163]
v_mfma_f32_16x16x32_bf16 v[164:167], v[20:23], v[60:63], v[164:167]
v_mfma_f32_16x16x32_bf16 v[168:171], v[24:27], v[60:63], v[168:171]
v_mfma_f32_16x16x32_bf16 v[172:175], v[28:31], v[60:63], v[172:175]
s_waitcnt lgkmcnt(6)
s_waitcnt vmcnt(19)
v_mfma_f32_16x16x32_bf16 v[112:115], v[32:35], v[64:67], v[112:115]
s_waitcnt lgkmcnt(4)
v_mfma_f32_16x16x32_bf16 v[116:119], v[36:39], v[64:67], v[116:119]
s_waitcnt vmcnt(12)
s_waitcnt lgkmcnt(2)
v_mfma_f32_16x16x32_bf16 v[120:123], v[40:43], v[64:67], v[120:123]
ds_read_b64_tr_b16 v[16:17], v4 offset:8192
s_waitcnt lgkmcnt(1)
v_mfma_f32_16x16x32_bf16 v[124:127], v[44:47], v[64:67], v[124:127]
ds_read_b64_tr_b16 v[18:19], v4 offset:10240
v_mfma_f32_16x16x32_bf16 v[128:131], v[32:35], v[68:71], v[128:131]
ds_read_b64_tr_b16 v[20:21], v5 offset:8192
v_mfma_f32_16x16x32_bf16 v[132:135], v[36:39], v[68:71], v[132:135]
ds_read_b64_tr_b16 v[22:23], v5 offset:10240
v_mfma_f32_16x16x32_bf16 v[136:139], v[40:43], v[68:71], v[136:139]
ds_read_b64_tr_b16 v[24:25], v6 offset:8192
v_mfma_f32_16x16x32_bf16 v[140:143], v[44:47], v[68:71], v[140:143]
ds_read_b64_tr_b16 v[26:27], v6 offset:10240
v_mfma_f32_16x16x32_bf16 v[144:147], v[32:35], v[72:75], v[144:147]
ds_read_b64_tr_b16 v[28:29], v7 offset:8192
v_mfma_f32_16x16x32_bf16 v[148:151], v[36:39], v[72:75], v[148:151]
ds_read_b64_tr_b16 v[30:31], v7 offset:10240
v_mfma_f32_16x16x32_bf16 v[152:155], v[40:43], v[72:75], v[152:155]
v_mfma_f32_16x16x32_bf16 v[156:159], v[44:47], v[72:75], v[156:159]
v_mfma_f32_16x16x32_bf16 v[160:163], v[32:35], v[76:79], v[160:163]
v_mfma_f32_16x16x32_bf16 v[164:167], v[36:39], v[76:79], v[164:167]
v_mfma_f32_16x16x32_bf16 v[168:171], v[40:43], v[76:79], v[168:171]
v_mfma_f32_16x16x32_bf16 v[172:175], v[44:47], v[76:79], v[172:175]
s_waitcnt lgkmcnt(6)
s_waitcnt vmcnt(11)
v_mfma_f32_16x16x32_bf16 v[112:115], v[16:19], v[80:83], v[112:115]
s_waitcnt lgkmcnt(4)
v_mfma_f32_16x16x32_bf16 v[116:119], v[20:23], v[80:83], v[116:119]
s_waitcnt vmcnt(4)
s_waitcnt lgkmcnt(2)
v_mfma_f32_16x16x32_bf16 v[120:123], v[24:27], v[80:83], v[120:123]
ds_read_b64_tr_b16 v[32:33], v4 offset:12288
s_waitcnt lgkmcnt(1)
v_mfma_f32_16x16x32_bf16 v[124:127], v[28:31], v[80:83], v[124:127]
ds_read_b64_tr_b16 v[34:35], v4 offset:14336
v_mfma_f32_16x16x32_bf16 v[128:131], v[16:19], v[84:87], v[128:131]
ds_read_b64_tr_b16 v[36:37], v5 offset:12288
v_mfma_f32_16x16x32_bf16 v[132:135], v[20:23], v[84:87], v[132:135]
ds_read_b64_tr_b16 v[38:39], v5 offset:14336
v_mfma_f32_16x16x32_bf16 v[136:139], v[24:27], v[84:87], v[136:139]
ds_read_b64_tr_b16 v[40:41], v6 offset:12288
v_mfma_f32_16x16x32_bf16 v[140:143], v[28:31], v[84:87], v[140:143]
ds_read_b64_tr_b16 v[42:43], v6 offset:14336
v_mfma_f32_16x16x32_bf16 v[144:147], v[16:19], v[88:91], v[144:147]
ds_read_b64_tr_b16 v[44:45], v7 offset:12288
v_mfma_f32_16x16x32_bf16 v[148:151], v[20:23], v[88:91], v[148:151]
ds_read_b64_tr_b16 v[46:47], v7 offset:14336
v_mfma_f32_16x16x32_bf16 v[152:155], v[24:27], v[88:91], v[152:155]
v_mfma_f32_16x16x32_bf16 v[156:159], v[28:31], v[88:91], v[156:159]
v_mfma_f32_16x16x32_bf16 v[160:163], v[16:19], v[92:95], v[160:163]
v_mfma_f32_16x16x32_bf16 v[164:167], v[20:23], v[92:95], v[164:167]
v_mfma_f32_16x16x32_bf16 v[168:171], v[24:27], v[92:95], v[168:171]
v_mfma_f32_16x16x32_bf16 v[172:175], v[28:31], v[92:95], v[172:175]
s_waitcnt lgkmcnt(6)
s_waitcnt vmcnt(3)
v_mfma_f32_16x16x32_bf16 v[112:115], v[32:35], v[96:99], v[112:115]
s_waitcnt lgkmcnt(4)
v_mfma_f32_16x16x32_bf16 v[116:119], v[36:39], v[96:99], v[116:119]
s_waitcnt lgkmcnt(2)
v_mfma_f32_16x16x32_bf16 v[120:123], v[40:43], v[96:99], v[120:123]
s_waitcnt lgkmcnt(0)
v_mfma_f32_16x16x32_bf16 v[124:127], v[44:47], v[96:99], v[124:127]
s_waitcnt vmcnt(2)
v_mfma_f32_16x16x32_bf16 v[128:131], v[32:35], v[100:103], v[128:131]
v_mfma_f32_16x16x32_bf16 v[132:135], v[36:39], v[100:103], v[132:135]
v_mfma_f32_16x16x32_bf16 v[136:139], v[40:43], v[100:103], v[136:139]
v_mfma_f32_16x16x32_bf16 v[140:143], v[44:47], v[100:103], v[140:143]
s_waitcnt vmcnt(1)
v_mfma_f32_16x16x32_bf16 v[144:147], v[32:35], v[104:107], v[144:147]
v_mfma_f32_16x16x32_bf16 v[148:151], v[36:39], v[104:107], v[148:151]
v_mfma_f32_16x16x32_bf16 v[152:155], v[40:43], v[104:107], v[152:155]
v_mfma_f32_16x16x32_bf16 v[156:159], v[44:47], v[104:107], v[156:159]
s_waitcnt vmcnt(0)
v_mfma_f32_16x16x32_bf16 v[160:163], v[32:35], v[108:111], v[160:163]
v_mfma_f32_16x16x32_bf16 v[164:167], v[36:39], v[108:111], v[164:167]
v_mfma_f32_16x16x32_bf16 v[168:171], v[40:43], v[108:111], v[168:171]
v_mfma_f32_16x16x32_bf16 v[172:175], v[44:47], v[108:111], v[172:175]
v_and_b32 v13, 15, v1
v_lshrrev_b32 v14, 4, v1
v_lshlrev_b32 v15, 8, v13
v_add_u32 v15, s25, v15
v_add_u32 v16, 0, v14
v_xor_b32 v16, v16, v13
v_lshlrev_b32 v16, 4, v16
v_add_u32 v16, v16, v15
v_add_u32 v17, 4, v14
v_xor_b32 v17, v17, v13
v_lshlrev_b32 v17, 4, v17
v_add_u32 v17, v17, v15
v_add_u32 v18, 8, v14
v_xor_b32 v18, v18, v13
v_lshlrev_b32 v18, 4, v18
v_add_u32 v18, v18, v15
v_add_u32 v19, 12, v14
v_xor_b32 v19, v19, v13
v_lshlrev_b32 v19, 4, v19
v_add_u32 v19, v19, v15
s_nop 1
ds_write_b128 v16, v[112:115] offset:0
ds_write_b128 v17, v[116:119] offset:0
ds_write_b128 v18, v[120:123] offset:0
ds_write_b128 v19, v[124:127] offset:0
ds_write_b128 v16, v[128:131] offset:4096
ds_write_b128 v17, v[132:135] offset:4096
ds_write_b128 v18, v[136:139] offset:4096
ds_write_b128 v19, v[140:143] offset:4096
ds_write_b128 v16, v[144:147] offset:8192
ds_write_b128 v17, v[148:151] offset:8192
ds_write_b128 v18, v[152:155] offset:8192
ds_write_b128 v19, v[156:159] offset:8192
ds_write_b128 v16, v[160:163] offset:12288
ds_write_b128 v17, v[164:167] offset:12288
ds_write_b128 v18, v[168:171] offset:12288
ds_write_b128 v19, v[172:175] offset:12288
v_mov_b32 v176, 0
v_mov_b32 v177, 0
v_mov_b32 v178, 0
v_mov_b32 v179, 0
v_mov_b32 v180, 0
v_mov_b32 v181, 0
v_mov_b32 v182, 0
v_mov_b32 v183, 0
s_cmp_eq_u32 s50, 0
s_cbranch_scc1 L_k3_noy
s_waitcnt vmcnt(0)
v_add_f32 v16, v192, v200
v_add_f32 v17, v193, v201
v_add_f32 v18, v194, v202
v_add_f32 v19, v195, v203
v_add_f32 v20, v196, v204
v_add_f32 v21, v197, v205
v_add_f32 v22, v198, v206
v_add_f32 v23, v199, v207
s_nop 1
v_add_f32 v16, v16, v16 row_ror:8 row_mask:0xf bank_mask:0xf
v_add_f32 v17, v17, v17 row_ror:8 row_mask:0xf bank_mask:0xf
v_add_f32 v18, v18, v18 row_ror:8 row_mask:0xf bank_mask:0xf
v_add_f32 v19, v19, v19 row_ror:8 row_mask:0xf bank_mask:0xf
v_add_f32 v20, v20, v20 row_ror:8 row_mask:0xf bank_mask:0xf
v_add_f32 v21, v21, v21 row_ror:8 row_mask:0xf bank_mask:0xf
v_add_f32 v22, v22, v22 row_ror:8 row_mask:0xf bank_mask:0xf
v_add_f32 v23, v23, v23 row_ror:8 row_mask:0xf bank_mask:0xf
v_mov_b32 v24, v16
v_mov_b32 v25, v17
v_mov_b32 v26, v18
v_mov_b32 v27, v19
v_mov_b32 v28, v20
v_mov_b32 v29, v21
v_mov_b32 v30, v22
v_mov_b32 v31, v23
s_nop 1
v_permlane16_swap_b32 v16, v24
v_permlane16_swap_b32 v17, v25
v_permlane16_swap_b32 v18, v26
v_permlane16_swap_b32 v19, v27
v_permlane16_swap_b32 v20, v28
v_permlane16_swap_b32 v21, v29
v_permlane16_swap_b32 v22, v30
v_permlane16_swap_b32 v23, v31
s_nop 1
v_add_f32 v16, v16, v24
v_add_f32 v17, v17, v25
v_add_f32 v18, v18, v26
v_add_f32 v19, v19, v27
v_add_f32 v20, v20, v28
v_add_f32 v21, v21, v29
v_add_f32 v22, v22, v30
v_add_f32 v23, v23, v31
v_mov_b32 v24, v16
v_mov_b32 v25, v17
v_mov_b32 v26, v18
v_mov_b32 v27, v19
v_mov_b32 v28, v20
v_mov_b32 v29, v21
v_mov_b32 v30, v22
v_mov_b32 v31, v23
s_nop 1
v_permlane32_swap_b32 v16, v24
v_permlane32_swap_b32 v17, v25
v_permlane32_swap_b32 v18, v26
v_permlane32_swap_b32 v19, v27
v_permlane32_swap_b32 v20, v28
v_permlane32_swap_b32 v21, v29
v_permlane32_swap_b32 v22, v30
v_permlane32_swap_b32 v23, v31
s_nop 1
v_add_f32 v16, v16, v24
v_add_f32 v17, v17, v25
v_add_f32 v18, v18, v26
v_add_f32 v19, v19, v27
v_add_f32 v20, v20, v28
v_add_f32 v21, v21, v29
v_add_f32 v22, v22, v30
v_add_f32 v23, v23, v31
v_lshlrev_b32 v35, 5, v9
s_lshl_b32 s27, s22, 8
s_add_u32 s27, s27, 131072
v_add_u32 v35, s27, v35
ds_write_b128 v35, v[16:19]
ds_write_b128 v35, v[20:23] offset:16
s_waitcnt lgkmcnt(0)
s_barrier
v_lshlrev_b32 v35, 5, v9
v_add_u32 v35, 131072, v35
ds_read_b128 v[112:115], v35 offset:0
ds_read_b128 v[116:119], v35 offset:16
ds_read_b128 v[120:123], v35 offset:256
ds_read_b128 v[124:127], v35 offset:272
ds_read_b128 v[128:131], v35 offset:512
ds_read_b128 v[132:135], v35 offset:528
ds_read_b128 v[136:139], v35 offset:768
ds_read_b128 v[140:143], v35 offset:784
ds_read_b128 v[144:147], v35 offset:1024
ds_read_b128 v[148:151], v35 offset:1040
ds_read_b128 v[152:155], v35 offset:1280
ds_read_b128 v[156:159], v35 offset:1296
ds_read_b128 v[160:163], v35 offset:1536
ds_read_b128 v[164:167], v35 offset:1552
ds_read_b128 v[168:171], v35 offset:1792
ds_read_b128 v[172:175], v35 offset:1808
s_waitcnt lgkmcnt(0)
v_add_f32 v176, v176, v112
v_add_f32 v177, v177, v113
v_add_f32 v178, v178, v114
v_add_f32 v179, v179, v115
v_add_f32 v180, v180, v116
v_add_f32 v181, v181, v117
v_add_f32 v182, v182, v118
v_add_f32 v183, v183, v119
v_add_f32 v176, v176, v120
v_add_f32 v177, v177, v121
v_add_f32 v178, v178, v122
v_add_f32 v179, v179, v123
v_add_f32 v180, v180, v124
v_add_f32 v181, v181, v125
v_add_f32 v182, v182, v126
v_add_f32 v183, v183, v127
v_add_f32 v176, v176, v128
v_add_f32 v177, v177, v129
v_add_f32 v178, v178, v130
v_add_f32 v179, v179, v131
v_add_f32 v180, v180, v132
v_add_f32 v181, v181, v133
v_add_f32 v182, v182, v134
v_add_f32 v183, v183, v135
v_add_f32 v176, v176, v136
v_add_f32 v177, v177, v137
v_add_f32 v178, v178, v138
v_add_f32 v179, v179, v139
v_add_f32 v180, v180, v140
v_add_f32 v181, v181, v141
v_add_f32 v182, v182, v142
v_add_f32 v183, v183, v143
v_add_f32 v176, v176, v144
v_add_f32 v177, v177, v145
v_add_f32 v178, v178, v146
v_add_f32 v179, v179, v147
v_add_f32 v180, v180, v148
v_add_f32 v181, v181, v149
v_add_f32 v182, v182, v150
v_add_f32 v183, v183, v151
v_add_f32 v176, v176, v152
v_add_f32 v177, v177, v153
v_add_f32 v178, v178, v154
v_add_f32 v179, v179, v155
v_add_f32 v180, v180, v156
v_add_f32 v181, v181, v157
v_add_f32 v182, v182, v158
v_add_f32 v183, v183, v159
v_add_f32 v176, v176, v160
v_add_f32 v177, v177, v161
v_add_f32 v178, v178, v162
v_add_f32 v179, v179, v163
v_add_f32 v180, v180, v164
v_add_f32 v181, v181, v165
v_add_f32 v182, v182, v166
v_add_f32 v183, v183, v167
v_add_f32 v176, v176, v168
v_add_f32 v177, v177, v169
v_add_f32 v178, v178, v170
v_add_f32 v179, v179, v171
v_add_f32 v180, v180, v172
v_add_f32 v181, v181, v173
v_add_f32 v182, v182, v174
v_add_f32 v183, v183, v175
v_cmp_eq_u32 vcc, s30, v10
v_mov_b32 v35, s31
s_nop 1
v_cndmask_b32 v35, 0, v35, vcc
v_mul_f32 v176, v176, v35
v_mul_f32 v177, v177, v35
v_mul_f32 v178, v178, v35
v_mul_f32 v179, v179, v35
v_mul_f32 v180, v180, v35
v_mul_f32 v181, v181, v35
v_mul_f32 v182, v182, v35
v_mul_f32 v183, v183, v35
s_branch L_k3_fin
L_k3_noy:
s_waitcnt lgkmcnt(0)
s_barrier
L_k3_fin:
v_and_b32 v14, 15, v8
v_lshlrev_b32 v15, 1, v9
v_xor_b32 v14, v14, v15
v_lshlrev_b32 v14, 4, v14
v_lshlrev_b32 v13, 8, v8
v_add_u32 v40, v13, v14
v_xor_b32 v41, 16, v40
v_add_u32 v42, 0x10000, v40
v_add_u32 v43, 0x10000, v41
ds_read_b128 v[48:51], v40 offset:0
ds_read_b128 v[52:55], v41 offset:0
ds_read_b128 v[56:59], v40 offset:16384
ds_read_b128 v[60:63], v41 offset:16384
ds_read_b128 v[64:67], v40 offset:32768
ds_read_b128 v[68:71], v41 offset:32768
ds_read_b128 v[72:75], v40 offset:49152
ds_read_b128 v[76:79], v41 offset:49152
ds_read_b128 v[80:83], v42 offset:0
ds_read_b128 v[84:87], v43 offset:0
ds_read_b128 v[88:91], v42 offset:16384
ds_read_b128 v[92:95], v43 offset:16384
ds_read_b128 v[96:99], v42 offset:32768
ds_read_b128 v[100:103], v43 offset:32768
ds_read_b128 v[104:107], v42 offset:49152
ds_read_b128 v[108:111], v43 offset:49152
s_waitcnt lgkmcnt(13)
v_add_f32 v48, v48, v56
v_add_f32 v49, v49, v57
v_add_f32 v50, v50, v58
v_add_f32 v51, v51, v59
s_waitcnt lgkmcnt(12)
v_add_f32 v52, v52, v60
v_add_f32 v53, v53, v61
v_add_f32 v54, v54, v62
v_add_f32 v55, v55, v63
s_waitcnt lgkmcnt(11)
v_add_f32 v48, v48, v64
v_add_f32 v49, v49, v65
v_add_f32 v50, v50, v66
v_add_f32 v51, v51, v67
s_waitcnt lgkmcnt(10)
v_add_f32 v52, v52, v68
v_add_f32 v53, v53, v69
v_add_f32 v54, v54, v70
v_add_f32 v55, v55, v71
s_waitcnt lgkmcnt(9)
v_add_f32 v48, v48, v72
v_add_f32 v49, v49, v73
v_add_f32 v50, v50, v74
v_add_f32 v51, v51, v75
s_waitcnt lgkmcnt(8)
v_add_f32 v52, v52, v76
v_add_f32 v53, v53, v77
v_add_f32 v54, v54, v78
v_add_f32 v55, v55, v79
s_waitcnt lgkmcnt(7)
v_add_f32 v48, v48, v80
v_add_f32 v49, v49, v81
v_add_f32 v50, v50, v82
v_add_f32 v51, v51, v83
s_waitcnt lgkmcnt(6)
v_add_f32 v52, v52, v84
v_add_f32 v53, v53, v85
v_add_f32 v54, v54, v86
v_add_f32 v55, v55, v87
s_waitcnt lgkmcnt(5)
v_add_f32 v48, v48, v88
v_add_f32 v49, v49, v89
v_add_f32 v50, v50, v90
v_add_f32 v51, v51, v91
s_waitcnt lgkmcnt(4)
v_add_f32 v52, v52, v92
v_add_f32 v53, v53, v93
v_add_f32 v54, v54, v94
v_add_f32 v55, v55, v95
s_waitcnt lgkmcnt(3)
v_add_f32 v48, v48, v96
v_add_f32 v49, v49, v97
v_add_f32 v50, v50, v98
v_add_f32 v51, v51, v99
s_waitcnt lgkmcnt(2)
v_add_f32 v52, v52, v100
v_add_f32 v53, v53, v101
v_add_f32 v54, v54, v102
v_add_f32 v55, v55, v103
s_waitcnt lgkmcnt(1)
v_add_f32 v48, v48, v104
v_add_f32 v49, v49, v105
v_add_f32 v50, v50, v106
v_add_f32 v51, v51, v107
s_waitcnt lgkmcnt(0)
v_add_f32 v52, v52, v108
v_add_f32 v53, v53, v109
v_add_f32 v54, v54, v110
v_add_f32 v55, v55, v111
v_sub_f32 v189, 1.0, v188
v_lshlrev_b32 v16, 16, v184
v_and_b32 v17, 0xffff0000, v184
v_lshlrev_b32 v18, 16, v185
v_and_b32 v19, 0xffff0000, v185
v_lshlrev_b32 v20, 16, v186
v_and_b32 v21, 0xffff0000, v186
v_lshlrev_b32 v22, 16, v187
v_and_b32 v23, 0xffff0000, v187
v_add_f32 v16, v16, v176
v_mul_f32 v16, v189, v16
v_fmac_f32 v16, v188, v48
v_add_f32 v17, v17, v177
v_mul_f32 v17, v189, v17
v_fmac_f32 v17, v188, v49
v_add_f32 v18, v18, v178
v_mul_f32 v18, v189, v18
v_fmac_f32 v18, v188, v50
v_add_f32 v19, v19, v179
v_mul_f32 v19, v189, v19
v_fmac_f32 v19, v188, v51
v_add_f32 v20, v20, v180
v_mul_f32 v20, v189, v20
v_fmac_f32 v20, v188, v52
v_add_f32 v21, v21, v181
v_mul_f32 v21, v189, v21
v_fmac_f32 v21, v188, v53
v_add_f32 v22, v22, v182
v_mul_f32 v22, v189, v22
v_fmac_f32 v22, v188, v54
v_add_f32 v23, v23, v183
v_mul_f32 v23, v189, v23
v_fmac_f32 v23, v188, v55
v_cvt_pk_bf16_f32 v16, v16, v17
v_cvt_pk_bf16_f32 v17, v18, v19
v_cvt_pk_bf16_f32 v18, v20, v21
v_cvt_pk_bf16_f32 v19, v22, v23
buffer_store_dwordx4 v[16:19], v11, s[16:19], 0 offen
L_k3_end:
s_endpgm
L_k12_end:
s_endpgm
L_sst0:
buffer_store_dwordx4 v[128:131], v2, s[20:23], s44 offen offset:0 sc1
s_branch L_sstr0
L_sst1:
buffer_store_dwordx4 v[132:135], v2, s[20:23], s44 offen offset:1024 sc1
s_branch L_sstr1
L_sst2:
buffer_store_dwordx4 v[136:139], v2, s[20:23], s44 offen offset:0 sc1
s_branch L_sstr2
L_sst3:
buffer_store_dwordx4 v[140:143], v2, s[20:23], s44 offen offset:1024 sc1
s_branch L_sstr3
L_sst4:
buffer_store_dwordx4 v[144:147], v2, s[20:23], s44 offen offset:0 sc1
s_branch L_sstr4
L_sst5:
buffer_store_dwordx4 v[148:151], v2, s[20:23], s44 offen offset:1024 sc1
s_branch L_sstr5
L_sst6:
buffer_store_dwordx4 v[152:155], v2, s[20:23], s44 offen offset:0 sc1
s_branch L_sstr6
L_sst7:
buffer_store_dwordx4 v[156:159], v2, s[20:23], s44 offen offset:1024 sc1
s_branch L_sstr7
L_sst8:
buffer_store_dwordx4 v[160:163], v2, s[20:23], s44 offen offset:0 sc1
s_branch L_sstr8
L_sst9:
buffer_store_dwordx4 v[164:167], v2, s[20:23], s44 offen offset:1024 sc1
s_branch L_sstr9
L_sst10:
buffer_store_dwordx4 v[168:171], v2, s[20:23], s44 offen offset:0 sc1
s_branch L_sstr10
L_sst11:
buffer_store_dwordx4 v[172:175], v2, s[20:23], s44 offen offset:1024 sc1
s_branch L_sstr11
L_sst12:
buffer_store_dwordx4 v[176:179], v2, s[20:23], s44 offen offset:0 sc1
s_branch L_sstr12
L_sst13:
buffer_store_dwordx4 v[180:183], v2, s[20:23], s44 offen offset:1024 sc1
s_branch L_sstr13
L_sst14:
buffer_store_dwordx4 v[184:187], v2, s[20:23], s44 offen offset:0 sc1
s_branch L_sstr14
L_sst15:
buffer_store_dwordx4 v[188:191], v2, s[20:23], s44 offen offset:1024 sc1
s_branch L_sstr15
L_sst16:
buffer_store_dwordx4 v[128:131], v2, s[20:23], s44 offen offset:0 sc1
s_branch L_sstr16
L_sst17:
buffer_store_dwordx4 v[132:135], v2, s[20:23], s44 offen offset:1024 sc1
s_branch L_sstr17
L_sst18:
buffer_store_dwordx4 v[136:139], v2, s[20:23], s44 offen offset:0 sc1
s_branch L_sstr18
L_sst19:
buffer_store_dwordx4 v[140:143], v2, s[20:23], s44 offen offset:1024 sc1
s_branch L_sstr19
L_sst20:
buffer_store_dwordx4 v[144:147], v2, s[20:23], s44 offen offset:0 sc1
s_branch L_sstr20
L_sst21:
buffer_store_dwordx4 v[148:151], v2, s[20:23], s44 offen offset:1024 sc1
s_branch L_sstr21
L_sst22:
buffer_store_dwordx4 v[152:155], v2, s[20:23], s44 offen offset:0 sc1
s_branch L_sstr22
L_sst23:
buffer_store_dwordx4 v[156:159], v2, s[20:23], s44 offen offset:1024 sc1
s_branch L_sstr23
L_sst24:
buffer_store_dwordx4 v[160:163], v2, s[20:23], s44 offen offset:0 sc1
s_branch L_sstr24
L_sst25:
buffer_store_dwordx4 v[164:167], v2, s[20:23], s44 offen offset:1024 sc1
s_branch L_sstr25
L_sst26:
buffer_store_dwordx4 v[168:171], v2, s[20:23], s44 offen offset:0 sc1
s_branch L_sstr26
L_sst27:
buffer_store_dwordx4 v[172:175], v2, s[20:23], s44 offen offset:1024 sc1
s_branch L_sstr27
L_sst28:
buffer_store_dwordx4 v[176:179], v2, s[20:23], s44 offen offset:0 sc1
s_branch L_sstr28
L_sst29:
buffer_store_dwordx4 v[180:183], v2, s[20:23], s44 offen offset:1024 sc1
s_branch L_sstr29
L_sst30:
buffer_store_dwordx4 v[184:187], v2, s[20:23], s44 offen offset:0 sc1
s_branch L_sstr30
L_sst31:
buffer_store_dwordx4 v[188:191], v2, s[20:23], s44 offen offset:1024 sc1
s_branch L_sstr31
L_sst32:
buffer_store_dwordx4 v[128:131], v2, s[20:23], s44 offen offset:0 sc1
s_branch L_sstr32
L_sst33:
buffer_store_dwordx4 v[132:135], v2, s[20:23], s44 offen offset:1024 sc1
s_branch L_sstr33
L_sst34:
buffer_store_dwordx4 v[136:139], v2, s[20:23], s44 offen offset:2048 sc1
s_branch L_sstr34
L_sst35:
buffer_store_dwordx4 v[140:143], v2, s[20:23], s44 offen offset:3072 sc1
s_branch L_sstr35
L_sst36:
buffer_store_dwordx4 v[144:147], v2, s[20:23], s44 offen offset:0 sc1
s_branch L_sstr36
L_sst37:
buffer_store_dwordx4 v[148:151], v2, s[20:23], s44 offen offset:1024 sc1
s_branch L_sstr37
L_sst38:
buffer_store_dwordx4 v[152:155], v2, s[20:23], s44 offen offset:2048 sc1
s_branch L_sstr38
L_sst39:
buffer_store_dwordx4 v[156:159], v2, s[20:23], s44 offen offset:3072 sc1
s_branch L_sstr39
L_sst40:
buffer_store_dwordx4 v[160:163], v2, s[20:23], s44 offen offset:0 sc1
s_branch L_sstr40
L_sst41:
buffer_store_dwordx4 v[164:167], v2, s[20:23], s44 offen offset:1024 sc1
s_branch L_sstr41
L_sst42:
buffer_store_dwordx4 v[168:171], v2, s[20:23], s44 offen offset:2048 sc1
s_branch L_sstr42
L_sst43:
buffer_store_dwordx4 v[172:175], v2, s[20:23], s44 offen offset:3072 sc1
s_branch L_sstr43
L_sst44:
buffer_store_dwordx4 v[176:179], v2, s[20:23], s44 offen offset:0 sc1
s_branch L_sstr44
L_sst45:
buffer_store_dwordx4 v[180:183], v2, s[20:23], s44 offen offset:1024 sc1
s_branch L_sstr45
L_sst46:
buffer_store_dwordx4 v[184:187], v2, s[20:23], s44 offen offset:2048 sc1
s_branch L_sstr46
L_sst47:
buffer_store_dwordx4 v[188:191], v2, s[20:23], s44 offen offset:3072 sc1
s_branch L_sstr47
L_sst48:
buffer_store_dwordx4 v[128:131], v2, s[20:23], s44 offen offset:0 sc1
s_branch L_sstr48
L_sst49:
buffer_store_dwordx4 v[132:135], v2, s[20:23], s44 offen offset:1024 sc1
s_branch L_sstr49
L_sst50:
buffer_store_dwordx4 v[136:139], v2, s[20:23], s44 offen offset:2048 sc1
s_branch L_sstr50
L_sst51:
buffer_store_dwordx4 v[140:143], v2, s[20:23], s44 offen offset:3072 sc1
s_branch L_sstr51
L_sst52:
buffer_store_dwordx4 v[144:147], v2, s[20:23], s44 offen offset:0 sc1
s_branch L_sstr52
L_sst53:
buffer_store_dwordx4 v[148:151], v2, s[20:23], s44 offen offset:1024 sc1
s_branch L_sstr53
L_sst54:
buffer_store_dwordx4 v[152:155], v2, s[20:23], s44 offen offset:2048 sc1
s_branch L_sstr54
L_sst55:
buffer_store_dwordx4 v[156:159], v2, s[20:23], s44 offen offset:3072 sc1
s_branch L_sstr55
L_sst56:
buffer_store_dwordx4 v[160:163], v2, s[20:23], s44 offen offset:0 sc1
s_branch L_sstr56
L_sst57:
buffer_store_dwordx4 v[164:167], v2, s[20:23], s44 offen offset:1024 sc1
s_branch L_sstr57
L_sst58:
buffer_store_dwordx4 v[168:171], v2, s[20:23], s44 offen offset:2048 sc1
s_branch L_sstr58
L_sst59:
buffer_store_dwordx4 v[172:175], v2, s[20:23], s44 offen offset:3072 sc1
s_branch L_sstr59
L_sst60:
buffer_store_dwordx4 v[176:179], v2, s[20:23], s44 offen offset:0 sc1
s_branch L_sstr60
L_sst61:
buffer_store_dwordx4 v[180:183], v2, s[20:23], s44 offen offset:1024 sc1
s_branch L_sstr61
L_sst62:
buffer_store_dwordx4 v[184:187], v2, s[20:23], s44 offen offset:2048 sc1
s_branch L_sstr62
L_sst63:
buffer_store_dwordx4 v[188:191], v2, s[20:23], s44 offen offset:3072 sc1
s_branch L_sstr63
L_text_end:

.section .rodata,"a"
.p2align 6
.amdhsa_kernel k12_kernel
  .amdhsa_next_free_vgpr 256
  .amdhsa_next_free_sgpr 102
  .amdhsa_accum_offset 256
  .amdhsa_group_segment_fixed_size 0
  .amdhsa_kernarg_size 120
  .amdhsa_user_sgpr_count 2
  .amdhsa_user_sgpr_kernarg_segment_ptr 1
  .amdhsa_system_sgpr_workgroup_id_x 1
.end_amdhsa_kernel
.text
```
